```python
import torch

def _softmax(x, axis=-1):
    return torch.softmax(x, dim=axis)
def _gelu(x):
    return torch.nn.functional.gelu(x, approximate="tanh")
def _silu(x):
    return torch.nn.functional.silu(x)
def _sigmoid(x):
    return torch.sigmoid(x)
def _layernorm(x, axis=-1, eps=1e-5):
    m = x.mean(dim=axis, keepdim=True)
    v = x.var(dim=axis, keepdim=True, unbiased=False)
    return (x - m) / torch.sqrt(v + eps)
def _scatter_add(tgt, idx, src, axis=0):
    return tgt.clone().index_add_(axis, idx, src)
def _segment_sum(src, seg, n):
    out = torch.zeros((n,) + src.shape[1:], dtype=src.dtype)
    return out.index_add_(0, seg, src)
def _pad(x, pw):
    flat = tuple(v for pair in reversed(pw) for v in pair)
    return torch.nn.functional.pad(x, flat)

kernel_name = 'interleave_layers__sliding_block__mixer_channel_mlp__prompt'

def setup_inputs():

    _w = (lambda a: (lambda t: t.to(torch.bfloat16) if t.is_floating_point() else t)(torch.as_tensor(a)))
    def _A_setup():
        B, S, D = 1, 2048, 512
        return {
            "x": _w((lambda *s: torch.randn(*s, dtype=torch.bfloat16) * 0.05)(B, S, D)),
            "wqkv": _w((lambda *s: torch.randn(*s, dtype=torch.bfloat16) * 0.05)(D, 3 * D)),
            "wo": _w((lambda *s: torch.randn(*s, dtype=torch.bfloat16) * 0.05)(D, D)),
        }
    _A_in = _A_setup()

    def _B_setup():
        B, S, D, F = 1, 2048, 512, 1792
        return {
            "x": _w((lambda *s: torch.randn(*s, dtype=torch.bfloat16) * 0.05)(B, S, D)),
            "w1": _w((lambda *s: torch.randn(*s, dtype=torch.bfloat16) * 3.2)(D, F) * (D ** -0.5)),
            "b1": _w((lambda *s: torch.randn(*s, dtype=torch.bfloat16) * 0.8)(F)),
            "w2": _w((lambda *s: torch.randn(*s, dtype=torch.bfloat16) * 0.2)(F, D) * (F ** -0.5)),
            "b2": _w((lambda *s: torch.randn(*s, dtype=torch.bfloat16) * 0.2)(D)),
        }
    _B_in = _B_setup()

    return {
        "A_x": _A_in["x"],
        "A_wqkv": _A_in["wqkv"],
        "A_wo": _A_in["wo"],
        "B_x": _B_in["x"],
        "B_w1": _B_in["w1"],
        "B_b1": _B_in["b1"],
        "B_w2": _B_in["w2"],
        "B_b2": _B_in["b2"],
    }

def reference(A_x, A_wqkv, A_wo, B_x, B_w1, B_b1, B_w2, B_b2):
    def _A_ref(x, wqkv, wo):
        B, S, D = x.shape
        H = 32; Dh = D // H; W = 256
        qkv = (lambda x, *d: x.permute(*d))((x @ wqkv).reshape(B, S, 3, H, Dh), 2, 0, 3, 1, 4)
        q, k, v = qkv[0], qkv[1], qkv[2]
        scores = torch.einsum("bhqd,bhkd->bhqk", q, k) * (Dh ** -0.5)
        idx = torch.arange(S)
        mask = (idx[:, None] - idx[None, :] >= 0) & (idx[:, None] - idx[None, :] < W)
        scores = torch.where(mask[None, None], scores, -1e9)
        p = _softmax(scores, axis=-1)
        o = torch.einsum("bhqk,bhkd->bhqd", p, v)
        return (lambda x, *d: x.permute(*d))(o, 0, 2, 1, 3).reshape(B, S, D) @ wo

    def _B_ref(x, w1, b1, w2, b2):
        y = _layernorm(x, axis=-1)
        h = _gelu(torch.einsum("bsd,df->bsf", y, w1) + b1)
        return torch.einsum("bsf,fd->bsd", h, w2) + b2

    x = A_x
    x = x + _A_ref(_layernorm(x, axis=-1), A_wqkv, A_wo)
    x = x + _B_ref(_layernorm(x, axis=-1), B_w1, B_b1, B_w2, B_b2)
    x = x + _A_ref(_layernorm(x, axis=-1), A_wqkv, A_wo)
    x = x + _B_ref(_layernorm(x, axis=-1), B_w1, B_b1, B_w2, B_b2)
    return x
```

```asm
; @launch grid=(256,1,1) block=(256,1,1) lds=163840
.amdgcn_target "amdgcn-amd-amdhsa--gfx950"
.text
.globl interleave_layers__sliding_block__mixer_channel_mlp__prompt_kernel
.p2align 8
.type interleave_layers__sliding_block__mixer_channel_mlp__prompt_kernel,@function
interleave_layers__sliding_block__mixer_channel_mlp__prompt_kernel:

    s_cmp_ge_u32 s2, 256
    s_cbranch_scc1 .EXIT
    s_load_dwordx4 s[4:7], s[0:1], 0
    s_load_dwordx2 s[24:25], s[0:1], 80
    s_load_dwordx2 s[8:9], s[0:1], 16
    s_load_dwordx8 s[12:19], s[0:1], 32
    s_load_dwordx4 s[20:23], s[0:1], 64
    v_lshrrev_b32 v5, 6, v0
    v_and_b32 v1, 63, v0
    s_and_b32 s26, s2, 7
    v_readfirstlane_b32 s28, v5
    s_lshl_b32 s26, s26, 2
    s_lshr_b32 s26, 0x34562107, s26
    s_and_b32 s26, s26, 7
    s_lshr_b32 s27, s2, 3
    s_getpc_b64 s[10:11]
.PC0:
    s_lshl_b32 s44, s27, 2
    s_add_u32 s44, s44, s28
    s_mul_i32 s44, s44, 640
    v_min_u32 v5, 4, v1
    v_lshl_add_u32 v5, v5, 7, s44
    v_min_u32 v5, .CEND-.PC0-4, v5
    v_mov_b32 v7, s11
    v_add_co_u32 v6, vcc, s10, v5
    s_lshr_b32 s29, s27, 3
    s_and_b32 s30, s27, 7
    v_addc_co_u32 v7, vcc, 0, v7, vcc
    global_load_dword v76, v[6:7], off
    s_lshl_b32 s53, s28, 10
    v_lshlrev_b32 v2, 4, v1
    v_and_b32 v3, 31, v1
    v_lshrrev_b32 v4, 5, v1
    v_mov_b32 v0, 0
    s_add_u32 s44, s27, 0
    s_and_b32 s44, s44, 3
    s_lshl_b32 s58, s44, 13
    s_add_u32 s44, s27, 1
    s_and_b32 s44, s44, 3
    s_lshl_b32 s59, s44, 13
    s_add_u32 s44, s27, 2
    s_and_b32 s44, s44, 3
    s_lshl_b32 s60, s44, 13
    s_add_u32 s44, s27, 3
    s_and_b32 s44, s44, 3
    s_lshl_b32 s61, s44, 13
    v_lshrrev_b32 v62, 2, v1
    s_lshl_b32 s44, s28, 4
    v_add_u32 v62, s44, v62
    s_movk_i32 s46, 3072
    v_mul_u32_u24 v62, s46, v62
    v_bfe_u32 v63, v1, 1, 1
    v_lshl_add_u32 v62, v63, 10, v62
    v_and_b32 v63, 1, v1
    s_lshl_b32 s45, s27, 5
    v_lshl_add_u32 v63, v63, 4, s45
    v_add_u32 v118, v62, v63
    v_lshrrev_b32 v62, 1, v1
    s_lshl_b32 s44, s28, 5
    v_add_u32 v62, s44, v62
    v_mad_u32_u24 v119, v62, s46, v63
    s_lshl_b32 s44, s26, 18
    s_lshl_b32 s45, s28, 15
    s_add_u32 s44, s44, s45
    s_mul_i32 s50, s28, 14336
    s_add_u32 s50, s50, 2048
    v_lshrrev_b32 v62, 3, v1
    v_and_b32 v63, 7, v1
    v_lshrrev_b32 v64, 1, v62
    v_xor_b32 v63, v63, v64
    v_lshl_add_u32 v62, v62, 10, s44
    v_lshl_add_u32 v88, v63, 4, v62
    v_xor_b32 v63, 4, v63
    v_lshl_add_u32 v89, v63, 4, v62
    v_add_u32 v89, 8192, v89
    v_add_u32 v90, 16384, v88
    v_add_u32 v91, 16384, v89
    s_lshl_b32 s39, s26, 18
    s_lshl_b32 s44, s29, 15
    s_add_u32 s39, s39, s44
    s_lshl_b32 s44, s30, 7
    s_add_u32 s39, s39, s44
    s_lshl_b32 s44, s28, 13
    s_add_u32 s39, s39, s44
    s_waitcnt lgkmcnt(0)
    s_mul_i32 s44, s58, 48
    s_add_u32 m0, s53, 57344
    v_add_u32 v67, s44, v118
    global_load_lds_dwordx4 v67, s[6:7]
    s_lshr_b32 s44, s58, 5
    s_add_u32 s44, s44, 0x20000
    s_add_u32 s10, s4, s44
    s_addc_u32 s11, s5, 0
    s_add_u32 m0, s50, 0x2000
    s_nop 0
    global_load_lds_dwordx4 v88, s[10:11] offset:0
    s_add_u32 m0, s50, 0x2400
    s_nop 0
    global_load_lds_dwordx4 v89, s[10:11] offset:0
    s_add_u32 m0, s50, 0x2800
    s_nop 0
    global_load_lds_dwordx4 v90, s[10:11] offset:0
    s_add_u32 m0, s50, 0x2c00
    s_nop 0
    global_load_lds_dwordx4 v91, s[10:11] offset:0
    s_mul_i32 s44, s58, 48
    s_add_u32 m0, s53, 88064
    v_add_u32 v67, s44, v119
    global_load_lds_dwordx4 v67, s[6:7] offset:2048
    v_mov_b32 v67, 0
    global_load_dword v82, v67, s[24:25] sc1
    s_lshl2_add_u32 s45, s2, s28
    s_mov_b32 s33, 0
    s_mov_b64 s[22:23], 0
    s_mov_b32 s37, 40000
    s_mov_b32 s38, 0x3f803f80
    s_mov_b32 s40, 0
    s_mov_b32 s41, -1
    s_mov_b32 s42, 0xffff
    s_mov_b32 s43, 0xffff
    s_mul_i32 s34, s26, 3145728
    s_add_u32 s34, s34, 1048576
    s_lshl_b32 s35, s26, 13
    s_add_u32 s35, s35, 20480
    s_getreg_b32 s3, hwreg(HW_REG_XCC_ID)
    s_and_b32 s3, s3, 7
    v_cndmask_b32 v8, 1.0, 0, s[40:41]
    v_bfe_u32 v62, v1, 2, 2
    v_bfe_u32 v66, v1, 4, 1
    v_and_b32 v64, 3, v1
    v_lshlrev_b32 v64, 3, v64
    v_lshl_add_u32 v63, v66, 5, v64
    v_lshl_add_u32 v65, v4, 3, v62
    v_lshl_add_u32 v5, v65, 6, v63
    v_mul_u32_u24 v77, 0xe00, v4
    v_add_u32 v77, v5, v77
    v_add_u32 v75, s50, v77
    v_subrev_u32 v75, 2048, v75
    v_add_u32 v5, 57344, v5
    v_lshl_add_u32 v6, v65, 5, v64
    v_add_u32 v6, 90112, v6
    v_lshlrev_b32 v65, 1, v4
    v_lshl_add_u32 v65, v62, 2, v65
    v_mul_u32_u24 v65, 112, v65
    v_add_u32 v7, v65, v63
    v_mov_b32 v16, 0
    v_mov_b32 v17, 0
    v_mov_b32 v19, 0
    v_mov_b32 v20, 0
    v_mov_b32 v21, 0
    v_mov_b32 v39, 0
    v_mov_b32 v41, 0
    s_lshl_b32 s36, s28, 11
    s_add_u32 s36, s36, 106496
    v_add_u32 v9, s36, v2
    s_add_u32 s44, s53, 114688
    v_add_u32 v77, s44, v77
    v_lshlrev_b32 v66, 6, v66
    v_lshl_add_u32 v66, v4, 4, v66
    v_add_u32 v10, s36, v66
    s_lshl_b32 s44, s28, 13
    s_add_u32 s44, s44, 106496
    v_add_u32 v11, s44, v2
    v_xor_b32 v12, 128, v11
    v_lshrrev_b32 v62, 3, v1
    v_and_b32 v63, 7, v1
    s_lshl_b32 s44, s28, 3
    v_add_u32 v63, s44, v63
    v_lshlrev_b32 v64, 4, v63
    v_lshl_add_u32 v14, v62, 9, v64
    v_and_b32 v65, 8, v1
    v_lshlrev_b32 v65, 4, v65
    v_xor_b32 v65, v65, v64
    v_lshl_add_u32 v13, v62, 10, v65
    v_add_u32 v13, 106496, v13
    s_lshl_b32 s32, s29, 15
    s_add_u32 s32, s32, s34
    s_lshl_b32 s44, s30, 12
    s_add_u32 s44, s44, s32
    v_add_u32 v14, s44, v14
    s_lshl_b32 s44, s29, 11
    s_add_u32 s44, s44, s34
    s_lshr_b32 s45, s30, 1
    s_lshl_b32 s45, s45, 9
    s_add_u32 s44, s44, s45
    s_and_b32 s45, s30, 1
    s_lshl_b32 s45, s45, 3
    s_add_u32 s44, s44, s45
    s_add_u32 s44, s44, 1441792
    v_lshl_add_u32 v15, v4, 2, v64
    v_add_u32 v15, s44, v15
    s_lshl_b32 s62, s28, 15
    s_add_u32 s62, s62, s34
    s_mul_i32 s63, s28, 114688
    s_add_u32 s63, s63, s34
    s_lshr_b32 s44, s27, 1
    s_mul_i32 s44, s44, 7168
    s_add_u32 s63, s63, s44
    s_mul_i32 s100, s29, 114688
    s_add_u32 s100, s100, s34
    s_mul_i32 s44, s28, 28672
    s_add_u32 s100, s100, s44
    s_lshl3_add_u32 s101, s27, s28
    s_mul_i32 s101, s101, 3072
    s_add_u32 s101, s101, s34
    s_cmp_eq_u32 s26, 0
    s_cselect_b32 s44, 3, -8
    s_sub_i32 s56, s44, s28
    s_add_i32 s57, s56, 4
    v_lshlrev_b32 v62, 2, v4
    v_sub_u32 v62, v3, v62
    v_mov_b32 v63, 0xffff
    v_mov_b32 v64, 0xffff0000
    s_add_u32 s96, s29, 0
    s_and_b32 s96, s96, 3
    s_lshl2_add_u32 s46, s28, s96
    s_mul_i32 s46, s46, 114688
    s_add_u32 s97, s29, 1
    s_and_b32 s97, s97, 3
    s_lshl2_add_u32 s47, s28, s97
    s_mul_i32 s47, s47, 114688
    s_add_u32 s98, s29, 2
    s_and_b32 s98, s98, 3
    s_lshl2_add_u32 s48, s28, s98
    s_mul_i32 s48, s48, 114688
    s_add_u32 s99, s29, 3
    s_and_b32 s99, s99, 3
    s_lshl2_add_u32 s49, s28, s99
    s_mul_i32 s49, s49, 114688
    v_cmp_le_i32 s[64:65], 0, v62
    v_cmp_le_i32 s[66:67], 1, v62
    v_cmp_le_i32 s[68:69], 2, v62
    v_cmp_le_i32 s[70:71], 3, v62
    v_cmp_le_i32 s[72:73], 8, v62
    v_cmp_le_i32 s[74:75], 9, v62
    v_cmp_le_i32 s[76:77], 10, v62
    v_cmp_le_i32 s[78:79], 11, v62
    v_cmp_le_i32 s[80:81], 16, v62
    v_cmp_le_i32 s[82:83], 17, v62
    v_cmp_le_i32 s[84:85], 18, v62
    v_cmp_le_i32 s[86:87], 19, v62
    v_cmp_le_i32 s[88:89], 24, v62
    v_cmp_le_i32 s[90:91], 25, v62
    v_cmp_le_i32 s[92:93], 26, v62
    v_cmp_le_i32 s[94:95], 27, v62
    v_cndmask_b32 v46, 0, v63, s[64:65]
    v_cndmask_b32 v65, 0, v64, s[66:67]
    v_or_b32 v46, v46, v65
    v_cndmask_b32 v47, 0, v63, s[68:69]
    v_cndmask_b32 v65, 0, v64, s[70:71]
    v_or_b32 v47, v47, v65
    v_cndmask_b32 v48, 0, v63, s[72:73]
    v_cndmask_b32 v65, 0, v64, s[74:75]
    v_or_b32 v48, v48, v65
    v_cndmask_b32 v49, 0, v63, s[76:77]
    v_cndmask_b32 v65, 0, v64, s[78:79]
    v_or_b32 v49, v49, v65
    v_cndmask_b32 v50, 0, v63, s[80:81]
    v_cndmask_b32 v65, 0, v64, s[82:83]
    v_or_b32 v50, v50, v65
    v_cndmask_b32 v51, 0, v63, s[84:85]
    v_cndmask_b32 v65, 0, v64, s[86:87]
    v_or_b32 v51, v51, v65
    v_cndmask_b32 v52, 0, v63, s[88:89]
    v_cndmask_b32 v65, 0, v64, s[90:91]
    v_or_b32 v52, v52, v65
    v_cndmask_b32 v53, 0, v63, s[92:93]
    v_cndmask_b32 v65, 0, v64, s[94:95]
    v_or_b32 v53, v53, v65
    v_bfe_u32 v62, v3, 1, 3
    v_lshlrev_b32 v63, 7, v3
    s_mul_i32 s0, s28, 12288
    s_lshl_b32 s44, s28, 12
    s_and_b32 s44, s44, 8192
    s_add_u32 s0, s0, s44
    s_add_u32 s0, s0, 106496
    v_add_u32 v64, 0, v4
    v_xor_b32 v64, v64, v62
    v_lshl_add_u32 v64, v64, 4, v63
    v_add_u32 v92, s50, v64
    v_add_u32 v240, s0, v64
    v_add_u32 v64, 2, v4
    v_xor_b32 v64, v64, v62
    v_lshl_add_u32 v64, v64, 4, v63
    v_add_u32 v93, s50, v64
    v_add_u32 v241, s0, v64
    v_add_u32 v64, 4, v4
    v_xor_b32 v64, v64, v62
    v_lshl_add_u32 v64, v64, 4, v63
    v_add_u32 v94, s50, v64
    v_add_u32 v242, s0, v64
    v_add_u32 v64, 6, v4
    v_xor_b32 v64, v64, v62
    v_lshl_add_u32 v64, v64, 4, v63
    v_add_u32 v95, s50, v64
    v_add_u32 v243, s0, v64
    v_bfe_u32 v62, v1, 2, 1
    v_bfe_u32 v63, v1, 4, 1
    v_cmp_eq_u32 vcc, v62, v63
    v_mov_b32 v62, s38
    s_nop 0
    v_cndmask_b32 v96, 0, v62, vcc
    v_cndmask_b32 v97, 0, v62, vcc
    v_cndmask_b32 v98, 0, v62, vcc
    v_cndmask_b32 v99, 0, v62, vcc
    s_mul_i32 s44, s58, 48
    s_add_u32 s44, s44, 196608
    s_add_u32 m0, s53, 61440
    v_add_u32 v67, s44, v118
    global_load_lds_dwordx4 v67, s[6:7]
    s_lshr_b32 s44, s58, 5
    s_add_u32 s44, s44, 0x20000
    s_add_u32 s10, s4, s44
    s_addc_u32 s11, s5, 0
    s_add_u32 m0, s0, 0xffffff80
    s_nop 0
    global_load_lds_dwordx4 v88, s[10:11] offset:128
    s_add_u32 m0, s0, 0x380
    s_nop 0
    global_load_lds_dwordx4 v89, s[10:11] offset:128
    s_add_u32 m0, s0, 0x780
    s_nop 0
    global_load_lds_dwordx4 v90, s[10:11] offset:128
    s_add_u32 m0, s0, 0xb80
    s_nop 0
    global_load_lds_dwordx4 v91, s[10:11] offset:128
    s_waitcnt vmcnt(6)
    s_waitcnt lgkmcnt(0)
    ds_read_b128 v[120:123], v92 offset:8192
    ds_read_b128 v[124:127], v93 offset:8192
    ds_read_b128 v[128:131], v94 offset:8192
    ds_read_b128 v[132:135], v95 offset:8192
    s_barrier
    ds_read_b64_tr_b16 a[0:1], v5 offset:0
    ds_read_b64_tr_b16 a[2:3], v5 offset:256
    ds_read_b64_tr_b16 a[4:5], v6 offset:0
    ds_read_b64_tr_b16 a[6:7], v6 offset:128
    ds_read_b64_tr_b16 a[8:9], v5 offset:1024
    ds_read_b64_tr_b16 a[10:11], v5 offset:1280
    ds_read_b64_tr_b16 a[12:13], v6 offset:512
    ds_read_b64_tr_b16 a[14:15], v6 offset:640
    s_waitcnt lgkmcnt(8)
    v_mfma_f32_4x4x4_16b_bf16 v[112:115], v[120:121], v[120:121], 0
    v_mfma_f32_16x16x32_bf16 v[108:111], v[96:99], v[120:123], 0
    s_nop 0
    v_mfma_f32_4x4x4_16b_bf16 v[112:115], v[122:123], v[122:123], v[112:115]
    s_nop 1
    v_mfma_f32_4x4x4_16b_bf16 v[112:115], v[124:125], v[124:125], v[112:115]
    v_mfma_f32_16x16x32_bf16 v[108:111], v[96:99], v[124:127], v[108:111]
    s_nop 0
    v_mfma_f32_4x4x4_16b_bf16 v[112:115], v[126:127], v[126:127], v[112:115]
    s_waitcnt lgkmcnt(6)
    v_mfma_f32_32x32x16_bf16 v[168:183], a[0:3], v[120:123], 0
    ds_read_b64_tr_b16 a[16:17], v5 offset:2048
    ds_read_b64_tr_b16 a[18:19], v5 offset:2304
    v_mfma_f32_4x4x4_16b_bf16 v[112:115], v[128:129], v[128:129], v[112:115]
    v_mfma_f32_16x16x32_bf16 v[108:111], v[96:99], v[128:131], v[108:111]
    v_mfma_f32_16x16x32_bf16 v[100:103], v[96:99], a[0:3], 0
    s_mul_i32 s44, s59, 48
    s_add_u32 m0, s53, 65536
    v_add_u32 v67, s44, v118
    global_load_lds_dwordx4 v67, s[6:7]
    s_waitcnt lgkmcnt(6)
    v_mfma_f32_32x32x16_bf16 v[184:199], v[120:123], a[4:7], 0
    ds_read_b64_tr_b16 a[20:21], v6 offset:1024
    ds_read_b64_tr_b16 a[22:23], v6 offset:1152
    v_mfma_f32_4x4x4_16b_bf16 v[112:115], v[130:131], v[130:131], v[112:115]
    v_mfma_f32_16x16x32_bf16 v[104:107], v[96:99], a[4:7], 0
    s_mul_i32 s44, s59, 48
    s_add_u32 m0, s53, 92160
    v_add_u32 v67, s44, v119
    global_load_lds_dwordx4 v67, s[6:7] offset:2048
    s_waitcnt lgkmcnt(6)
    v_mfma_f32_32x32x16_bf16 v[168:183], a[8:11], v[124:127], v[168:183]
    ds_read_b64_tr_b16 a[24:25], v5 offset:3072
    ds_read_b64_tr_b16 a[26:27], v5 offset:3328
    s_add_u32 s44, s27, s28
    s_and_b32 s44, s44, 3
    s_mul_i32 s44, s44, 458752
    s_mul_i32 s45, s27, 112
    s_add_u32 s44, s44, s45
    s_and_b32 s45, s27, 1
    v_mov_b32 v64, 3584
    v_add_u32 v67, 0, v1
    v_mul_u32_u24 v65, 9363, v67
    v_lshrrev_b32 v65, 16, v65
    v_mul_u32_u24 v68, 7, v65
    v_sub_u32 v67, v67, v68
    v_add_u32 v67, s45, v67
    v_cmp_gt_u32 vcc, 7, v67
    v_and_b32 v68, 3, v65
    s_nop 0
    v_cndmask_b32 v67, 0, v67, vcc
    v_lshlrev_b32 v68, 2, v68
    v_and_or_b32 v68, v65, 48, v68
    v_bfe_u32 v65, v65, 2, 2
    v_or_b32 v65, v65, v68
    v_mad_u32_u24 v65, v65, v64, s44
    v_lshl_add_u32 v65, v67, 4, v65
    v_accvgpr_write_b32 a217, v65
    v_mfma_f32_4x4x4_16b_bf16 v[112:115], v[132:133], v[132:133], v[112:115]
    v_mfma_f32_16x16x32_bf16 v[108:111], v[96:99], v[132:135], v[108:111]
    v_mfma_f32_16x16x32_bf16 v[100:103], v[96:99], a[8:11], v[100:103]
    s_waitcnt vmcnt(2)
    ds_read_b128 v[136:139], v240 offset:0
    ds_read_b128 v[140:143], v241 offset:0
    ds_read_b128 v[144:147], v242 offset:0
    ds_read_b128 v[148:151], v243 offset:0
    s_lshr_b32 s44, s59, 5
    s_add_u32 s44, s44, 0x20000
    s_add_u32 s10, s4, s44
    s_addc_u32 s11, s5, 0
    s_add_u32 m0, s0, 0x1000
    s_nop 0
    global_load_lds_dwordx4 v88, s[10:11] offset:0
    s_waitcnt lgkmcnt(10)
    v_mfma_f32_32x32x16_bf16 v[184:199], v[124:127], a[12:15], v[184:199]
    ds_read_b64_tr_b16 a[28:29], v6 offset:1536
    ds_read_b64_tr_b16 a[30:31], v6 offset:1664
    v_mfma_f32_4x4x4_16b_bf16 v[112:115], v[134:135], v[134:135], v[112:115]
    v_mfma_f32_16x16x32_bf16 v[104:107], v[96:99], a[12:15], v[104:107]
    s_barrier
    s_add_u32 m0, s0, 0x1400
    s_nop 0
    global_load_lds_dwordx4 v89, s[10:11] offset:0
    s_waitcnt lgkmcnt(10)
    v_mfma_f32_32x32x16_bf16 v[168:183], a[16:19], v[128:131], v[168:183]
    ds_read_b64_tr_b16 a[32:33], v5 offset:4096
    ds_read_b64_tr_b16 a[34:35], v5 offset:4352
    s_add_u32 s44, s27, s28
    s_and_b32 s44, s44, 3
    s_mul_i32 s44, s44, 458752
    s_mul_i32 s45, s27, 112
    s_add_u32 s44, s44, s45
    s_and_b32 s45, s27, 1
    v_mov_b32 v64, 3584
    v_add_u32 v67, 64, v1
    v_mul_u32_u24 v65, 9363, v67
    v_lshrrev_b32 v65, 16, v65
    v_mul_u32_u24 v68, 7, v65
    v_sub_u32 v67, v67, v68
    v_add_u32 v67, s45, v67
    v_cmp_gt_u32 vcc, 7, v67
    v_and_b32 v68, 3, v65
    s_nop 0
    v_cndmask_b32 v67, 0, v67, vcc
    v_lshlrev_b32 v68, 2, v68
    v_and_or_b32 v68, v65, 48, v68
    v_bfe_u32 v65, v65, 2, 2
    v_or_b32 v65, v65, v68
    v_mad_u32_u24 v65, v65, v64, s44
    v_lshl_add_u32 v65, v67, 4, v65
    v_accvgpr_write_b32 a218, v65
    s_waitcnt lgkmcnt(4)
    v_mfma_f32_4x4x4_16b_bf16 v[112:115], v[136:137], v[136:137], v[112:115]
    v_mfma_f32_16x16x32_bf16 v[108:111], v[96:99], v[136:139], v[108:111]
    v_mfma_f32_16x16x32_bf16 v[100:103], v[96:99], a[16:19], v[100:103]
    s_add_u32 m0, s0, 0x1800
    s_nop 0
    global_load_lds_dwordx4 v90, s[10:11] offset:0
    v_mfma_f32_32x32x16_bf16 v[184:199], v[128:131], a[20:23], v[184:199]
    ds_read_b64_tr_b16 a[36:37], v6 offset:2048
    ds_read_b64_tr_b16 a[38:39], v6 offset:2176
    v_mfma_f32_4x4x4_16b_bf16 v[112:115], v[138:139], v[138:139], v[112:115]
    v_mfma_f32_16x16x32_bf16 v[104:107], v[96:99], a[20:23], v[104:107]
    s_add_u32 m0, s0, 0x1c00
    s_nop 0
    global_load_lds_dwordx4 v91, s[10:11] offset:0
    v_mfma_f32_32x32x16_bf16 v[168:183], a[24:27], v[132:135], v[168:183]
    ds_read_b64_tr_b16 a[40:41], v5 offset:5120
    ds_read_b64_tr_b16 a[42:43], v5 offset:5376
    s_add_u32 s44, s27, s28
    s_and_b32 s44, s44, 3
    s_mul_i32 s44, s44, 458752
    s_mul_i32 s45, s27, 112
    s_add_u32 s44, s44, s45
    s_and_b32 s45, s27, 1
    v_mov_b32 v64, 3584
    v_add_u32 v67, 128, v1
    v_mul_u32_u24 v65, 9363, v67
    v_lshrrev_b32 v65, 16, v65
    v_mul_u32_u24 v68, 7, v65
    v_sub_u32 v67, v67, v68
    v_add_u32 v67, s45, v67
    v_cmp_gt_u32 vcc, 7, v67
    v_and_b32 v68, 3, v65
    s_nop 0
    v_cndmask_b32 v67, 0, v67, vcc
    v_lshlrev_b32 v68, 2, v68
    v_and_or_b32 v68, v65, 48, v68
    v_bfe_u32 v65, v65, 2, 2
    v_or_b32 v65, v65, v68
    v_mad_u32_u24 v65, v65, v64, s44
    v_lshl_add_u32 v65, v67, 4, v65
    v_accvgpr_write_b32 a219, v65
    v_mfma_f32_4x4x4_16b_bf16 v[112:115], v[140:141], v[140:141], v[112:115]
    v_mfma_f32_16x16x32_bf16 v[108:111], v[96:99], v[140:143], v[108:111]
    v_mfma_f32_16x16x32_bf16 v[100:103], v[96:99], a[24:27], v[100:103]
    s_mul_i32 s44, s59, 48
    s_add_u32 s44, s44, 196608
    s_add_u32 m0, s53, 69632
    v_add_u32 v67, s44, v118
    global_load_lds_dwordx4 v67, s[6:7]
    s_waitcnt lgkmcnt(6)
    v_mfma_f32_32x32x16_bf16 v[184:199], v[132:135], a[28:31], v[184:199]
    ds_read_b64_tr_b16 a[44:45], v6 offset:2560
    ds_read_b64_tr_b16 a[46:47], v6 offset:2688
    v_mfma_f32_4x4x4_16b_bf16 v[112:115], v[142:143], v[142:143], v[112:115]
    v_mfma_f32_16x16x32_bf16 v[104:107], v[96:99], a[28:31], v[104:107]
    s_lshr_b32 s44, s59, 5
    s_add_u32 s44, s44, 0x20000
    s_add_u32 s10, s4, s44
    s_addc_u32 s11, s5, 0
    s_add_u32 m0, s0, 0x1f80
    s_nop 0
    global_load_lds_dwordx4 v88, s[10:11] offset:128
    s_waitcnt lgkmcnt(6)
    v_mfma_f32_32x32x16_bf16 v[168:183], a[32:35], v[136:139], v[168:183]
    ds_read_b64_tr_b16 a[48:49], v5 offset:6144
    ds_read_b64_tr_b16 a[50:51], v5 offset:6400
    s_add_u32 s44, s27, s28
    s_and_b32 s44, s44, 3
    s_mul_i32 s44, s44, 458752
    s_mul_i32 s45, s27, 112
    s_add_u32 s44, s44, s45
    s_and_b32 s45, s27, 1
    v_mov_b32 v64, 3584
    v_add_u32 v67, 192, v1
    v_mul_u32_u24 v65, 9363, v67
    v_lshrrev_b32 v65, 16, v65
    v_mul_u32_u24 v68, 7, v65
    v_sub_u32 v67, v67, v68
    v_add_u32 v67, s45, v67
    v_cmp_gt_u32 vcc, 7, v67
    v_and_b32 v68, 3, v65
    s_nop 0
    v_cndmask_b32 v67, 0, v67, vcc
    v_lshlrev_b32 v68, 2, v68
    v_and_or_b32 v68, v65, 48, v68
    v_bfe_u32 v65, v65, 2, 2
    v_or_b32 v65, v65, v68
    v_mad_u32_u24 v65, v65, v64, s44
    v_lshl_add_u32 v65, v67, 4, v65
    v_accvgpr_write_b32 a220, v65
    v_mfma_f32_4x4x4_16b_bf16 v[112:115], v[144:145], v[144:145], v[112:115]
    v_mfma_f32_16x16x32_bf16 v[108:111], v[96:99], v[144:147], v[108:111]
    v_mfma_f32_16x16x32_bf16 v[100:103], v[96:99], a[32:35], v[100:103]
    s_add_u32 m0, s0, 0x2380
    s_nop 0
    global_load_lds_dwordx4 v89, s[10:11] offset:128
    s_waitcnt lgkmcnt(6)
    v_mfma_f32_32x32x16_bf16 v[184:199], v[136:139], a[36:39], v[184:199]
    ds_read_b64_tr_b16 a[52:53], v6 offset:3072
    ds_read_b64_tr_b16 a[54:55], v6 offset:3200
    v_mfma_f32_4x4x4_16b_bf16 v[112:115], v[146:147], v[146:147], v[112:115]
    v_mfma_f32_16x16x32_bf16 v[104:107], v[96:99], a[36:39], v[104:107]
    s_add_u32 m0, s0, 0x2780
    s_nop 0
    global_load_lds_dwordx4 v90, s[10:11] offset:128
    s_waitcnt lgkmcnt(6)
    v_mfma_f32_32x32x16_bf16 v[168:183], a[40:43], v[140:143], v[168:183]
    ds_read_b64_tr_b16 a[56:57], v5 offset:7168
    ds_read_b64_tr_b16 a[58:59], v5 offset:7424
    s_add_u32 s44, s27, s28
    s_and_b32 s44, s44, 3
    s_mul_i32 s44, s44, 458752
    s_mul_i32 s45, s27, 112
    s_add_u32 s44, s44, s45
    s_and_b32 s45, s27, 1
    v_mov_b32 v64, 3584
    v_add_u32 v67, 256, v1
    v_mul_u32_u24 v65, 9363, v67
    v_lshrrev_b32 v65, 16, v65
    v_mul_u32_u24 v68, 7, v65
    v_sub_u32 v67, v67, v68
    v_add_u32 v67, s45, v67
    v_cmp_gt_u32 vcc, 7, v67
    v_and_b32 v68, 3, v65
    s_nop 0
    v_cndmask_b32 v67, 0, v67, vcc
    v_lshlrev_b32 v68, 2, v68
    v_and_or_b32 v68, v65, 48, v68
    v_bfe_u32 v65, v65, 2, 2
    v_or_b32 v65, v65, v68
    v_mad_u32_u24 v65, v65, v64, s44
    v_lshl_add_u32 v65, v67, 4, v65
    v_accvgpr_write_b32 a221, v65
    v_mfma_f32_4x4x4_16b_bf16 v[112:115], v[148:149], v[148:149], v[112:115]
    v_mfma_f32_16x16x32_bf16 v[108:111], v[96:99], v[148:151], v[108:111]
    v_mfma_f32_16x16x32_bf16 v[100:103], v[96:99], a[40:43], v[100:103]
    s_waitcnt vmcnt(4)
    ds_read_b128 v[152:155], v240 offset:4096
    ds_read_b128 v[156:159], v241 offset:4096
    ds_read_b128 v[160:163], v242 offset:4096
    ds_read_b128 v[164:167], v243 offset:4096
    s_add_u32 m0, s0, 0x2b80
    s_nop 0
    global_load_lds_dwordx4 v91, s[10:11] offset:128
    s_waitcnt lgkmcnt(10)
    v_mfma_f32_32x32x16_bf16 v[184:199], v[140:143], a[44:47], v[184:199]
    ds_read_b64_tr_b16 a[60:61], v6 offset:3584
    ds_read_b64_tr_b16 a[62:63], v6 offset:3712
    v_mfma_f32_4x4x4_16b_bf16 v[112:115], v[150:151], v[150:151], v[112:115]
    v_mfma_f32_16x16x32_bf16 v[104:107], v[96:99], a[44:47], v[104:107]
    s_barrier
    s_mul_i32 s44, s60, 48
    s_add_u32 m0, s53, 73728
    v_add_u32 v67, s44, v118
    global_load_lds_dwordx4 v67, s[6:7]
    s_waitcnt lgkmcnt(10)
    v_mfma_f32_32x32x16_bf16 v[168:183], a[48:51], v[144:147], v[168:183]
    ds_read_b64_tr_b16 a[64:65], v5 offset:8192
    ds_read_b64_tr_b16 a[66:67], v5 offset:8448
    s_add_u32 s44, s27, s28
    s_and_b32 s44, s44, 3
    s_mul_i32 s44, s44, 458752
    s_mul_i32 s45, s27, 112
    s_add_u32 s44, s44, s45
    s_and_b32 s45, s27, 1
    v_mov_b32 v64, 3584
    v_add_u32 v67, 320, v1
    v_mul_u32_u24 v65, 9363, v67
    v_lshrrev_b32 v65, 16, v65
    v_mul_u32_u24 v68, 7, v65
    v_sub_u32 v67, v67, v68
    v_add_u32 v67, s45, v67
    v_cmp_gt_u32 vcc, 7, v67
    v_and_b32 v68, 3, v65
    s_nop 0
    v_cndmask_b32 v67, 0, v67, vcc
    v_lshlrev_b32 v68, 2, v68
    v_and_or_b32 v68, v65, 48, v68
    v_bfe_u32 v65, v65, 2, 2
    v_or_b32 v65, v65, v68
    v_mad_u32_u24 v65, v65, v64, s44
    v_lshl_add_u32 v65, v67, 4, v65
    v_accvgpr_write_b32 a222, v65
    s_waitcnt lgkmcnt(4)
    v_mfma_f32_4x4x4_16b_bf16 v[112:115], v[152:153], v[152:153], v[112:115]
    v_mfma_f32_16x16x32_bf16 v[108:111], v[96:99], v[152:155], v[108:111]
    v_mfma_f32_16x16x32_bf16 v[100:103], v[96:99], a[48:51], v[100:103]
    s_mul_i32 s44, s60, 48
    s_add_u32 m0, s53, 96256
    v_add_u32 v67, s44, v119
    global_load_lds_dwordx4 v67, s[6:7] offset:2048
    v_mfma_f32_32x32x16_bf16 v[184:199], v[144:147], a[52:55], v[184:199]
    ds_read_b64_tr_b16 a[68:69], v6 offset:4096
    ds_read_b64_tr_b16 a[70:71], v6 offset:4224
    v_mfma_f32_4x4x4_16b_bf16 v[112:115], v[154:155], v[154:155], v[112:115]
    v_mfma_f32_16x16x32_bf16 v[104:107], v[96:99], a[52:55], v[104:107]
    s_lshr_b32 s44, s60, 5
    s_add_u32 s44, s44, 0x20000
    s_add_u32 s10, s4, s44
    s_addc_u32 s11, s5, 0
    s_add_u32 m0, s50, 0x0
    s_nop 0
    global_load_lds_dwordx4 v88, s[10:11] offset:0
    v_mfma_f32_32x32x16_bf16 v[168:183], a[56:59], v[148:151], v[168:183]
    ds_read_b64_tr_b16 a[72:73], v5 offset:9216
    ds_read_b64_tr_b16 a[74:75], v5 offset:9472
    s_add_u32 s44, s27, s28
    s_and_b32 s44, s44, 3
    s_mul_i32 s44, s44, 458752
    s_mul_i32 s45, s27, 112
    s_add_u32 s44, s44, s45
    s_and_b32 s45, s27, 1
    v_mov_b32 v64, 3584
    v_add_u32 v67, 384, v1
    v_mul_u32_u24 v65, 9363, v67
    v_lshrrev_b32 v65, 16, v65
    v_mul_u32_u24 v68, 7, v65
    v_sub_u32 v67, v67, v68
    v_add_u32 v67, s45, v67
    v_cmp_gt_u32 vcc, 7, v67
    v_and_b32 v68, 3, v65
    s_nop 0
    v_cndmask_b32 v67, 0, v67, vcc
    v_lshlrev_b32 v68, 2, v68
    v_and_or_b32 v68, v65, 48, v68
    v_bfe_u32 v65, v65, 2, 2
    v_or_b32 v65, v65, v68
    v_mad_u32_u24 v65, v65, v64, s44
    v_lshl_add_u32 v65, v67, 4, v65
    v_accvgpr_write_b32 a223, v65
    v_mfma_f32_4x4x4_16b_bf16 v[112:115], v[156:157], v[156:157], v[112:115]
    v_mfma_f32_16x16x32_bf16 v[108:111], v[96:99], v[156:159], v[108:111]
    v_mfma_f32_16x16x32_bf16 v[100:103], v[96:99], a[56:59], v[100:103]
    s_add_u32 m0, s50, 0x400
    s_nop 0
    global_load_lds_dwordx4 v89, s[10:11] offset:0
    s_waitcnt lgkmcnt(6)
    v_mfma_f32_32x32x16_bf16 v[184:199], v[148:151], a[60:63], v[184:199]
    ds_read_b64_tr_b16 a[76:77], v6 offset:4608
    ds_read_b64_tr_b16 a[78:79], v6 offset:4736
    v_mfma_f32_4x4x4_16b_bf16 v[112:115], v[158:159], v[158:159], v[112:115]
    v_mfma_f32_16x16x32_bf16 v[104:107], v[96:99], a[60:63], v[104:107]
    s_add_u32 m0, s50, 0x800
    s_nop 0
    global_load_lds_dwordx4 v90, s[10:11] offset:0
    s_waitcnt lgkmcnt(6)
    v_mfma_f32_32x32x16_bf16 v[168:183], a[64:67], v[152:155], v[168:183]
    ds_read_b64_tr_b16 a[80:81], v5 offset:10240
    ds_read_b64_tr_b16 a[82:83], v5 offset:10496
    v_and_b32 v66, 28, v1
    v_and_b32 v67, 16, v1
    v_add_u32 v66, v66, v67
    v_lshlrev_b32 v66, 8, v66
    v_lshl_add_u32 v66, v4, 6, v66
    v_and_b32 v67, 3, v1
    v_lshl_add_u32 v66, v67, 4, v66
    s_lshl_b32 s44, s30, 7
    s_add_u32 s44, s44, 2048
    v_add_u32 v66, s44, v66
    v_mfma_f32_4x4x4_16b_bf16 v[112:115], v[160:161], v[160:161], v[112:115]
    v_mfma_f32_16x16x32_bf16 v[108:111], v[96:99], v[160:163], v[108:111]
    v_mfma_f32_16x16x32_bf16 v[100:103], v[96:99], a[64:67], v[100:103]
    s_add_u32 m0, s50, 0xc00
    s_nop 0
    global_load_lds_dwordx4 v91, s[10:11] offset:0
    s_waitcnt lgkmcnt(6)
    v_mfma_f32_32x32x16_bf16 v[184:199], v[152:155], a[68:71], v[184:199]
    ds_read_b64_tr_b16 a[84:85], v6 offset:5120
    ds_read_b64_tr_b16 a[86:87], v6 offset:5248
    v_mfma_f32_4x4x4_16b_bf16 v[112:115], v[162:163], v[162:163], v[112:115]
    v_mfma_f32_16x16x32_bf16 v[104:107], v[96:99], a[68:71], v[104:107]
    s_mul_i32 s44, s60, 48
    s_add_u32 s44, s44, 196608
    s_add_u32 m0, s53, 77824
    v_add_u32 v67, s44, v118
    global_load_lds_dwordx4 v67, s[6:7]
    s_waitcnt lgkmcnt(6)
    v_mfma_f32_32x32x16_bf16 v[168:183], a[72:75], v[156:159], v[168:183]
    ds_read_b64_tr_b16 a[88:89], v5 offset:11264
    ds_read_b64_tr_b16 a[90:91], v5 offset:11520
    v_mfma_f32_4x4x4_16b_bf16 v[112:115], v[164:165], v[164:165], v[112:115]
    v_mfma_f32_16x16x32_bf16 v[108:111], v[96:99], v[164:167], v[108:111]
    v_mfma_f32_16x16x32_bf16 v[100:103], v[96:99], a[72:75], v[100:103]
    s_waitcnt vmcnt(7)
    ds_read_b128 v[120:123], v240 offset:8192
    ds_read_b128 v[124:127], v241 offset:8192
    ds_read_b128 v[128:131], v242 offset:8192
    ds_read_b128 v[132:135], v243 offset:8192
    s_lshr_b32 s44, s60, 5
    s_add_u32 s44, s44, 0x20000
    s_add_u32 s10, s4, s44
    s_addc_u32 s11, s5, 0
    s_add_u32 m0, s50, 0xf80
    s_nop 0
    global_load_lds_dwordx4 v88, s[10:11] offset:128
    s_waitcnt lgkmcnt(10)
    v_mfma_f32_32x32x16_bf16 v[184:199], v[156:159], a[76:79], v[184:199]
    ds_read_b64_tr_b16 a[92:93], v6 offset:5632
    ds_read_b64_tr_b16 a[94:95], v6 offset:5760
    v_mfma_f32_4x4x4_16b_bf16 v[112:115], v[166:167], v[166:167], v[112:115]
    v_mfma_f32_16x16x32_bf16 v[104:107], v[96:99], a[76:79], v[104:107]
    s_barrier
    s_add_u32 m0, s50, 0x1380
    s_nop 0
    global_load_lds_dwordx4 v89, s[10:11] offset:128
    s_waitcnt lgkmcnt(10)
    v_mfma_f32_32x32x16_bf16 v[168:183], a[80:83], v[160:163], v[168:183]
    ds_read_b64_tr_b16 a[96:97], v5 offset:12288
    ds_read_b64_tr_b16 a[98:99], v5 offset:12544
    s_waitcnt lgkmcnt(4)
    v_mfma_f32_4x4x4_16b_bf16 v[112:115], v[120:121], v[120:121], v[112:115]
    v_mfma_f32_16x16x32_bf16 v[108:111], v[96:99], v[120:123], v[108:111]
    v_mfma_f32_16x16x32_bf16 v[100:103], v[96:99], a[80:83], v[100:103]
    s_add_u32 m0, s50, 0x1780
    s_nop 0
    global_load_lds_dwordx4 v90, s[10:11] offset:128
    v_mfma_f32_32x32x16_bf16 v[184:199], v[160:163], a[84:87], v[184:199]
    ds_read_b64_tr_b16 a[100:101], v6 offset:6144
    ds_read_b64_tr_b16 a[102:103], v6 offset:6272
    v_mfma_f32_4x4x4_16b_bf16 v[112:115], v[122:123], v[122:123], v[112:115]
    v_mfma_f32_16x16x32_bf16 v[104:107], v[96:99], a[84:87], v[104:107]
    s_add_u32 m0, s50, 0x1b80
    s_nop 0
    global_load_lds_dwordx4 v91, s[10:11] offset:128
    v_mfma_f32_32x32x16_bf16 v[168:183], a[88:91], v[164:167], v[168:183]
    ds_read_b64_tr_b16 a[104:105], v5 offset:13312
    ds_read_b64_tr_b16 a[106:107], v5 offset:13568
    v_mfma_f32_4x4x4_16b_bf16 v[112:115], v[124:125], v[124:125], v[112:115]
    v_mfma_f32_16x16x32_bf16 v[108:111], v[96:99], v[124:127], v[108:111]
    v_mfma_f32_16x16x32_bf16 v[100:103], v[96:99], a[88:91], v[100:103]
    s_mul_i32 s44, s61, 48
    s_add_u32 m0, s53, 81920
    v_add_u32 v67, s44, v118
    global_load_lds_dwordx4 v67, s[6:7]
    s_waitcnt lgkmcnt(6)
    v_mfma_f32_32x32x16_bf16 v[184:199], v[164:167], a[92:95], v[184:199]
    ds_read_b64_tr_b16 a[108:109], v6 offset:6656
    ds_read_b64_tr_b16 a[110:111], v6 offset:6784
    v_mfma_f32_4x4x4_16b_bf16 v[112:115], v[126:127], v[126:127], v[112:115]
    v_mfma_f32_16x16x32_bf16 v[104:107], v[96:99], a[92:95], v[104:107]
    s_mul_i32 s44, s61, 48
    s_add_u32 m0, s53, 100352
    v_add_u32 v67, s44, v119
    global_load_lds_dwordx4 v67, s[6:7] offset:2048
    s_waitcnt lgkmcnt(6)
    v_mfma_f32_32x32x16_bf16 v[168:183], a[96:99], v[120:123], v[168:183]
    ds_read_b64_tr_b16 a[112:113], v5 offset:14336
    ds_read_b64_tr_b16 a[114:115], v5 offset:14592
    v_mfma_f32_4x4x4_16b_bf16 v[112:115], v[128:129], v[128:129], v[112:115]
    v_mfma_f32_16x16x32_bf16 v[108:111], v[96:99], v[128:131], v[108:111]
    v_mfma_f32_16x16x32_bf16 v[100:103], v[96:99], a[96:99], v[100:103]
    s_lshr_b32 s44, s61, 5
    s_add_u32 s44, s44, 0x20000
    s_add_u32 s10, s4, s44
    s_addc_u32 s11, s5, 0
    s_add_u32 m0, s50, 0x2000
    s_nop 0
    global_load_lds_dwordx4 v88, s[10:11] offset:0
    s_waitcnt lgkmcnt(6)
    v_mfma_f32_32x32x16_bf16 v[184:199], v[120:123], a[100:103], v[184:199]
    ds_read_b64_tr_b16 a[116:117], v6 offset:7168
    ds_read_b64_tr_b16 a[118:119], v6 offset:7296
    v_mfma_f32_4x4x4_16b_bf16 v[112:115], v[130:131], v[130:131], v[112:115]
    v_mfma_f32_16x16x32_bf16 v[104:107], v[96:99], a[100:103], v[104:107]
    s_add_u32 m0, s50, 0x2400
    s_nop 0
    global_load_lds_dwordx4 v89, s[10:11] offset:0
    s_waitcnt lgkmcnt(6)
    v_mfma_f32_32x32x16_bf16 v[168:183], a[104:107], v[124:127], v[168:183]
    ds_read_b64_tr_b16 a[120:121], v5 offset:15360
    ds_read_b64_tr_b16 a[122:123], v5 offset:15616
    v_mfma_f32_4x4x4_16b_bf16 v[112:115], v[132:133], v[132:133], v[112:115]
    v_mfma_f32_16x16x32_bf16 v[108:111], v[96:99], v[132:135], v[108:111]
    v_mfma_f32_16x16x32_bf16 v[100:103], v[96:99], a[104:107], v[100:103]
    s_waitcnt vmcnt(9)
    ds_read_b128 v[136:139], v92 offset:0
    ds_read_b128 v[140:143], v93 offset:0
    ds_read_b128 v[144:147], v94 offset:0
    ds_read_b128 v[148:151], v95 offset:0
    s_add_u32 m0, s50, 0x2800
    s_nop 0
    global_load_lds_dwordx4 v90, s[10:11] offset:0
    s_waitcnt lgkmcnt(10)
    v_mfma_f32_32x32x16_bf16 v[184:199], v[124:127], a[108:111], v[184:199]
    ds_read_b64_tr_b16 a[124:125], v6 offset:7680
    ds_read_b64_tr_b16 a[126:127], v6 offset:7808
    v_mfma_f32_4x4x4_16b_bf16 v[112:115], v[134:135], v[134:135], v[112:115]
    v_mfma_f32_16x16x32_bf16 v[104:107], v[96:99], a[108:111], v[104:107]
    s_barrier
    s_add_u32 m0, s50, 0x2c00
    s_nop 0
    global_load_lds_dwordx4 v91, s[10:11] offset:0
    s_waitcnt lgkmcnt(10)
    v_mfma_f32_32x32x16_bf16 v[168:183], a[112:115], v[128:131], v[168:183]
    ds_read_b64_tr_b16 a[128:129], v5 offset:16384
    ds_read_b64_tr_b16 a[130:131], v5 offset:16640
    s_waitcnt lgkmcnt(4)
    v_mfma_f32_4x4x4_16b_bf16 v[112:115], v[136:137], v[136:137], v[112:115]
    v_mfma_f32_16x16x32_bf16 v[108:111], v[96:99], v[136:139], v[108:111]
    v_mfma_f32_16x16x32_bf16 v[100:103], v[96:99], a[112:115], v[100:103]
    s_mul_i32 s44, s61, 48
    s_add_u32 s44, s44, 196608
    s_add_u32 m0, s53, 86016
    v_add_u32 v67, s44, v118
    global_load_lds_dwordx4 v67, s[6:7]
    v_mfma_f32_32x32x16_bf16 v[184:199], v[128:131], a[116:119], v[184:199]
    ds_read_b64_tr_b16 a[132:133], v6 offset:8192
    ds_read_b64_tr_b16 a[134:135], v6 offset:8320
    v_mfma_f32_4x4x4_16b_bf16 v[112:115], v[138:139], v[138:139], v[112:115]
    v_mfma_f32_16x16x32_bf16 v[104:107], v[96:99], a[116:119], v[104:107]
    s_lshr_b32 s44, s61, 5
    s_add_u32 s44, s44, 0x20000
    s_add_u32 s10, s4, s44
    s_addc_u32 s11, s5, 0
    s_add_u32 m0, s0, 0xffffff80
    s_nop 0
    global_load_lds_dwordx4 v88, s[10:11] offset:128
    v_mfma_f32_32x32x16_bf16 v[168:183], a[120:123], v[132:135], v[168:183]
    ds_read_b64_tr_b16 a[136:137], v5 offset:17408
    ds_read_b64_tr_b16 a[138:139], v5 offset:17664
    v_mfma_f32_4x4x4_16b_bf16 v[112:115], v[140:141], v[140:141], v[112:115]
    v_mfma_f32_16x16x32_bf16 v[108:111], v[96:99], v[140:143], v[108:111]
    v_mfma_f32_16x16x32_bf16 v[100:103], v[96:99], a[120:123], v[100:103]
    s_add_u32 m0, s0, 0x380
    s_nop 0
    global_load_lds_dwordx4 v89, s[10:11] offset:128
    s_waitcnt lgkmcnt(6)
    v_mfma_f32_32x32x16_bf16 v[184:199], v[132:135], a[124:127], v[184:199]
    ds_read_b64_tr_b16 a[140:141], v6 offset:8704
    ds_read_b64_tr_b16 a[142:143], v6 offset:8832
    v_mfma_f32_4x4x4_16b_bf16 v[112:115], v[142:143], v[142:143], v[112:115]
    v_mfma_f32_16x16x32_bf16 v[104:107], v[96:99], a[124:127], v[104:107]
    s_add_u32 m0, s0, 0x780
    s_nop 0
    global_load_lds_dwordx4 v90, s[10:11] offset:128
    s_waitcnt lgkmcnt(6)
    v_mfma_f32_32x32x16_bf16 v[168:183], a[128:131], v[136:139], v[168:183]
    ds_read_b64_tr_b16 a[144:145], v5 offset:18432
    ds_read_b64_tr_b16 a[146:147], v5 offset:18688
    v_mfma_f32_4x4x4_16b_bf16 v[112:115], v[144:145], v[144:145], v[112:115]
    v_mfma_f32_16x16x32_bf16 v[108:111], v[96:99], v[144:147], v[108:111]
    v_mfma_f32_16x16x32_bf16 v[100:103], v[96:99], a[128:131], v[100:103]
    s_add_u32 m0, s0, 0xb80
    s_nop 0
    global_load_lds_dwordx4 v91, s[10:11] offset:128
    s_waitcnt lgkmcnt(6)
    v_mfma_f32_32x32x16_bf16 v[184:199], v[136:139], a[132:135], v[184:199]
    ds_read_b64_tr_b16 a[148:149], v6 offset:9216
    ds_read_b64_tr_b16 a[150:151], v6 offset:9344
    v_mfma_f32_4x4x4_16b_bf16 v[112:115], v[146:147], v[146:147], v[112:115]
    v_mfma_f32_16x16x32_bf16 v[104:107], v[96:99], a[132:135], v[104:107]
    s_waitcnt lgkmcnt(6)
    v_mfma_f32_32x32x16_bf16 v[168:183], a[136:139], v[140:143], v[168:183]
    ds_read_b64_tr_b16 a[152:153], v5 offset:19456
    ds_read_b64_tr_b16 a[154:155], v5 offset:19712
    v_mfma_f32_4x4x4_16b_bf16 v[112:115], v[148:149], v[148:149], v[112:115]
    v_mfma_f32_16x16x32_bf16 v[108:111], v[96:99], v[148:151], v[108:111]
    v_mfma_f32_16x16x32_bf16 v[100:103], v[96:99], a[136:139], v[100:103]
    s_waitcnt vmcnt(11)
    ds_read_b128 v[152:155], v92 offset:4096
    ds_read_b128 v[156:159], v93 offset:4096
    ds_read_b128 v[160:163], v94 offset:4096
    ds_read_b128 v[164:167], v95 offset:4096
    s_lshr_b32 s44, s58, 5
    s_add_u32 s10, s4, s44
    s_addc_u32 s11, s5, 0
    s_add_u32 m0, s0, 0x1000
    s_nop 0
    global_load_lds_dwordx4 v88, s[10:11] offset:0
    s_waitcnt lgkmcnt(10)
    v_mfma_f32_32x32x16_bf16 v[184:199], v[140:143], a[140:143], v[184:199]
    ds_read_b64_tr_b16 a[156:157], v6 offset:9728
    ds_read_b64_tr_b16 a[158:159], v6 offset:9856
    v_mfma_f32_4x4x4_16b_bf16 v[112:115], v[150:151], v[150:151], v[112:115]
    v_mfma_f32_16x16x32_bf16 v[104:107], v[96:99], a[140:143], v[104:107]
    s_barrier
    s_add_u32 m0, s0, 0x1400
    s_nop 0
    global_load_lds_dwordx4 v89, s[10:11] offset:0
    s_waitcnt lgkmcnt(10)
    v_mfma_f32_32x32x16_bf16 v[168:183], a[144:147], v[144:147], v[168:183]
    ds_read_b64_tr_b16 a[160:161], v5 offset:20480
    ds_read_b64_tr_b16 a[162:163], v5 offset:20736
    s_waitcnt lgkmcnt(4)
    v_mfma_f32_4x4x4_16b_bf16 v[112:115], v[152:153], v[152:153], v[112:115]
    v_mfma_f32_16x16x32_bf16 v[108:111], v[96:99], v[152:155], v[108:111]
    v_mfma_f32_16x16x32_bf16 v[100:103], v[96:99], a[144:147], v[100:103]
    s_add_u32 m0, s0, 0x1800
    s_nop 0
    global_load_lds_dwordx4 v90, s[10:11] offset:0
    v_mfma_f32_32x32x16_bf16 v[184:199], v[144:147], a[148:151], v[184:199]
    ds_read_b64_tr_b16 a[164:165], v6 offset:10240
    ds_read_b64_tr_b16 a[166:167], v6 offset:10368
    v_mfma_f32_4x4x4_16b_bf16 v[112:115], v[154:155], v[154:155], v[112:115]
    v_mfma_f32_16x16x32_bf16 v[104:107], v[96:99], a[148:151], v[104:107]
    s_add_u32 m0, s0, 0x1c00
    s_nop 0
    global_load_lds_dwordx4 v91, s[10:11] offset:0
    v_mfma_f32_32x32x16_bf16 v[168:183], a[152:155], v[148:151], v[168:183]
    ds_read_b64_tr_b16 a[168:169], v5 offset:21504
    ds_read_b64_tr_b16 a[170:171], v5 offset:21760
    v_mfma_f32_4x4x4_16b_bf16 v[112:115], v[156:157], v[156:157], v[112:115]
    v_mfma_f32_16x16x32_bf16 v[108:111], v[96:99], v[156:159], v[108:111]
    v_mfma_f32_16x16x32_bf16 v[100:103], v[96:99], a[152:155], v[100:103]
    s_waitcnt lgkmcnt(6)
    v_mfma_f32_32x32x16_bf16 v[184:199], v[148:151], a[156:159], v[184:199]
    ds_read_b64_tr_b16 a[172:173], v6 offset:10752
    ds_read_b64_tr_b16 a[174:175], v6 offset:10880
    v_mfma_f32_4x4x4_16b_bf16 v[112:115], v[158:159], v[158:159], v[112:115]
    v_mfma_f32_16x16x32_bf16 v[104:107], v[96:99], a[156:159], v[104:107]
    s_waitcnt lgkmcnt(6)
    v_mfma_f32_32x32x16_bf16 v[168:183], a[160:163], v[152:155], v[168:183]
    ds_read_b64_tr_b16 a[176:177], v5 offset:22528
    ds_read_b64_tr_b16 a[178:179], v5 offset:22784
    v_mfma_f32_4x4x4_16b_bf16 v[112:115], v[160:161], v[160:161], v[112:115]
    v_mfma_f32_16x16x32_bf16 v[108:111], v[96:99], v[160:163], v[108:111]
    v_mfma_f32_16x16x32_bf16 v[100:103], v[96:99], a[160:163], v[100:103]
    s_waitcnt lgkmcnt(6)
    v_mfma_f32_32x32x16_bf16 v[184:199], v[152:155], a[164:167], v[184:199]
    ds_read_b64_tr_b16 a[180:181], v6 offset:11264
    ds_read_b64_tr_b16 a[182:183], v6 offset:11392
    v_mfma_f32_4x4x4_16b_bf16 v[112:115], v[162:163], v[162:163], v[112:115]
    v_mfma_f32_16x16x32_bf16 v[104:107], v[96:99], a[164:167], v[104:107]
    s_waitcnt lgkmcnt(6)
    v_mfma_f32_32x32x16_bf16 v[168:183], a[168:171], v[156:159], v[168:183]
    ds_read_b64_tr_b16 a[184:185], v5 offset:23552
    ds_read_b64_tr_b16 a[186:187], v5 offset:23808
    v_mfma_f32_4x4x4_16b_bf16 v[112:115], v[164:165], v[164:165], v[112:115]
    v_mfma_f32_16x16x32_bf16 v[108:111], v[96:99], v[164:167], v[108:111]
    v_mfma_f32_16x16x32_bf16 v[100:103], v[96:99], a[168:171], v[100:103]
    s_waitcnt vmcnt(9)
    ds_read_b128 v[120:123], v92 offset:8192
    ds_read_b128 v[124:127], v93 offset:8192
    ds_read_b128 v[128:131], v94 offset:8192
    ds_read_b128 v[132:135], v95 offset:8192
    s_lshr_b32 s44, s58, 5
    s_add_u32 s10, s4, s44
    s_addc_u32 s11, s5, 0
    s_add_u32 m0, s0, 0x1f80
    s_nop 0
    global_load_lds_dwordx4 v88, s[10:11] offset:128
    s_waitcnt lgkmcnt(10)
    v_mfma_f32_32x32x16_bf16 v[184:199], v[156:159], a[172:175], v[184:199]
    ds_read_b64_tr_b16 a[188:189], v6 offset:11776
    ds_read_b64_tr_b16 a[190:191], v6 offset:11904
    v_mfma_f32_4x4x4_16b_bf16 v[112:115], v[166:167], v[166:167], v[112:115]
    v_mfma_f32_16x16x32_bf16 v[104:107], v[96:99], a[172:175], v[104:107]
    s_barrier
    s_add_u32 m0, s0, 0x2380
    s_nop 0
    global_load_lds_dwordx4 v89, s[10:11] offset:128
    s_waitcnt lgkmcnt(10)
    v_mfma_f32_32x32x16_bf16 v[168:183], a[176:179], v[160:163], v[168:183]
    ds_read_b64_tr_b16 a[192:193], v5 offset:24576
    ds_read_b64_tr_b16 a[194:195], v5 offset:24832
    s_waitcnt lgkmcnt(4)
    v_mfma_f32_4x4x4_16b_bf16 v[112:115], v[120:121], v[120:121], v[112:115]
    v_mfma_f32_16x16x32_bf16 v[108:111], v[96:99], v[120:123], v[108:111]
    v_mfma_f32_16x16x32_bf16 v[100:103], v[96:99], a[176:179], v[100:103]
    s_add_u32 m0, s0, 0x2780
    s_nop 0
    global_load_lds_dwordx4 v90, s[10:11] offset:128
    v_mfma_f32_32x32x16_bf16 v[184:199], v[160:163], a[180:183], v[184:199]
    ds_read_b64_tr_b16 a[196:197], v6 offset:12288
    ds_read_b64_tr_b16 a[198:199], v6 offset:12416
    v_mfma_f32_4x4x4_16b_bf16 v[112:115], v[122:123], v[122:123], v[112:115]
    v_mfma_f32_16x16x32_bf16 v[104:107], v[96:99], a[180:183], v[104:107]
    s_add_u32 m0, s0, 0x2b80
    s_nop 0
    global_load_lds_dwordx4 v91, s[10:11] offset:128
    v_mfma_f32_32x32x16_bf16 v[168:183], a[184:187], v[164:167], v[168:183]
    ds_read_b64_tr_b16 a[200:201], v5 offset:25600
    ds_read_b64_tr_b16 a[202:203], v5 offset:25856
    v_mfma_f32_4x4x4_16b_bf16 v[112:115], v[124:125], v[124:125], v[112:115]
    v_mfma_f32_16x16x32_bf16 v[108:111], v[96:99], v[124:127], v[108:111]
    v_mfma_f32_16x16x32_bf16 v[100:103], v[96:99], a[184:187], v[100:103]
    s_lshr_b32 s44, s59, 5
    s_add_u32 s10, s4, s44
    s_addc_u32 s11, s5, 0
    s_add_u32 m0, s50, 0x0
    s_nop 0
    global_load_lds_dwordx4 v88, s[10:11] offset:0
    s_waitcnt lgkmcnt(6)
    v_mfma_f32_32x32x16_bf16 v[184:199], v[164:167], a[188:191], v[184:199]
    ds_read_b64_tr_b16 a[204:205], v6 offset:12800
    ds_read_b64_tr_b16 a[206:207], v6 offset:12928
    v_mfma_f32_4x4x4_16b_bf16 v[112:115], v[126:127], v[126:127], v[112:115]
    v_mfma_f32_16x16x32_bf16 v[104:107], v[96:99], a[188:191], v[104:107]
    s_add_u32 m0, s50, 0x400
    s_nop 0
    global_load_lds_dwordx4 v89, s[10:11] offset:0
    s_waitcnt lgkmcnt(6)
    v_mfma_f32_32x32x16_bf16 v[168:183], a[192:195], v[120:123], v[168:183]
    ds_read_b64_tr_b16 a[208:209], v5 offset:26624
    ds_read_b64_tr_b16 a[210:211], v5 offset:26880
    v_mfma_f32_4x4x4_16b_bf16 v[112:115], v[128:129], v[128:129], v[112:115]
    v_mfma_f32_16x16x32_bf16 v[108:111], v[96:99], v[128:131], v[108:111]
    v_mfma_f32_16x16x32_bf16 v[100:103], v[96:99], a[192:195], v[100:103]
    s_add_u32 m0, s50, 0x800
    s_nop 0
    global_load_lds_dwordx4 v90, s[10:11] offset:0
    s_waitcnt lgkmcnt(6)
    v_mfma_f32_32x32x16_bf16 v[184:199], v[120:123], a[196:199], v[184:199]
    ds_read_b64_tr_b16 a[212:213], v6 offset:13312
    ds_read_b64_tr_b16 a[214:215], v6 offset:13440
    v_mfma_f32_4x4x4_16b_bf16 v[112:115], v[130:131], v[130:131], v[112:115]
    v_mfma_f32_16x16x32_bf16 v[104:107], v[96:99], a[196:199], v[104:107]
    s_add_u32 m0, s50, 0xc00
    s_nop 0
    global_load_lds_dwordx4 v91, s[10:11] offset:0
    s_waitcnt lgkmcnt(6)
    v_mfma_f32_32x32x16_bf16 v[168:183], a[200:203], v[124:127], v[168:183]
    ds_read_b64_tr_b16 v[232:233], v5 offset:27648
    ds_read_b64_tr_b16 v[234:235], v5 offset:27904
    v_mfma_f32_4x4x4_16b_bf16 v[112:115], v[132:133], v[132:133], v[112:115]
    v_mfma_f32_16x16x32_bf16 v[108:111], v[96:99], v[132:135], v[108:111]
    v_mfma_f32_16x16x32_bf16 v[100:103], v[96:99], a[200:203], v[100:103]
    s_waitcnt vmcnt(12)
    ds_read_b128 v[136:139], v240 offset:0
    ds_read_b128 v[140:143], v241 offset:0
    ds_read_b128 v[144:147], v242 offset:0
    ds_read_b128 v[148:151], v243 offset:0
    s_lshr_b32 s44, s59, 5
    s_add_u32 s10, s4, s44
    s_addc_u32 s11, s5, 0
    s_add_u32 m0, s50, 0xf80
    s_nop 0
    global_load_lds_dwordx4 v88, s[10:11] offset:128
    s_waitcnt lgkmcnt(10)
    v_mfma_f32_32x32x16_bf16 v[184:199], v[124:127], a[204:207], v[184:199]
    ds_read_b64_tr_b16 v[236:237], v6 offset:13824
    ds_read_b64_tr_b16 v[238:239], v6 offset:13952
    v_mfma_f32_4x4x4_16b_bf16 v[112:115], v[134:135], v[134:135], v[112:115]
    v_mfma_f32_16x16x32_bf16 v[104:107], v[96:99], a[204:207], v[104:107]
    s_barrier
    s_add_u32 m0, s50, 0x1380
    s_nop 0
    global_load_lds_dwordx4 v89, s[10:11] offset:128
    s_waitcnt lgkmcnt(10)
    v_mfma_f32_32x32x16_bf16 v[168:183], a[208:211], v[128:131], v[168:183]
    ds_read_b64_tr_b16 a[224:225], v5 offset:28672
    ds_read_b64_tr_b16 a[226:227], v5 offset:28928
    s_waitcnt lgkmcnt(4)
    v_mfma_f32_4x4x4_16b_bf16 v[112:115], v[136:137], v[136:137], v[112:115]
    v_mfma_f32_16x16x32_bf16 v[108:111], v[96:99], v[136:139], v[108:111]
    v_mfma_f32_16x16x32_bf16 v[100:103], v[96:99], a[208:211], v[100:103]
    s_add_u32 m0, s50, 0x1780
    s_nop 0
    global_load_lds_dwordx4 v90, s[10:11] offset:128
    v_mfma_f32_32x32x16_bf16 v[184:199], v[128:131], a[212:215], v[184:199]
    ds_read_b64_tr_b16 a[228:229], v6 offset:14336
    ds_read_b64_tr_b16 a[230:231], v6 offset:14464
    v_mfma_f32_4x4x4_16b_bf16 v[112:115], v[138:139], v[138:139], v[112:115]
    v_mfma_f32_16x16x32_bf16 v[104:107], v[96:99], a[212:215], v[104:107]
    s_add_u32 m0, s50, 0x1b80
    s_nop 0
    global_load_lds_dwordx4 v91, s[10:11] offset:128
    v_mfma_f32_32x32x16_bf16 v[168:183], v[232:235], v[132:135], v[168:183]
    ds_read_b64_tr_b16 a[232:233], v5 offset:29696
    ds_read_b64_tr_b16 a[234:235], v5 offset:29952
    v_mfma_f32_4x4x4_16b_bf16 v[112:115], v[140:141], v[140:141], v[112:115]
    v_mfma_f32_16x16x32_bf16 v[108:111], v[96:99], v[140:143], v[108:111]
    v_mfma_f32_16x16x32_bf16 v[100:103], v[96:99], v[232:235], v[100:103]
    s_lshr_b32 s44, s60, 5
    s_add_u32 s10, s4, s44
    s_addc_u32 s11, s5, 0
    s_add_u32 m0, s50, 0x2000
    s_nop 0
    global_load_lds_dwordx4 v88, s[10:11] offset:0
    s_waitcnt lgkmcnt(6)
    v_mfma_f32_32x32x16_bf16 v[184:199], v[132:135], v[236:239], v[184:199]
    ds_read_b64_tr_b16 a[236:237], v6 offset:14848
    ds_read_b64_tr_b16 a[238:239], v6 offset:14976
    v_mfma_f32_4x4x4_16b_bf16 v[112:115], v[142:143], v[142:143], v[112:115]
    v_mfma_f32_16x16x32_bf16 v[104:107], v[96:99], v[236:239], v[104:107]
    s_add_u32 m0, s50, 0x2400
    s_nop 0
    global_load_lds_dwordx4 v89, s[10:11] offset:0
    s_waitcnt lgkmcnt(6)
    v_mfma_f32_32x32x16_bf16 v[168:183], a[224:227], v[136:139], v[168:183]
    ds_read_b64_tr_b16 a[240:241], v5 offset:30720
    ds_read_b64_tr_b16 a[242:243], v5 offset:30976
    v_mfma_f32_4x4x4_16b_bf16 v[112:115], v[144:145], v[144:145], v[112:115]
    v_mfma_f32_16x16x32_bf16 v[108:111], v[96:99], v[144:147], v[108:111]
    v_mfma_f32_16x16x32_bf16 v[100:103], v[96:99], a[224:227], v[100:103]
    s_add_u32 m0, s50, 0x2800
    s_nop 0
    global_load_lds_dwordx4 v90, s[10:11] offset:0
    s_waitcnt lgkmcnt(6)
    v_mfma_f32_32x32x16_bf16 v[184:199], v[136:139], a[228:231], v[184:199]
    ds_read_b64_tr_b16 a[244:245], v6 offset:15360
    ds_read_b64_tr_b16 a[246:247], v6 offset:15488
    v_mfma_f32_4x4x4_16b_bf16 v[112:115], v[146:147], v[146:147], v[112:115]
    v_mfma_f32_16x16x32_bf16 v[104:107], v[96:99], a[228:231], v[104:107]
    s_add_u32 m0, s50, 0x2c00
    s_nop 0
    global_load_lds_dwordx4 v91, s[10:11] offset:0
    s_waitcnt lgkmcnt(6)
    v_mfma_f32_32x32x16_bf16 v[168:183], a[232:235], v[140:143], v[168:183]
    ds_read_b64_tr_b16 a[248:249], v5 offset:31744
    ds_read_b64_tr_b16 a[250:251], v5 offset:32000
    v_mfma_f32_4x4x4_16b_bf16 v[112:115], v[148:149], v[148:149], v[112:115]
    v_mfma_f32_16x16x32_bf16 v[108:111], v[96:99], v[148:151], v[108:111]
    v_mfma_f32_16x16x32_bf16 v[100:103], v[96:99], a[232:235], v[100:103]
    s_waitcnt vmcnt(16)
    ds_read_b128 v[152:155], v240 offset:4096
    ds_read_b128 v[156:159], v241 offset:4096
    ds_read_b128 v[160:163], v242 offset:4096
    ds_read_b128 v[164:167], v243 offset:4096
    s_lshr_b32 s44, s60, 5
    s_add_u32 s10, s4, s44
    s_addc_u32 s11, s5, 0
    s_add_u32 m0, s0, 0xffffff80
    s_nop 0
    global_load_lds_dwordx4 v88, s[10:11] offset:128
    s_waitcnt lgkmcnt(10)
    v_mfma_f32_32x32x16_bf16 v[184:199], v[140:143], a[236:239], v[184:199]
    ds_read_b64_tr_b16 a[252:253], v6 offset:15872
    ds_read_b64_tr_b16 a[254:255], v6 offset:16000
    v_mfma_f32_4x4x4_16b_bf16 v[112:115], v[150:151], v[150:151], v[112:115]
    v_mfma_f32_16x16x32_bf16 v[104:107], v[96:99], a[236:239], v[104:107]
    s_add_u32 m0, s0, 0x380
    s_nop 0
    global_load_lds_dwordx4 v89, s[10:11] offset:128
    s_waitcnt lgkmcnt(10)
    v_mfma_f32_32x32x16_bf16 v[168:183], a[240:243], v[144:147], v[168:183]
    s_mov_b32 vcc_lo, 0xaaaaaaaa
    s_mov_b32 vcc_hi, 0xaaaaaaaa
    v_cndmask_b32 v72, v112, v113, vcc
    v_cndmask_b32 v73, v114, v115, vcc
    s_mov_b32 vcc_lo, 0xcccccccc
    s_mov_b32 vcc_hi, 0xcccccccc
    v_cndmask_b32 v71, v72, v73, vcc
    v_cndmask_b32 v72, v72, v73, vcc
    s_waitcnt lgkmcnt(2)
    v_mfma_f32_4x4x4_16b_bf16 v[248:251], v[152:153], v[152:153], 0
    v_mfma_f32_16x16x32_bf16 v[244:247], v[96:99], v[152:155], 0
    v_mfma_f32_16x16x32_bf16 v[100:103], v[96:99], a[240:243], v[100:103]
    v_mul_f32 v70, 0xbb000000, v108
    v_permlane32_swap_b32 v71, v72
    s_add_u32 m0, s0, 0x780
    s_nop 0
    global_load_lds_dwordx4 v90, s[10:11] offset:128
    v_mfma_f32_32x32x16_bf16 v[184:199], v[144:147], a[244:247], v[184:199]
    v_add_f32 v71, v71, v72
    v_mul_f32 v72, v70, v70
    v_mfma_f32_4x4x4_16b_bf16 v[248:251], v[154:155], v[154:155], v[248:251]
    v_mfma_f32_16x16x32_bf16 v[104:107], v[96:99], a[244:247], v[104:107]
    v_mul_f32 v71, 0x3b000000, v71
    v_sub_f32 v71, v71, v72
    s_add_u32 m0, s0, 0xb80
    s_nop 0
    global_load_lds_dwordx4 v91, s[10:11] offset:128
    v_mfma_f32_32x32x16_bf16 v[168:183], a[248:251], v[148:151], v[168:183]
    v_readfirstlane_b32 s31, v82
    s_nop 0
    s_add_u32 s31, s31, 0x9E3779B9
    s_mov_b32 s52, s31
    v_max_f32 v71, 0, v71
    v_add_f32 v72, 0x3727c5ac, v71
    v_mfma_f32_4x4x4_16b_bf16 v[248:251], v[156:157], v[156:157], v[248:251]
    v_mfma_f32_16x16x32_bf16 v[244:247], v[96:99], v[156:159], v[244:247]
    v_mfma_f32_16x16x32_bf16 v[100:103], v[96:99], a[248:251], v[100:103]
    v_rsq_f32 v22, v72
    v_cvt_pk_bf16_f32 v73, v70, v70
    s_lshr_b32 s44, s61, 5
    s_add_u32 s10, s4, s44
    s_addc_u32 s11, s5, 0
    s_add_u32 m0, s0, 0x1000
    s_nop 0
    global_load_lds_dwordx4 v88, s[10:11] offset:0
    s_waitcnt lgkmcnt(0)
    v_mfma_f32_32x32x16_bf16 v[184:199], v[148:151], a[252:255], v[184:199]
    v_lshlrev_b32 v73, 16, v73
    v_sub_f32 v73, v70, v73
    v_mfma_f32_4x4x4_16b_bf16 v[248:251], v[158:159], v[158:159], v[248:251]
    v_mfma_f32_16x16x32_bf16 v[104:107], v[96:99], a[252:255], v[104:107]
    v_mul_f32 v73, v73, v8
    v_cvt_pk_bf16_f32 v18, v70, v73
    s_add_u32 m0, s0, 0x1400
    s_nop 0
    global_load_lds_dwordx4 v89, s[10:11] offset:0
    v_mfma_f32_32x32x16_bf16 v[200:215], a[0:3], v[152:155], 0
    v_mul_f32 v23, 0x3eb8aa3b, v22
    v_cvt_pk_bf16_f32 v78, v100, v100
    v_lshlrev_b32 v78, 16, v78
    v_sub_f32 v78, v100, v78
    v_mfma_f32_4x4x4_16b_bf16 v[248:251], v[160:161], v[160:161], v[248:251]
    v_mfma_f32_16x16x32_bf16 v[244:247], v[96:99], v[160:163], v[244:247]
    v_cndmask_b32 v78, v100, v78, s[40:41]
    v_mul_f32 v79, v100, v8
    v_cvt_pk_bf16_f32 v38, v78, v79
    s_add_u32 m0, s0, 0x1800
    s_nop 0
    global_load_lds_dwordx4 v90, s[10:11] offset:0
    v_mfma_f32_32x32x16_bf16 v[216:231], v[152:155], a[4:7], 0
    v_cvt_pk_bf16_f32 v80, v104, v104
    v_lshlrev_b32 v80, 16, v80
    v_sub_f32 v80, v104, v80
    v_mfma_f32_4x4x4_16b_bf16 v[248:251], v[162:163], v[162:163], v[248:251]
    v_cndmask_b32 v80, v104, v80, s[40:41]
    v_mul_f32 v81, v104, v8
    v_cvt_pk_bf16_f32 v40, v80, v81
    s_add_u32 m0, s0, 0x1c00
    s_nop 0
    global_load_lds_dwordx4 v91, s[10:11] offset:0
    v_mfma_f32_32x32x16_bf16 v[200:215], a[8:11], v[156:159], v[200:215]
    v_mfma_f32_32x32x16_bf16 v[168:183], v[38:41], v[18:21], v[168:183]
    v_lshl_add_u32 v67, v3, 2, s36
    ds_write_b32 v67, v22 offset:24576
    v_mfma_f32_32x32x16_bf16 v[184:199], v[16:19], v[38:41], v[184:199]
    v_mfma_f32_4x4x4_16b_bf16 v[248:251], v[164:165], v[164:165], v[248:251]
    v_mfma_f32_16x16x32_bf16 v[244:247], v[96:99], v[164:167], v[244:247]
    s_waitcnt vmcnt(20)
    ds_read_b128 v[120:123], v240 offset:8192
    ds_read_b128 v[124:127], v241 offset:8192
    ds_read_b128 v[128:131], v242 offset:8192
    ds_read_b128 v[132:135], v243 offset:8192
    s_add_u32 s44, s101, 1585152
    v_add_u32 v63, s44, v2
    ds_read_b128 v[78:81], v10 offset:24576
    ds_read_b128 v[82:85], v10 offset:24608
    s_waitcnt lgkmcnt(2)
    s_lshr_b32 s44, s61, 5
    s_add_u32 s10, s4, s44
    s_addc_u32 s11, s5, 0
    s_add_u32 m0, s0, 0x1f80
    s_nop 0
    global_load_lds_dwordx4 v88, s[10:11] offset:128
    v_mfma_f32_32x32x16_bf16 v[216:231], v[156:159], a[12:15], v[216:231]
    v_mul_f32 v176, v176, v22
    v_mfma_f32_4x4x4_16b_bf16 v[248:251], v[166:167], v[166:167], v[248:251]
    v_mul_f32 v177, v177, v22
    v_mul_f32 v178, v178, v22
    v_mul_f32 v179, v179, v22
    s_add_u32 m0, s0, 0x2380
    s_nop 0
    global_load_lds_dwordx4 v89, s[10:11] offset:128
    v_mfma_f32_32x32x16_bf16 v[200:215], a[16:19], v[160:163], v[200:215]
    v_mul_f32 v180, v180, v22
    v_mul_f32 v181, v181, v22
    v_mul_f32 v182, v182, v22
    v_mfma_f32_4x4x4_16b_bf16 v[248:251], v[120:121], v[120:121], v[248:251]
    v_mfma_f32_16x16x32_bf16 v[244:247], v[96:99], v[120:123], v[244:247]
    v_mul_f32 v183, v183, v22
    v_cvt_pk_bf16_f32 v176, v176, v177
    v_cvt_pk_bf16_f32 v177, v178, v179
    s_add_u32 m0, s0, 0x2780
    s_nop 0
    global_load_lds_dwordx4 v90, s[10:11] offset:128
    v_mfma_f32_32x32x16_bf16 v[216:231], v[160:163], a[20:23], v[216:231]
    v_cvt_pk_bf16_f32 v178, v180, v181
    v_cvt_pk_bf16_f32 v179, v182, v183
    ds_write_b128 v9, v[176:179] offset:24576
    v_mfma_f32_4x4x4_16b_bf16 v[248:251], v[122:123], v[122:123], v[248:251]
    v_cndmask_b32 v184, v192, v184, s[42:43]
    v_cndmask_b32 v185, v193, v185, s[42:43]
    v_cndmask_b32 v186, v194, v186, s[42:43]
    s_add_u32 m0, s0, 0x2b80
    s_nop 0
    global_load_lds_dwordx4 v91, s[10:11] offset:128
    v_mfma_f32_32x32x16_bf16 v[200:215], a[24:27], v[164:167], v[200:215]
    v_cndmask_b32 v187, v195, v187, s[42:43]
    v_cndmask_b32 v188, v196, v188, s[42:43]
    v_cndmask_b32 v189, v197, v189, s[42:43]
    v_mfma_f32_4x4x4_16b_bf16 v[248:251], v[124:125], v[124:125], v[248:251]
    v_mfma_f32_16x16x32_bf16 v[244:247], v[96:99], v[124:127], v[244:247]
    v_cndmask_b32 v190, v198, v190, s[42:43]
    v_cndmask_b32 v191, v199, v191, s[42:43]
    v_mov_b32 v183, s52
    v_and_b32 v68, 7, v1
    s_add_u32 s44, s39, 0
    v_lshl_add_u32 v68, v68, 10, s44
    v_lshrrev_b32 v67, 3, v1
    v_lshl_add_u32 v68, v67, 4, v68
    global_load_dwordx4 v[34:37], v68, s[4:5]
    v_add_u32 v68, 131072, v68
    global_load_dwordx4 v[30:33], v68, s[4:5]
    v_mfma_f32_32x32x16_bf16 v[216:231], v[164:167], a[28:31], v[216:231]
    v_mov_b32 v180, v179
    v_mov_b32 v179, s52
    v_mov_b32 v182, s52
    v_mfma_f32_4x4x4_16b_bf16 v[248:251], v[126:127], v[126:127], v[248:251]
    global_store_dwordx4 v63, v[176:179], s[24:25] sc1
    s_waitcnt lgkmcnt(1)
    v_mul_f32 v184, v184, v78
    v_mfma_f32_32x32x16_bf16 v[200:215], a[32:35], v[120:123], v[200:215]
    v_mul_f32 v185, v185, v79
    v_mul_f32 v186, v186, v80
    v_mul_f32 v187, v187, v81
    v_mfma_f32_4x4x4_16b_bf16 v[248:251], v[128:129], v[128:129], v[248:251]
    v_mfma_f32_16x16x32_bf16 v[244:247], v[96:99], v[128:131], v[244:247]
    v_mul_f32 v188, v188, v82
    v_mul_f32 v189, v189, v83
    v_mul_f32 v190, v190, v84
    v_mfma_f32_32x32x16_bf16 v[216:231], v[120:123], a[36:39], v[216:231]
    v_mul_f32 v191, v191, v85
    v_cvt_pk_bf16_f32 v184, v184, v185
    v_cvt_pk_bf16_f32 v185, v186, v187
    v_mfma_f32_4x4x4_16b_bf16 v[248:251], v[130:131], v[130:131], v[248:251]
    v_cvt_pk_bf16_f32 v186, v188, v189
    v_cvt_pk_bf16_f32 v187, v190, v191
    ds_write_b128 v9, v[184:187] offset:25600
    v_mfma_f32_32x32x16_bf16 v[200:215], a[40:43], v[124:127], v[200:215]
    v_mov_b32 v181, v187
    global_store_dwordx4 v63, v[180:183], s[24:25] offset:2048 sc1
    v_mov_b32 v187, s52
    global_store_dwordx4 v63, v[184:187], s[24:25] offset:1024 sc1
    v_mfma_f32_4x4x4_16b_bf16 v[248:251], v[132:133], v[132:133], v[248:251]
    v_mfma_f32_16x16x32_bf16 v[244:247], v[96:99], v[132:135], v[244:247]
    s_waitcnt vmcnt(25)
    ds_read_b128 v[136:139], v92 offset:0
    ds_read_b128 v[140:143], v93 offset:0
    ds_read_b128 v[144:147], v94 offset:0
    ds_read_b128 v[148:151], v95 offset:0
    v_mul_f32 v168, v168, v23
    v_mul_f32 v169, v169, v23
    v_mul_f32 v170, v170, v23
    v_mfma_f32_32x32x16_bf16 v[216:231], v[124:127], a[44:47], v[216:231]
    v_mul_f32 v171, v171, v23
    v_mul_f32 v172, v172, v23
    v_mul_f32 v173, v173, v23
    v_mfma_f32_4x4x4_16b_bf16 v[248:251], v[134:135], v[134:135], v[248:251]
    v_mul_f32 v174, v174, v23
    v_mul_f32 v175, v175, v23
    v_cvt_pk_bf16_f32 v54, v168, v169
    v_mfma_f32_32x32x16_bf16 v[200:215], a[48:51], v[128:131], v[200:215]
    v_cvt_pk_bf16_f32 v55, v170, v171
    v_cvt_pk_bf16_f32 v56, v172, v173
    v_cvt_pk_bf16_f32 v57, v174, v175
    s_waitcnt lgkmcnt(0)
    v_mfma_f32_4x4x4_16b_bf16 v[248:251], v[136:137], v[136:137], v[248:251]
    v_mfma_f32_16x16x32_bf16 v[244:247], v[96:99], v[136:139], v[244:247]
    v_mfma_f32_32x32x16_bf16 v[216:231], v[128:131], a[52:55], v[216:231]
    v_mfma_f32_4x4x4_16b_bf16 v[248:251], v[138:139], v[138:139], v[248:251]
    v_mfma_f32_32x32x16_bf16 v[200:215], a[56:59], v[132:135], v[200:215]
    s_nop 0
    v_mfma_f32_4x4x4_16b_bf16 v[248:251], v[140:141], v[140:141], v[248:251]
    v_mfma_f32_16x16x32_bf16 v[244:247], v[96:99], v[140:143], v[244:247]
    v_mfma_f32_32x32x16_bf16 v[216:231], v[132:135], a[60:63], v[216:231]
    v_mfma_f32_4x4x4_16b_bf16 v[248:251], v[142:143], v[142:143], v[248:251]
    v_mfma_f32_32x32x16_bf16 v[200:215], a[64:67], v[136:139], v[200:215]
    s_nop 0
    v_mfma_f32_4x4x4_16b_bf16 v[248:251], v[144:145], v[144:145], v[248:251]
    v_mfma_f32_16x16x32_bf16 v[244:247], v[96:99], v[144:147], v[244:247]
    v_mfma_f32_32x32x16_bf16 v[216:231], v[136:139], a[68:71], v[216:231]
    v_mfma_f32_4x4x4_16b_bf16 v[248:251], v[146:147], v[146:147], v[248:251]
    s_lshl2_add_u32 s44, s2, s28
    s_mul_i32 s45, s44, 1792
    v_min_u32 v67, 13, v1
    v_lshl_add_u32 v67, v67, 7, s45
    s_lshl_b32 s44, s44, 9
    v_and_b32 v68, 3, v1
    v_lshl_add_u32 v68, v68, 7, s44
    s_mov_b64 exec, 0xffff
    global_load_dword v76, v68, s[8:9]
    global_load_dword v76, v67, s[12:13]
    s_mov_b64 exec, -1
    v_mfma_f32_32x32x16_bf16 v[200:215], a[72:75], v[140:143], v[200:215]
    v_mfma_f32_4x4x4_16b_bf16 v[248:251], v[148:149], v[148:149], v[248:251]
    v_mfma_f32_16x16x32_bf16 v[244:247], v[96:99], v[148:151], v[244:247]
    s_waitcnt vmcnt(23)
    ds_read_b128 v[152:155], v92 offset:4096
    ds_read_b128 v[156:159], v93 offset:4096
    ds_read_b128 v[160:163], v94 offset:4096
    ds_read_b128 v[164:167], v95 offset:4096
    v_mfma_f32_32x32x16_bf16 v[216:231], v[140:143], a[76:79], v[216:231]
    v_mfma_f32_4x4x4_16b_bf16 v[248:251], v[150:151], v[150:151], v[248:251]
    v_mfma_f32_32x32x16_bf16 v[200:215], a[80:83], v[144:147], v[200:215]
    s_waitcnt lgkmcnt(0)
    v_mfma_f32_4x4x4_16b_bf16 v[248:251], v[152:153], v[152:153], v[248:251]
    v_mfma_f32_16x16x32_bf16 v[244:247], v[96:99], v[152:155], v[244:247]
    v_mfma_f32_32x32x16_bf16 v[216:231], v[144:147], a[84:87], v[216:231]
    s_lshl_b32 s44, s27, 10
    s_add_u32 s44, s44, s62
    s_add_u32 s44, s44, 393216
    v_add_u32 v67, s44, v2
    global_store_dwordx4 v67, v[16:19], s[24:25] sc1
    v_mfma_f32_4x4x4_16b_bf16 v[248:251], v[154:155], v[154:155], v[248:251]
    v_mfma_f32_32x32x16_bf16 v[200:215], a[88:91], v[148:151], v[200:215]
    s_nop 0
    v_mfma_f32_4x4x4_16b_bf16 v[248:251], v[156:157], v[156:157], v[248:251]
    v_mfma_f32_16x16x32_bf16 v[244:247], v[96:99], v[156:159], v[244:247]
    v_mfma_f32_32x32x16_bf16 v[216:231], v[148:151], a[92:95], v[216:231]
    s_lshl_b32 s44, s26, 5
    s_add_u32 s44, s44, s27
    s_lshl_b32 s44, s44, 5
    s_add_u32 s44, s44, s28
    s_lshl_b32 s44, s44, 2
    s_add_u32 s44, s44, 131072
    v_mov_b32 v68, s44
    s_and_b32 s44, s31, -8
    s_or_b32 s44, s44, s3
    v_not_b32 v67, s44
    global_store_dword v68, v67, s[24:25] sc1
    v_mfma_f32_4x4x4_16b_bf16 v[248:251], v[158:159], v[158:159], v[248:251]
    v_mfma_f32_32x32x16_bf16 v[200:215], a[96:99], v[152:155], v[200:215]
    s_nop 0
    v_mfma_f32_4x4x4_16b_bf16 v[248:251], v[160:161], v[160:161], v[248:251]
    v_mfma_f32_16x16x32_bf16 v[244:247], v[96:99], v[160:163], v[244:247]
    v_mfma_f32_32x32x16_bf16 v[216:231], v[152:155], a[100:103], v[216:231]
    v_add_u32 v67, 4096, v15
    global_store_dword v67, v16, s[24:25] offset:-4096 sc1
    v_add_u32 v67, 4096, v67
    global_store_dword v67, v16, s[24:25] sc1
    v_mfma_f32_4x4x4_16b_bf16 v[248:251], v[162:163], v[162:163], v[248:251]
    v_mfma_f32_32x32x16_bf16 v[200:215], a[104:107], v[156:159], v[200:215]
    s_nop 0
    v_mfma_f32_4x4x4_16b_bf16 v[248:251], v[164:165], v[164:165], v[248:251]
    v_mfma_f32_16x16x32_bf16 v[244:247], v[96:99], v[164:167], v[244:247]
    s_waitcnt vmcnt(23)
    ds_read_b128 v[120:123], v92 offset:8192
    ds_read_b128 v[124:127], v93 offset:8192
    ds_read_b128 v[128:131], v94 offset:8192
    ds_read_b128 v[132:135], v95 offset:8192
    v_mfma_f32_32x32x16_bf16 v[216:231], v[156:159], a[108:111], v[216:231]
    v_add_u32 v67, 131072, v14
    global_store_dwordx4 v67, v[16:19], s[24:25] sc1
    v_mfma_f32_4x4x4_16b_bf16 v[248:251], v[166:167], v[166:167], v[248:251]
    v_mfma_f32_32x32x16_bf16 v[200:215], a[112:115], v[160:163], v[200:215]
    s_waitcnt lgkmcnt(0)
    v_mfma_f32_4x4x4_16b_bf16 v[248:251], v[120:121], v[120:121], v[248:251]
    v_mfma_f32_16x16x32_bf16 v[244:247], v[96:99], v[120:123], v[244:247]
    v_mfma_f32_32x32x16_bf16 v[216:231], v[160:163], a[116:119], v[216:231]
    s_lshl_b32 s44, s27, 10
    s_add_u32 s44, s44, s62
    s_add_u32 s44, s44, 262144
    v_add_u32 v67, s44, v2
    global_store_dwordx4 v67, v[16:19], s[24:25] sc1
    v_mfma_f32_4x4x4_16b_bf16 v[248:251], v[122:123], v[122:123], v[248:251]
    v_mfma_f32_32x32x16_bf16 v[200:215], a[120:123], v[164:167], v[200:215]
    s_nop 0
    v_mfma_f32_4x4x4_16b_bf16 v[248:251], v[124:125], v[124:125], v[248:251]
    v_mfma_f32_16x16x32_bf16 v[244:247], v[96:99], v[124:127], v[244:247]
    v_mfma_f32_32x32x16_bf16 v[216:231], v[164:167], a[124:127], v[216:231]
    global_store_dwordx4 v14, v[16:19], s[24:25] sc1
    v_mfma_f32_4x4x4_16b_bf16 v[248:251], v[126:127], v[126:127], v[248:251]
    v_mfma_f32_32x32x16_bf16 v[200:215], a[128:131], v[120:123], v[200:215]
    s_nop 0
    v_mfma_f32_4x4x4_16b_bf16 v[248:251], v[128:129], v[128:129], v[248:251]
    v_mfma_f32_16x16x32_bf16 v[244:247], v[96:99], v[128:131], v[244:247]
    v_mfma_f32_32x32x16_bf16 v[216:231], v[120:123], a[132:135], v[216:231]
    v_mfma_f32_4x4x4_16b_bf16 v[248:251], v[130:131], v[130:131], v[248:251]
    v_mfma_f32_32x32x16_bf16 v[200:215], a[136:139], v[124:127], v[200:215]
    s_nop 0
    v_mfma_f32_4x4x4_16b_bf16 v[248:251], v[132:133], v[132:133], v[248:251]
    v_mfma_f32_16x16x32_bf16 v[244:247], v[96:99], v[132:135], v[244:247]
    s_waitcnt vmcnt(22)
    ds_read_b128 v[136:139], v240 offset:0
    ds_read_b128 v[140:143], v241 offset:0
    ds_read_b128 v[144:147], v242 offset:0
    ds_read_b128 v[148:151], v243 offset:0
    v_mfma_f32_32x32x16_bf16 v[216:231], v[124:127], a[140:143], v[216:231]
    v_mfma_f32_4x4x4_16b_bf16 v[248:251], v[134:135], v[134:135], v[248:251]
    v_mfma_f32_32x32x16_bf16 v[200:215], a[144:147], v[128:131], v[200:215]
    s_waitcnt lgkmcnt(0)
    v_mfma_f32_4x4x4_16b_bf16 v[248:251], v[136:137], v[136:137], v[248:251]
    v_mfma_f32_16x16x32_bf16 v[244:247], v[96:99], v[136:139], v[244:247]
    v_mfma_f32_32x32x16_bf16 v[216:231], v[128:131], a[148:151], v[216:231]
    v_mfma_f32_4x4x4_16b_bf16 v[248:251], v[138:139], v[138:139], v[248:251]
    v_mfma_f32_32x32x16_bf16 v[200:215], a[152:155], v[132:135], v[200:215]
    s_nop 0
    v_mfma_f32_4x4x4_16b_bf16 v[248:251], v[140:141], v[140:141], v[248:251]
    v_mfma_f32_16x16x32_bf16 v[244:247], v[96:99], v[140:143], v[244:247]
    v_mfma_f32_32x32x16_bf16 v[216:231], v[132:135], a[156:159], v[216:231]
    v_mfma_f32_4x4x4_16b_bf16 v[248:251], v[142:143], v[142:143], v[248:251]
    v_mfma_f32_32x32x16_bf16 v[200:215], a[160:163], v[136:139], v[200:215]
    s_nop 0
    v_mfma_f32_4x4x4_16b_bf16 v[248:251], v[144:145], v[144:145], v[248:251]
    v_mfma_f32_16x16x32_bf16 v[244:247], v[96:99], v[144:147], v[244:247]
    v_mfma_f32_32x32x16_bf16 v[216:231], v[136:139], a[164:167], v[216:231]
    v_mfma_f32_4x4x4_16b_bf16 v[248:251], v[146:147], v[146:147], v[248:251]
    v_mfma_f32_32x32x16_bf16 v[200:215], a[168:171], v[140:143], v[200:215]
    s_nop 0
    v_mfma_f32_4x4x4_16b_bf16 v[248:251], v[148:149], v[148:149], v[248:251]
    v_mfma_f32_16x16x32_bf16 v[244:247], v[96:99], v[148:151], v[244:247]
    s_waitcnt vmcnt(18)
    ds_read_b128 v[152:155], v240 offset:4096
    ds_read_b128 v[156:159], v241 offset:4096
    ds_read_b128 v[160:163], v242 offset:4096
    ds_read_b128 v[164:167], v243 offset:4096
    v_mfma_f32_32x32x16_bf16 v[216:231], v[140:143], a[172:175], v[216:231]
    v_mfma_f32_4x4x4_16b_bf16 v[248:251], v[150:151], v[150:151], v[248:251]
    v_mfma_f32_32x32x16_bf16 v[200:215], a[176:179], v[144:147], v[200:215]
    s_waitcnt lgkmcnt(0)
    v_mfma_f32_4x4x4_16b_bf16 v[248:251], v[152:153], v[152:153], v[248:251]
    v_mfma_f32_16x16x32_bf16 v[244:247], v[96:99], v[152:155], v[244:247]
    v_mfma_f32_32x32x16_bf16 v[216:231], v[144:147], a[180:183], v[216:231]
    v_mfma_f32_4x4x4_16b_bf16 v[248:251], v[154:155], v[154:155], v[248:251]
    v_mfma_f32_32x32x16_bf16 v[200:215], a[184:187], v[148:151], v[200:215]
    s_nop 0
    v_mfma_f32_4x4x4_16b_bf16 v[248:251], v[156:157], v[156:157], v[248:251]
    v_mfma_f32_16x16x32_bf16 v[244:247], v[96:99], v[156:159], v[244:247]
    v_mfma_f32_32x32x16_bf16 v[216:231], v[148:151], a[188:191], v[216:231]
    v_mfma_f32_4x4x4_16b_bf16 v[248:251], v[158:159], v[158:159], v[248:251]
    v_mfma_f32_32x32x16_bf16 v[200:215], a[192:195], v[152:155], v[200:215]
    s_nop 0
    v_mfma_f32_4x4x4_16b_bf16 v[248:251], v[160:161], v[160:161], v[248:251]
    v_mfma_f32_16x16x32_bf16 v[244:247], v[96:99], v[160:163], v[244:247]
    v_mfma_f32_32x32x16_bf16 v[216:231], v[152:155], a[196:199], v[216:231]
    v_mfma_f32_4x4x4_16b_bf16 v[248:251], v[162:163], v[162:163], v[248:251]
    v_mfma_f32_32x32x16_bf16 v[200:215], a[200:203], v[156:159], v[200:215]
    s_nop 0
    v_mfma_f32_4x4x4_16b_bf16 v[248:251], v[164:165], v[164:165], v[248:251]
    v_mfma_f32_16x16x32_bf16 v[244:247], v[96:99], v[164:167], v[244:247]
    s_waitcnt vmcnt(14)
    ds_read_b128 v[120:123], v240 offset:8192
    ds_read_b128 v[124:127], v241 offset:8192
    ds_read_b128 v[128:131], v242 offset:8192
    ds_read_b128 v[132:135], v243 offset:8192
    v_mfma_f32_32x32x16_bf16 v[216:231], v[156:159], a[204:207], v[216:231]
    v_mfma_f32_4x4x4_16b_bf16 v[248:251], v[166:167], v[166:167], v[248:251]
    v_mfma_f32_32x32x16_bf16 v[200:215], a[208:211], v[160:163], v[200:215]
    s_waitcnt lgkmcnt(0)
    v_mfma_f32_4x4x4_16b_bf16 v[248:251], v[120:121], v[120:121], v[248:251]
    v_mfma_f32_16x16x32_bf16 v[244:247], v[96:99], v[120:123], v[244:247]
    v_mfma_f32_32x32x16_bf16 v[216:231], v[160:163], a[212:215], v[216:231]
    v_mfma_f32_4x4x4_16b_bf16 v[248:251], v[122:123], v[122:123], v[248:251]
    v_mfma_f32_32x32x16_bf16 v[200:215], v[232:235], v[164:167], v[200:215]
    s_nop 0
    v_mfma_f32_4x4x4_16b_bf16 v[248:251], v[124:125], v[124:125], v[248:251]
    v_mfma_f32_16x16x32_bf16 v[244:247], v[96:99], v[124:127], v[244:247]
    v_mfma_f32_32x32x16_bf16 v[216:231], v[164:167], v[236:239], v[216:231]
    v_mfma_f32_4x4x4_16b_bf16 v[248:251], v[126:127], v[126:127], v[248:251]
    v_mfma_f32_32x32x16_bf16 v[200:215], a[224:227], v[120:123], v[200:215]
    s_barrier
    s_cmp_eq_u32 s26, 0
    s_cselect_b32 s44, 0, 3145728
    s_sub_u32 s44, s101, s44
    s_add_u32 s44, s44, 1585152
    v_add_u32 v86, s44, v2
    global_load_dwordx4 v[136:139], v86, s[24:25] offset:0 sc1
    global_load_dwordx4 v[140:143], v86, s[24:25] offset:1024 sc1
    global_load_dwordx4 v[144:147], v86, s[24:25] offset:2048 sc1
    v_mfma_f32_4x4x4_16b_bf16 v[248:251], v[128:129], v[128:129], v[248:251]
    v_mfma_f32_16x16x32_bf16 v[244:247], v[96:99], v[128:131], v[244:247]
    v_mfma_f32_32x32x16_bf16 v[216:231], v[120:123], a[228:231], v[216:231]
    v_mfma_f32_4x4x4_16b_bf16 v[248:251], v[130:131], v[130:131], v[248:251]
    v_mfma_f32_32x32x16_bf16 v[200:215], a[232:235], v[124:127], v[200:215]
    s_nop 0
    v_mfma_f32_4x4x4_16b_bf16 v[248:251], v[132:133], v[132:133], v[248:251]
    v_mfma_f32_16x16x32_bf16 v[244:247], v[96:99], v[132:135], v[244:247]
    v_mfma_f32_32x32x16_bf16 v[216:231], v[124:127], a[236:239], v[216:231]
    v_mfma_f32_4x4x4_16b_bf16 v[248:251], v[134:135], v[134:135], v[248:251]
    s_lshl2_add_u32 s44, s2, s28
    s_mul_i32 s45, s44, 1792
    v_min_u32 v67, 13, v1
    v_lshl_add_u32 v67, v67, 7, s45
    s_lshl_b32 s44, s44, 9
    v_and_b32 v68, 3, v1
    v_lshl_add_u32 v68, v68, 7, s44
    s_mov_b64 exec, 0xffff
    global_load_dword v76, v67, s[16:17]
    s_mov_b64 exec, -1
    v_mfma_f32_32x32x16_bf16 v[200:215], a[240:243], v[128:131], v[200:215]
    s_mov_b32 vcc_lo, 0xaaaaaaaa
    s_mov_b32 vcc_hi, 0xaaaaaaaa
    v_cndmask_b32 v72, v248, v249, vcc
    v_cndmask_b32 v73, v250, v251, vcc
    s_mov_b32 vcc_lo, 0xcccccccc
    s_mov_b32 vcc_hi, 0xcccccccc
    v_cndmask_b32 v71, v72, v73, vcc
    v_cndmask_b32 v72, v72, v73, vcc
    v_mul_f32 v70, 0xbb000000, v244
    s_nop 0
    v_permlane32_swap_b32 v71, v72
    v_add_f32 v71, v71, v72
    v_mul_f32 v72, v70, v70
    v_mfma_f32_32x32x16_bf16 v[216:231], v[128:131], a[244:247], v[216:231]
    v_mul_f32 v71, 0x3b000000, v71
    v_sub_f32 v71, v71, v72
    v_max_f32 v71, 0, v71
    v_add_f32 v72, 0x3727c5ac, v71
    v_rsq_f32 v26, v72
    v_cvt_pk_bf16_f32 v73, v70, v70
    v_mfma_f32_32x32x16_bf16 v[200:215], a[248:251], v[132:135], v[200:215]
    v_lshlrev_b32 v73, 16, v73
    v_sub_f32 v73, v70, v73
    v_mul_f32 v73, v73, v8
    v_cvt_pk_bf16_f32 v18, v70, v73
    v_mul_f32 v27, 0x3eb8aa3b, v26
    v_mfma_f32_32x32x16_bf16 v[216:231], v[132:135], a[252:255], v[216:231]
    ds_read_b128 v[232:235], v9 offset:24576
    v_mfma_f32_32x32x16_bf16 v[200:215], v[38:41], v[18:21], v[200:215]
    v_lshl_add_u32 v67, v3, 2, s36
    ds_write_b32 v67, v26 offset:16384
    v_mfma_f32_32x32x16_bf16 v[216:231], v[16:19], v[38:41], v[216:231]
    s_add_u32 s44, s101, 1572864
    v_add_u32 v63, s44, v2
    ds_read_b128 v[78:81], v10 offset:16384
    ds_read_b128 v[82:85], v10 offset:16416
    s_nop 4
    v_pk_mul_f32 v[208:209], v[208:209], v[26:27] op_sel:[0,0] op_sel_hi:[1,0]
    v_pk_mul_f32 v[210:211], v[210:211], v[26:27] op_sel:[0,0] op_sel_hi:[1,0]
    v_pk_mul_f32 v[212:213], v[212:213], v[26:27] op_sel:[0,0] op_sel_hi:[1,0]
    v_pk_mul_f32 v[214:215], v[214:215], v[26:27] op_sel:[0,0] op_sel_hi:[1,0]
    v_cvt_pk_bf16_f32 v208, v208, v209
    v_cvt_pk_bf16_f32 v209, v210, v211
    v_cvt_pk_bf16_f32 v210, v212, v213
    v_cvt_pk_bf16_f32 v211, v214, v215
    ds_write_b128 v9, v[208:211] offset:16384
    v_cndmask_b32 v216, v224, v216, s[42:43]
    v_cndmask_b32 v217, v225, v217, s[42:43]
    v_cndmask_b32 v218, v226, v218, s[42:43]
    v_cndmask_b32 v219, v227, v219, s[42:43]
    v_cndmask_b32 v220, v228, v220, s[42:43]
    v_cndmask_b32 v221, v229, v221, s[42:43]
    v_cndmask_b32 v222, v230, v222, s[42:43]
    v_cndmask_b32 v223, v231, v223, s[42:43]
    v_mov_b32 v215, s52
    v_mov_b32 v212, v211
    v_mov_b32 v211, s52
    v_mov_b32 v214, s52
    global_store_dwordx4 v63, v[208:211], s[24:25] sc1
    s_waitcnt lgkmcnt(1)
    v_pk_mul_f32 v[216:217], v[216:217], v[78:79]
    v_pk_mul_f32 v[218:219], v[218:219], v[80:81]
    v_pk_mul_f32 v[220:221], v[220:221], v[82:83]
    v_pk_mul_f32 v[222:223], v[222:223], v[84:85]
    v_cvt_pk_bf16_f32 v216, v216, v217
    v_cvt_pk_bf16_f32 v217, v218, v219
    v_cvt_pk_bf16_f32 v218, v220, v221
    v_cvt_pk_bf16_f32 v219, v222, v223
    ds_write_b128 v9, v[216:219] offset:17408
    v_mov_b32 v213, v219
    global_store_dwordx4 v63, v[212:215], s[24:25] offset:2048 sc1
    v_mov_b32 v219, s52
    global_store_dwordx4 v63, v[216:219], s[24:25] offset:1024 sc1
    s_waitcnt vmcnt(4)
    s_mov_b32 s51, 0
.hchk_1:
    v_bitop3_b32 v87, v139, v143, v147 bitop3:0x7e
    v_bitop3_b32 v87, v139, s52, v87 bitop3:0xbe
    v_mov_b32 v139, v144
    v_cmp_ne_u32 vcc, 0, v87
    v_mov_b32 v143, v145
    s_cbranch_vccnz .hrt_2
.hok_3:
    ds_write_b128 v9, v[136:139] offset:8192
    ds_write_b128 v9, v[140:143] offset:9216
    v_mfma_f32_32x32x16_bf16 v[184:199], v[232:235], v[54:57], 0
    v_mov_b32 v254, 0xf149f2ca
    v_mov_b32 v244, s38
    v_mov_b32 v245, s38
    v_mov_b32 v246, s38
    v_mov_b32 v247, s38
    v_mov_b32 v248, s38
    v_mov_b32 v249, s38
    v_mov_b32 v250, s38
    v_mov_b32 v251, s38
    s_lshl_b32 s44, s26, 5
    s_add_u32 s44, s44, s27
    s_lshl_b32 s44, s44, 5
    s_add_u32 s44, s44, s28
    s_lshl_b32 s44, s44, 2
    s_add_u32 s44, s44, 131072
    v_mov_b32 v68, s44
    s_and_b32 s44, s31, -8
    s_or_b32 s44, s44, s3
    v_mov_b32 v67, s44
    global_store_dword v68, v67, s[24:25] sc1
    s_waitcnt lgkmcnt(0)
    s_barrier
    ds_read_b128 v[236:239], v9 offset:22528
    ds_read_b128 v[240:243], v9 offset:20480
    ds_read_b128 v[232:235], v9 offset:18432
    v_mov_b32 v78, s38
    v_mov_b32 v79, s38
    v_mov_b32 v80, s38
    v_mov_b32 v81, s38
    v_mov_b32 v82, s38
    v_mov_b32 v83, s38
    v_mov_b32 v84, s38
    v_mov_b32 v85, s38
    s_mov_b64 exec, s[42:43]
    ds_read_b128 v[244:247], v9 offset:25600
    ds_read_b128 v[248:251], v9 offset:25856
    s_mov_b64 exec, -1
    s_mov_b64 exec, s[42:43]
    ds_read_b128 v[78:81], v9 offset:9216
    ds_read_b128 v[82:85], v9 offset:9472
    s_mov_b64 exec, -1
    v_pk_mul_f32 v[200:201], v[200:201], v[26:27] op_sel:[0,1] op_sel_hi:[1,1]
    v_pk_mul_f32 v[202:203], v[202:203], v[26:27] op_sel:[0,1] op_sel_hi:[1,1]
    v_pk_mul_f32 v[204:205], v[204:205], v[26:27] op_sel:[0,1] op_sel_hi:[1,1]
    v_pk_mul_f32 v[206:207], v[206:207], v[26:27] op_sel:[0,1] op_sel_hi:[1,1]
    v_cvt_pk_bf16_f32 v58, v200, v201
    v_cvt_pk_bf16_f32 v59, v202, v203
    v_cvt_pk_bf16_f32 v60, v204, v205
    v_cvt_pk_bf16_f32 v61, v206, v207
    s_waitcnt lgkmcnt(6)
    v_mfma_f32_32x32x16_bf16 v[168:183], v[236:239], v[54:57], 0
    ds_read_b128 v[236:239], v9 offset:16384
    s_waitcnt lgkmcnt(6)
    v_mfma_f32_32x32x16_bf16 v[152:167], v[240:243], v[54:57], 0
    ds_read_b128 v[240:243], v9 offset:8192
    v_mov_b32 v252, v254
    s_waitcnt lgkmcnt(6)
    v_mfma_f32_32x32x16_bf16 v[200:215], v[232:235], v[54:57], 0
    ds_read_b128 v[232:235], v9 offset:14336
    s_nop 3
    v_max3_f32 v252, v168, v169, v252
    v_max3_f32 v252, v170, v171, v252
    v_max3_f32 v252, v172, v173, v252
    v_max3_f32 v252, v174, v175, v252
    v_max3_f32 v252, v176, v177, v252
    v_max3_f32 v252, v178, v179, v252
    v_max3_f32 v252, v180, v181, v252
    v_max3_f32 v252, v182, v183, v252
    s_waitcnt lgkmcnt(2)
    v_mfma_f32_32x32x16_bf16 v[168:183], v[236:239], v[54:57], 0
    ds_read_b128 v[236:239], v9 offset:12288
    s_lshl2_add_u32 s44, s28, s96
    s_lshl_b32 s44, s44, 15
    s_add_u32 m0, s50, 0
    v_add_u32 v67, s44, v66
    global_load_lds_dwordx4 v67, s[8:9] offset:-2048
    global_load_lds_dwordx4 v67, s[8:9] offset:2048
    v_max3_f32 v252, v152, v153, v252
    v_max3_f32 v252, v154, v155, v252
    v_max3_f32 v252, v156, v157, v252
    v_max3_f32 v252, v158, v159, v252
    v_max3_f32 v252, v160, v161, v252
    v_max3_f32 v252, v162, v163, v252
    v_max3_f32 v252, v164, v165, v252
    v_max3_f32 v252, v166, v167, v252
    s_waitcnt lgkmcnt(2)
    v_mfma_f32_32x32x16_bf16 v[152:167], v[240:243], v[54:57], 0
    ds_read_b128 v[240:243], v9 offset:10240
    v_max3_f32 v252, v200, v201, v252
    v_max3_f32 v252, v202, v203, v252
    v_max3_f32 v252, v204, v205, v252
    v_max3_f32 v252, v206, v207, v252
    v_max3_f32 v252, v208, v209, v252
    v_max3_f32 v252, v210, v211, v252
    v_max3_f32 v252, v212, v213, v252
    v_max3_f32 v252, v214, v215, v252
    s_waitcnt lgkmcnt(2)
    v_mfma_f32_32x32x16_bf16 v[200:215], v[232:235], v[54:57], 0
    ds_read_b128 v[232:235], v9 offset:22528
    v_max3_f32 v252, v168, v169, v252
    v_max3_f32 v252, v170, v171, v252
    v_max3_f32 v252, v172, v173, v252
    v_max3_f32 v252, v174, v175, v252
    v_max3_f32 v252, v176, v177, v252
    v_max3_f32 v252, v178, v179, v252
    v_max3_f32 v252, v180, v181, v252
    v_max3_f32 v252, v182, v183, v252
    s_waitcnt lgkmcnt(2)
    v_mfma_f32_32x32x16_bf16 v[168:183], v[236:239], v[54:57], 0
    ds_read_b128 v[236:239], v9 offset:20480
    s_lshl2_add_u32 s44, s28, s96
    s_lshl_b32 s44, s44, 15
    s_add_u32 s44, s44, 16384
    s_add_u32 m0, s50, 1024
    v_add_u32 v67, s44, v66
    global_load_lds_dwordx4 v67, s[8:9] offset:-2048
    global_load_lds_dwordx4 v67, s[8:9] offset:2048
    s_cmp_eq_u32 s26, 0
    s_cbranch_scc1 .g0_4
.g0r_5:
    v_cndmask_b32 v184, v152, v184, s[64:65]
    v_cndmask_b32 v185, v153, v185, s[66:67]
    v_cndmask_b32 v186, v154, v186, s[68:69]
    v_cndmask_b32 v187, v155, v187, s[70:71]
    v_cndmask_b32 v188, v156, v188, s[72:73]
    v_cndmask_b32 v189, v157, v189, s[74:75]
    v_cndmask_b32 v190, v158, v190, s[76:77]
    v_cndmask_b32 v191, v159, v191, s[78:79]
    v_cndmask_b32 v192, v160, v192, s[80:81]
    v_cndmask_b32 v193, v161, v193, s[82:83]
    v_cndmask_b32 v194, v162, v194, s[84:85]
    v_cndmask_b32 v195, v163, v195, s[86:87]
    v_cndmask_b32 v196, v164, v196, s[88:89]
    v_cndmask_b32 v197, v165, v197, s[90:91]
    v_cndmask_b32 v198, v166, v198, s[92:93]
    v_cndmask_b32 v199, v167, v199, s[94:95]
    s_waitcnt lgkmcnt(2)
    v_mfma_f32_32x32x16_bf16 v[152:167], v[240:243], v[54:57], 0
    ds_read_b128 v[240:243], v9 offset:18432
    v_max3_f32 v252, v184, v185, v252
    v_max3_f32 v252, v186, v187, v252
    v_max3_f32 v252, v188, v189, v252
    v_max3_f32 v252, v190, v191, v252
    v_max3_f32 v252, v192, v193, v252
    v_max3_f32 v252, v194, v195, v252
    v_max3_f32 v252, v196, v197, v252
    v_max3_f32 v252, v198, v199, v252
    s_cmp_ge_i32 s56, 3
    s_cbranch_scc1 .sk_6
    v_max3_f32 v252, v200, v201, v252
    v_max3_f32 v252, v202, v203, v252
    v_max3_f32 v252, v204, v205, v252
    v_max3_f32 v252, v206, v207, v252
    v_max3_f32 v252, v208, v209, v252
    v_max3_f32 v252, v210, v211, v252
    v_max3_f32 v252, v212, v213, v252
    v_max3_f32 v252, v214, v215, v252
.skr_7:
    s_cmp_ge_i32 s56, 2
    s_cbranch_scc1 .sk_8
    v_max3_f32 v252, v168, v169, v252
    v_max3_f32 v252, v170, v171, v252
    v_max3_f32 v252, v172, v173, v252
    v_max3_f32 v252, v174, v175, v252
    v_max3_f32 v252, v176, v177, v252
    v_max3_f32 v252, v178, v179, v252
    v_max3_f32 v252, v180, v181, v252
    v_max3_f32 v252, v182, v183, v252
.skr_9:
    s_cmp_ge_i32 s56, 1
    s_cbranch_scc1 .sk_10
    v_max3_f32 v252, v152, v153, v252
    v_max3_f32 v252, v154, v155, v252
    v_max3_f32 v252, v156, v157, v252
    v_max3_f32 v252, v158, v159, v252
    v_max3_f32 v252, v160, v161, v252
    v_max3_f32 v252, v162, v163, v252
    v_max3_f32 v252, v164, v165, v252
    v_max3_f32 v252, v166, v167, v252
.skr_11:
    v_accvgpr_read_b32 v65, a220
    s_add_u32 m0, s50, 0x2000
    v_add_u32 v65, 229376, v65
    global_load_lds_dwordx4 v65, s[12:13]
    v_mov_b32 v255, v252
    s_nop 1
    v_permlane32_swap_b32 v252, v255
    v_min_f32 v252, -v252, -v255
    v_pk_mov_b32 v[168:169], v[252:253], v[252:253] op_sel:[0,0]
    v_pk_mov_b32 v[170:171], v[252:253], v[252:253] op_sel:[0,0]
    v_pk_mov_b32 v[172:173], v[252:253], v[252:253] op_sel:[0,0]
    v_pk_mov_b32 v[174:175], v[252:253], v[252:253] op_sel:[0,0]
    v_pk_mov_b32 v[176:177], v[252:253], v[252:253] op_sel:[0,0]
    v_pk_mov_b32 v[178:179], v[252:253], v[252:253] op_sel:[0,0]
    v_pk_mov_b32 v[180:181], v[252:253], v[252:253] op_sel:[0,0]
    v_pk_mov_b32 v[182:183], v[252:253], v[252:253] op_sel:[0,0]
    v_pk_add_f32 v[184:185], v[184:185], v[252:253] op_sel_hi:[1,0]
    v_pk_add_f32 v[186:187], v[186:187], v[252:253] op_sel_hi:[1,0]
    v_pk_add_f32 v[188:189], v[188:189], v[252:253] op_sel_hi:[1,0]
    v_pk_add_f32 v[190:191], v[190:191], v[252:253] op_sel_hi:[1,0]
    v_pk_add_f32 v[192:193], v[192:193], v[252:253] op_sel_hi:[1,0]
    v_pk_add_f32 v[194:195], v[194:195], v[252:253] op_sel_hi:[1,0]
    v_pk_add_f32 v[196:197], v[196:197], v[252:253] op_sel_hi:[1,0]
    v_pk_add_f32 v[198:199], v[198:199], v[252:253] op_sel_hi:[1,0]
    s_waitcnt lgkmcnt(2)
    v_mfma_f32_32x32x16_bf16 v[200:215], v[232:235], v[54:57], v[168:183]
    ds_read_b128 v[232:235], v9 offset:16384
    v_exp_f32 v184, v184
    v_exp_f32 v185, v185
    v_exp_f32 v186, v186
    v_exp_f32 v187, v187
    v_cvt_pk_bf16_f32 v184, v184, v185
    v_exp_f32 v188, v188
    v_accvgpr_read_b32 v65, a221
    s_add_u32 m0, s50, 0x2400
    v_add_u32 v65, 229376, v65
    global_load_lds_dwordx4 v65, s[12:13]
    v_exp_f32 v189, v189
    v_cvt_pk_bf16_f32 v185, v186, v187
    v_exp_f32 v190, v190
    v_exp_f32 v191, v191
    v_cvt_pk_bf16_f32 v186, v188, v189
    v_exp_f32 v192, v192
    v_exp_f32 v193, v193
    v_cvt_pk_bf16_f32 v187, v190, v191
    v_exp_f32 v194, v194
    v_exp_f32 v195, v195
    v_cvt_pk_bf16_f32 v188, v192, v193
    v_exp_f32 v196, v196
    v_exp_f32 v197, v197
    v_cvt_pk_bf16_f32 v189, v194, v195
    v_exp_f32 v198, v198
    v_exp_f32 v199, v199
    v_cvt_pk_bf16_f32 v190, v196, v197
    v_cvt_pk_bf16_f32 v191, v198, v199
    v_and_b32 v192, v184, v46
    v_and_b32 v193, v185, v47
    v_and_b32 v194, v186, v48
    v_and_b32 v195, v187, v49
    v_and_b32 v196, v188, v50
    v_and_b32 v197, v189, v51
    v_and_b32 v198, v190, v52
    v_and_b32 v199, v191, v53
    v_xor_b32 v184, v184, v192
    v_xor_b32 v185, v185, v193
    v_mfma_f32_32x32x16_bf16 v[216:231], v[244:247], v[192:195], 0
    v_xor_b32 v186, v186, v194
    v_xor_b32 v187, v187, v195
    v_xor_b32 v188, v188, v196
    v_xor_b32 v189, v189, v197
    v_xor_b32 v190, v190, v198
    v_xor_b32 v191, v191, v199
    v_mfma_f32_32x32x16_bf16 v[216:231], v[248:251], v[196:199], v[216:231]
    s_mov_b64 exec, s[42:43]
    ds_read_b128 v[244:247], v9 offset:23552
    ds_read_b128 v[248:251], v9 offset:23808
    s_mov_b64 exec, -1
    v_exp_f32 v200, v200
    v_exp_f32 v201, v201
    v_exp_f32 v202, v202
    v_exp_f32 v203, v203
    v_mfma_f32_32x32x16_bf16 v[216:231], v[78:81], v[184:187], v[216:231]
    v_cvt_pk_bf16_f32 v200, v200, v201
    v_exp_f32 v204, v204
    v_exp_f32 v205, v205
    v_cvt_pk_bf16_f32 v201, v202, v203
    v_exp_f32 v206, v206
    v_mfma_f32_32x32x16_bf16 v[216:231], v[82:85], v[188:191], v[216:231]
    s_mov_b64 exec, s[42:43]
    ds_read_b128 v[78:81], v9 offset:21504
    ds_read_b128 v[82:85], v9 offset:21760
    s_mov_b64 exec, -1
    v_exp_f32 v207, v207
    v_cvt_pk_bf16_f32 v202, v204, v205
    v_exp_f32 v208, v208
    v_exp_f32 v209, v209
    v_cvt_pk_bf16_f32 v203, v206, v207
    s_waitcnt lgkmcnt(6)
    v_mfma_f32_32x32x16_bf16 v[184:199], v[236:239], v[54:57], v[168:183]
    ds_read_b128 v[236:239], v9 offset:14336
    s_waitcnt vmcnt(4)
    ds_read_b64_tr_b16 a[224:225], v75 offset:0
    ds_read_b64_tr_b16 a[226:227], v75 offset:256
    ds_read_b64_tr_b16 a[228:229], v75 offset:512
    ds_read_b64_tr_b16 a[230:231], v75 offset:768
    v_accvgpr_read_b32 v65, a218
    s_add_u32 m0, s50, 0x1800
    v_add_u32 v65, 229376, v65
    global_load_lds_dwordx4 v65, s[12:13]
    v_exp_f32 v210, v210
    v_exp_f32 v211, v211
    v_cvt_pk_bf16_f32 v204, v208, v209
    v_exp_f32 v212, v212
    v_exp_f32 v213, v213
    v_accvgpr_read_b32 v65, a222
    s_add_u32 m0, s50, 0x2800
    v_add_u32 v65, 229376, v65
    global_load_lds_dwordx4 v65, s[12:13]
    v_cvt_pk_bf16_f32 v205, v210, v211
    v_exp_f32 v214, v214
    v_exp_f32 v215, v215
    v_cvt_pk_bf16_f32 v206, v212, v213
    v_cvt_pk_bf16_f32 v207, v214, v215
    s_waitcnt lgkmcnt(7)
    v_mfma_f32_32x32x16_bf16 v[216:231], v[244:247], v[200:203], v[216:231]
    v_exp_f32 v184, v184
    v_exp_f32 v185, v185
    v_exp_f32 v186, v186
    v_exp_f32 v187, v187
    v_mfma_f32_32x32x16_bf16 v[216:231], v[248:251], v[204:207], v[216:231]
    s_mov_b64 exec, s[42:43]
    ds_read_b128 v[244:247], v9 offset:19456
    ds_read_b128 v[248:251], v9 offset:19712
    s_mov_b64 exec, -1
    v_cvt_pk_bf16_f32 v184, v184, v185
    v_exp_f32 v188, v188
    v_exp_f32 v189, v189
    v_cvt_pk_bf16_f32 v185, v186, v187
    v_exp_f32 v190, v190
    v_mfma_f32_32x32x16_bf16 v[200:215], v[240:243], v[54:57], v[168:183]
    ds_read_b128 v[240:243], v9 offset:12288
    v_exp_f32 v191, v191
    v_cvt_pk_bf16_f32 v186, v188, v189
    v_exp_f32 v192, v192
    v_exp_f32 v193, v193
    v_cvt_pk_bf16_f32 v187, v190, v191
    s_waitcnt vmcnt(4)
    ds_read_b64_tr_b16 a[232:233], v75 offset:1024
    ds_read_b64_tr_b16 a[234:235], v75 offset:1280
    ds_read_b64_tr_b16 a[236:237], v75 offset:1536
    ds_read_b64_tr_b16 a[238:239], v75 offset:1792
    v_accvgpr_read_b32 v65, a219
    s_add_u32 m0, s50, 0x1c00
    v_add_u32 v65, 229376, v65
    global_load_lds_dwordx4 v65, s[12:13]
    v_exp_f32 v194, v194
    v_exp_f32 v195, v195
    v_cvt_pk_bf16_f32 v188, v192, v193
    v_exp_f32 v196, v196
    v_exp_f32 v197, v197
    v_cvt_pk_bf16_f32 v189, v194, v195
    v_exp_f32 v198, v198
    v_exp_f32 v199, v199
    v_cvt_pk_bf16_f32 v190, v196, v197
    v_cvt_pk_bf16_f32 v191, v198, v199
    s_waitcnt lgkmcnt(12)
    v_mfma_f32_32x32x16_bf16 v[216:231], v[78:81], v[184:187], v[216:231]
    v_exp_f32 v200, v200
    v_exp_f32 v201, v201
    v_exp_f32 v202, v202
    v_exp_f32 v203, v203
    v_mfma_f32_32x32x16_bf16 v[216:231], v[82:85], v[188:191], v[216:231]
    s_mov_b64 exec, s[42:43]
    ds_read_b128 v[78:81], v9 offset:17408
    ds_read_b128 v[82:85], v9 offset:17664
    s_mov_b64 exec, -1
    v_cvt_pk_bf16_f32 v200, v200, v201
    v_exp_f32 v204, v204
    v_exp_f32 v205, v205
    v_cvt_pk_bf16_f32 v201, v202, v203
    v_exp_f32 v206, v206
    v_mfma_f32_32x32x16_bf16 v[184:199], v[232:235], v[54:57], v[168:183]
    ds_read_b128 v[232:235], v9 offset:10240
    v_exp_f32 v207, v207
    v_cvt_pk_bf16_f32 v202, v204, v205
    v_exp_f32 v208, v208
    v_exp_f32 v209, v209
    v_cvt_pk_bf16_f32 v203, v206, v207
    v_accvgpr_read_b32 v65, a223
    s_add_u32 m0, s50, 0x2c00
    v_add_u32 v65, 229376, v65
    global_load_lds_dwordx4 v65, s[12:13]
    s_cmp_eq_u32 s26, 0
    s_cselect_b32 s44, 0, 3145728
    s_sub_u32 s44, s101, s44
    s_add_u32 s44, s44, 1572864
    v_add_u32 v86, s44, v2
    global_load_dwordx4 v[120:123], v86, s[24:25] offset:0 sc1
    global_load_dwordx4 v[124:127], v86, s[24:25] offset:1024 sc1
    global_load_dwordx4 v[128:131], v86, s[24:25] offset:2048 sc1
    v_exp_f32 v210, v210
    v_exp_f32 v211, v211
    v_cvt_pk_bf16_f32 v204, v208, v209
    v_exp_f32 v212, v212
    v_exp_f32 v213, v213
    s_lshl2_add_u32 s44, s28, s97
    s_lshl_b32 s44, s44, 15
    s_add_u32 m0, s50, 2048
    v_add_u32 v67, s44, v66
    global_load_lds_dwordx4 v67, s[8:9] offset:-2048
    global_load_lds_dwordx4 v67, s[8:9] offset:2048
    v_cvt_pk_bf16_f32 v205, v210, v211
    v_exp_f32 v214, v214
    v_exp_f32 v215, v215
    v_cvt_pk_bf16_f32 v206, v212, v213
    v_cvt_pk_bf16_f32 v207, v214, v215
    s_waitcnt lgkmcnt(8)
    v_mfma_f32_32x32x16_bf16 v[216:231], v[244:247], v[200:203], v[216:231]
    v_exp_f32 v184, v184
    v_exp_f32 v185, v185
    v_exp_f32 v186, v186
    v_exp_f32 v187, v187
    v_mfma_f32_32x32x16_bf16 v[216:231], v[248:251], v[204:207], v[216:231]
    s_mov_b64 exec, s[42:43]
    ds_read_b128 v[244:247], v9 offset:15360
    ds_read_b128 v[248:251], v9 offset:15616
    s_mov_b64 exec, -1
    v_cvt_pk_bf16_f32 v184, v184, v185
    v_exp_f32 v188, v188
    v_exp_f32 v189, v189
    v_cvt_pk_bf16_f32 v185, v186, v187
    v_exp_f32 v190, v190
    s_cmp_eq_i32 s56, 3
    s_cbranch_scc1 .fix_12
.fixr_13:
    v_mfma_f32_32x32x16_bf16 v[200:215], v[236:239], v[54:57], v[168:183]
    ds_read_b128 v[236:239], v9 offset:16384
    v_exp_f32 v191, v191
    v_cvt_pk_bf16_f32 v186, v188, v189
    v_exp_f32 v192, v192
    v_exp_f32 v193, v193
    v_cvt_pk_bf16_f32 v187, v190, v191
    s_lshl2_add_u32 s44, s28, s97
    s_lshl_b32 s44, s44, 15
    s_add_u32 s44, s44, 16384
    s_add_u32 m0, s50, 3072
    v_add_u32 v67, s44, v66
    global_load_lds_dwordx4 v67, s[8:9] offset:-2048
    global_load_lds_dwordx4 v67, s[8:9] offset:2048
    v_exp_f32 v194, v194
    v_exp_f32 v195, v195
    v_cvt_pk_bf16_f32 v188, v192, v193
    v_exp_f32 v196, v196
    v_exp_f32 v197, v197
    s_lshl2_add_u32 s44, s28, s98
    s_lshl_b32 s44, s44, 15
    s_add_u32 m0, s53, 141312
    v_add_u32 v67, s44, v66
    global_load_lds_dwordx4 v67, s[8:9] offset:-2048
    global_load_lds_dwordx4 v67, s[8:9] offset:2048
    v_cvt_pk_bf16_f32 v189, v194, v195
    v_exp_f32 v198, v198
    v_exp_f32 v199, v199
    v_cvt_pk_bf16_f32 v190, v196, v197
    v_cvt_pk_bf16_f32 v191, v198, v199
    s_waitcnt lgkmcnt(4)
    v_mfma_f32_32x32x16_bf16 v[216:231], v[78:81], v[184:187], v[216:231]
    v_exp_f32 v200, v200
    v_exp_f32 v201, v201
    v_exp_f32 v202, v202
    v_exp_f32 v203, v203
    v_mfma_f32_32x32x16_bf16 v[216:231], v[82:85], v[188:191], v[216:231]
    s_mov_b64 exec, s[42:43]
    ds_read_b128 v[78:81], v9 offset:13312
    ds_read_b128 v[82:85], v9 offset:13568
    s_mov_b64 exec, -1
    v_cvt_pk_bf16_f32 v200, v200, v201
    v_exp_f32 v204, v204
    v_exp_f32 v205, v205
    v_cvt_pk_bf16_f32 v201, v202, v203
    v_exp_f32 v206, v206
    s_cmp_eq_i32 s56, 2
    s_cbranch_scc1 .fix_14
.fixr_15:
    v_mfma_f32_32x32x16_bf16 v[184:199], v[240:243], v[54:57], v[168:183]
    ds_read_b128 v[240:243], v9 offset:14336
    v_exp_f32 v207, v207
    v_cvt_pk_bf16_f32 v202, v204, v205
    v_exp_f32 v208, v208
    v_exp_f32 v209, v209
    v_cvt_pk_bf16_f32 v203, v206, v207
    s_lshl2_add_u32 s44, s28, s98
    s_lshl_b32 s44, s44, 15
    s_add_u32 s44, s44, 16384
    s_add_u32 m0, s53, 149504
    v_add_u32 v67, s44, v66
    global_load_lds_dwordx4 v67, s[8:9] offset:-2048
    global_load_lds_dwordx4 v67, s[8:9] offset:2048
    s_lshl_b32 s44, s26, 12
    s_add_u32 s44, s44, 131072
    v_lshl_add_u32 v69, v3, 7, s44
    global_load_dwordx4 v[148:151], v69, s[24:25] sc1
    v_exp_f32 v210, v210
    v_exp_f32 v211, v211
    v_cvt_pk_bf16_f32 v204, v208, v209
    v_exp_f32 v212, v212
    v_exp_f32 v213, v213
    s_lshl2_add_u32 s44, s28, s99
    s_lshl_b32 s44, s44, 15
    s_add_u32 m0, s53, 157696
    v_add_u32 v67, s44, v66
    global_load_lds_dwordx4 v67, s[8:9] offset:-2048
    global_load_lds_dwordx4 v67, s[8:9] offset:2048
    v_cvt_pk_bf16_f32 v205, v210, v211
    v_exp_f32 v214, v214
    v_exp_f32 v215, v215
    v_cvt_pk_bf16_f32 v206, v212, v213
    v_cvt_pk_bf16_f32 v207, v214, v215
    s_waitcnt lgkmcnt(4)
    v_mfma_f32_32x32x16_bf16 v[216:231], v[244:247], v[200:203], v[216:231]
    v_exp_f32 v184, v184
    v_exp_f32 v185, v185
    v_exp_f32 v186, v186
    v_exp_f32 v187, v187
    v_mfma_f32_32x32x16_bf16 v[216:231], v[248:251], v[204:207], v[216:231]
    s_mov_b64 exec, s[42:43]
    ds_read_b128 v[244:247], v9 offset:11264
    ds_read_b128 v[248:251], v9 offset:11520
    s_mov_b64 exec, -1
    v_cvt_pk_bf16_f32 v184, v184, v185
    v_exp_f32 v188, v188
    v_exp_f32 v189, v189
    v_cvt_pk_bf16_f32 v185, v186, v187
    v_exp_f32 v190, v190
    s_cmp_eq_i32 s56, 1
    s_cbranch_scc1 .fix_16
.fixr_17:
    v_mfma_f32_32x32x16_bf16 v[200:215], v[232:235], v[54:57], v[168:183]
    ds_read_b128 v[232:235], v9 offset:12288
    v_exp_f32 v191, v191
    v_cvt_pk_bf16_f32 v186, v188, v189
    v_exp_f32 v192, v192
    v_exp_f32 v193, v193
    v_cvt_pk_bf16_f32 v187, v190, v191
    s_lshl2_add_u32 s44, s28, s99
    s_lshl_b32 s44, s44, 15
    s_add_u32 s44, s44, 16384
    s_add_u32 m0, s50, 0
    v_add_u32 v67, s44, v66
    global_load_lds_dwordx4 v67, s[8:9] offset:-2048
    global_load_lds_dwordx4 v67, s[8:9] offset:2048
    v_exp_f32 v194, v194
    v_exp_f32 v195, v195
    v_cvt_pk_bf16_f32 v188, v192, v193
    v_exp_f32 v196, v196
    v_exp_f32 v197, v197
    s_waitcnt vmcnt(11)
    ds_read_b64_tr_b16 a[240:241], v75 offset:2048
    ds_read_b64_tr_b16 a[242:243], v75 offset:2304
    ds_read_b64_tr_b16 a[244:245], v75 offset:2560
    ds_read_b64_tr_b16 a[246:247], v75 offset:2816
    s_lshl_b32 s44, s27, 2
    s_add_u32 s44, s44, s28
    s_lshl_b32 s44, s44, 7
    s_add_u32 s45, s44, s34
    s_add_u32 s45, s45, 1441792
    s_and_b32 s44, s44, 0x1fff
    s_add_u32 s44, s44, s35
    s_sub_u32 s44, s44, 4096
    v_mov_b32 v67, s44
    v_mov_b32 v68, s45
    v_cndmask_b32 v67, v67, v68, s[40:41]
    global_load_dword v76, v67, s[24:25]
    v_cvt_pk_bf16_f32 v189, v194, v195
    v_exp_f32 v198, v198
    v_exp_f32 v199, v199
    v_cvt_pk_bf16_f32 v190, v196, v197
    v_cvt_pk_bf16_f32 v191, v198, v199
    s_waitcnt lgkmcnt(8)
    v_mfma_f32_32x32x16_bf16 v[216:231], v[78:81], v[184:187], v[216:231]
    v_exp_f32 v200, v200
    v_exp_f32 v201, v201
    v_exp_f32 v202, v202
    v_exp_f32 v203, v203
    v_mfma_f32_32x32x16_bf16 v[216:231], v[82:85], v[188:191], v[216:231]
    s_mov_b64 exec, s[42:43]
    ds_read_b128 v[78:81], v9 offset:17408
    ds_read_b128 v[82:85], v9 offset:17664
    s_mov_b64 exec, -1
    v_cvt_pk_bf16_f32 v200, v200, v201
    v_exp_f32 v204, v204
    v_exp_f32 v205, v205
    v_cvt_pk_bf16_f32 v201, v202, v203
    v_exp_f32 v206, v206
    v_mfma_f32_32x32x16_bf16 v[184:199], v[236:239], v[58:61], 0
    ds_read_b128 v[236:239], v9 offset:10240
    v_exp_f32 v207, v207
    v_cvt_pk_bf16_f32 v202, v204, v205
    v_exp_f32 v208, v208
    v_exp_f32 v209, v209
    v_cvt_pk_bf16_f32 v203, v206, v207
    s_waitcnt lgkmcnt(10)
    v_mfma_f32_32x32x16_bf16 v[168:183], v[240:243], v[58:61], 0
    ds_read_b128 v[240:243], v9 offset:8192
    s_waitcnt vmcnt(10)
    ds_read_b64_tr_b16 a[248:249], v75 offset:3072
    ds_read_b64_tr_b16 a[250:251], v75 offset:3328
    ds_read_b64_tr_b16 a[252:253], v75 offset:3584
    ds_read_b64_tr_b16 a[254:255], v75 offset:3840
    s_and_b32 s44, s27, 1
    s_lshl_b32 s44, s44, 3
    s_mul_i32 s45, s27, 112
    v_add_u32 v67, s44, v3
    v_lshl_add_u32 v68, v67, 1, s45
    global_load_ushort v43, v68, s[14:15]
    v_add_u32 v68, 32, v67
    v_subrev_u32 v67, 24, v67
    v_min_u32 v67, v67, v68
    v_lshl_add_u32 v68, v67, 1, s45
    global_load_ushort v45, v68, s[14:15]
    v_exp_f32 v210, v210
    v_exp_f32 v211, v211
    v_cvt_pk_bf16_f32 v204, v208, v209
    v_exp_f32 v212, v212
    v_exp_f32 v213, v213
    s_waitcnt lgkmcnt(13)
    v_mfma_f32_32x32x16_bf16 v[216:231], v[244:247], v[200:203], v[216:231]
    s_waitcnt vmcnt(10)
    ds_read_b64_tr_b16 v[88:89], v77 offset:24576
    ds_read_b64_tr_b16 v[90:91], v77 offset:24832
    ds_read_b64_tr_b16 v[92:93], v77 offset:25088
    ds_read_b64_tr_b16 v[94:95], v77 offset:25344
    s_add_u32 s44, s46, 0
    s_add_u32 m0, s50, 1024
    v_add_u32 v67, s44, v66
    global_load_lds_dwordx4 v67, s[16:17] offset:-2048
    global_load_lds_dwordx4 v67, s[16:17] offset:2048
    v_cvt_pk_bf16_f32 v205, v210, v211
    v_exp_f32 v214, v214
    v_exp_f32 v215, v215
    v_cvt_pk_bf16_f32 v206, v212, v213
    v_cvt_pk_bf16_f32 v207, v214, v215
    s_nop 1
    v_mfma_f32_32x32x16_bf16 v[216:231], v[248:251], v[204:207], v[216:231]
    s_waitcnt lgkmcnt(15)
    v_mfma_f32_32x32x16_bf16 v[152:167], v[232:235], v[58:61], 0
    s_lshl_b32 s44, s27, 10
    s_add_u32 s44, s44, s62
    s_add_u32 s44, s44, 393216
    v_add_u32 v63, s44, v2
    s_mov_b32 s51, 0
.hchk_18:
    v_bitop3_b32 v87, v123, v127, v131 bitop3:0x7e
    v_bitop3_b32 v87, v123, s52, v87 bitop3:0xbe
    v_mov_b32 v123, v128
    v_cmp_ne_u32 vcc, 0, v87
    v_mov_b32 v127, v129
    s_cbranch_vccnz .hrt_19
.hok_20:
    ds_write_b128 v9, v[120:123] offset:0
    ds_write_b128 v9, v[124:127] offset:1024
    s_waitcnt vmcnt(9)
    s_mov_b32 s51, 0
.ichk_21:
    v_xor_b32 v67, s31, v148
    v_xor_b32 v149, s31, v149
    v_xor_b32 v150, s31, v150
    v_xor_b32 v151, s31, v151
    v_or3_b32 v67, v67, v149, v150
    v_or_b32 v67, v67, v151
    v_cmp_le_u32 vcc, 8, v67
    s_cbranch_vccnz .irt_22
.iok_23:
    v_and_b32 v67, 7, v148
    v_cmp_ne_u32 vcc, s3, v67
    s_nop 0
    s_cmp_eq_u32 vcc_lo, 0
    s_cselect_b32 s33, 1, 0
    v_rcp_f32 v252, v224
    s_nop 0
    v_mul_f32 v216, v216, v252
    v_mul_f32 v217, v217, v252
    v_mul_f32 v218, v218, v252
    v_mul_f32 v219, v219, v252
    v_mul_f32 v220, v220, v252
    v_mul_f32 v221, v221, v252
    v_mul_f32 v222, v222, v252
    v_mul_f32 v223, v223, v252
    v_cvt_pk_bf16_f32 v216, v216, v217
    v_cvt_pk_bf16_f32 v217, v218, v219
    v_cvt_pk_bf16_f32 v218, v220, v221
    v_cvt_pk_bf16_f32 v219, v222, v223
    v_or_b32 v216, 1, v216
    s_cmp_eq_u32 s33, 1
    s_cbranch_scc0 .slow_24
    global_store_dwordx4 v63, v[216:219], s[24:25]
.sten_25:
    s_waitcnt lgkmcnt(0)
    s_barrier
    ds_read_b128 v[232:235], v9 offset:0
    s_mov_b64 exec, s[42:43]
    ds_read_b128 v[244:247], v9 offset:1024
    ds_read_b128 v[248:251], v9 offset:1280
    s_mov_b64 exec, -1
    v_mov_b32 v252, v254
    v_mfma_f32_32x32x16_bf16 v[200:215], v[236:239], v[58:61], 0
    ds_read_b128 v[236:239], v9 offset:6144
    s_cmp_ge_i32 s57, 7
    s_cbranch_scc1 .sk_26
    v_max3_f32 v252, v168, v169, v252
    v_max3_f32 v252, v170, v171, v252
    v_max3_f32 v252, v172, v173, v252
    v_max3_f32 v252, v174, v175, v252
    v_max3_f32 v252, v176, v177, v252
    v_max3_f32 v252, v178, v179, v252
    v_max3_f32 v252, v180, v181, v252
    v_max3_f32 v252, v182, v183, v252
.skr_27:
    v_mfma_f32_32x32x16_bf16 v[168:183], v[240:243], v[58:61], 0
    ds_read_b128 v[240:243], v9 offset:4096
    ds_read_b64_tr_b16 v[96:97], v77 offset:32768
    ds_read_b64_tr_b16 v[98:99], v77 offset:33024
    ds_read_b64_tr_b16 v[100:101], v77 offset:33280
    ds_read_b64_tr_b16 v[102:103], v77 offset:33536
    s_add_u32 s44, s46, 16384
    s_add_u32 m0, s50, 2048
    v_add_u32 v67, s44, v66
    global_load_lds_dwordx4 v67, s[16:17] offset:-2048
    global_load_lds_dwordx4 v67, s[16:17] offset:2048
    s_cmp_ge_i32 s57, 6
    s_cbranch_scc1 .sk_28
    v_max3_f32 v252, v152, v153, v252
    v_max3_f32 v252, v154, v155, v252
    v_max3_f32 v252, v156, v157, v252
    v_max3_f32 v252, v158, v159, v252
    v_max3_f32 v252, v160, v161, v252
    v_max3_f32 v252, v162, v163, v252
    v_max3_f32 v252, v164, v165, v252
    v_max3_f32 v252, v166, v167, v252
.skr_29:
    s_waitcnt lgkmcnt(8)
    v_mfma_f32_32x32x16_bf16 v[152:167], v[232:235], v[58:61], 0
    ds_read_b128 v[232:235], v9 offset:2048
    s_waitcnt vmcnt(10)
    ds_read_b64_tr_b16 v[104:105], v77 offset:40960
    ds_read_b64_tr_b16 v[106:107], v77 offset:41216
    ds_read_b64_tr_b16 v[108:109], v77 offset:41472
    ds_read_b64_tr_b16 v[110:111], v77 offset:41728
    s_cmp_ge_i32 s57, 5
    s_cbranch_scc1 .sk_30
    v_max3_f32 v252, v200, v201, v252
    v_max3_f32 v252, v202, v203, v252
    v_max3_f32 v252, v204, v205, v252
    v_max3_f32 v252, v206, v207, v252
    v_max3_f32 v252, v208, v209, v252
    v_max3_f32 v252, v210, v211, v252
    v_max3_f32 v252, v212, v213, v252
    v_max3_f32 v252, v214, v215, v252
.skr_31:
    s_waitcnt lgkmcnt(10)
    v_mfma_f32_32x32x16_bf16 v[200:215], v[236:239], v[58:61], 0
    ds_read_b128 v[236:239], v9 offset:14336
    s_waitcnt vmcnt(8)
    ds_read_b64_tr_b16 v[112:113], v75 offset:0
    ds_read_b64_tr_b16 v[114:115], v75 offset:256
    ds_read_b64_tr_b16 v[116:117], v75 offset:512
    ds_read_b64_tr_b16 v[118:119], v75 offset:768
    s_add_u32 s44, s46, 32768
    s_add_u32 m0, s50, 3072
    v_add_u32 v67, s44, v66
    global_load_lds_dwordx4 v67, s[16:17] offset:-2048
    global_load_lds_dwordx4 v67, s[16:17] offset:2048
    s_cmp_ge_i32 s57, 4
    s_cbranch_scc1 .sk_32
    v_max3_f32 v252, v168, v169, v252
    v_max3_f32 v252, v170, v171, v252
    v_max3_f32 v252, v172, v173, v252
    v_max3_f32 v252, v174, v175, v252
    v_max3_f32 v252, v176, v177, v252
    v_max3_f32 v252, v178, v179, v252
    v_max3_f32 v252, v180, v181, v252
    v_max3_f32 v252, v182, v183, v252
.skr_33:
    s_waitcnt lgkmcnt(14)
    v_mfma_f32_32x32x16_bf16 v[168:183], v[240:243], v[58:61], 0
    ds_read_b128 v[240:243], v9 offset:12288
    s_cmp_eq_u32 s26, 0
    s_cbranch_scc1 .g0_34
.g0r_35:
    v_cndmask_b32 v184, v152, v184, s[64:65]
    v_cndmask_b32 v185, v153, v185, s[66:67]
    v_cndmask_b32 v186, v154, v186, s[68:69]
    v_cndmask_b32 v187, v155, v187, s[70:71]
    v_cndmask_b32 v188, v156, v188, s[72:73]
    v_cndmask_b32 v189, v157, v189, s[74:75]
    v_cndmask_b32 v190, v158, v190, s[76:77]
    v_cndmask_b32 v191, v159, v191, s[78:79]
    v_cndmask_b32 v192, v160, v192, s[80:81]
    v_cndmask_b32 v193, v161, v193, s[82:83]
    v_cndmask_b32 v194, v162, v194, s[84:85]
    v_cndmask_b32 v195, v163, v195, s[86:87]
    v_cndmask_b32 v196, v164, v196, s[88:89]
    v_cndmask_b32 v197, v165, v197, s[90:91]
    v_cndmask_b32 v198, v166, v198, s[92:93]
    v_cndmask_b32 v199, v167, v199, s[94:95]
    s_waitcnt lgkmcnt(10)
    v_mfma_f32_32x32x16_bf16 v[152:167], v[232:235], v[58:61], 0
    ds_read_b128 v[232:235], v9 offset:10240
    v_max3_f32 v252, v184, v185, v252
    v_max3_f32 v252, v186, v187, v252
    v_max3_f32 v252, v188, v189, v252
    v_max3_f32 v252, v190, v191, v252
    v_max3_f32 v252, v192, v193, v252
    v_max3_f32 v252, v194, v195, v252
    v_max3_f32 v252, v196, v197, v252
    v_max3_f32 v252, v198, v199, v252
    s_lshl2_add_u32 s44, s28, s96
    s_lshl_b32 s44, s44, 11
    s_add_u32 s44, s44, s32
    s_add_u32 s44, s44, 396288
    v_add_u32 v62, s44, v2
    global_load_dwordx4 v[132:135], v62, s[24:25] offset:-3072 sc1
    global_load_dwordx4 v[136:139], v62, s[24:25] offset:-2048 sc1
    s_lshl2_add_u32 s44, s28, s97
    s_lshl_b32 s44, s44, 11
    s_add_u32 s44, s44, s32
    s_add_u32 s44, s44, 396288
    v_add_u32 v62, s44, v2
    global_load_dwordx4 v[140:143], v62, s[24:25] offset:-3072 sc1
    s_cmp_ge_i32 s57, 3
    s_cbranch_scc1 .sk_36
    v_max3_f32 v252, v200, v201, v252
    v_max3_f32 v252, v202, v203, v252
    v_max3_f32 v252, v204, v205, v252
    v_max3_f32 v252, v206, v207, v252
    v_max3_f32 v252, v208, v209, v252
    v_max3_f32 v252, v210, v211, v252
    v_max3_f32 v252, v212, v213, v252
    v_max3_f32 v252, v214, v215, v252
.skr_37:
    s_add_u32 s44, s46, 49152
    s_add_u32 m0, s53, 141312
    v_add_u32 v67, s44, v66
    global_load_lds_dwordx4 v67, s[16:17] offset:-2048
    global_load_lds_dwordx4 v67, s[16:17] offset:2048
    global_load_dwordx4 v[144:147], v62, s[24:25] offset:-2048 sc1
    s_lshl2_add_u32 s44, s28, s98
    s_lshl_b32 s44, s44, 11
    s_add_u32 s44, s44, s32
    s_add_u32 s44, s44, 396288
    v_add_u32 v62, s44, v2
    global_load_dwordx4 v[120:123], v62, s[24:25] offset:-3072 sc1
    global_load_dwordx4 v[124:127], v62, s[24:25] offset:-2048 sc1
    s_cmp_ge_i32 s57, 2
    s_cbranch_scc1 .sk_38
    v_max3_f32 v252, v168, v169, v252
    v_max3_f32 v252, v170, v171, v252
    v_max3_f32 v252, v172, v173, v252
    v_max3_f32 v252, v174, v175, v252
    v_max3_f32 v252, v176, v177, v252
    v_max3_f32 v252, v178, v179, v252
    v_max3_f32 v252, v180, v181, v252
    v_max3_f32 v252, v182, v183, v252
.skr_39:
    s_waitcnt vmcnt(13)
    ds_read_b64_tr_b16 a[0:1], v75 offset:1024
    ds_read_b64_tr_b16 a[2:3], v75 offset:1280
    ds_read_b64_tr_b16 a[4:5], v75 offset:1536
    ds_read_b64_tr_b16 a[6:7], v75 offset:1792
    s_lshl2_add_u32 s44, s28, s99
    s_lshl_b32 s44, s44, 11
    s_add_u32 s44, s44, s32
    s_add_u32 s44, s44, 396288
    v_add_u32 v62, s44, v2
    global_load_dwordx4 v[128:131], v62, s[24:25] offset:-3072 sc1
    global_load_dwordx4 v[148:151], v62, s[24:25] offset:-2048 sc1
    s_cmp_ge_i32 s57, 1
    s_cbranch_scc1 .sk_40
    v_max3_f32 v252, v152, v153, v252
    v_max3_f32 v252, v154, v155, v252
    v_max3_f32 v252, v156, v157, v252
    v_max3_f32 v252, v158, v159, v252
    v_max3_f32 v252, v160, v161, v252
    v_max3_f32 v252, v162, v163, v252
    v_max3_f32 v252, v164, v165, v252
    v_max3_f32 v252, v166, v167, v252
.skr_41:
    v_mov_b32 v255, v252
    s_nop 1
    v_permlane32_swap_b32 v252, v255
    v_min_f32 v252, -v252, -v255
    v_pk_mov_b32 v[168:169], v[252:253], v[252:253] op_sel:[0,0]
    v_pk_mov_b32 v[170:171], v[252:253], v[252:253] op_sel:[0,0]
    v_pk_mov_b32 v[172:173], v[252:253], v[252:253] op_sel:[0,0]
    v_pk_mov_b32 v[174:175], v[252:253], v[252:253] op_sel:[0,0]
    v_pk_mov_b32 v[176:177], v[252:253], v[252:253] op_sel:[0,0]
    v_pk_mov_b32 v[178:179], v[252:253], v[252:253] op_sel:[0,0]
    v_pk_mov_b32 v[180:181], v[252:253], v[252:253] op_sel:[0,0]
    v_pk_mov_b32 v[182:183], v[252:253], v[252:253] op_sel:[0,0]
    v_pk_add_f32 v[184:185], v[184:185], v[252:253] op_sel_hi:[1,0]
    v_pk_add_f32 v[186:187], v[186:187], v[252:253] op_sel_hi:[1,0]
    v_pk_add_f32 v[188:189], v[188:189], v[252:253] op_sel_hi:[1,0]
    v_pk_add_f32 v[190:191], v[190:191], v[252:253] op_sel_hi:[1,0]
    v_pk_add_f32 v[192:193], v[192:193], v[252:253] op_sel_hi:[1,0]
    v_pk_add_f32 v[194:195], v[194:195], v[252:253] op_sel_hi:[1,0]
    v_pk_add_f32 v[196:197], v[196:197], v[252:253] op_sel_hi:[1,0]
    v_pk_add_f32 v[198:199], v[198:199], v[252:253] op_sel_hi:[1,0]
    s_cmp_eq_i32 s57, 7
    s_cbranch_scc1 .fix_42
.fixr_43:
    s_waitcnt lgkmcnt(10)
    v_mfma_f32_32x32x16_bf16 v[200:215], v[236:239], v[58:61], v[168:183]
    ds_read_b128 v[236:239], v9 offset:8192
    v_exp_f32 v184, v184
    v_exp_f32 v185, v185
    v_exp_f32 v186, v186
    v_exp_f32 v187, v187
    v_cvt_pk_bf16_f32 v184, v184, v185
    v_exp_f32 v188, v188
    s_add_u32 s44, s46, 65536
    s_add_u32 m0, s53, 149504
    v_add_u32 v67, s44, v66
    global_load_lds_dwordx4 v67, s[16:17] offset:-2048
    global_load_lds_dwordx4 v67, s[16:17] offset:2048
    v_exp_f32 v189, v189
    v_cvt_pk_bf16_f32 v185, v186, v187
    v_exp_f32 v190, v190
    v_exp_f32 v191, v191
    v_cvt_pk_bf16_f32 v186, v188, v189
    v_exp_f32 v192, v192
    v_exp_f32 v193, v193
    s_waitcnt vmcnt(6)
    v_bitop3_b32 v67, v132, v136, v140 bitop3:0x80
    v_bitop3_b32 v67, v67, v144, 1 bitop3:0x80
    v_cmp_eq_u32 vcc, 0, v67
    s_cbranch_vccnz .crt_44
.cok_46:
    v_mfma_f32_32x32x16_bf16 v[152:167], a[224:227], v[132:135], 0
    v_cvt_pk_bf16_f32 v187, v190, v191
    v_exp_f32 v194, v194
    v_exp_f32 v195, v195
    v_cvt_pk_bf16_f32 v188, v192, v193
    v_mfma_f32_32x32x16_bf16 v[152:167], a[232:235], v[136:139], v[152:167]
    v_exp_f32 v196, v196
    ds_read_b64_tr_b16 a[8:9], v75 offset:2048
    ds_read_b64_tr_b16 a[10:11], v75 offset:2304
    ds_read_b64_tr_b16 a[12:13], v75 offset:2560
    ds_read_b64_tr_b16 a[14:15], v75 offset:2816
    v_exp_f32 v197, v197
    v_mfma_f32_32x32x16_bf16 v[152:167], a[240:243], v[140:143], v[152:167]
    v_cvt_pk_bf16_f32 v189, v194, v195
    v_exp_f32 v198, v198
    v_exp_f32 v199, v199
    v_cvt_pk_bf16_f32 v190, v196, v197
    v_mfma_f32_32x32x16_bf16 v[152:167], a[248:251], v[144:147], v[152:167]
    s_waitcnt vmcnt(2)
    v_bitop3_b32 v67, v120, v124, v128 bitop3:0x80
    v_bitop3_b32 v67, v67, v148, 1 bitop3:0x80
    v_cmp_eq_u32 vcc, 0, v67
    s_cbranch_vccnz .crt_47
.cok_49:
    v_cvt_pk_bf16_f32 v191, v198, v199
    v_mfma_f32_32x32x16_bf16 v[152:167], v[88:91], v[120:123], v[152:167]
    v_and_b32 v192, v184, v46
    v_and_b32 v193, v185, v47
    v_and_b32 v194, v186, v48
    v_and_b32 v195, v187, v49
    v_and_b32 v196, v188, v50
    v_and_b32 v197, v189, v51
    v_mfma_f32_32x32x16_bf16 v[152:167], v[96:99], v[124:127], v[152:167]
    v_and_b32 v198, v190, v52
    v_and_b32 v199, v191, v53
    v_xor_b32 v184, v184, v192
    v_xor_b32 v185, v185, v193
    v_mfma_f32_32x32x16_bf16 v[216:231], v[78:81], v[192:195], 0
    v_xor_b32 v186, v186, v194
    v_xor_b32 v187, v187, v195
    v_xor_b32 v188, v188, v196
    v_xor_b32 v189, v189, v197
    v_xor_b32 v190, v190, v198
    v_xor_b32 v191, v191, v199
    v_mfma_f32_32x32x16_bf16 v[216:231], v[82:85], v[196:199], v[216:231]
    s_mov_b64 exec, s[42:43]
    ds_read_b128 v[78:81], v9 offset:15360
    ds_read_b128 v[82:85], v9 offset:15616
    s_mov_b64 exec, -1
    v_exp_f32 v200, v200
    v_mfma_f32_32x32x16_bf16 v[152:167], v[104:107], v[128:131], v[152:167]
    v_exp_f32 v201, v201
    v_exp_f32 v202, v202
    v_exp_f32 v203, v203
    s_waitcnt lgkmcnt(13)
    v_mfma_f32_32x32x16_bf16 v[152:167], v[112:115], v[148:151], v[152:167]
    v_add_u32 v63, 131072, v14
    v_add_u32 v64, 8192, v15
    v_mfma_f32_32x32x16_bf16 v[216:231], v[244:247], v[184:187], v[216:231]
    v_cvt_pk_bf16_f32 v200, v200, v201
    ds_read_b64_tr_b16 a[16:17], v75 offset:3072
    ds_read_b64_tr_b16 a[18:19], v75 offset:3328
    ds_read_b64_tr_b16 a[20:21], v75 offset:3584
    ds_read_b64_tr_b16 a[22:23], v75 offset:3840
    v_mul_u32_u24 v67, 0xf00, v4
    v_sub_u32 v67, v77, v67
    ds_read_b64_tr_b16 a[24:25], v67 offset:24576
    ds_read_b64_tr_b16 a[26:27], v67 offset:28672
    ds_read_b64_tr_b16 a[28:29], v67 offset:25088
    ds_read_b64_tr_b16 a[30:31], v67 offset:29184
    s_waitcnt vmcnt(0)
    ds_read_b64_tr_b16 a[32:33], v77 offset:32768
    ds_read_b64_tr_b16 a[34:35], v77 offset:33024
    ds_read_b64_tr_b16 a[36:37], v77 offset:33280
    ds_read_b64_tr_b16 a[38:39], v77 offset:33536
    s_waitcnt lgkmcnt(0)
    s_barrier
    ds_write_b128 v11, v[152:155] offset:24576
    v_exp_f32 v204, v204
    ds_write_b128 v12, v[156:159] offset:25600
    ds_write_b128 v11, v[160:163] offset:26624
    v_exp_f32 v205, v205
    ds_write_b128 v12, v[164:167] offset:27648
    v_mfma_f32_32x32x16_bf16 v[152:167], a[228:231], v[132:135], 0
    v_cvt_pk_bf16_f32 v201, v202, v203
    v_exp_f32 v206, v206
    v_mfma_f32_32x32x16_bf16 v[216:231], v[248:251], v[188:191], v[216:231]
    s_mov_b64 exec, s[42:43]
    ds_read_b128 v[244:247], v9 offset:13312
    ds_read_b128 v[248:251], v9 offset:13568
    s_mov_b64 exec, -1
    v_exp_f32 v207, v207
    v_cvt_pk_bf16_f32 v202, v204, v205
    v_exp_f32 v208, v208
    v_mfma_f32_32x32x16_bf16 v[152:167], a[236:239], v[136:139], v[152:167]
    v_exp_f32 v209, v209
    v_cvt_pk_bf16_f32 v203, v206, v207
    s_cmp_eq_i32 s57, 6
    s_cbranch_scc1 .fix_50
.fixr_51:
    v_mfma_f32_32x32x16_bf16 v[184:199], v[240:243], v[58:61], v[168:183]
    ds_read_b128 v[240:243], v9 offset:6144
    v_accvgpr_read_b32 v65, a217
    s_add_u32 m0, s50, 0xfffff800
    s_nop 0
    global_load_lds_dwordx4 v65, s[12:13]
    v_exp_f32 v210, v210
    v_mfma_f32_32x32x16_bf16 v[152:167], a[244:247], v[140:143], v[152:167]
    v_exp_f32 v211, v211
    v_cvt_pk_bf16_f32 v204, v208, v209
    v_exp_f32 v212, v212
    v_exp_f32 v213, v213
    v_mfma_f32_32x32x16_bf16 v[152:167], a[252:255], v[144:147], v[152:167]
    v_accvgpr_read_b32 v65, a218
    s_add_u32 m0, s50, 0xfffffc00
    s_nop 0
    global_load_lds_dwordx4 v65, s[12:13]
    v_cvt_pk_bf16_f32 v205, v210, v211
    v_exp_f32 v214, v214
    v_mfma_f32_32x32x16_bf16 v[152:167], v[92:95], v[120:123], v[152:167]
    v_exp_f32 v215, v215
    v_cvt_pk_bf16_f32 v206, v212, v213
    v_cvt_pk_bf16_f32 v207, v214, v215
    v_mfma_f32_32x32x16_bf16 v[216:231], v[78:81], v[200:203], v[216:231]
    v_exp_f32 v184, v184
    v_exp_f32 v185, v185
    v_exp_f32 v186, v186
    v_exp_f32 v187, v187
    v_mfma_f32_32x32x16_bf16 v[152:167], v[100:103], v[124:127], v[152:167]
    v_mfma_f32_32x32x16_bf16 v[216:231], v[82:85], v[204:207], v[216:231]
    s_mov_b64 exec, s[42:43]
    ds_read_b128 v[78:81], v9 offset:11264
    ds_read_b128 v[82:85], v9 offset:11520
    s_mov_b64 exec, -1
    v_cvt_pk_bf16_f32 v184, v184, v185
    v_exp_f32 v188, v188
    v_exp_f32 v189, v189
    v_cvt_pk_bf16_f32 v185, v186, v187
    v_exp_f32 v190, v190
    v_mfma_f32_32x32x16_bf16 v[152:167], v[108:111], v[128:131], v[152:167]
    s_cmp_eq_i32 s57, 5
    s_cbranch_scc1 .fix_52
.fixr_53:
    v_mfma_f32_32x32x16_bf16 v[200:215], v[232:235], v[58:61], v[168:183]
    ds_read_b128 v[232:235], v9 offset:4096
    v_exp_f32 v191, v191
    v_cvt_pk_bf16_f32 v186, v188, v189
    v_exp_f32 v192, v192
    v_exp_f32 v193, v193
    v_cvt_pk_bf16_f32 v187, v190, v191
    v_mfma_f32_32x32x16_bf16 v[152:167], v[116:119], v[148:151], v[152:167]
    v_accvgpr_read_b32 v65, a219
    s_add_u32 m0, s50, 0x0
    s_nop 0
    global_load_lds_dwordx4 v65, s[12:13]
    v_exp_f32 v194, v194
    v_exp_f32 v195, v195
    v_cvt_pk_bf16_f32 v188, v192, v193
    v_exp_f32 v196, v196
    v_exp_f32 v197, v197
    v_cvt_pk_bf16_f32 v189, v194, v195
    v_exp_f32 v198, v198
    v_exp_f32 v199, v199
    ds_write_b128 v11, v[152:155] offset:28672
    ds_write_b128 v12, v[156:159] offset:29696
    v_cvt_pk_bf16_f32 v190, v196, v197
    ds_write_b128 v11, v[160:163] offset:30720
    ds_write_b128 v12, v[164:167] offset:31744
    v_cvt_pk_bf16_f32 v191, v198, v199
    v_lshlrev_b32 v152, 16, v30
    v_and_b32 v153, 0xffff0000, v30
    s_waitcnt lgkmcnt(8)
    v_mfma_f32_32x32x16_bf16 v[216:231], v[244:247], v[184:187], v[216:231]
    v_exp_f32 v200, v200
    v_lshlrev_b32 v154, 16, v31
    v_and_b32 v155, 0xffff0000, v31
    v_exp_f32 v201, v201
    v_lshlrev_b32 v156, 16, v32
    v_and_b32 v157, 0xffff0000, v32
    v_exp_f32 v202, v202
    v_lshlrev_b32 v158, 16, v33
    v_and_b32 v159, 0xffff0000, v33
    v_exp_f32 v203, v203
    v_mfma_f32_32x32x16_bf16 v[216:231], v[248:251], v[188:191], v[216:231]
    s_mov_b64 exec, s[42:43]
    ds_read_b128 v[244:247], v9 offset:9216
    ds_read_b128 v[248:251], v9 offset:9472
    s_mov_b64 exec, -1
    v_cvt_pk_bf16_f32 v200, v200, v201
    s_waitcnt lgkmcnt(2)
    s_barrier
    v_exp_f32 v204, v204
    ds_read_b128 v[120:123], v13 offset:24576
    ds_read_b128 v[124:127], v13 offset:32768
    v_exp_f32 v205, v205
    ds_read_b128 v[128:131], v13 offset:40960
    ds_read_b128 v[132:135], v13 offset:49152
    v_cvt_pk_bf16_f32 v201, v202, v203
    ds_read_b128 v[136:139], v13 offset:25088
    ds_read_b128 v[140:143], v13 offset:33280
    v_exp_f32 v206, v206
    ds_read_b128 v[144:147], v13 offset:41472
    ds_read_b128 v[148:151], v13 offset:49664
    s_cmp_eq_i32 s57, 4
    s_cbranch_scc1 .fix_54
.fixr_55:
    v_mfma_f32_32x32x16_bf16 v[184:199], v[236:239], v[58:61], v[168:183]
    ds_read_b128 v[236:239], v9 offset:2048
    v_exp_f32 v207, v207
    v_cvt_pk_bf16_f32 v202, v204, v205
    v_exp_f32 v208, v208
    v_exp_f32 v209, v209
    v_cvt_pk_bf16_f32 v203, v206, v207
    s_waitcnt lgkmcnt(7)
    v_add_f32 v120, v120, v124
    v_accvgpr_read_b32 v65, a220
    s_add_u32 m0, s50, 0x400
    s_nop 0
    global_load_lds_dwordx4 v65, s[12:13]
    v_exp_f32 v210, v210
    v_add_f32 v121, v121, v125
    v_add_f32 v122, v122, v126
    v_exp_f32 v211, v211
    v_add_f32 v123, v123, v127
    v_add_f32 v120, v120, v152
    v_cvt_pk_bf16_f32 v204, v208, v209
    v_add_f32 v121, v121, v153
    v_add_f32 v122, v122, v154
    v_exp_f32 v212, v212
    v_add_f32 v123, v123, v155
    s_waitcnt lgkmcnt(5)
    v_exp_f32 v213, v213
    v_add_f32 v128, v128, v132
    v_add_f32 v129, v129, v133
    v_accvgpr_read_b32 v65, a221
    s_add_u32 m0, s50, 0x800
    s_nop 0
    global_load_lds_dwordx4 v65, s[12:13]
    v_cvt_pk_bf16_f32 v205, v210, v211
    v_add_f32 v130, v130, v134
    v_add_f32 v131, v131, v135
    v_exp_f32 v214, v214
    v_add_f32 v120, v120, v128
    v_add_f32 v121, v121, v129
    v_exp_f32 v215, v215
    v_add_f32 v122, v122, v130
    v_add_f32 v123, v123, v131
    v_cvt_pk_bf16_f32 v206, v212, v213
    v_cvt_pk_bf16_f32 v30, v120, v121
    v_cvt_pk_bf16_f32 v31, v122, v123
    v_cvt_pk_bf16_f32 v207, v214, v215
    v_or_b32 v30, 1, v30
    s_waitcnt lgkmcnt(3)
    v_mfma_f32_32x32x16_bf16 v[216:231], v[78:81], v[200:203], v[216:231]
    v_exp_f32 v184, v184
    v_add_f32 v136, v136, v140
    v_add_f32 v137, v137, v141
    v_exp_f32 v185, v185
    v_add_f32 v138, v138, v142
    v_add_f32 v139, v139, v143
    v_exp_f32 v186, v186
    v_add_f32 v136, v136, v156
    v_add_f32 v137, v137, v157
    v_exp_f32 v187, v187
    v_add_f32 v138, v138, v158
    v_add_f32 v139, v139, v159
    v_mfma_f32_32x32x16_bf16 v[216:231], v[82:85], v[204:207], v[216:231]
    s_mov_b64 exec, s[42:43]
    ds_read_b128 v[78:81], v9 offset:7168
    ds_read_b128 v[82:85], v9 offset:7424
    s_mov_b64 exec, -1
    v_cvt_pk_bf16_f32 v184, v184, v185
    s_waitcnt lgkmcnt(3)
    v_add_f32 v144, v144, v148
    v_exp_f32 v188, v188
    v_add_f32 v145, v145, v149
    v_add_f32 v146, v146, v150
    v_exp_f32 v189, v189
    v_add_f32 v147, v147, v151
    v_add_f32 v136, v136, v144
    v_cvt_pk_bf16_f32 v185, v186, v187
    v_add_f32 v137, v137, v145
    v_add_f32 v138, v138, v146
    v_exp_f32 v190, v190
    v_add_f32 v139, v139, v147
    v_cvt_pk_bf16_f32 v32, v136, v137
    s_cmp_eq_i32 s57, 3
    s_cbranch_scc1 .fix_56
.fixr_57:
    v_mfma_f32_32x32x16_bf16 v[200:215], v[240:243], v[58:61], v[168:183]
    v_exp_f32 v191, v191
    v_cvt_pk_bf16_f32 v33, v138, v139
    s_cmp_eq_u32 s33, 1
    s_cbranch_scc0 .slow_58
    global_store_dwordx4 v63, v[30:33], s[24:25]
.sten_59:
    v_cvt_pk_bf16_f32 v186, v188, v189
    v_add_f32 v124, v120, v121
    v_mul_f32 v125, v120, v120
    v_exp_f32 v192, v192
    v_fmac_f32 v125, v121, v121
    v_add_f32 v124, v124, v122
    v_exp_f32 v193, v193
    v_fmac_f32 v125, v122, v122
    v_add_f32 v124, v124, v123
    v_cvt_pk_bf16_f32 v187, v190, v191
    v_fmac_f32 v125, v123, v123
    v_add_f32 v124, v124, v136
    v_accvgpr_read_b32 v65, a222
    s_add_u32 m0, s50, 0xc00
    s_nop 0
    global_load_lds_dwordx4 v65, s[12:13]
    v_exp_f32 v194, v194
    v_fmac_f32 v125, v136, v136
    v_add_f32 v124, v124, v137
    v_exp_f32 v195, v195
    v_fmac_f32 v125, v137, v137
    v_add_f32 v124, v124, v138
    v_cvt_pk_bf16_f32 v188, v192, v193
    v_fmac_f32 v125, v138, v138
    v_add_f32 v124, v124, v139
    v_exp_f32 v196, v196
    v_fmac_f32 v125, v139, v139
    v_exp_f32 v197, v197
    v_accvgpr_read_b32 v65, a223
    s_add_u32 m0, s50, 0x1000
    s_nop 0
    global_load_lds_dwordx4 v65, s[12:13]
    v_cvt_pk_bf16_f32 v189, v194, v195
    v_permlane32_swap_b32 v124, v125
    v_add_f32 v124, v124, v125
    v_exp_f32 v198, v198
    v_cvt_pk_bf16_f32 v30, v120, v121
    v_mov_b32 v125, v124
    v_exp_f32 v199, v199
    v_cvt_pk_bf16_f32 v190, v196, v197
    v_permlane16_swap_b32 v124, v125
    v_add_f32 v124, v124, v125
    v_cvt_pk_bf16_f32 v191, v198, v199
    v_mfma_f32_32x32x16_bf16 v[216:231], v[244:247], v[184:187], v[216:231]
    v_exp_f32 v200, v200
    v_add_f32_dpp v124, v124, v124 row_ror:8 row_mask:0xf bank_mask:0xf
    v_or_b32 v124, 1, v124
    v_exp_f32 v201, v201
    s_cmp_eq_u32 s33, 1
    s_cbranch_scc0 .slow_60
    global_store_dword v64, v124, s[24:25]
.sten_61:
    v_exp_f32 v202, v202
    v_exp_f32 v203, v203
    v_mfma_f32_32x32x16_bf16 v[216:231], v[248:251], v[188:191], v[216:231]
    s_mov_b64 exec, s[42:43]
    ds_read_b128 v[244:247], v9 offset:5120
    ds_read_b128 v[248:251], v9 offset:5376
    s_mov_b64 exec, -1
    v_cvt_pk_bf16_f32 v200, v200, v201
    v_exp_f32 v204, v204
    v_exp_f32 v205, v205
    v_cvt_pk_bf16_f32 v201, v202, v203
    v_exp_f32 v206, v206
    s_cmp_eq_i32 s57, 2
    s_cbranch_scc1 .fix_62
.fixr_63:
    v_mfma_f32_32x32x16_bf16 v[184:199], v[232:235], v[58:61], v[168:183]
    v_exp_f32 v207, v207
    v_cvt_pk_bf16_f32 v202, v204, v205
    v_exp_f32 v208, v208
    v_exp_f32 v209, v209
    v_cvt_pk_bf16_f32 v203, v206, v207
    v_accvgpr_read_b32 v65, a217
    s_add_u32 m0, s50, 0x1400
    v_add_u32 v65, 229376, v65
    global_load_lds_dwordx4 v65, s[12:13]
    v_exp_f32 v210, v210
    v_exp_f32 v211, v211
    v_cvt_pk_bf16_f32 v204, v208, v209
    v_exp_f32 v212, v212
    v_exp_f32 v213, v213
    v_cvt_pk_bf16_f32 v205, v210, v211
    v_exp_f32 v214, v214
    v_exp_f32 v215, v215
    v_cvt_pk_bf16_f32 v206, v212, v213
    v_cvt_pk_bf16_f32 v207, v214, v215
    s_waitcnt lgkmcnt(2)
    v_mfma_f32_32x32x16_bf16 v[216:231], v[78:81], v[200:203], v[216:231]
    v_exp_f32 v184, v184
    v_exp_f32 v185, v185
    v_exp_f32 v186, v186
    v_exp_f32 v187, v187
    v_mfma_f32_32x32x16_bf16 v[216:231], v[82:85], v[204:207], v[216:231]
    s_mov_b64 exec, s[42:43]
    ds_read_b128 v[78:81], v9 offset:3072
    ds_read_b128 v[82:85], v9 offset:3328
    s_mov_b64 exec, -1
    v_cvt_pk_bf16_f32 v184, v184, v185
    v_exp_f32 v188, v188
    v_exp_f32 v189, v189
    v_cvt_pk_bf16_f32 v185, v186, v187
    v_exp_f32 v190, v190
    s_cmp_eq_i32 s57, 1
    s_cbranch_scc1 .fix_64
.fixr_65:
    v_mfma_f32_32x32x16_bf16 v[200:215], v[236:239], v[58:61], v[168:183]
    v_exp_f32 v191, v191
    v_cvt_pk_bf16_f32 v186, v188, v189
    s_add_u32 s44, s62, s58
    s_add_u32 s44, s44, 135168
    v_add_u32 v62, s44, v2
    global_load_dwordx4 v[132:135], v62, s[24:25] offset:-4096 sc1
    v_exp_f32 v192, v192
    v_exp_f32 v193, v193
    global_load_dwordx4 v[136:139], v62, s[24:25] offset:-3072 sc1
    v_cvt_pk_bf16_f32 v187, v190, v191
    v_exp_f32 v194, v194
    v_exp_f32 v195, v195
    global_load_dwordx4 v[140:143], v62, s[24:25] offset:-2048 sc1
    v_cvt_pk_bf16_f32 v188, v192, v193
    v_exp_f32 v196, v196
    v_exp_f32 v197, v197
    global_load_dwordx4 v[144:147], v62, s[24:25] offset:-1024 sc1
    v_cvt_pk_bf16_f32 v189, v194, v195
    v_exp_f32 v198, v198
    v_exp_f32 v199, v199
    global_load_dwordx4 v[120:123], v62, s[24:25] offset:0 sc1
    v_cvt_pk_bf16_f32 v190, v196, v197
    v_cvt_pk_bf16_f32 v191, v198, v199
    s_waitcnt lgkmcnt(2)
    v_mfma_f32_32x32x16_bf16 v[216:231], v[244:247], v[184:187], v[216:231]
    v_exp_f32 v200, v200
    global_load_dwordx4 v[124:127], v62, s[24:25] offset:1024 sc1
    v_exp_f32 v201, v201
    v_exp_f32 v202, v202
    global_load_dwordx4 v[128:131], v62, s[24:25] offset:2048 sc1
    v_exp_f32 v203, v203
    v_mfma_f32_32x32x16_bf16 v[216:231], v[248:251], v[188:191], v[216:231]
    v_cvt_pk_bf16_f32 v200, v200, v201
    global_load_dwordx4 v[148:151], v62, s[24:25] offset:3072 sc1
    v_exp_f32 v204, v204
    v_exp_f32 v205, v205
    s_add_u32 s44, s62, s59
    s_add_u32 s44, s44, 135168
    v_add_u32 v62, s44, v2
    global_load_dwordx4 v[152:155], v62, s[24:25] offset:-4096 sc1
    v_cvt_pk_bf16_f32 v201, v202, v203
    v_exp_f32 v206, v206
    v_exp_f32 v207, v207
    global_load_dwordx4 v[156:159], v62, s[24:25] offset:-3072 sc1
    v_cvt_pk_bf16_f32 v202, v204, v205
    v_exp_f32 v208, v208
    v_exp_f32 v209, v209
    global_load_dwordx4 v[160:163], v62, s[24:25] offset:-2048 sc1
    v_cvt_pk_bf16_f32 v203, v206, v207
    v_exp_f32 v210, v210
    v_exp_f32 v211, v211
    global_load_dwordx4 v[164:167], v62, s[24:25] offset:-1024 sc1
    v_cvt_pk_bf16_f32 v204, v208, v209
    v_exp_f32 v212, v212
    v_exp_f32 v213, v213
    s_waitcnt lgkmcnt(0)
    v_mfma_f32_32x32x16_bf16 v[216:231], v[78:81], v[200:203], v[216:231]
    v_cvt_pk_bf16_f32 v205, v210, v211
    v_exp_f32 v214, v214
    v_exp_f32 v215, v215
    v_cvt_pk_bf16_f32 v206, v212, v213
    v_cvt_pk_bf16_f32 v207, v214, v215
    s_nop 1
    v_mfma_f32_32x32x16_bf16 v[216:231], v[82:85], v[204:207], v[216:231]
    s_lshl_b32 s44, s27, 10
    s_add_u32 s44, s44, s62
    s_add_u32 s44, s44, 262144
    v_add_u32 v63, s44, v2
    s_nop 7
    v_rcp_f32 v252, v224
    s_nop 0
    v_pk_mul_f32 v[216:217], v[216:217], v[252:253] op_sel_hi:[1,0]
    v_pk_mul_f32 v[218:219], v[218:219], v[252:253] op_sel_hi:[1,0]
    v_pk_mul_f32 v[220:221], v[220:221], v[252:253] op_sel_hi:[1,0]
    v_pk_mul_f32 v[222:223], v[222:223], v[252:253] op_sel_hi:[1,0]
    v_cvt_pk_bf16_f32 v216, v216, v217
    v_cvt_pk_bf16_f32 v217, v218, v219
    v_cvt_pk_bf16_f32 v218, v220, v221
    v_cvt_pk_bf16_f32 v219, v222, v223
    v_or_b32 v216, 1, v216
    s_cmp_eq_u32 s33, 1
    s_cbranch_scc0 .slow_66
    global_store_dwordx4 v63, v[216:219], s[24:25]
.sten_67:
    s_waitcnt vmcnt(13)
    s_barrier
    ds_read_b64_tr_b16 v[232:233], v7 offset:0
    ds_read_b64_tr_b16 v[234:235], v7 offset:112
    ds_read_b64_tr_b16 v[236:237], v7 offset:64
    ds_read_b64_tr_b16 v[238:239], v7 offset:176
    ds_read_b64_tr_b16 v[240:241], v7 offset:1792
    ds_read_b64_tr_b16 v[242:243], v7 offset:1904
    ds_read_b64_tr_b16 v[244:245], v7 offset:1856
    ds_read_b64_tr_b16 v[246:247], v7 offset:1968
    v_bfe_u32 v67, v1, 2, 1
    v_bfe_u32 v68, v1, 4, 1
    v_cmp_eq_u32 vcc, v67, v68
    v_mov_b32 v67, s38
    s_nop 0
    v_cndmask_b32 v26, 0, v67, vcc
    v_cndmask_b32 v27, 0, v67, vcc
    v_cndmask_b32 v28, 0, v67, vcc
    v_cndmask_b32 v29, 0, v67, vcc
    v_lshl_or_b32 v43, v43, 16, v43
    v_lshl_or_b32 v45, v45, 16, v45
    s_waitcnt vmcnt(9)
    v_bitop3_b32 v67, v132, v136, v140 bitop3:0x80
    v_bitop3_b32 v67, v67, v144, 1 bitop3:0x80
    v_cmp_eq_u32 vcc, 0, v67
    s_cbranch_vccnz .crt_68
.cok_70:
    s_waitcnt lgkmcnt(6)
    v_mfma_f32_32x32x16_bf16 v[168:183], v[232:235], v[132:135], 0
    ds_read_b64_tr_b16 v[248:249], v7 offset:3584
    ds_read_b64_tr_b16 v[250:251], v7 offset:3696
    s_waitcnt lgkmcnt(6)
    v_mfma_f32_32x32x16_bf16 v[184:199], v[236:239], v[132:135], 0
    ds_read_b64_tr_b16 v[252:253], v7 offset:3648
    ds_read_b64_tr_b16 v[254:255], v7 offset:3760
    global_load_dwordx4 v[132:135], v62, s[24:25] offset:0 sc1
    s_add_u32 s44, s46, 81920
    s_add_u32 m0, s53, 141312
    v_add_u32 v67, s44, v66
    global_load_lds_dwordx4 v67, s[16:17] offset:-2048
    global_load_lds_dwordx4 v67, s[16:17] offset:2048
    s_cmp_lg_u32 s28, 0
    s_cbranch_scc1 .cs_71
    v_mfma_f32_16x16x32_bf16 v[54:57], v[26:29], v[232:235], 0
    v_mfma_f32_16x16x32_bf16 v[58:61], v[26:29], v[236:239], 0
.cs_71:
    s_waitcnt lgkmcnt(6)
    v_mfma_f32_32x32x16_bf16 v[168:183], v[240:243], v[136:139], v[168:183]
    ds_read_b64_tr_b16 v[232:233], v7 offset:5376
    ds_read_b64_tr_b16 v[234:235], v7 offset:5488
    s_waitcnt lgkmcnt(6)
    v_mfma_f32_32x32x16_bf16 v[184:199], v[244:247], v[136:139], v[184:199]
    ds_read_b64_tr_b16 v[236:237], v7 offset:5440
    ds_read_b64_tr_b16 v[238:239], v7 offset:5552
    global_load_dwordx4 v[136:139], v62, s[24:25] offset:1024 sc1
    s_cmp_lg_u32 s28, 1
    s_cbranch_scc1 .cs_72
    v_mfma_f32_16x16x32_bf16 v[54:57], v[26:29], v[240:243], 0
    v_mfma_f32_16x16x32_bf16 v[58:61], v[26:29], v[244:247], 0
.cs_72:
    s_waitcnt lgkmcnt(6)
    v_mfma_f32_32x32x16_bf16 v[168:183], v[248:251], v[140:143], v[168:183]
    ds_read_b64_tr_b16 v[240:241], v7 offset:7168
    ds_read_b64_tr_b16 v[242:243], v7 offset:7280
    v_lshlrev_b32 v78, 16, v34
    s_waitcnt lgkmcnt(6)
    v_mfma_f32_32x32x16_bf16 v[184:199], v[252:255], v[140:143], v[184:199]
    ds_read_b64_tr_b16 v[244:245], v7 offset:7232
    ds_read_b64_tr_b16 v[246:247], v7 offset:7344
    s_add_u32 s44, s36, s34
    s_add_u32 s44, s44, 0x148000
    v_add_u32 v67, s44, v2
    global_load_dwordx4 v[140:143], v67, s[24:25] offset:0 sc1
    v_and_b32 v79, 0xffff0000, v34
    s_add_u32 s44, s46, 98304
    s_add_u32 m0, s53, 149504
    v_add_u32 v67, s44, v66
    global_load_lds_dwordx4 v67, s[16:17] offset:-2048
    global_load_lds_dwordx4 v67, s[16:17] offset:2048
    s_cmp_lg_u32 s28, 2
    s_cbranch_scc1 .cs_73
    v_mfma_f32_16x16x32_bf16 v[54:57], v[26:29], v[248:251], 0
    v_mfma_f32_16x16x32_bf16 v[58:61], v[26:29], v[252:255], 0
.cs_73:
    s_waitcnt lgkmcnt(6)
    v_mfma_f32_32x32x16_bf16 v[168:183], v[232:235], v[144:147], v[168:183]
    ds_read_b64_tr_b16 v[248:249], v7 offset:8960
    ds_read_b64_tr_b16 v[250:251], v7 offset:9072
    v_lshlrev_b32 v80, 16, v35
    s_waitcnt lgkmcnt(6)
    v_mfma_f32_32x32x16_bf16 v[184:199], v[236:239], v[144:147], v[184:199]
    ds_read_b64_tr_b16 v[252:253], v7 offset:9024
    ds_read_b64_tr_b16 v[254:255], v7 offset:9136
    s_add_u32 s44, s36, s34
    s_add_u32 s44, s44, 0x148000
    v_add_u32 v67, s44, v2
    global_load_dwordx4 v[144:147], v67, s[24:25] offset:1024 sc1
    v_and_b32 v81, 0xffff0000, v35
    s_cmp_lg_u32 s28, 3
    s_cbranch_scc1 .cs_74
    v_mfma_f32_16x16x32_bf16 v[54:57], v[26:29], v[232:235], 0
    v_mfma_f32_16x16x32_bf16 v[58:61], v[26:29], v[236:239], 0
.cs_74:
    s_waitcnt vmcnt(13)
    v_bitop3_b32 v67, v120, v124, v128 bitop3:0x80
    v_bitop3_b32 v67, v67, v148, 1 bitop3:0x80
    v_cmp_eq_u32 vcc, 0, v67
    s_cbranch_vccnz .crt_75
.cok_77:
    s_waitcnt lgkmcnt(6)
    v_mfma_f32_32x32x16_bf16 v[168:183], v[240:243], v[120:123], v[168:183]
    ds_read_b64_tr_b16 v[232:233], v7 offset:10752
    ds_read_b64_tr_b16 v[234:235], v7 offset:10864
    v_lshlrev_b32 v82, 16, v36
    s_waitcnt lgkmcnt(6)
    v_mfma_f32_32x32x16_bf16 v[184:199], v[244:247], v[120:123], v[184:199]
    ds_read_b64_tr_b16 v[236:237], v7 offset:10816
    ds_read_b64_tr_b16 v[238:239], v7 offset:10928
    global_load_dwordx4 v[120:123], v62, s[24:25] offset:2048 sc1
    v_and_b32 v83, 0xffff0000, v36
    s_cmp_lg_u32 s28, 0
    s_cbranch_scc1 .cs_78
    v_mfma_f32_16x16x32_bf16 v[54:57], v[26:29], v[240:243], v[54:57]
    v_mfma_f32_16x16x32_bf16 v[58:61], v[26:29], v[244:247], v[58:61]
.cs_78:
    s_waitcnt lgkmcnt(6)
    v_mfma_f32_32x32x16_bf16 v[168:183], v[248:251], v[124:127], v[168:183]
    ds_read_b64_tr_b16 v[240:241], v7 offset:12544
    ds_read_b64_tr_b16 v[242:243], v7 offset:12656
    v_lshlrev_b32 v84, 16, v37
    s_waitcnt lgkmcnt(6)
    v_mfma_f32_32x32x16_bf16 v[184:199], v[252:255], v[124:127], v[184:199]
    ds_read_b64_tr_b16 v[244:245], v7 offset:12608
    ds_read_b64_tr_b16 v[246:247], v7 offset:12720
    global_load_dwordx4 v[124:127], v62, s[24:25] offset:3072 sc1
    v_and_b32 v85, 0xffff0000, v37
    s_add_u32 s44, s47, 0
    s_add_u32 m0, s53, 157696
    v_add_u32 v67, s44, v66
    global_load_lds_dwordx4 v67, s[16:17] offset:-2048
    global_load_lds_dwordx4 v67, s[16:17] offset:2048
    s_cmp_lg_u32 s28, 1
    s_cbranch_scc1 .cs_79
    v_mfma_f32_16x16x32_bf16 v[54:57], v[26:29], v[248:251], v[54:57]
    v_mfma_f32_16x16x32_bf16 v[58:61], v[26:29], v[252:255], v[58:61]
.cs_79:
    s_waitcnt lgkmcnt(6)
    v_mfma_f32_32x32x16_bf16 v[168:183], v[232:235], v[128:131], v[168:183]
    ds_read_b64_tr_b16 v[248:249], v7 offset:14336
    ds_read_b64_tr_b16 v[250:251], v7 offset:14448
    s_waitcnt lgkmcnt(6)
    v_mfma_f32_32x32x16_bf16 v[184:199], v[236:239], v[128:131], v[184:199]
    ds_read_b64_tr_b16 v[252:253], v7 offset:14400
    ds_read_b64_tr_b16 v[254:255], v7 offset:14512
    s_add_u32 s44, s62, s60
    s_add_u32 s44, s44, 135168
    v_add_u32 v62, s44, v2
    global_load_dwordx4 v[128:131], v62, s[24:25] offset:-4096 sc1
    s_cmp_lg_u32 s28, 2
    s_cbranch_scc1 .cs_80
    v_mfma_f32_16x16x32_bf16 v[54:57], v[26:29], v[232:235], v[54:57]
    v_mfma_f32_16x16x32_bf16 v[58:61], v[26:29], v[236:239], v[58:61]
.cs_80:
    s_waitcnt lgkmcnt(6)
    v_mfma_f32_32x32x16_bf16 v[168:183], v[240:243], v[148:151], v[168:183]
    ds_read_b64_tr_b16 v[232:233], v7 offset:16128
    ds_read_b64_tr_b16 v[234:235], v7 offset:16240
    s_waitcnt lgkmcnt(6)
    v_mfma_f32_32x32x16_bf16 v[184:199], v[244:247], v[148:151], v[184:199]
    ds_read_b64_tr_b16 v[236:237], v7 offset:16192
    ds_read_b64_tr_b16 v[238:239], v7 offset:16304
    global_load_dwordx4 v[148:151], v62, s[24:25] offset:-3072 sc1
    s_cmp_lg_u32 s28, 3
    s_cbranch_scc1 .cs_81
    v_mfma_f32_16x16x32_bf16 v[54:57], v[26:29], v[240:243], v[54:57]
    v_mfma_f32_16x16x32_bf16 v[58:61], v[26:29], v[244:247], v[58:61]
.cs_81:
    s_waitcnt vmcnt(15)
    v_bitop3_b32 v67, v152, v156, v160 bitop3:0x80
    v_bitop3_b32 v67, v67, v164, 1 bitop3:0x80
    v_cmp_eq_u32 vcc, 0, v67
    s_cbranch_vccnz .crt_82
.cok_84:
    s_waitcnt lgkmcnt(6)
    v_mfma_f32_32x32x16_bf16 v[168:183], v[248:251], v[152:155], v[168:183]
    ds_read_b64_tr_b16 v[240:241], v7 offset:17920
    ds_read_b64_tr_b16 v[242:243], v7 offset:18032
    s_cmp_eq_u32 s26, 0
    s_cselect_b32 s44, 0, 3158016
    s_sub_u32 s44, s101, s44
    s_add_u32 s44, s44, 1587208
    v_mov_b32 v68, s44
    s_add_u32 s44, s31, 2
    v_mov_b32 v67, s44
    global_store_dword v68, v67, s[24:25] sc1
    s_waitcnt lgkmcnt(6)
    v_mfma_f32_32x32x16_bf16 v[184:199], v[252:255], v[152:155], v[184:199]
    ds_read_b64_tr_b16 v[244:245], v7 offset:17984
    ds_read_b64_tr_b16 v[246:247], v7 offset:18096
    s_lshl2_add_u32 s44, s28, s96
    s_lshl_b32 s44, s44, 11
    s_add_u32 s44, s44, s32
    s_add_u32 s44, s44, 265216
    v_add_u32 v62, s44, v2
    global_load_dwordx4 v[152:155], v62, s[24:25] offset:-3072 sc1
    s_cmp_lg_u32 s28, 0
    s_cbranch_scc1 .cs_85
    v_mfma_f32_16x16x32_bf16 v[54:57], v[26:29], v[248:251], v[54:57]
    v_mfma_f32_16x16x32_bf16 v[58:61], v[26:29], v[252:255], v[58:61]
.cs_85:
    s_waitcnt lgkmcnt(6)
    v_mfma_f32_32x32x16_bf16 v[168:183], v[232:235], v[156:159], v[168:183]
    ds_read_b64_tr_b16 v[248:249], v7 offset:19712
    ds_read_b64_tr_b16 v[250:251], v7 offset:19824
    s_waitcnt lgkmcnt(6)
    v_mfma_f32_32x32x16_bf16 v[184:199], v[236:239], v[156:159], v[184:199]
    ds_read_b64_tr_b16 v[252:253], v7 offset:19776
    ds_read_b64_tr_b16 v[254:255], v7 offset:19888
    global_load_dwordx4 v[156:159], v62, s[24:25] offset:-2048 sc1
    s_cmp_lg_u32 s28, 1
    s_cbranch_scc1 .cs_86
    v_mfma_f32_16x16x32_bf16 v[54:57], v[26:29], v[232:235], v[54:57]
    v_mfma_f32_16x16x32_bf16 v[58:61], v[26:29], v[236:239], v[58:61]
.cs_86:
    s_waitcnt lgkmcnt(6)
    v_mfma_f32_32x32x16_bf16 v[168:183], v[240:243], v[160:163], v[168:183]
    ds_read_b64_tr_b16 v[232:233], v7 offset:21504
    ds_read_b64_tr_b16 v[234:235], v7 offset:21616
    s_waitcnt lgkmcnt(6)
    v_mfma_f32_32x32x16_bf16 v[184:199], v[244:247], v[160:163], v[184:199]
    ds_read_b64_tr_b16 v[236:237], v7 offset:21568
    ds_read_b64_tr_b16 v[238:239], v7 offset:21680
    s_lshl2_add_u32 s44, s28, s97
    s_lshl_b32 s44, s44, 11
    s_add_u32 s44, s44, s32
    s_add_u32 s44, s44, 265216
    v_add_u32 v62, s44, v2
    global_load_dwordx4 v[160:163], v62, s[24:25] offset:-3072 sc1
    s_cmp_lg_u32 s28, 2
    s_cbranch_scc1 .cs_87
    v_mfma_f32_16x16x32_bf16 v[54:57], v[26:29], v[240:243], v[54:57]
    v_mfma_f32_16x16x32_bf16 v[58:61], v[26:29], v[244:247], v[58:61]
.cs_87:
    s_waitcnt lgkmcnt(6)
    v_mfma_f32_32x32x16_bf16 v[168:183], v[248:251], v[164:167], v[168:183]
    ds_read_b64_tr_b16 v[240:241], v7 offset:23296
    ds_read_b64_tr_b16 v[242:243], v7 offset:23408
    s_waitcnt lgkmcnt(6)
    v_mfma_f32_32x32x16_bf16 v[184:199], v[252:255], v[164:167], v[184:199]
    ds_read_b64_tr_b16 v[244:245], v7 offset:23360
    ds_read_b64_tr_b16 v[246:247], v7 offset:23472
    global_load_dwordx4 v[164:167], v62, s[24:25] offset:-2048 sc1
    s_cmp_lg_u32 s28, 3
    s_cbranch_scc1 .cs_88
    v_mfma_f32_16x16x32_bf16 v[54:57], v[26:29], v[248:251], v[54:57]
    v_mfma_f32_16x16x32_bf16 v[58:61], v[26:29], v[252:255], v[58:61]
.cs_88:
    s_waitcnt vmcnt(9)
    v_bitop3_b32 v67, v132, v136, v120 bitop3:0x80
    v_bitop3_b32 v67, v67, v124, 1 bitop3:0x80
    v_cmp_eq_u32 vcc, 0, v67
    s_cbranch_vccnz .crt_89
.cok_91:
    s_waitcnt lgkmcnt(6)
    v_mfma_f32_32x32x16_bf16 v[168:183], v[232:235], v[132:135], v[168:183]
    ds_read_b64_tr_b16 v[248:249], v7 offset:25088
    ds_read_b64_tr_b16 v[250:251], v7 offset:25200
    s_waitcnt lgkmcnt(6)
    v_mfma_f32_32x32x16_bf16 v[184:199], v[236:239], v[132:135], v[184:199]
    ds_read_b64_tr_b16 v[252:253], v7 offset:25152
    ds_read_b64_tr_b16 v[254:255], v7 offset:25264
    s_add_u32 s44, s62, s60
    s_add_u32 s44, s44, 135168
    v_add_u32 v62, s44, v2
    global_load_dwordx4 v[132:135], v62, s[24:25] offset:-2048 sc1
    ds_read_b64_tr_b16 a[40:41], v77 offset:24576
    ds_read_b64_tr_b16 a[42:43], v77 offset:24832
    ds_read_b64_tr_b16 a[44:45], v77 offset:25088
    ds_read_b64_tr_b16 a[46:47], v77 offset:25344
    s_waitcnt lgkmcnt(0)
    s_add_u32 s44, s47, 16384
    s_add_u32 m0, s53, 141312
    v_add_u32 v67, s44, v66
    global_load_lds_dwordx4 v67, s[16:17] offset:-2048
    global_load_lds_dwordx4 v67, s[16:17] offset:2048
    s_cmp_lg_u32 s28, 0
    s_cbranch_scc1 .cs_92
    v_mfma_f32_16x16x32_bf16 v[54:57], v[26:29], v[232:235], v[54:57]
    v_mfma_f32_16x16x32_bf16 v[58:61], v[26:29], v[236:239], v[58:61]
.cs_92:
    v_mfma_f32_32x32x16_bf16 v[168:183], v[240:243], v[136:139], v[168:183]
    ds_read_b64_tr_b16 v[232:233], v7 offset:26880
    ds_read_b64_tr_b16 v[234:235], v7 offset:26992
    v_mfma_f32_32x32x16_bf16 v[184:199], v[244:247], v[136:139], v[184:199]
    ds_read_b64_tr_b16 v[236:237], v7 offset:26944
    ds_read_b64_tr_b16 v[238:239], v7 offset:27056
    global_load_dwordx4 v[136:139], v62, s[24:25] offset:-1024 sc1
    s_cmp_lg_u32 s28, 1
    s_cbranch_scc1 .cs_93
    v_mfma_f32_16x16x32_bf16 v[54:57], v[26:29], v[240:243], v[54:57]
    v_mfma_f32_16x16x32_bf16 v[58:61], v[26:29], v[244:247], v[58:61]
.cs_93:
    v_mfma_f32_32x32x16_bf16 v[168:183], v[248:251], v[120:123], v[168:183]
    ds_read_b64_tr_b16 v[240:241], v7 offset:28672
    ds_read_b64_tr_b16 v[242:243], v7 offset:28784
    v_mfma_f32_32x32x16_bf16 v[184:199], v[252:255], v[120:123], v[184:199]
    ds_read_b64_tr_b16 v[244:245], v7 offset:28736
    ds_read_b64_tr_b16 v[246:247], v7 offset:28848
    s_lshl2_add_u32 s44, s28, s98
    s_lshl_b32 s44, s44, 11
    s_add_u32 s44, s44, s32
    s_add_u32 s44, s44, 265216
    v_add_u32 v62, s44, v2
    global_load_dwordx4 v[120:123], v62, s[24:25] offset:-3072 sc1
    s_cmp_lg_u32 s28, 2
    s_cbranch_scc1 .cs_94
    v_mfma_f32_16x16x32_bf16 v[54:57], v[26:29], v[248:251], v[54:57]
    v_mfma_f32_16x16x32_bf16 v[58:61], v[26:29], v[252:255], v[58:61]
.cs_94:
    s_waitcnt lgkmcnt(6)
    v_mfma_f32_32x32x16_bf16 v[168:183], v[232:235], v[124:127], v[168:183]
    ds_read_b64_tr_b16 v[248:249], v7 offset:30464
    ds_read_b64_tr_b16 v[250:251], v7 offset:30576
    s_waitcnt vmcnt(5)
    v_bitop3_b32 v67, v152, v156, v160 bitop3:0x80
    v_bitop3_b32 v67, v67, v164, 1 bitop3:0x80
    v_cmp_eq_u32 vcc, 0, v67
    s_cbranch_vccnz .crt_95
.cok_97:
    v_mfma_f32_32x32x16_bf16 v[200:215], a[224:227], v[152:155], 0
    v_mfma_f32_32x32x16_bf16 v[216:231], a[228:231], v[152:155], 0
    global_load_dwordx4 v[152:155], v62, s[24:25] offset:-2048 sc1
    v_bitop3_b32 v67, v140, v141, v142 bitop3:0x80
    v_bitop3_b32 v67, v67, v143, v144 bitop3:0x80
    v_bitop3_b32 v67, v67, v145, v146 bitop3:0x80
    v_bitop3_b32 v67, v67, v147, 1 bitop3:0x80
    v_cmp_eq_u32 vcc, 0, v67
    s_cbranch_vccnz .crt_98
.cok_100:
    v_add_f32 v140, v140, v142
    v_add_f32 v141, v141, v143
    v_add_f32 v144, v144, v146
    v_add_f32 v145, v145, v147
    v_add_f32 v70, v140, v144
    v_add_f32 v71, v141, v145
    s_nop 1
    v_permlane32_swap_b32 v70, v71
    s_waitcnt lgkmcnt(6)
    v_mfma_f32_32x32x16_bf16 v[184:199], v[236:239], v[124:127], v[184:199]
    ds_read_b64_tr_b16 v[252:253], v7 offset:30528
    ds_read_b64_tr_b16 v[254:255], v7 offset:30640
    s_lshl2_add_u32 s44, s28, s99
    s_lshl_b32 s44, s44, 11
    s_add_u32 s44, s44, s32
    s_add_u32 s44, s44, 265216
    v_add_u32 v62, s44, v2
    global_load_dwordx4 v[140:143], v62, s[24:25] offset:-3072 sc1
    v_mfma_f32_32x32x16_bf16 v[200:215], a[232:235], v[156:159], v[200:215]
    global_load_dwordx4 v[144:147], v62, s[24:25] offset:-2048 sc1
    v_mfma_f32_32x32x16_bf16 v[216:231], a[236:239], v[156:159], v[216:231]
    s_add_u32 s44, s62, s60
    s_add_u32 s44, s44, 135168
    v_add_u32 v62, s44, v2
    global_load_dwordx4 v[124:127], v62, s[24:25] offset:0 sc1
    v_add_f32 v70, v70, v71
    v_mov_b32 v71, v70
    ds_read_b64_tr_b16 a[48:49], v77 offset:32768
    ds_read_b64_tr_b16 a[50:51], v77 offset:33024
    ds_read_b64_tr_b16 a[52:53], v77 offset:33280
    ds_read_b64_tr_b16 a[54:55], v77 offset:33536
    s_waitcnt lgkmcnt(0)
    s_add_u32 s44, s47, 32768
    s_add_u32 m0, s53, 149504
    v_add_u32 v67, s44, v66
    global_load_lds_dwordx4 v67, s[16:17] offset:-2048
    global_load_lds_dwordx4 v67, s[16:17] offset:2048
    s_cmp_lg_u32 s28, 3
    s_cbranch_scc1 .cs_101
    v_mfma_f32_16x16x32_bf16 v[54:57], v[26:29], v[232:235], v[54:57]
    v_mfma_f32_16x16x32_bf16 v[58:61], v[26:29], v[236:239], v[58:61]
.cs_101:
    s_waitcnt vmcnt(7)
    v_bitop3_b32 v67, v128, v148, v132 bitop3:0x80
    v_bitop3_b32 v67, v67, v136, 1 bitop3:0x80
    v_cmp_eq_u32 vcc, 0, v67
    s_cbranch_vccnz .crt_102
.cok_104:
    v_mfma_f32_32x32x16_bf16 v[168:183], v[240:243], v[128:131], v[168:183]
    ds_read_b64_tr_b16 v[232:233], v7 offset:32256
    ds_read_b64_tr_b16 v[234:235], v7 offset:32368
    global_load_dwordx4 v[156:159], v62, s[24:25] offset:1024 sc1
    v_mfma_f32_32x32x16_bf16 v[200:215], a[240:243], v[160:163], v[200:215]
    v_mfma_f32_32x32x16_bf16 v[216:231], a[244:247], v[160:163], v[216:231]
    global_load_dwordx4 v[160:163], v62, s[24:25] offset:2048 sc1
    v_permlane32_swap_b32 v70, v71
    v_mul_f32 v70, 0xbb000000, v70
    v_mfma_f32_32x32x16_bf16 v[184:199], v[244:247], v[128:131], v[184:199]
    ds_read_b64_tr_b16 v[236:237], v7 offset:32320
    ds_read_b64_tr_b16 v[238:239], v7 offset:32432
    global_load_dwordx4 v[128:131], v62, s[24:25] offset:3072 sc1
    v_mfma_f32_32x32x16_bf16 v[200:215], a[248:251], v[164:167], v[200:215]
    v_mfma_f32_32x32x16_bf16 v[216:231], a[252:255], v[164:167], v[216:231]
    s_add_u32 s44, s62, s61
    s_add_u32 s44, s44, 135168
    v_add_u32 v62, s44, v2
    global_load_dwordx4 v[164:167], v62, s[24:25] offset:-4096 sc1
    v_mul_f32 v72, v70, v70
    v_mul_f32 v71, 0x3b000000, v71
    ds_read_b64_tr_b16 a[56:57], v77 offset:40960
    ds_read_b64_tr_b16 a[58:59], v77 offset:41216
    ds_read_b64_tr_b16 a[60:61], v77 offset:41472
    ds_read_b64_tr_b16 a[62:63], v77 offset:41728
    s_waitcnt lgkmcnt(0)
    s_add_u32 s44, s47, 49152
    s_add_u32 m0, s53, 157696
    v_add_u32 v67, s44, v66
    global_load_lds_dwordx4 v67, s[16:17] offset:-2048
    global_load_lds_dwordx4 v67, s[16:17] offset:2048
    s_cmp_lg_u32 s28, 0
    s_cbranch_scc1 .cs_105
    v_mfma_f32_16x16x32_bf16 v[54:57], v[26:29], v[240:243], v[54:57]
    v_mfma_f32_16x16x32_bf16 v[58:61], v[26:29], v[244:247], v[58:61]
.cs_105:
    v_mfma_f32_32x32x16_bf16 v[168:183], v[248:251], v[148:151], v[168:183]
    ds_read_b64_tr_b16 v[240:241], v7 offset:34048
    ds_read_b64_tr_b16 v[242:243], v7 offset:34160
    s_waitcnt vmcnt(9)
    v_bitop3_b32 v67, v120, v152, v140 bitop3:0x80
    v_bitop3_b32 v67, v67, v144, 1 bitop3:0x80
    v_cmp_eq_u32 vcc, 0, v67
    s_cbranch_vccnz .crt_106
.cok_108:
    v_mfma_f32_32x32x16_bf16 v[200:215], v[88:91], v[120:123], v[200:215]
    v_mfma_f32_32x32x16_bf16 v[200:215], v[96:99], v[152:155], v[200:215]
    v_sub_f32 v71, v71, v72
    v_max_f32 v71, 0, v71
    v_mfma_f32_32x32x16_bf16 v[184:199], v[252:255], v[148:151], v[184:199]
    ds_read_b64_tr_b16 v[244:245], v7 offset:34112
    ds_read_b64_tr_b16 v[246:247], v7 offset:34224
    global_load_dwordx4 v[148:151], v62, s[24:25] offset:-3072 sc1
    v_mfma_f32_32x32x16_bf16 v[200:215], v[104:107], v[140:143], v[200:215]
    v_mfma_f32_32x32x16_bf16 v[200:215], v[112:115], v[144:147], v[200:215]
    v_add_f32 v72, 0x3727c5ac, v71
    v_rsq_f32 v22, v72
    ds_read_b64_tr_b16 a[64:65], v77 offset:24576
    ds_read_b64_tr_b16 a[66:67], v77 offset:24832
    ds_read_b64_tr_b16 a[68:69], v77 offset:25088
    ds_read_b64_tr_b16 a[70:71], v77 offset:25344
    s_waitcnt lgkmcnt(0)
    s_add_u32 s44, s47, 65536
    s_add_u32 m0, s53, 141312
    v_add_u32 v67, s44, v66
    global_load_lds_dwordx4 v67, s[16:17] offset:-2048
    global_load_lds_dwordx4 v67, s[16:17] offset:2048
    s_cmp_lg_u32 s28, 1
    s_cbranch_scc1 .cs_109
    v_mfma_f32_16x16x32_bf16 v[54:57], v[26:29], v[248:251], v[54:57]
    v_mfma_f32_16x16x32_bf16 v[58:61], v[26:29], v[252:255], v[58:61]
.cs_109:
    v_mfma_f32_32x32x16_bf16 v[168:183], v[232:235], v[132:135], v[168:183]
    ds_read_b64_tr_b16 v[248:249], v7 offset:35840
    ds_read_b64_tr_b16 v[250:251], v7 offset:35952
    v_mfma_f32_32x32x16_bf16 v[216:231], v[92:95], v[120:123], v[216:231]
    global_load_dwordx4 v[120:123], v62, s[24:25] offset:-2048 sc1
    ds_write_b128 v11, v[200:203] offset:0
    v_mfma_f32_32x32x16_bf16 v[216:231], v[100:103], v[152:155], v[216:231]
    global_load_dwordx4 v[152:155], v62, s[24:25] offset:-1024 sc1
    ds_write_b128 v12, v[204:207] offset:1024
    v_cvt_pk_bf16_f32 v73, v70, v70
    v_lshlrev_b32 v73, 16, v73
    v_mfma_f32_32x32x16_bf16 v[184:199], v[236:239], v[132:135], v[184:199]
    ds_read_b64_tr_b16 v[252:253], v7 offset:35904
    ds_read_b64_tr_b16 v[254:255], v7 offset:36016
    global_load_dwordx4 v[132:135], v62, s[24:25] offset:0 sc1
    v_mfma_f32_32x32x16_bf16 v[216:231], v[108:111], v[140:143], v[216:231]
    global_load_dwordx4 v[140:143], v62, s[24:25] offset:1024 sc1
    ds_write_b128 v11, v[208:211] offset:2048
    v_mfma_f32_32x32x16_bf16 v[216:231], v[116:119], v[144:147], v[216:231]
    global_load_dwordx4 v[144:147], v62, s[24:25] offset:2048 sc1
    ds_write_b128 v12, v[212:215] offset:3072
    v_sub_f32 v73, v70, v73
    v_mul_f32 v73, v73, v8
    s_cmp_lg_u32 s28, 2
    s_cbranch_scc1 .cs_110
    v_mfma_f32_16x16x32_bf16 v[54:57], v[26:29], v[232:235], v[54:57]
    v_mfma_f32_16x16x32_bf16 v[58:61], v[26:29], v[236:239], v[58:61]
.cs_110:
    v_mfma_f32_32x32x16_bf16 v[168:183], v[240:243], v[136:139], v[168:183]
    ds_read_b64_tr_b16 v[232:233], v7 offset:37632
    ds_read_b64_tr_b16 v[234:235], v7 offset:37744
    v_cvt_pk_bf16_f32 v18, v70, v73
    v_mul_f32 v74, v22, v22
    v_mfma_f32_32x32x16_bf16 v[184:199], v[244:247], v[136:139], v[184:199]
    ds_read_b64_tr_b16 v[236:237], v7 offset:37696
    ds_read_b64_tr_b16 v[238:239], v7 offset:37808
    global_load_dwordx4 v[136:139], v62, s[24:25] offset:3072 sc1
    ds_write_b128 v11, v[216:219] offset:4096
    v_mul_f32 v23, v72, v22
    v_mov_b32 v75, 0x3727c5ac
    s_cmp_lg_u32 s28, 3
    s_cbranch_scc1 .cs_111
    v_mfma_f32_16x16x32_bf16 v[54:57], v[26:29], v[240:243], v[54:57]
    v_mfma_f32_16x16x32_bf16 v[58:61], v[26:29], v[244:247], v[58:61]
.cs_111:
    s_waitcnt vmcnt(12)
    v_bitop3_b32 v67, v124, v156, v160 bitop3:0x80
    v_bitop3_b32 v67, v67, v128, 1 bitop3:0x80
    v_cmp_eq_u32 vcc, 0, v67
    s_cbranch_vccnz .crt_112
.cok_114:
    s_waitcnt lgkmcnt(11)
    v_mfma_f32_32x32x16_bf16 v[168:183], v[248:251], v[124:127], v[168:183]
    ds_read_b64_tr_b16 v[240:241], v7 offset:39424
    ds_read_b64_tr_b16 v[242:243], v7 offset:39536
    ds_write_b128 v12, v[220:223] offset:5120
    v_fma_f32 v74, v71, v74, v75
    v_rsq_f32 v75, v74
    s_waitcnt lgkmcnt(10)
    v_mfma_f32_32x32x16_bf16 v[184:199], v[252:255], v[124:127], v[184:199]
    ds_read_b64_tr_b16 v[244:245], v7 offset:39488
    ds_read_b64_tr_b16 v[246:247], v7 offset:39600
    ds_write_b128 v11, v[224:227] offset:6144
    v_mul_f32 v23, v23, v74
    v_mul_f32 v22, v22, v75
    ds_read_b64_tr_b16 a[72:73], v77 offset:32768
    ds_read_b64_tr_b16 a[74:75], v77 offset:33024
    ds_read_b64_tr_b16 a[76:77], v77 offset:33280
    ds_read_b64_tr_b16 a[78:79], v77 offset:33536
    s_cmp_lg_u32 s28, 0
    s_cbranch_scc1 .cs_115
    v_mfma_f32_16x16x32_bf16 v[54:57], v[26:29], v[248:251], v[54:57]
    v_mfma_f32_16x16x32_bf16 v[58:61], v[26:29], v[252:255], v[58:61]
.cs_115:
    s_waitcnt lgkmcnt(13)
    v_mfma_f32_32x32x16_bf16 v[168:183], v[232:235], v[156:159], v[168:183]
    ds_read_b64_tr_b16 v[248:249], v7 offset:41216
    ds_read_b64_tr_b16 v[250:251], v7 offset:41328
    ds_write_b128 v12, v[228:231] offset:7168
    v_mul_f32 v23, v23, v75
    v_cvt_pk_bf16_f32 v73, v23, v23
    s_waitcnt lgkmcnt(14)
    v_mfma_f32_32x32x16_bf16 v[184:199], v[236:239], v[156:159], v[184:199]
    ds_read_b64_tr_b16 v[252:253], v7 offset:41280
    ds_read_b64_tr_b16 v[254:255], v7 offset:41392
    v_add_u32 v63, 0, v14
    v_add_u32 v64, 0, v15
    v_lshlrev_b32 v73, 16, v73
    v_sub_f32 v73, v23, v73
    s_cmp_lg_u32 s28, 1
    s_cbranch_scc1 .cs_116
    v_mfma_f32_16x16x32_bf16 v[54:57], v[26:29], v[232:235], v[54:57]
    v_mfma_f32_16x16x32_bf16 v[58:61], v[26:29], v[236:239], v[58:61]
.cs_116:
    s_waitcnt lgkmcnt(13)
    v_mfma_f32_32x32x16_bf16 v[168:183], v[240:243], v[160:163], v[168:183]
    ds_read_b64_tr_b16 v[232:233], v7 offset:43008
    ds_read_b64_tr_b16 v[234:235], v7 offset:43120
    v_mul_f32 v73, v73, v8
    v_mul_f32 v74, v23, v8
    s_waitcnt lgkmcnt(12)
    v_mfma_f32_32x32x16_bf16 v[184:199], v[244:247], v[160:163], v[184:199]
    ds_read_b64_tr_b16 v[236:237], v7 offset:43072
    ds_read_b64_tr_b16 v[238:239], v7 offset:43184
    s_waitcnt lgkmcnt(6)
    s_barrier
    ds_read_b128 v[200:203], v13 offset:0
    ds_read_b128 v[204:207], v13 offset:8192
    ds_read_b128 v[208:211], v13 offset:16384
    v_cvt_pk_bf16_f32 v19, v74, v73
    v_mul_f32 v72, v22, v22
    v_mul_u32_u24 v67, 0xf00, v4
    v_sub_u32 v67, v77, v67
    s_waitcnt vmcnt(9)
    ds_read_b64_tr_b16 a[80:81], v67 offset:40960
    ds_read_b64_tr_b16 a[82:83], v67 offset:45056
    ds_read_b64_tr_b16 a[84:85], v67 offset:41472
    ds_read_b64_tr_b16 a[86:87], v67 offset:45568
    s_cmp_lg_u32 s28, 2
    s_cbranch_scc1 .cs_117
    v_mfma_f32_16x16x32_bf16 v[54:57], v[26:29], v[240:243], v[54:57]
    v_mfma_f32_16x16x32_bf16 v[58:61], v[26:29], v[244:247], v[58:61]
.cs_117:
    v_mfma_f32_32x32x16_bf16 v[168:183], v[248:251], v[128:131], v[168:183]
    ds_read_b64_tr_b16 v[240:241], v7 offset:44800
    ds_read_b64_tr_b16 v[242:243], v7 offset:44912
    ds_read_b128 v[212:215], v13 offset:24576
    ds_read_b128 v[216:219], v13 offset:512
    ds_read_b128 v[220:223], v13 offset:8704
    ds_read_b128 v[224:227], v13 offset:16896
    ds_read_b128 v[228:231], v13 offset:25088
    v_mul_f32 v24, 0xc0135761, v22
    v_mul_f32 v72, v72, v22
    s_waitcnt lgkmcnt(15)
    v_mfma_f32_32x32x16_bf16 v[184:199], v[252:255], v[128:131], v[184:199]
    ds_read_b64_tr_b16 v[244:245], v7 offset:44864
    ds_read_b64_tr_b16 v[246:247], v7 offset:44976
    v_mul_f32 v25, 0xbdd2d3e8, v72
    s_cmp_lg_u32 s28, 3
    s_cbranch_scc1 .cs_118
    v_mfma_f32_16x16x32_bf16 v[54:57], v[26:29], v[248:251], v[54:57]
    v_mfma_f32_16x16x32_bf16 v[58:61], v[26:29], v[252:255], v[58:61]
.cs_118:
    s_waitcnt vmcnt(4)
    v_bitop3_b32 v67, v164, v148, v120 bitop3:0x80
    v_bitop3_b32 v67, v67, v152, 1 bitop3:0x80
    v_cmp_eq_u32 vcc, 0, v67
    s_cbranch_vccnz .crt_119
.cok_121:
    v_mfma_f32_32x32x16_bf16 v[168:183], v[232:235], v[164:167], v[168:183]
    ds_read_b64_tr_b16 v[248:249], v7 offset:46592
    ds_read_b64_tr_b16 v[250:251], v7 offset:46704
    s_waitcnt lgkmcnt(15)
    v_mfma_f32_32x32x16_bf16 v[184:199], v[236:239], v[164:167], v[184:199]
    ds_read_b64_tr_b16 v[252:253], v7 offset:46656
    ds_read_b64_tr_b16 v[254:255], v7 offset:46768
    v_add_f32 v200, v200, v204
    v_add_f32 v201, v201, v205
    v_add_f32 v202, v202, v206
    v_add_f32 v203, v203, v207
    v_add_f32 v200, v200, v78
    v_add_f32 v201, v201, v79
    ds_read_b64_tr_b16 a[88:89], v77 offset:24576
    ds_read_b64_tr_b16 a[90:91], v77 offset:24832
    ds_read_b64_tr_b16 a[92:93], v77 offset:25088
    ds_read_b64_tr_b16 a[94:95], v77 offset:25344
    s_cmp_lg_u32 s28, 0
    s_cbranch_scc1 .cs_122
    v_mfma_f32_16x16x32_bf16 v[54:57], v[26:29], v[232:235], v[54:57]
    v_mfma_f32_16x16x32_bf16 v[58:61], v[26:29], v[236:239], v[58:61]
.cs_122:
    s_waitcnt lgkmcnt(15)
    v_mfma_f32_32x32x16_bf16 v[168:183], v[240:243], v[148:151], v[168:183]
    ds_read_b64_tr_b16 v[232:233], v7 offset:48384
    ds_read_b64_tr_b16 v[234:235], v7 offset:48496
    v_add_f32 v202, v202, v80
    v_add_f32 v203, v203, v81
    s_waitcnt lgkmcnt(15)
    v_add_f32 v208, v208, v212
    v_add_f32 v209, v209, v213
    v_add_f32 v210, v210, v214
    v_add_f32 v211, v211, v215
    s_waitcnt lgkmcnt(10)
    v_mfma_f32_32x32x16_bf16 v[184:199], v[244:247], v[148:151], v[184:199]
    ds_read_b64_tr_b16 v[236:237], v7 offset:48448
    ds_read_b64_tr_b16 v[238:239], v7 offset:48560
    v_add_f32 v200, v200, v208
    v_add_f32 v201, v201, v209
    v_add_f32 v202, v202, v210
    v_add_f32 v203, v203, v211
    v_cvt_pk_bf16_f32 v34, v200, v201
    v_cvt_pk_bf16_f32 v35, v202, v203
    v_or_b32 v34, 1, v34
    s_cmp_lg_u32 s28, 1
    s_cbranch_scc1 .cs_123
    v_mfma_f32_16x16x32_bf16 v[54:57], v[26:29], v[240:243], v[54:57]
    v_mfma_f32_16x16x32_bf16 v[58:61], v[26:29], v[244:247], v[58:61]
.cs_123:
    s_waitcnt lgkmcnt(10)
    v_mfma_f32_32x32x16_bf16 v[168:183], v[248:251], v[120:123], v[168:183]
    ds_read_b64_tr_b16 v[240:241], v7 offset:50176
    ds_read_b64_tr_b16 v[242:243], v7 offset:50288
    v_add_f32 v216, v216, v220
    v_add_f32 v217, v217, v221
    v_add_f32 v218, v218, v222
    v_add_f32 v219, v219, v223
    v_add_f32 v216, v216, v82
    v_add_f32 v217, v217, v83
    s_waitcnt lgkmcnt(10)
    v_mfma_f32_32x32x16_bf16 v[184:199], v[252:255], v[120:123], v[184:199]
    ds_read_b64_tr_b16 v[244:245], v7 offset:50240
    ds_read_b64_tr_b16 v[246:247], v7 offset:50352
    v_add_f32 v218, v218, v84
    v_add_f32 v219, v219, v85
    v_add_f32 v224, v224, v228
    v_add_f32 v225, v225, v229
    v_add_f32 v226, v226, v230
    v_add_f32 v227, v227, v231
    s_cmp_lg_u32 s28, 2
    s_cbranch_scc1 .cs_124
    v_mfma_f32_16x16x32_bf16 v[54:57], v[26:29], v[248:251], v[54:57]
    v_mfma_f32_16x16x32_bf16 v[58:61], v[26:29], v[252:255], v[58:61]
.cs_124:
    s_waitcnt lgkmcnt(6)
    v_mfma_f32_32x32x16_bf16 v[168:183], v[232:235], v[152:155], v[168:183]
    ds_read_b64_tr_b16 v[248:249], v7 offset:51968
    ds_read_b64_tr_b16 v[250:251], v7 offset:52080
    v_add_f32 v216, v216, v224
    v_add_f32 v217, v217, v225
    v_add_f32 v218, v218, v226
    v_add_f32 v219, v219, v227
    v_cvt_pk_bf16_f32 v36, v216, v217
    v_cvt_pk_bf16_f32 v37, v218, v219
    s_cmp_eq_u32 s33, 1
    s_cbranch_scc0 .slow_125
    global_store_dwordx4 v63, v[34:37], s[24:25]
.sten_126:
    s_waitcnt lgkmcnt(6)
    v_mfma_f32_32x32x16_bf16 v[184:199], v[236:239], v[152:155], v[184:199]
    ds_read_b64_tr_b16 v[252:253], v7 offset:52032
    ds_read_b64_tr_b16 v[254:255], v7 offset:52144
    v_add_f32 v204, v200, v201
    v_mul_f32 v205, v200, v200
    v_fmac_f32 v205, v201, v201
    v_add_f32 v204, v204, v202
    v_fmac_f32 v205, v202, v202
    v_add_f32 v204, v204, v203
    v_fmac_f32 v205, v203, v203
    s_cmp_lg_u32 s28, 3
    s_cbranch_scc1 .cs_127
    v_mfma_f32_16x16x32_bf16 v[54:57], v[26:29], v[232:235], v[54:57]
    v_mfma_f32_16x16x32_bf16 v[58:61], v[26:29], v[236:239], v[58:61]
.cs_127:
    s_waitcnt vmcnt(1)
    v_bitop3_b32 v67, v132, v140, v144 bitop3:0x80
    v_bitop3_b32 v67, v67, v136, 1 bitop3:0x80
    v_cmp_eq_u32 vcc, 0, v67
    s_cbranch_vccnz .crt_128
.cok_130:
    s_waitcnt lgkmcnt(6)
    v_mfma_f32_32x32x16_bf16 v[168:183], v[240:243], v[132:135], v[168:183]
    ds_read_b64_tr_b16 v[232:233], v7 offset:53760
    ds_read_b64_tr_b16 v[234:235], v7 offset:53872
    v_add_f32 v204, v204, v216
    v_fmac_f32 v205, v216, v216
    v_add_f32 v204, v204, v217
    v_fmac_f32 v205, v217, v217
    v_add_f32 v204, v204, v218
    v_fmac_f32 v205, v218, v218
    v_add_f32 v204, v204, v219
    s_waitcnt lgkmcnt(6)
    v_mfma_f32_32x32x16_bf16 v[184:199], v[244:247], v[132:135], v[184:199]
    ds_read_b64_tr_b16 v[236:237], v7 offset:53824
    ds_read_b64_tr_b16 v[238:239], v7 offset:53936
    v_fmac_f32 v205, v219, v219
    s_nop 1
    v_permlane32_swap_b32 v204, v205
    v_add_f32 v204, v204, v205
    v_cvt_pk_bf16_f32 v34, v200, v201
    v_mov_b32 v205, v204
    s_nop 1
    v_permlane16_swap_b32 v204, v205
    v_add_f32 v204, v204, v205
    s_cmp_lg_u32 s28, 0
    s_cbranch_scc1 .cs_131
    v_mfma_f32_16x16x32_bf16 v[54:57], v[26:29], v[240:243], v[54:57]
    v_mfma_f32_16x16x32_bf16 v[58:61], v[26:29], v[244:247], v[58:61]
.cs_131:
    s_waitcnt lgkmcnt(6)
    v_mfma_f32_32x32x16_bf16 v[168:183], v[248:251], v[140:143], v[168:183]
    ds_read_b64_tr_b16 v[240:241], v7 offset:55552
    ds_read_b64_tr_b16 v[242:243], v7 offset:55664
    v_add_f32_dpp v204, v204, v204 row_ror:8 row_mask:0xf bank_mask:0xf
    v_or_b32 v204, 1, v204
    s_cmp_eq_u32 s33, 1
    s_cbranch_scc0 .slow_132
    global_store_dword v64, v204, s[24:25]
.sten_133:
    s_barrier
    s_waitcnt lgkmcnt(6)
    v_mfma_f32_32x32x16_bf16 v[184:199], v[252:255], v[140:143], v[184:199]
    ds_read_b64_tr_b16 v[244:245], v7 offset:55616
    ds_read_b64_tr_b16 v[246:247], v7 offset:55728
    s_cmp_lg_u32 s28, 1
    s_cbranch_scc1 .cs_134
    v_mfma_f32_16x16x32_bf16 v[54:57], v[26:29], v[248:251], v[54:57]
    v_mfma_f32_16x16x32_bf16 v[58:61], v[26:29], v[252:255], v[58:61]
.cs_134:
    s_waitcnt lgkmcnt(6)
    v_mfma_f32_32x32x16_bf16 v[168:183], v[232:235], v[144:147], v[168:183]
    ds_read_b64_tr_b16 v[248:249], v7 offset:0
    ds_read_b64_tr_b16 v[250:251], v7 offset:112
    s_waitcnt lgkmcnt(6)
    v_mfma_f32_32x32x16_bf16 v[184:199], v[236:239], v[144:147], v[184:199]
    ds_read_b64_tr_b16 v[252:253], v7 offset:64
    ds_read_b64_tr_b16 v[254:255], v7 offset:176
    s_cmp_lg_u32 s28, 2
    s_cbranch_scc1 .cs_135
    v_mfma_f32_16x16x32_bf16 v[54:57], v[26:29], v[232:235], v[54:57]
    v_mfma_f32_16x16x32_bf16 v[58:61], v[26:29], v[236:239], v[58:61]
.cs_135:
    s_waitcnt lgkmcnt(6)
    v_mfma_f32_32x32x16_bf16 v[168:183], v[240:243], v[136:139], v[168:183]
    ds_read_b64_tr_b16 v[232:233], v7 offset:1792
    ds_read_b64_tr_b16 v[234:235], v7 offset:1904
    s_waitcnt lgkmcnt(6)
    v_mfma_f32_32x32x16_bf16 v[184:199], v[244:247], v[136:139], v[184:199]
    ds_read_b64_tr_b16 v[236:237], v7 offset:1856
    ds_read_b64_tr_b16 v[238:239], v7 offset:1968
    s_add_u32 s44, s47, 81920
    s_add_u32 m0, s53, 149504
    v_add_u32 v67, s44, v66
    global_load_lds_dwordx4 v67, s[16:17] offset:-2048
    global_load_lds_dwordx4 v67, s[16:17] offset:2048
    s_cmp_lg_u32 s28, 3
    s_cbranch_scc1 .cs_136
    v_mfma_f32_16x16x32_bf16 v[54:57], v[26:29], v[240:243], v[54:57]
    v_mfma_f32_16x16x32_bf16 v[58:61], v[26:29], v[244:247], v[58:61]
.cs_136:
    s_mul_i32 s44, s28, 512
    s_add_u32 s44, s44, 106496
    v_lshl_add_u32 v67, v1, 3, s44
    s_nop 6
    ds_write2_b32 v67, v54, v58 offset1:1
    s_waitcnt lgkmcnt(0)
    s_barrier
    v_lshlrev_b32 v67, 3, v1
    v_add_u32 v67, 106496, v67
    ds_read_b64 v[78:79], v67 offset:0
    ds_read_b64 v[80:81], v67 offset:512
    ds_read_b64 v[82:83], v67 offset:1024
    ds_read_b64 v[84:85], v67 offset:1536
    s_waitcnt lgkmcnt(0)
    v_pk_add_f32 v[78:79], v[78:79], v[80:81]
    v_pk_add_f32 v[82:83], v[82:83], v[84:85]
    v_pk_add_f32 v[78:79], v[78:79], v[82:83]
    v_cvt_pk_bf16_f32 v80, v78, v78
    v_lshlrev_b32 v80, 16, v80
    v_sub_f32 v80, v78, v80
    v_cndmask_b32 v80, v78, v80, s[40:41]
    v_mul_f32 v81, v78, v8
    v_cvt_pk_bf16_f32 v42, v80, v81
    v_cvt_pk_bf16_f32 v82, v79, v79
    v_lshlrev_b32 v82, 16, v82
    v_sub_f32 v82, v79, v82
    v_cndmask_b32 v82, v79, v82, s[40:41]
    v_mul_f32 v83, v79, v8
    v_cvt_pk_bf16_f32 v44, v82, v83
    s_nop 1
    v_mfma_f32_32x32x16_bf16 v[168:183], v[42:45], v[18:21], v[168:183]
    s_and_b32 s44, s27, 1
    s_lshl_b32 s45, s44, 12
    s_add_u32 s45, s45, s63
    s_add_u32 s45, s45, 983040
    v_add_u32 v63, s45, v2
    v_mfma_f32_32x32x16_bf16 v[184:199], v[42:45], v[16:19], v[184:199]
    s_and_b32 s44, s27, 1
    s_lshl_b32 s45, s44, 9
    s_add_u32 s45, s45, s63
    s_add_u32 s45, s45, 986112
    v_lshl_add_u32 v64, v3, 4, s45
    s_add_u32 s44, s47, 98304
    s_add_u32 m0, s53, 157696
    v_add_u32 v67, s44, v66
    global_load_lds_dwordx4 v67, s[16:17] offset:-2048
    global_load_lds_dwordx4 v67, s[16:17] offset:2048
    v_mul_f32 v78, v168, v168
    v_mul_f32 v79, v169, v169
    v_mul_f32 v80, v170, v170
    v_mul_f32 v81, v171, v171
    v_mul_f32 v82, v172, v172
    v_mul_f32 v83, v173, v173
    s_add_u32 s44, s62, s58
    s_add_u32 s44, s44, 4096
    v_add_u32 v62, s44, v2
    global_load_dwordx4 v[124:127], v62, s[24:25] offset:-4096 sc1
    s_add_u32 s44, s48, 0
    s_add_u32 m0, s53, 141312
    v_add_u32 v67, s44, v66
    global_load_lds_dwordx4 v67, s[16:17] offset:-2048
    global_load_lds_dwordx4 v67, s[16:17] offset:2048
    v_mul_f32 v84, v174, v174
    v_mul_f32 v85, v175, v175
    v_fma_f32 v78, v78, v25, v24
    global_load_dwordx4 v[156:159], v62, s[24:25] offset:-3072 sc1
    v_fma_f32 v79, v79, v25, v24
    v_fma_f32 v80, v80, v25, v24
    v_fma_f32 v81, v81, v25, v24
    global_load_dwordx4 v[160:163], v62, s[24:25] offset:-2048 sc1
    v_fma_f32 v82, v82, v25, v24
    v_fma_f32 v83, v83, v25, v24
    s_add_u32 s44, s48, 16384
    s_add_u32 m0, s53, 116736
    v_add_u32 v67, s44, v66
    global_load_lds_dwordx4 v67, s[16:17] offset:-2048
    global_load_lds_dwordx4 v67, s[16:17] offset:2048
    v_fma_f32 v84, v84, v25, v24
    global_load_dwordx4 v[128:131], v62, s[24:25] offset:-1024 sc1
    v_fma_f32 v85, v85, v25, v24
    v_mul_f32 v78, v78, v168
    v_mul_f32 v79, v79, v169
    global_load_dwordx4 v[164:167], v62, s[24:25] offset:0 sc1
    v_mul_f32 v80, v80, v170
    v_mul_f32 v81, v81, v171
    v_mul_f32 v82, v82, v172
    global_load_dwordx4 v[148:151], v62, s[24:25] offset:1024 sc1
    v_mul_f32 v83, v83, v173
    v_mul_f32 v84, v84, v174
    v_mul_f32 v85, v85, v175
    global_load_dwordx4 v[120:123], v62, s[24:25] offset:2048 sc1
    v_exp_f32 v78, v78
    v_exp_f32 v79, v79
    v_exp_f32 v80, v80
    global_load_dwordx4 v[152:155], v62, s[24:25] offset:3072 sc1
    v_exp_f32 v81, v81
    v_exp_f32 v82, v82
    v_exp_f32 v83, v83
    s_add_u32 s44, s62, s59
    s_add_u32 s44, s44, 4096
    v_add_u32 v62, s44, v2
    global_load_dwordx4 v[132:135], v62, s[24:25] offset:-4096 sc1
    v_exp_f32 v84, v84
    v_exp_f32 v85, v85
    v_fma_f32 v78, v78, v23, v23
    global_load_dwordx4 v[140:143], v62, s[24:25] offset:-3072 sc1
    v_fma_f32 v79, v79, v23, v23
    v_fma_f32 v80, v80, v23, v23
    v_fma_f32 v81, v81, v23, v23
    global_load_dwordx4 v[144:147], v62, s[24:25] offset:-2048 sc1
    v_fma_f32 v82, v82, v23, v23
    v_fma_f32 v83, v83, v23, v23
    v_fma_f32 v84, v84, v23, v23
    global_load_dwordx4 v[136:139], v62, s[24:25] offset:-1024 sc1
    v_fma_f32 v85, v85, v23, v23
    v_rcp_f32 v78, v78
    v_rcp_f32 v79, v79
    v_rcp_f32 v80, v80
    v_rcp_f32 v81, v81
    v_rcp_f32 v82, v82
    v_rcp_f32 v83, v83
    v_rcp_f32 v84, v84
    v_rcp_f32 v85, v85
    v_mul_f32 v78, v78, v168
    v_mul_f32 v79, v79, v169
    v_mul_f32 v80, v80, v170
    v_mul_f32 v81, v81, v171
    v_mul_f32 v82, v82, v172
    v_mul_f32 v83, v83, v173
    v_mul_f32 v84, v84, v174
    v_mul_f32 v85, v85, v175
    v_cvt_pk_bf16_f32 v168, v78, v79
    v_cvt_pk_bf16_f32 v169, v80, v81
    v_cvt_pk_bf16_f32 v170, v82, v83
    v_and_b32 v168, -2, v168
    v_cvt_pk_bf16_f32 v171, v84, v85
    global_store_dwordx4 v63, v[168:171], s[24:25] offset:0 sc1
    v_mul_f32 v78, v176, v176
    v_mul_f32 v79, v177, v177
    v_mul_f32 v80, v178, v178
    v_mul_f32 v81, v179, v179
    v_mul_f32 v82, v180, v180
    v_mul_f32 v83, v181, v181
    v_mul_f32 v84, v182, v182
    v_mul_f32 v85, v183, v183
    v_fma_f32 v78, v78, v25, v24
    v_fma_f32 v79, v79, v25, v24
    v_fma_f32 v80, v80, v25, v24
    v_fma_f32 v81, v81, v25, v24
    v_fma_f32 v82, v82, v25, v24
    v_fma_f32 v83, v83, v25, v24
    v_fma_f32 v84, v84, v25, v24
    v_fma_f32 v85, v85, v25, v24
    s_waitcnt vmcnt(19)
    ds_read_b64_tr_b16 a[96:97], v77 offset:32768
    ds_read_b64_tr_b16 a[98:99], v77 offset:33024
    ds_read_b64_tr_b16 a[100:101], v77 offset:33280
    ds_read_b64_tr_b16 a[102:103], v77 offset:33536
    v_mul_f32 v78, v78, v176
    v_mul_f32 v79, v79, v177
    v_mul_f32 v80, v80, v178
    v_mul_f32 v81, v81, v179
    v_mul_f32 v82, v82, v180
    v_mul_f32 v83, v83, v181
    v_mul_f32 v84, v84, v182
    v_mul_f32 v85, v85, v183
    v_exp_f32 v78, v78
    v_exp_f32 v79, v79
    v_exp_f32 v80, v80
    v_exp_f32 v81, v81
    v_exp_f32 v82, v82
    v_exp_f32 v83, v83
    v_exp_f32 v84, v84
    v_exp_f32 v85, v85
    v_fma_f32 v78, v78, v23, v23
    v_fma_f32 v79, v79, v23, v23
    v_fma_f32 v80, v80, v23, v23
    v_fma_f32 v81, v81, v23, v23
    s_waitcnt vmcnt(9)
    v_bitop3_b32 v67, v124, v156, v160 bitop3:0x80
    v_bitop3_b32 v67, v67, v128, 1 bitop3:0x80
    v_cmp_eq_u32 vcc, 0, v67
    s_cbranch_vccnz .crt_137
.cok_139:
    v_mfma_f32_32x32x16_bf16 v[200:215], v[248:251], v[124:127], 0
    ds_read_b64_tr_b16 v[240:241], v7 offset:3584
    ds_read_b64_tr_b16 v[242:243], v7 offset:3696
    v_fma_f32 v82, v82, v23, v23
    v_fma_f32 v83, v83, v23, v23
    v_fma_f32 v84, v84, v23, v23
    v_fma_f32 v85, v85, v23, v23
    v_rcp_f32 v78, v78
    v_mfma_f32_32x32x16_bf16 v[216:231], v[252:255], v[124:127], 0
    ds_read_b64_tr_b16 v[244:245], v7 offset:3648
    ds_read_b64_tr_b16 v[246:247], v7 offset:3760
    global_load_dwordx4 v[124:127], v62, s[24:25] offset:0 sc1
    s_add_u32 s44, s48, 32768
    s_add_u32 m0, s53, 124928
    v_add_u32 v67, s44, v66
    global_load_lds_dwordx4 v67, s[16:17] offset:-2048
    global_load_lds_dwordx4 v67, s[16:17] offset:2048
    v_rcp_f32 v79, v79
    v_rcp_f32 v80, v80
    v_rcp_f32 v81, v81
    v_mfma_f32_32x32x16_bf16 v[200:215], v[232:235], v[156:159], v[200:215]
    ds_read_b64_tr_b16 v[248:249], v7 offset:5376
    ds_read_b64_tr_b16 v[250:251], v7 offset:5488
    v_rcp_f32 v82, v82
    v_rcp_f32 v83, v83
    v_rcp_f32 v84, v84
    v_mfma_f32_32x32x16_bf16 v[216:231], v[236:239], v[156:159], v[216:231]
    ds_read_b64_tr_b16 v[252:253], v7 offset:5440
    ds_read_b64_tr_b16 v[254:255], v7 offset:5552
    global_load_dwordx4 v[156:159], v62, s[24:25] offset:1024 sc1
    ds_read_b64_tr_b16 a[104:105], v77 offset:40960
    ds_read_b64_tr_b16 a[106:107], v77 offset:41216
    ds_read_b64_tr_b16 a[108:109], v77 offset:41472
    ds_read_b64_tr_b16 a[110:111], v77 offset:41728
    s_add_u32 s44, s48, 49152
    s_add_u32 m0, s53, 133120
    v_add_u32 v67, s44, v66
    global_load_lds_dwordx4 v67, s[16:17] offset:-2048
    global_load_lds_dwordx4 v67, s[16:17] offset:2048
    v_rcp_f32 v85, v85
    v_mul_f32 v78, v78, v176
    v_mul_f32 v79, v79, v177
    v_mul_f32 v80, v80, v178
    v_mul_f32 v81, v81, v179
    s_waitcnt lgkmcnt(10)
    v_mfma_f32_32x32x16_bf16 v[200:215], v[240:243], v[160:163], v[200:215]
    ds_read_b64_tr_b16 v[232:233], v7 offset:7168
    ds_read_b64_tr_b16 v[234:235], v7 offset:7280
    v_mul_f32 v82, v82, v180
    v_mul_f32 v83, v83, v181
    v_mul_f32 v84, v84, v182
    v_mul_f32 v85, v85, v183
    v_cvt_pk_bf16_f32 v176, v78, v79
    v_cvt_pk_bf16_f32 v177, v80, v81
    s_waitcnt lgkmcnt(10)
    v_mfma_f32_32x32x16_bf16 v[216:231], v[244:247], v[160:163], v[216:231]
    ds_read_b64_tr_b16 v[236:237], v7 offset:7232
    ds_read_b64_tr_b16 v[238:239], v7 offset:7344
    s_add_u32 s44, s36, s34
    s_add_u32 s44, s44, 0x146000
    v_add_u32 v67, s44, v2
    global_load_dwordx4 v[160:163], v67, s[24:25] offset:0 sc1
    ds_read_b64_tr_b16 a[112:113], v77 offset:24576
    ds_read_b64_tr_b16 a[114:115], v77 offset:24832
    ds_read_b64_tr_b16 a[116:117], v77 offset:25088
    ds_read_b64_tr_b16 a[118:119], v77 offset:25344
    s_add_u32 s44, s48, 65536
    s_add_u32 m0, s53, 149504
    v_add_u32 v67, s44, v66
    global_load_lds_dwordx4 v67, s[16:17] offset:-2048
    global_load_lds_dwordx4 v67, s[16:17] offset:2048
    v_cvt_pk_bf16_f32 v178, v82, v83
    v_and_b32 v176, -2, v176
    v_cvt_pk_bf16_f32 v179, v84, v85
    global_store_dwordx4 v63, v[176:179], s[24:25] offset:1024 sc1
    v_mul_f32 v78, v184, v184
    s_waitcnt lgkmcnt(14)
    v_mfma_f32_32x32x16_bf16 v[200:215], v[248:251], v[128:131], v[200:215]
    ds_read_b64_tr_b16 v[240:241], v7 offset:8960
    ds_read_b64_tr_b16 v[242:243], v7 offset:9072
    v_mul_f32 v79, v185, v185
    v_mul_f32 v80, v186, v186
    v_mul_f32 v81, v187, v187
    v_mul_f32 v82, v188, v188
    v_mul_f32 v83, v189, v189
    v_mul_f32 v84, v190, v190
    s_waitcnt lgkmcnt(14)
    v_mfma_f32_32x32x16_bf16 v[216:231], v[252:255], v[128:131], v[216:231]
    ds_read_b64_tr_b16 v[244:245], v7 offset:9024
    ds_read_b64_tr_b16 v[246:247], v7 offset:9136
    s_add_u32 s44, s36, s34
    s_add_u32 s44, s44, 0x146000
    v_add_u32 v67, s44, v2
    global_load_dwordx4 v[128:131], v67, s[24:25] offset:1024 sc1
    ds_read_b64_tr_b16 a[120:121], v77 offset:0
    ds_read_b64_tr_b16 a[122:123], v77 offset:256
    ds_read_b64_tr_b16 a[124:125], v77 offset:512
    ds_read_b64_tr_b16 a[126:127], v77 offset:768
    s_waitcnt lgkmcnt(15)
    s_add_u32 s44, s48, 81920
    s_add_u32 m0, s53, 157696
    v_add_u32 v67, s44, v66
    global_load_lds_dwordx4 v67, s[16:17] offset:-2048
    global_load_lds_dwordx4 v67, s[16:17] offset:2048
    v_mul_f32 v85, v191, v191
    v_fma_f32 v78, v78, v25, v24
    v_fma_f32 v79, v79, v25, v24
    v_fma_f32 v80, v80, v25, v24
    v_fma_f32 v81, v81, v25, v24
    v_fma_f32 v82, v82, v25, v24
    s_waitcnt vmcnt(18)
    v_bitop3_b32 v67, v164, v148, v120 bitop3:0x80
    v_bitop3_b32 v67, v67, v152, 1 bitop3:0x80
    v_cmp_eq_u32 vcc, 0, v67
    s_cbranch_vccnz .crt_140
.cok_142:
    s_waitcnt lgkmcnt(14)
    v_mfma_f32_32x32x16_bf16 v[200:215], v[232:235], v[164:167], v[200:215]
    ds_read_b64_tr_b16 v[248:249], v7 offset:10752
    ds_read_b64_tr_b16 v[250:251], v7 offset:10864
    v_fma_f32 v83, v83, v25, v24
    v_fma_f32 v84, v84, v25, v24
    v_fma_f32 v85, v85, v25, v24
    v_mul_f32 v78, v78, v184
    v_mul_f32 v79, v79, v185
    v_mul_f32 v80, v80, v186
    s_waitcnt lgkmcnt(14)
    v_mfma_f32_32x32x16_bf16 v[216:231], v[236:239], v[164:167], v[216:231]
    ds_read_b64_tr_b16 v[252:253], v7 offset:10816
    ds_read_b64_tr_b16 v[254:255], v7 offset:10928
    global_load_dwordx4 v[164:167], v62, s[24:25] offset:2048 sc1
    v_mul_f32 v81, v81, v187
    v_mul_f32 v82, v82, v188
    v_mul_f32 v83, v83, v189
    v_mul_f32 v84, v84, v190
    v_mul_f32 v85, v85, v191
    v_exp_f32 v78, v78
    s_waitcnt lgkmcnt(10)
    v_mfma_f32_32x32x16_bf16 v[200:215], v[240:243], v[148:151], v[200:215]
    ds_read_b64_tr_b16 v[232:233], v7 offset:12544
    ds_read_b64_tr_b16 v[234:235], v7 offset:12656
    v_exp_f32 v79, v79
    v_exp_f32 v80, v80
    v_exp_f32 v81, v81
    s_waitcnt lgkmcnt(10)
    v_mfma_f32_32x32x16_bf16 v[216:231], v[244:247], v[148:151], v[216:231]
    ds_read_b64_tr_b16 v[236:237], v7 offset:12608
    ds_read_b64_tr_b16 v[238:239], v7 offset:12720
    global_load_dwordx4 v[148:151], v62, s[24:25] offset:3072 sc1
    v_exp_f32 v82, v82
    v_exp_f32 v83, v83
    v_exp_f32 v84, v84
    s_waitcnt lgkmcnt(6)
    v_mfma_f32_32x32x16_bf16 v[200:215], v[248:251], v[120:123], v[200:215]
    ds_read_b64_tr_b16 v[240:241], v7 offset:14336
    ds_read_b64_tr_b16 v[242:243], v7 offset:14448
    v_exp_f32 v85, v85
    v_fma_f32 v78, v78, v23, v23
    v_fma_f32 v79, v79, v23, v23
    v_fma_f32 v80, v80, v23, v23
    s_waitcnt lgkmcnt(6)
    v_mfma_f32_32x32x16_bf16 v[216:231], v[252:255], v[120:123], v[216:231]
    ds_read_b64_tr_b16 v[244:245], v7 offset:14400
    ds_read_b64_tr_b16 v[246:247], v7 offset:14512
    s_add_u32 s44, s62, s60
    s_add_u32 s44, s44, 4096
    v_add_u32 v62, s44, v2
    global_load_dwordx4 v[120:123], v62, s[24:25] offset:-4096 sc1
    v_fma_f32 v81, v81, v23, v23
    v_fma_f32 v82, v82, v23, v23
    v_fma_f32 v83, v83, v23, v23
    v_fma_f32 v84, v84, v23, v23
    v_fma_f32 v85, v85, v23, v23
    v_rcp_f32 v78, v78
    s_waitcnt lgkmcnt(6)
    v_mfma_f32_32x32x16_bf16 v[200:215], v[232:235], v[152:155], v[200:215]
    ds_read_b64_tr_b16 v[248:249], v7 offset:16128
    ds_read_b64_tr_b16 v[250:251], v7 offset:16240
    v_rcp_f32 v79, v79
    v_rcp_f32 v80, v80
    v_rcp_f32 v81, v81
    s_waitcnt lgkmcnt(6)
    v_mfma_f32_32x32x16_bf16 v[216:231], v[236:239], v[152:155], v[216:231]
    ds_read_b64_tr_b16 v[252:253], v7 offset:16192
    ds_read_b64_tr_b16 v[254:255], v7 offset:16304
    global_load_dwordx4 v[152:155], v62, s[24:25] offset:-3072 sc1
    s_waitcnt vmcnt(14)
    ds_read_b64_tr_b16 a[128:129], v77 offset:8192
    ds_read_b64_tr_b16 a[130:131], v77 offset:8448
    ds_read_b64_tr_b16 a[132:133], v77 offset:8704
    ds_read_b64_tr_b16 a[134:135], v77 offset:8960
    v_rcp_f32 v82, v82
    v_rcp_f32 v83, v83
    v_rcp_f32 v84, v84
    v_bitop3_b32 v67, v132, v140, v144 bitop3:0x80
    v_bitop3_b32 v67, v67, v136, 1 bitop3:0x80
    v_cmp_eq_u32 vcc, 0, v67
    s_cbranch_vccnz .crt_143
.cok_145:
    s_waitcnt lgkmcnt(10)
    v_mfma_f32_32x32x16_bf16 v[200:215], v[240:243], v[132:135], v[200:215]
    ds_read_b64_tr_b16 v[232:233], v7 offset:17920
    ds_read_b64_tr_b16 v[234:235], v7 offset:18032
    v_rcp_f32 v85, v85
    v_mul_f32 v78, v78, v184
    v_mul_f32 v79, v79, v185
    v_mul_f32 v80, v80, v186
    s_waitcnt lgkmcnt(10)
    v_mfma_f32_32x32x16_bf16 v[216:231], v[244:247], v[132:135], v[216:231]
    ds_read_b64_tr_b16 v[236:237], v7 offset:17984
    ds_read_b64_tr_b16 v[238:239], v7 offset:18096
    global_load_dwordx4 v[132:135], v62, s[24:25] offset:-2048 sc1
    v_mul_u32_u24 v67, 0xf00, v4
    v_sub_u32 v67, v77, v67
    s_waitcnt vmcnt(12)
    ds_read_b64_tr_b16 a[136:137], v67 offset:16384
    ds_read_b64_tr_b16 a[138:139], v67 offset:20480
    ds_read_b64_tr_b16 a[140:141], v67 offset:16896
    ds_read_b64_tr_b16 a[142:143], v67 offset:20992
    v_mul_f32 v81, v81, v187
    v_mul_f32 v82, v82, v188
    v_mul_f32 v83, v83, v189
    v_mul_f32 v84, v84, v190
    v_mul_f32 v85, v85, v191
    v_cvt_pk_bf16_f32 v184, v78, v79
    s_waitcnt lgkmcnt(14)
    v_mfma_f32_32x32x16_bf16 v[200:215], v[248:251], v[140:143], v[200:215]
    ds_read_b64_tr_b16 v[240:241], v7 offset:19712
    ds_read_b64_tr_b16 v[242:243], v7 offset:19824
    v_cvt_pk_bf16_f32 v185, v80, v81
    v_cvt_pk_bf16_f32 v186, v82, v83
    v_and_b32 v184, -2, v184
    v_cvt_pk_bf16_f32 v187, v84, v85
    global_store_dwordx4 v63, v[184:187], s[24:25] offset:2048 sc1
    s_waitcnt lgkmcnt(14)
    v_mfma_f32_32x32x16_bf16 v[216:231], v[252:255], v[140:143], v[216:231]
    ds_read_b64_tr_b16 v[244:245], v7 offset:19776
    ds_read_b64_tr_b16 v[246:247], v7 offset:19888
    global_load_dwordx4 v[140:143], v62, s[24:25] offset:-1024 sc1
    s_waitcnt vmcnt(11)
    ds_read_b64_tr_b16 a[144:145], v77 offset:32768
    ds_read_b64_tr_b16 a[146:147], v77 offset:33024
    ds_read_b64_tr_b16 a[148:149], v77 offset:33280
    ds_read_b64_tr_b16 a[150:151], v77 offset:33536
    v_mul_f32 v78, v192, v192
    v_mul_f32 v79, v193, v193
    v_mul_f32 v80, v194, v194
    v_mul_f32 v81, v195, v195
    v_fma_f32 v78, v78, v25, v24
    v_fma_f32 v79, v79, v25, v24
    s_waitcnt lgkmcnt(14)
    v_mfma_f32_32x32x16_bf16 v[200:215], v[232:235], v[144:147], v[200:215]
    ds_read_b64_tr_b16 v[248:249], v7 offset:21504
    ds_read_b64_tr_b16 v[250:251], v7 offset:21616
    v_fma_f32 v80, v80, v25, v24
    v_fma_f32 v81, v81, v25, v24
    v_mul_f32 v78, v78, v192
    v_mul_f32 v79, v79, v193
    v_mul_f32 v80, v80, v194
    v_mul_f32 v81, v81, v195
    s_waitcnt lgkmcnt(14)
    v_mfma_f32_32x32x16_bf16 v[216:231], v[236:239], v[144:147], v[216:231]
    ds_read_b64_tr_b16 v[252:253], v7 offset:21568
    ds_read_b64_tr_b16 v[254:255], v7 offset:21680
    global_load_dwordx4 v[144:147], v62, s[24:25] offset:0 sc1
    s_waitcnt vmcnt(8)
    ds_read_b64_tr_b16 a[152:153], v77 offset:40960
    ds_read_b64_tr_b16 a[154:155], v77 offset:41216
    ds_read_b64_tr_b16 a[156:157], v77 offset:41472
    ds_read_b64_tr_b16 a[158:159], v77 offset:41728
    v_exp_f32 v78, v78
    v_exp_f32 v79, v79
    v_exp_f32 v80, v80
    s_waitcnt lgkmcnt(14)
    v_mfma_f32_32x32x16_bf16 v[200:215], v[240:243], v[136:139], v[200:215]
    ds_read_b64_tr_b16 v[232:233], v7 offset:23296
    ds_read_b64_tr_b16 v[234:235], v7 offset:23408
    v_exp_f32 v81, v81
    v_fma_f32 v78, v78, v23, v23
    v_fma_f32 v79, v79, v23, v23
    v_fma_f32 v80, v80, v23, v23
    v_fma_f32 v81, v81, v23, v23
    s_waitcnt lgkmcnt(14)
    v_mfma_f32_32x32x16_bf16 v[216:231], v[244:247], v[136:139], v[216:231]
    ds_read_b64_tr_b16 v[236:237], v7 offset:23360
    ds_read_b64_tr_b16 v[238:239], v7 offset:23472
    global_load_dwordx4 v[136:139], v62, s[24:25] offset:1024 sc1
    v_rcp_f32 v78, v78
    v_rcp_f32 v79, v79
    v_rcp_f32 v80, v80
    s_waitcnt vmcnt(7)
    v_bitop3_b32 v67, v124, v156, v164 bitop3:0x80
    v_bitop3_b32 v67, v67, v148, 1 bitop3:0x80
    v_cmp_eq_u32 vcc, 0, v67
    s_cbranch_vccnz .crt_146
.cok_148:
    s_waitcnt lgkmcnt(10)
    v_mfma_f32_32x32x16_bf16 v[200:215], v[248:251], v[124:127], v[200:215]
    ds_read_b64_tr_b16 v[240:241], v7 offset:25088
    ds_read_b64_tr_b16 v[242:243], v7 offset:25200
    v_rcp_f32 v81, v81
    v_mul_f32 v78, v78, v192
    v_mul_f32 v79, v79, v193
    v_mul_f32 v80, v80, v194
    v_mul_f32 v81, v81, v195
    s_waitcnt lgkmcnt(10)
    v_mfma_f32_32x32x16_bf16 v[216:231], v[252:255], v[124:127], v[216:231]
    ds_read_b64_tr_b16 v[244:245], v7 offset:25152
    ds_read_b64_tr_b16 v[246:247], v7 offset:25264
    global_load_dwordx4 v[124:127], v62, s[24:25] offset:2048 sc1
    v_cvt_pk_bf16_f32 v192, v78, v79
    v_cvt_pk_bf16_f32 v193, v80, v81
    v_mov_b32 v194, v192
    v_mov_b32 v195, v193
    s_nop 0
    v_permlane32_swap_b32 v192, v194
    v_permlane32_swap_b32 v193, v195
    s_waitcnt lgkmcnt(6)
    v_mfma_f32_32x32x16_bf16 v[200:215], v[232:235], v[156:159], v[200:215]
    ds_read_b64_tr_b16 v[248:249], v7 offset:26880
    ds_read_b64_tr_b16 v[250:251], v7 offset:26992
    v_and_b32 v192, -2, v192
    global_store_dwordx4 v64, v[192:195], s[24:25] sc1
    s_waitcnt lgkmcnt(6)
    v_mfma_f32_32x32x16_bf16 v[216:231], v[236:239], v[156:159], v[216:231]
    ds_read_b64_tr_b16 v[252:253], v7 offset:26944
    ds_read_b64_tr_b16 v[254:255], v7 offset:27056
    global_load_dwordx4 v[156:159], v62, s[24:25] offset:3072 sc1
    s_waitcnt lgkmcnt(6)
    v_mfma_f32_32x32x16_bf16 v[200:215], v[240:243], v[164:167], v[200:215]
    ds_read_b64_tr_b16 v[232:233], v7 offset:28672
    ds_read_b64_tr_b16 v[234:235], v7 offset:28784
    s_waitcnt lgkmcnt(6)
    v_mfma_f32_32x32x16_bf16 v[216:231], v[244:247], v[164:167], v[216:231]
    ds_read_b64_tr_b16 v[236:237], v7 offset:28736
    ds_read_b64_tr_b16 v[238:239], v7 offset:28848
    s_add_u32 s44, s62, s61
    s_add_u32 s44, s44, 4096
    v_add_u32 v62, s44, v2
    global_load_dwordx4 v[164:167], v62, s[24:25] offset:-4096 sc1
    s_waitcnt lgkmcnt(6)
    v_mfma_f32_32x32x16_bf16 v[200:215], v[248:251], v[148:151], v[200:215]
    ds_read_b64_tr_b16 v[240:241], v7 offset:30464
    ds_read_b64_tr_b16 v[242:243], v7 offset:30576
    v_bitop3_b32 v67, v160, v161, v162 bitop3:0x80
    v_bitop3_b32 v67, v67, v163, v128 bitop3:0x80
    v_bitop3_b32 v67, v67, v129, v130 bitop3:0x80
    v_bitop3_b32 v67, v67, v131, 1 bitop3:0x80
    v_cmp_eq_u32 vcc, 0, v67
    s_cbranch_vccnz .crt_149
.cok_151:
    v_add_f32 v160, v160, v162
    v_add_f32 v161, v161, v163
    v_add_f32 v128, v128, v130
    v_add_f32 v129, v129, v131
    v_add_f32 v70, v160, v128
    v_add_f32 v71, v161, v129
    s_nop 1
    v_permlane32_swap_b32 v70, v71
    s_waitcnt lgkmcnt(6)
    v_mfma_f32_32x32x16_bf16 v[216:231], v[252:255], v[148:151], v[216:231]
    ds_read_b64_tr_b16 v[244:245], v7 offset:30528
    ds_read_b64_tr_b16 v[246:247], v7 offset:30640
    global_load_dwordx4 v[160:163], v62, s[24:25] offset:-3072 sc1
    v_add_f32 v70, v70, v71
    v_mov_b32 v71, v70
    s_waitcnt vmcnt(7)
    v_bitop3_b32 v67, v120, v152, v132 bitop3:0x80
    v_bitop3_b32 v67, v67, v140, 1 bitop3:0x80
    v_cmp_eq_u32 vcc, 0, v67
    s_cbranch_vccnz .crt_152
.cok_154:
    s_waitcnt lgkmcnt(6)
    v_mfma_f32_32x32x16_bf16 v[200:215], v[232:235], v[120:123], v[200:215]
    ds_read_b64_tr_b16 v[248:249], v7 offset:32256
    ds_read_b64_tr_b16 v[250:251], v7 offset:32368
    global_load_dwordx4 v[128:131], v62, s[24:25] offset:-2048 sc1
    v_permlane32_swap_b32 v70, v71
    v_mul_f32 v70, 0xbb000000, v70
    s_waitcnt lgkmcnt(6)
    v_mfma_f32_32x32x16_bf16 v[216:231], v[236:239], v[120:123], v[216:231]
    ds_read_b64_tr_b16 v[252:253], v7 offset:32320
    ds_read_b64_tr_b16 v[254:255], v7 offset:32432
    global_load_dwordx4 v[148:151], v62, s[24:25] offset:-1024 sc1
    v_mul_f32 v72, v70, v70
    v_mul_f32 v71, 0x3b000000, v71
    s_waitcnt lgkmcnt(6)
    v_mfma_f32_32x32x16_bf16 v[200:215], v[240:243], v[152:155], v[200:215]
    ds_read_b64_tr_b16 v[232:233], v7 offset:34048
    ds_read_b64_tr_b16 v[234:235], v7 offset:34160
    global_load_dwordx4 v[120:123], v62, s[24:25] offset:0 sc1
    v_sub_f32 v71, v71, v72
    v_max_f32 v71, 0, v71
    s_waitcnt lgkmcnt(6)
    v_mfma_f32_32x32x16_bf16 v[216:231], v[244:247], v[152:155], v[216:231]
    ds_read_b64_tr_b16 v[236:237], v7 offset:34112
    ds_read_b64_tr_b16 v[238:239], v7 offset:34224
    global_load_dwordx4 v[152:155], v62, s[24:25] offset:1024 sc1
    v_add_f32 v72, 0x3727c5ac, v71
    v_rsq_f32 v26, v72
    s_waitcnt lgkmcnt(6)
    v_mfma_f32_32x32x16_bf16 v[200:215], v[248:251], v[132:135], v[200:215]
    ds_read_b64_tr_b16 v[240:241], v7 offset:35840
    ds_read_b64_tr_b16 v[242:243], v7 offset:35952
    v_cvt_pk_bf16_f32 v73, v70, v70
    v_lshlrev_b32 v73, 16, v73
    s_waitcnt lgkmcnt(6)
    v_mfma_f32_32x32x16_bf16 v[216:231], v[252:255], v[132:135], v[216:231]
    ds_read_b64_tr_b16 v[244:245], v7 offset:35904
    ds_read_b64_tr_b16 v[246:247], v7 offset:36016
    global_load_dwordx4 v[132:135], v62, s[24:25] offset:2048 sc1
    v_sub_f32 v73, v70, v73
    v_mul_f32 v73, v73, v8
    s_waitcnt lgkmcnt(6)
    v_mfma_f32_32x32x16_bf16 v[200:215], v[232:235], v[140:143], v[200:215]
    ds_read_b64_tr_b16 v[248:249], v7 offset:37632
    ds_read_b64_tr_b16 v[250:251], v7 offset:37744
    v_cvt_pk_bf16_f32 v18, v70, v73
    v_mul_f32 v74, v26, v26
    s_waitcnt lgkmcnt(6)
    v_mfma_f32_32x32x16_bf16 v[216:231], v[236:239], v[140:143], v[216:231]
    ds_read_b64_tr_b16 v[252:253], v7 offset:37696
    ds_read_b64_tr_b16 v[254:255], v7 offset:37808
    global_load_dwordx4 v[140:143], v62, s[24:25] offset:3072 sc1
    v_mul_f32 v27, v72, v26
    v_mov_b32 v75, 0x3727c5ac
    s_waitcnt vmcnt(8)
    v_bitop3_b32 v67, v144, v136, v124 bitop3:0x80
    v_bitop3_b32 v67, v67, v156, 1 bitop3:0x80
    v_cmp_eq_u32 vcc, 0, v67
    s_cbranch_vccnz .crt_155
.cok_157:
    s_waitcnt lgkmcnt(6)
    v_mfma_f32_32x32x16_bf16 v[200:215], v[240:243], v[144:147], v[200:215]
    ds_read_b64_tr_b16 v[232:233], v7 offset:39424
    ds_read_b64_tr_b16 v[234:235], v7 offset:39536
    v_fma_f32 v74, v71, v74, v75
    v_rsq_f32 v75, v74
    s_waitcnt lgkmcnt(6)
    v_mfma_f32_32x32x16_bf16 v[216:231], v[244:247], v[144:147], v[216:231]
    ds_read_b64_tr_b16 v[236:237], v7 offset:39488
    ds_read_b64_tr_b16 v[238:239], v7 offset:39600
    v_mul_f32 v27, v27, v74
    v_mul_f32 v26, v26, v75
    s_waitcnt lgkmcnt(6)
    v_mfma_f32_32x32x16_bf16 v[200:215], v[248:251], v[136:139], v[200:215]
    ds_read_b64_tr_b16 v[240:241], v7 offset:41216
    ds_read_b64_tr_b16 v[242:243], v7 offset:41328
    v_mul_f32 v27, v27, v75
    v_cvt_pk_bf16_f32 v73, v27, v27
    s_lshl_b32 s44, s28, 5
    s_add_u32 s44, s44, s27
    s_lshl_b32 s44, s44, 2
    s_add_u32 s44, s44, s35
    v_mov_b32 v68, s44
    v_mov_b32 v67, s31
    s_cmp_eq_u32 s33, 1
    s_cbranch_scc0 .slow_158
    global_store_dword v68, v67, s[24:25] offset:1536
.sten_159:
    s_waitcnt lgkmcnt(6)
    v_mfma_f32_32x32x16_bf16 v[216:231], v[252:255], v[136:139], v[216:231]
    ds_read_b64_tr_b16 v[244:245], v7 offset:41280
    ds_read_b64_tr_b16 v[246:247], v7 offset:41392
    v_lshlrev_b32 v73, 16, v73
    v_sub_f32 v73, v27, v73
    s_waitcnt lgkmcnt(6)
    v_mfma_f32_32x32x16_bf16 v[200:215], v[232:235], v[124:127], v[200:215]
    ds_read_b64_tr_b16 v[248:249], v7 offset:43008
    ds_read_b64_tr_b16 v[250:251], v7 offset:43120
    v_mul_f32 v73, v73, v8
    v_mul_f32 v74, v27, v8
    s_waitcnt lgkmcnt(6)
    v_mfma_f32_32x32x16_bf16 v[216:231], v[236:239], v[124:127], v[216:231]
    ds_read_b64_tr_b16 v[252:253], v7 offset:43072
    ds_read_b64_tr_b16 v[254:255], v7 offset:43184
    v_cvt_pk_bf16_f32 v19, v74, v73
    v_mul_f32 v72, v26, v26
    s_waitcnt lgkmcnt(6)
    v_mfma_f32_32x32x16_bf16 v[200:215], v[240:243], v[156:159], v[200:215]
    ds_read_b64_tr_b16 v[232:233], v7 offset:44800
    ds_read_b64_tr_b16 v[234:235], v7 offset:44912
    v_mul_f32 v28, 0xc0135761, v26
    v_mul_f32 v72, v72, v26
    s_waitcnt lgkmcnt(6)
    v_mfma_f32_32x32x16_bf16 v[216:231], v[244:247], v[156:159], v[216:231]
    ds_read_b64_tr_b16 v[236:237], v7 offset:44864
    ds_read_b64_tr_b16 v[238:239], v7 offset:44976
    v_mul_f32 v29, 0xbdd2d3e8, v72
    s_waitcnt vmcnt(5)
    v_bitop3_b32 v67, v164, v160, v128 bitop3:0x80
    v_bitop3_b32 v67, v67, v148, 1 bitop3:0x80
    v_cmp_eq_u32 vcc, 0, v67
    s_cbranch_vccnz .crt_160
.cok_162:
    s_waitcnt lgkmcnt(6)
    v_mfma_f32_32x32x16_bf16 v[200:215], v[248:251], v[164:167], v[200:215]
    ds_read_b64_tr_b16 v[240:241], v7 offset:46592
    ds_read_b64_tr_b16 v[242:243], v7 offset:46704
    s_waitcnt lgkmcnt(6)
    v_mfma_f32_32x32x16_bf16 v[216:231], v[252:255], v[164:167], v[216:231]
    ds_read_b64_tr_b16 v[244:245], v7 offset:46656
    ds_read_b64_tr_b16 v[246:247], v7 offset:46768
    s_waitcnt lgkmcnt(6)
    v_mfma_f32_32x32x16_bf16 v[200:215], v[232:235], v[160:163], v[200:215]
    ds_read_b64_tr_b16 v[248:249], v7 offset:48384
    ds_read_b64_tr_b16 v[250:251], v7 offset:48496
    s_waitcnt lgkmcnt(6)
    v_mfma_f32_32x32x16_bf16 v[216:231], v[236:239], v[160:163], v[216:231]
    ds_read_b64_tr_b16 v[252:253], v7 offset:48448
    ds_read_b64_tr_b16 v[254:255], v7 offset:48560
    s_waitcnt lgkmcnt(6)
    v_mfma_f32_32x32x16_bf16 v[200:215], v[240:243], v[128:131], v[200:215]
    ds_read_b64_tr_b16 v[232:233], v7 offset:50176
    ds_read_b64_tr_b16 v[234:235], v7 offset:50288
    s_waitcnt lgkmcnt(6)
    v_mfma_f32_32x32x16_bf16 v[216:231], v[244:247], v[128:131], v[216:231]
    ds_read_b64_tr_b16 v[236:237], v7 offset:50240
    ds_read_b64_tr_b16 v[238:239], v7 offset:50352
    s_waitcnt lgkmcnt(6)
    v_mfma_f32_32x32x16_bf16 v[200:215], v[248:251], v[148:151], v[200:215]
    ds_read_b64_tr_b16 v[240:241], v7 offset:51968
    ds_read_b64_tr_b16 v[242:243], v7 offset:52080
    s_waitcnt lgkmcnt(6)
    v_mfma_f32_32x32x16_bf16 v[216:231], v[252:255], v[148:151], v[216:231]
    ds_read_b64_tr_b16 v[244:245], v7 offset:52032
    ds_read_b64_tr_b16 v[246:247], v7 offset:52144
    s_waitcnt vmcnt(1)
    v_bitop3_b32 v67, v120, v152, v132 bitop3:0x80
    v_bitop3_b32 v67, v67, v140, 1 bitop3:0x80
    v_cmp_eq_u32 vcc, 0, v67
    s_cbranch_vccnz .crt_163
.cok_165:
    s_waitcnt lgkmcnt(6)
    v_mfma_f32_32x32x16_bf16 v[200:215], v[232:235], v[120:123], v[200:215]
    ds_read_b64_tr_b16 v[248:249], v7 offset:53760
    ds_read_b64_tr_b16 v[250:251], v7 offset:53872
    s_waitcnt lgkmcnt(6)
    v_mfma_f32_32x32x16_bf16 v[216:231], v[236:239], v[120:123], v[216:231]
    ds_read_b64_tr_b16 v[252:253], v7 offset:53824
    ds_read_b64_tr_b16 v[254:255], v7 offset:53936
    s_lshl_b32 s44, s29, 2
    s_add_u32 s44, s44, s28
    s_lshl_b32 s44, s44, 5
    s_add_u32 s44, s44, s35
    v_and_b32 v69, 7, v1
    v_lshl_add_u32 v69, v69, 2, s44
    global_load_dword v76, v69, s[24:25] offset:1536 sc1
    s_add_u32 s44, s48, 98304
    s_add_u32 m0, s53, 141312
    v_add_u32 v67, s44, v66
    global_load_lds_dwordx4 v67, s[16:17] offset:-2048
    global_load_lds_dwordx4 v67, s[16:17] offset:2048
    s_waitcnt lgkmcnt(6)
    v_mfma_f32_32x32x16_bf16 v[200:215], v[240:243], v[152:155], v[200:215]
    ds_read_b64_tr_b16 v[232:233], v7 offset:55552
    ds_read_b64_tr_b16 v[234:235], v7 offset:55664
    s_waitcnt lgkmcnt(6)
    v_mfma_f32_32x32x16_bf16 v[216:231], v[244:247], v[152:155], v[216:231]
    ds_read_b64_tr_b16 v[236:237], v7 offset:55616
    ds_read_b64_tr_b16 v[238:239], v7 offset:55728
    s_add_u32 s44, s49, 0
    s_add_u32 m0, s53, 116736
    v_add_u32 v67, s44, v66
    global_load_lds_dwordx4 v67, s[16:17] offset:-2048
    global_load_lds_dwordx4 v67, s[16:17] offset:2048
    s_waitcnt lgkmcnt(6)
    v_mfma_f32_32x32x16_bf16 v[200:215], v[248:251], v[132:135], v[200:215]
    s_waitcnt lgkmcnt(4)
    v_mfma_f32_32x32x16_bf16 v[216:231], v[252:255], v[132:135], v[216:231]
    s_add_u32 s44, s49, 16384
    s_add_u32 m0, s53, 124928
    v_add_u32 v67, s44, v66
    global_load_lds_dwordx4 v67, s[16:17] offset:-2048
    global_load_lds_dwordx4 v67, s[16:17] offset:2048
    s_waitcnt lgkmcnt(2)
    v_mfma_f32_32x32x16_bf16 v[200:215], v[232:235], v[140:143], v[200:215]
    s_waitcnt lgkmcnt(0)
    v_mfma_f32_32x32x16_bf16 v[216:231], v[236:239], v[140:143], v[216:231]
    s_add_u32 s44, s49, 32768
    s_add_u32 m0, s53, 133120
    v_add_u32 v67, s44, v66
    global_load_lds_dwordx4 v67, s[16:17] offset:-2048
    global_load_lds_dwordx4 v67, s[16:17] offset:2048
    v_mfma_f32_32x32x16_bf16 v[200:215], v[42:45], v[18:21], v[200:215]
    s_and_b32 s44, s27, 1
    s_lshl_b32 s45, s44, 12
    s_add_u32 s45, s45, s63
    s_add_u32 s45, s45, 524288
    v_add_u32 v63, s45, v2
    v_mfma_f32_32x32x16_bf16 v[216:231], v[42:45], v[16:19], v[216:231]
    s_and_b32 s44, s27, 1
    s_lshl_b32 s45, s44, 9
    s_add_u32 s45, s45, s63
    s_add_u32 s45, s45, 527360
    v_lshl_add_u32 v64, v3, 4, s45
    s_nop 0
    v_pk_mul_f32 v[78:79], v[200:201], v[200:201]
    s_add_u32 s44, s49, 49152
    s_add_u32 m0, s53, 149504
    v_add_u32 v67, s44, v66
    global_load_lds_dwordx4 v67, s[16:17] offset:-2048
    global_load_lds_dwordx4 v67, s[16:17] offset:2048
    v_pk_mul_f32 v[80:81], v[202:203], v[202:203]
    v_pk_mul_f32 v[82:83], v[204:205], v[204:205]
    v_pk_mul_f32 v[84:85], v[206:207], v[206:207]
    v_pk_fma_f32 v[78:79], v[78:79], v[28:29], v[28:29] op_sel:[0,1,0] op_sel_hi:[1,1,0]
    v_pk_fma_f32 v[80:81], v[80:81], v[28:29], v[28:29] op_sel:[0,1,0] op_sel_hi:[1,1,0]
    v_pk_fma_f32 v[82:83], v[82:83], v[28:29], v[28:29] op_sel:[0,1,0] op_sel_hi:[1,1,0]
    v_pk_fma_f32 v[84:85], v[84:85], v[28:29], v[28:29] op_sel:[0,1,0] op_sel_hi:[1,1,0]
    v_pk_mul_f32 v[78:79], v[78:79], v[200:201]
    v_pk_mul_f32 v[80:81], v[80:81], v[202:203]
    v_pk_mul_f32 v[82:83], v[82:83], v[204:205]
    v_pk_mul_f32 v[84:85], v[84:85], v[206:207]
    v_exp_f32 v78, v78
    v_exp_f32 v79, v79
    v_exp_f32 v80, v80
    v_exp_f32 v81, v81
    v_exp_f32 v82, v82
    s_add_u32 s44, s49, 65536
    s_add_u32 m0, s53, 157696
    v_add_u32 v67, s44, v66
    global_load_lds_dwordx4 v67, s[16:17] offset:-2048
    global_load_lds_dwordx4 v67, s[16:17] offset:2048
    v_exp_f32 v83, v83
    v_exp_f32 v84, v84
    v_exp_f32 v85, v85
    v_pk_fma_f32 v[78:79], v[78:79], v[26:27], v[26:27] op_sel:[0,1,1] op_sel_hi:[1,1,1]
    v_pk_fma_f32 v[80:81], v[80:81], v[26:27], v[26:27] op_sel:[0,1,1] op_sel_hi:[1,1,1]
    v_pk_fma_f32 v[82:83], v[82:83], v[26:27], v[26:27] op_sel:[0,1,1] op_sel_hi:[1,1,1]
    v_pk_fma_f32 v[84:85], v[84:85], v[26:27], v[26:27] op_sel:[0,1,1] op_sel_hi:[1,1,1]
    v_rcp_f32 v78, v78
    v_rcp_f32 v79, v79
    v_rcp_f32 v80, v80
    v_rcp_f32 v81, v81
    v_rcp_f32 v82, v82
    v_rcp_f32 v83, v83
    v_rcp_f32 v84, v84
    v_rcp_f32 v85, v85
    v_pk_mul_f32 v[78:79], v[78:79], v[200:201]
    v_pk_mul_f32 v[80:81], v[80:81], v[202:203]
    v_pk_mul_f32 v[82:83], v[82:83], v[204:205]
    v_pk_mul_f32 v[84:85], v[84:85], v[206:207]
    v_cvt_pk_bf16_f32 v200, v78, v79
    v_cvt_pk_bf16_f32 v201, v80, v81
    v_cvt_pk_bf16_f32 v202, v82, v83
    v_and_b32 v200, -2, v200
    v_cvt_pk_bf16_f32 v203, v84, v85
    global_store_dwordx4 v63, v[200:203], s[24:25] offset:0 sc1
    v_pk_mul_f32 v[78:79], v[208:209], v[208:209]
    v_pk_mul_f32 v[80:81], v[210:211], v[210:211]
    v_pk_mul_f32 v[82:83], v[212:213], v[212:213]
    v_pk_mul_f32 v[84:85], v[214:215], v[214:215]
    v_pk_fma_f32 v[78:79], v[78:79], v[28:29], v[28:29] op_sel:[0,1,0] op_sel_hi:[1,1,0]
    v_pk_fma_f32 v[80:81], v[80:81], v[28:29], v[28:29] op_sel:[0,1,0] op_sel_hi:[1,1,0]
    v_pk_fma_f32 v[82:83], v[82:83], v[28:29], v[28:29] op_sel:[0,1,0] op_sel_hi:[1,1,0]
    v_pk_fma_f32 v[84:85], v[84:85], v[28:29], v[28:29] op_sel:[0,1,0] op_sel_hi:[1,1,0]
    v_pk_mul_f32 v[78:79], v[78:79], v[208:209]
    v_pk_mul_f32 v[80:81], v[80:81], v[210:211]
    v_pk_mul_f32 v[82:83], v[82:83], v[212:213]
    v_pk_mul_f32 v[84:85], v[84:85], v[214:215]
    v_exp_f32 v78, v78
    s_waitcnt vmcnt(13)
    v_cmp_ne_u32 vcc, s31, v76
    s_nop 0
    s_cmp_eq_u64 vcc, 0
    s_cbranch_scc1 .pok_166
    s_mov_b32 s51, 0
.poll_167:
    global_load_dword v76, v69, s[24:25] offset:1536 sc1
    s_waitcnt vmcnt(0)
    v_cmp_ne_u32 vcc, s31, v76
    s_add_u32 s51, s51, 1
    s_cmp_eq_u64 vcc, 0
    s_cbranch_scc1 .polld_168
    s_cmp_lt_u32 s51, s37
    s_cbranch_scc1 .poll_167
    s_mov_b32 s37, 1
.polld_168:
.pok_166:
    s_mul_i32 s44, s96, 7168
    s_add_u32 s44, s44, s100
    s_add_u32 s44, s44, 986112
    v_add_u32 v62, s44, v2
    global_load_dwordx4 v[144:147], v62, s[24:25] offset:-3072 sc1
    v_exp_f32 v79, v79
    v_exp_f32 v80, v80
    v_exp_f32 v81, v81
    v_exp_f32 v82, v82
    global_load_dwordx4 v[136:139], v62, s[24:25] offset:-2048 sc1
    v_exp_f32 v83, v83
    v_exp_f32 v84, v84
    s_waitcnt vmcnt(13)
    ds_read_b64_tr_b16 a[160:161], v77 offset:24576
    ds_read_b64_tr_b16 a[162:163], v77 offset:24832
    ds_read_b64_tr_b16 a[164:165], v77 offset:25088
    ds_read_b64_tr_b16 a[166:167], v77 offset:25344
    s_waitcnt lgkmcnt(0)
    s_add_u32 s44, s49, 81920
    s_add_u32 m0, s53, 141312
    v_add_u32 v67, s44, v66
    global_load_lds_dwordx4 v67, s[16:17] offset:-2048
    global_load_lds_dwordx4 v67, s[16:17] offset:2048
    v_exp_f32 v85, v85
    v_pk_fma_f32 v[78:79], v[78:79], v[26:27], v[26:27] op_sel:[0,1,1] op_sel_hi:[1,1,1]
    global_load_dwordx4 v[124:127], v62, s[24:25] offset:-1024 sc1
    v_pk_fma_f32 v[80:81], v[80:81], v[26:27], v[26:27] op_sel:[0,1,1] op_sel_hi:[1,1,1]
    v_pk_fma_f32 v[82:83], v[82:83], v[26:27], v[26:27] op_sel:[0,1,1] op_sel_hi:[1,1,1]
    v_pk_fma_f32 v[84:85], v[84:85], v[26:27], v[26:27] op_sel:[0,1,1] op_sel_hi:[1,1,1]
    v_rcp_f32 v78, v78
    global_load_dwordx4 v[156:159], v62, s[24:25] offset:0 sc1
    v_rcp_f32 v79, v79
    v_rcp_f32 v80, v80
    s_waitcnt vmcnt(15)
    ds_read_b64_tr_b16 a[168:169], v77 offset:0
    ds_read_b64_tr_b16 a[170:171], v77 offset:256
    ds_read_b64_tr_b16 a[172:173], v77 offset:512
    ds_read_b64_tr_b16 a[174:175], v77 offset:768
    s_waitcnt lgkmcnt(0)
    s_add_u32 s44, s49, 98304
    s_add_u32 m0, s53, 116736
    v_add_u32 v67, s44, v66
    global_load_lds_dwordx4 v67, s[16:17] offset:-2048
    global_load_lds_dwordx4 v67, s[16:17] offset:2048
    v_rcp_f32 v81, v81
    v_rcp_f32 v82, v82
    global_load_dwordx4 v[164:167], v62, s[24:25] offset:1024 sc1
    v_rcp_f32 v83, v83
    v_rcp_f32 v84, v84
    v_rcp_f32 v85, v85
    v_pk_mul_f32 v[78:79], v[78:79], v[208:209]
    global_load_dwordx4 v[160:163], v62, s[24:25] offset:2048 sc1
    v_pk_mul_f32 v[80:81], v[80:81], v[210:211]
    v_pk_mul_f32 v[82:83], v[82:83], v[212:213]
    s_waitcnt vmcnt(17)
    ds_read_b64_tr_b16 a[176:177], v77 offset:8192
    ds_read_b64_tr_b16 a[178:179], v77 offset:8448
    ds_read_b64_tr_b16 a[180:181], v77 offset:8704
    ds_read_b64_tr_b16 a[182:183], v77 offset:8960
    v_pk_mul_f32 v[84:85], v[84:85], v[214:215]
    v_cvt_pk_bf16_f32 v208, v78, v79
    global_load_dwordx4 v[128:131], v62, s[24:25] offset:3072 sc1
    v_cvt_pk_bf16_f32 v209, v80, v81
    v_cvt_pk_bf16_f32 v210, v82, v83
    v_and_b32 v208, -2, v208
    v_cvt_pk_bf16_f32 v211, v84, v85
    s_mul_i32 s44, s97, 7168
    s_add_u32 s44, s44, s100
    s_add_u32 s44, s44, 986112
    v_add_u32 v62, s44, v2
    global_load_dwordx4 v[148:151], v62, s[24:25] offset:-3072 sc1
    global_store_dwordx4 v63, v[208:211], s[24:25] offset:1024 sc1
    v_pk_mul_f32 v[78:79], v[216:217], v[216:217]
    v_pk_mul_f32 v[80:81], v[218:219], v[218:219]
    v_pk_mul_f32 v[82:83], v[220:221], v[220:221]
    global_load_dwordx4 v[120:123], v62, s[24:25] offset:-2048 sc1
    v_pk_mul_f32 v[84:85], v[222:223], v[222:223]
    v_pk_fma_f32 v[78:79], v[78:79], v[28:29], v[28:29] op_sel:[0,1,0] op_sel_hi:[1,1,0]
    s_waitcnt vmcnt(19)
    ds_read_b64_tr_b16 a[184:185], v77 offset:16384
    ds_read_b64_tr_b16 a[186:187], v77 offset:16640
    ds_read_b64_tr_b16 a[188:189], v77 offset:16896
    ds_read_b64_tr_b16 a[190:191], v77 offset:17152
    v_pk_fma_f32 v[80:81], v[80:81], v[28:29], v[28:29] op_sel:[0,1,0] op_sel_hi:[1,1,0]
    v_pk_fma_f32 v[82:83], v[82:83], v[28:29], v[28:29] op_sel:[0,1,0] op_sel_hi:[1,1,0]
    global_load_dwordx4 v[152:155], v62, s[24:25] offset:-1024 sc1
    v_pk_fma_f32 v[84:85], v[84:85], v[28:29], v[28:29] op_sel:[0,1,0] op_sel_hi:[1,1,0]
    v_pk_mul_f32 v[78:79], v[78:79], v[216:217]
    v_pk_mul_f32 v[80:81], v[80:81], v[218:219]
    v_pk_mul_f32 v[82:83], v[82:83], v[220:221]
    global_load_dwordx4 v[132:135], v62, s[24:25] offset:0 sc1
    v_pk_mul_f32 v[84:85], v[84:85], v[222:223]
    v_exp_f32 v78, v78
    v_exp_f32 v79, v79
    v_exp_f32 v80, v80
    global_load_dwordx4 v[140:143], v62, s[24:25] offset:1024 sc1
    v_exp_f32 v81, v81
    v_exp_f32 v82, v82
    v_mul_u32_u24 v67, 0xf00, v4
    v_sub_u32 v67, v77, v67
    s_waitcnt vmcnt(20)
    ds_read_b64_tr_b16 a[192:193], v67 offset:32768
    ds_read_b64_tr_b16 a[194:195], v67 offset:36864
    ds_read_b64_tr_b16 a[196:197], v67 offset:33280
    ds_read_b64_tr_b16 a[198:199], v67 offset:37376
    v_exp_f32 v83, v83
    v_exp_f32 v84, v84
    v_exp_f32 v85, v85
    v_pk_fma_f32 v[78:79], v[78:79], v[26:27], v[26:27] op_sel:[0,1,1] op_sel_hi:[1,1,1]
    v_pk_fma_f32 v[80:81], v[80:81], v[26:27], v[26:27] op_sel:[0,1,1] op_sel_hi:[1,1,1]
    v_pk_fma_f32 v[82:83], v[82:83], v[26:27], v[26:27] op_sel:[0,1,1] op_sel_hi:[1,1,1]
    v_pk_fma_f32 v[84:85], v[84:85], v[26:27], v[26:27] op_sel:[0,1,1] op_sel_hi:[1,1,1]
    v_rcp_f32 v78, v78
    v_rcp_f32 v79, v79
    v_rcp_f32 v80, v80
    v_rcp_f32 v81, v81
    v_rcp_f32 v82, v82
    s_waitcnt vmcnt(18)
    ds_read_b64_tr_b16 a[200:201], v77 offset:40960
    ds_read_b64_tr_b16 a[202:203], v77 offset:41216
    ds_read_b64_tr_b16 a[204:205], v77 offset:41472
    ds_read_b64_tr_b16 a[206:207], v77 offset:41728
    v_rcp_f32 v83, v83
    v_rcp_f32 v84, v84
    v_rcp_f32 v85, v85
    v_pk_mul_f32 v[78:79], v[78:79], v[216:217]
    v_pk_mul_f32 v[80:81], v[80:81], v[218:219]
    v_pk_mul_f32 v[82:83], v[82:83], v[220:221]
    v_pk_mul_f32 v[84:85], v[84:85], v[222:223]
    v_cvt_pk_bf16_f32 v216, v78, v79
    v_cvt_pk_bf16_f32 v217, v80, v81
    v_cvt_pk_bf16_f32 v218, v82, v83
    v_and_b32 v216, -2, v216
    v_cvt_pk_bf16_f32 v219, v84, v85
    global_store_dwordx4 v63, v[216:219], s[24:25] offset:2048 sc1
    v_pk_mul_f32 v[78:79], v[224:225], v[224:225]
    v_pk_mul_f32 v[80:81], v[226:227], v[226:227]
    v_pk_fma_f32 v[78:79], v[78:79], v[28:29], v[28:29] op_sel:[0,1,0] op_sel_hi:[1,1,0]
    v_pk_fma_f32 v[80:81], v[80:81], v[28:29], v[28:29] op_sel:[0,1,0] op_sel_hi:[1,1,0]
    v_pk_mul_f32 v[78:79], v[78:79], v[224:225]
    v_pk_mul_f32 v[80:81], v[80:81], v[226:227]
    v_exp_f32 v78, v78
    v_exp_f32 v79, v79
    v_exp_f32 v80, v80
    v_exp_f32 v81, v81
    v_pk_fma_f32 v[78:79], v[78:79], v[26:27], v[26:27] op_sel:[0,1,1] op_sel_hi:[1,1,1]
    v_pk_fma_f32 v[80:81], v[80:81], v[26:27], v[26:27] op_sel:[0,1,1] op_sel_hi:[1,1,1]
    v_rcp_f32 v78, v78
    v_rcp_f32 v79, v79
    v_rcp_f32 v80, v80
    v_rcp_f32 v81, v81
    v_pk_mul_f32 v[78:79], v[78:79], v[224:225]
    v_pk_mul_f32 v[80:81], v[80:81], v[226:227]
    v_cvt_pk_bf16_f32 v224, v78, v79
    v_cvt_pk_bf16_f32 v225, v80, v81
    v_mov_b32 v226, v224
    v_mov_b32 v227, v225
    s_nop 0
    v_permlane32_swap_b32 v224, v226
    v_permlane32_swap_b32 v225, v227
    v_and_b32 v224, -2, v224
    global_store_dwordx4 v64, v[224:227], s[24:25] sc1
    s_add_u32 s52, s52, 1
    s_waitcnt vmcnt(18)
    v_mfma_f32_32x32x16_bf16 v[168:183], a[0:3], v[144:147], 0
    s_add_u32 s44, s101, 1574920
    v_mov_b32 v68, s44
    global_load_dword v76, v68, s[24:25] sc1
    s_waitcnt vmcnt(16)
    ds_read_b64_tr_b16 a[208:209], v77 offset:24576
    ds_read_b64_tr_b16 a[210:211], v77 offset:24832
    ds_read_b64_tr_b16 a[212:213], v77 offset:25088
    ds_read_b64_tr_b16 a[214:215], v77 offset:25344
    v_mfma_f32_32x32x16_bf16 v[184:199], a[4:7], v[144:147], 0
    global_load_dwordx4 v[144:147], v62, s[24:25] offset:2048 sc1
    v_mfma_f32_32x32x16_bf16 v[168:183], a[8:11], v[136:139], v[168:183]
    v_mfma_f32_32x32x16_bf16 v[184:199], a[12:15], v[136:139], v[184:199]
    global_load_dwordx4 v[136:139], v62, s[24:25] offset:3072 sc1
    s_waitcnt vmcnt(17)
    v_mfma_f32_32x32x16_bf16 v[168:183], a[16:19], v[124:127], v[168:183]
    s_waitcnt vmcnt(14)
    ds_read_b64_tr_b16 a[216:217], v77 offset:0
    ds_read_b64_tr_b16 a[218:219], v77 offset:256
    ds_read_b64_tr_b16 a[220:221], v77 offset:512
    ds_read_b64_tr_b16 a[222:223], v77 offset:768
    v_mfma_f32_32x32x16_bf16 v[184:199], a[20:23], v[124:127], v[184:199]
    s_mul_i32 s44, s98, 7168
    s_add_u32 s44, s44, s100
    s_add_u32 s44, s44, 986112
    v_add_u32 v62, s44, v2
    global_load_dwordx4 v[124:127], v62, s[24:25] offset:-3072 sc1
    v_mfma_f32_32x32x16_bf16 v[168:183], a[24:27], v[156:159], v[168:183]
    v_mfma_f32_32x32x16_bf16 v[184:199], a[28:31], v[156:159], v[184:199]
    global_load_dwordx4 v[156:159], v62, s[24:25] offset:-2048 sc1
    s_waitcnt vmcnt(15)
    v_mfma_f32_32x32x16_bf16 v[168:183], a[32:35], v[164:167], v[168:183]
    v_mfma_f32_32x32x16_bf16 v[184:199], a[36:39], v[164:167], v[184:199]
    global_load_dwordx4 v[164:167], v62, s[24:25] offset:-1024 sc1
    s_waitcnt vmcnt(15)
    v_mfma_f32_32x32x16_bf16 v[168:183], a[40:43], v[160:163], v[168:183]
    v_mfma_f32_32x32x16_bf16 v[184:199], a[44:47], v[160:163], v[184:199]
    global_load_dwordx4 v[160:163], v62, s[24:25] offset:0 sc1
    s_waitcnt vmcnt(15)
    v_mfma_f32_32x32x16_bf16 v[168:183], a[48:51], v[128:131], v[168:183]
    v_mfma_f32_32x32x16_bf16 v[184:199], a[52:55], v[128:131], v[184:199]
    global_load_dwordx4 v[128:131], v62, s[24:25] offset:1024 sc1
    s_waitcnt vmcnt(15)
    v_mfma_f32_32x32x16_bf16 v[168:183], a[56:59], v[148:151], v[168:183]
    s_lshl_b32 s44, s28, 5
    s_add_u32 s44, s44, s27
    s_lshl_b32 s44, s44, 2
    s_add_u32 s44, s44, s35
    v_mov_b32 v68, s44
    v_mov_b32 v67, s31
    s_waitcnt vmcnt(8)
    s_cmp_eq_u32 s33, 1
    s_cbranch_scc0 .slow_169
    global_store_dword v68, v67, s[24:25] offset:1024
.sten_170:
    v_mfma_f32_32x32x16_bf16 v[184:199], a[60:63], v[148:151], v[184:199]
    global_load_dwordx4 v[148:151], v62, s[24:25] offset:2048 sc1
    v_mfma_f32_32x32x16_bf16 v[168:183], a[64:67], v[120:123], v[168:183]
    v_mfma_f32_32x32x16_bf16 v[184:199], a[68:71], v[120:123], v[184:199]
    global_load_dwordx4 v[120:123], v62, s[24:25] offset:3072 sc1
    v_mfma_f32_32x32x16_bf16 v[168:183], a[72:75], v[152:155], v[168:183]
    v_mfma_f32_32x32x16_bf16 v[184:199], a[76:79], v[152:155], v[184:199]
    s_mul_i32 s44, s99, 7168
    s_add_u32 s44, s44, s100
    s_add_u32 s44, s44, 986112
    v_add_u32 v62, s44, v2
    global_load_dwordx4 v[152:155], v62, s[24:25] offset:-3072 sc1
    v_mfma_f32_32x32x16_bf16 v[168:183], a[80:83], v[132:135], v[168:183]
    v_mfma_f32_32x32x16_bf16 v[184:199], a[84:87], v[132:135], v[184:199]
    global_load_dwordx4 v[132:135], v62, s[24:25] offset:-2048 sc1
    s_waitcnt vmcnt(12)
    s_mov_b32 s51, 0
.achk_171:
    s_add_u32 s44, s31, 2
    v_cmp_ne_u32 vcc, s44, v76
    s_cbranch_vccnz .art_172
.aok_173:
    v_mfma_f32_32x32x16_bf16 v[168:183], a[88:91], v[140:143], v[168:183]
    s_lshl_b32 s44, s29, 2
    s_add_u32 s44, s44, s28
    s_lshl_b32 s44, s44, 5
    s_add_u32 s44, s44, s35
    v_and_b32 v69, 7, v1
    v_lshl_add_u32 v69, v69, 2, s44
    global_load_dword v76, v69, s[24:25] offset:1024 sc1
    v_mfma_f32_32x32x16_bf16 v[184:199], a[92:95], v[140:143], v[184:199]
    global_load_dwordx4 v[140:143], v62, s[24:25] offset:-1024 sc1
    s_waitcnt vmcnt(13)
    v_mfma_f32_32x32x16_bf16 v[168:183], a[96:99], v[144:147], v[168:183]
    v_mfma_f32_32x32x16_bf16 v[184:199], a[100:103], v[144:147], v[184:199]
    global_load_dwordx4 v[144:147], v62, s[24:25] offset:0 sc1
    s_waitcnt vmcnt(13)
    v_mfma_f32_32x32x16_bf16 v[168:183], a[104:107], v[136:139], v[168:183]
    v_mfma_f32_32x32x16_bf16 v[184:199], a[108:111], v[136:139], v[184:199]
    global_load_dwordx4 v[136:139], v62, s[24:25] offset:1024 sc1
    s_waitcnt vmcnt(13)
    v_mfma_f32_32x32x16_bf16 v[168:183], a[112:115], v[124:127], v[168:183]
    v_mfma_f32_32x32x16_bf16 v[184:199], a[116:119], v[124:127], v[184:199]
    global_load_dwordx4 v[124:127], v62, s[24:25] offset:2048 sc1
    s_waitcnt vmcnt(13)
    v_mfma_f32_32x32x16_bf16 v[168:183], a[120:123], v[156:159], v[168:183]
    v_mfma_f32_32x32x16_bf16 v[184:199], a[124:127], v[156:159], v[184:199]
    global_load_dwordx4 v[156:159], v62, s[24:25] offset:3072 sc1
    s_waitcnt vmcnt(13)
    v_mfma_f32_32x32x16_bf16 v[168:183], a[128:131], v[164:167], v[168:183]
    v_mfma_f32_32x32x16_bf16 v[184:199], a[132:135], v[164:167], v[184:199]
    s_waitcnt vmcnt(12)
    v_mfma_f32_32x32x16_bf16 v[168:183], a[136:139], v[160:163], v[168:183]
    v_mfma_f32_32x32x16_bf16 v[184:199], a[140:143], v[160:163], v[184:199]
    s_waitcnt vmcnt(11)
    v_mfma_f32_32x32x16_bf16 v[168:183], a[144:147], v[128:131], v[168:183]
    v_mfma_f32_32x32x16_bf16 v[184:199], a[148:151], v[128:131], v[184:199]
    s_waitcnt vmcnt(5)
    v_cmp_ne_u32 vcc, s31, v76
    s_nop 0
    s_cmp_eq_u64 vcc, 0
    s_cbranch_scc1 .pok_174
    s_mov_b32 s51, 0
.poll_175:
    global_load_dword v76, v69, s[24:25] offset:1024 sc1
    s_waitcnt vmcnt(0)
    v_cmp_ne_u32 vcc, s31, v76
    s_add_u32 s51, s51, 1
    s_cmp_eq_u64 vcc, 0
    s_cbranch_scc1 .polld_176
    s_cmp_lt_u32 s51, s37
    s_cbranch_scc1 .poll_175
    s_mov_b32 s37, 1
.polld_176:
.pok_174:
    v_mfma_f32_32x32x16_bf16 v[168:183], a[152:155], v[148:151], v[168:183]
    s_lshl_b32 s44, s30, 7
    v_lshrrev_b32 v67, 3, v1
    v_lshl_add_u32 v67, v67, 4, s44
    global_load_dwordx4 v[164:167], v67, s[18:19]
    v_mfma_f32_32x32x16_bf16 v[184:199], a[156:159], v[148:151], v[184:199]
    s_mul_i32 s44, s96, 7168
    s_add_u32 s44, s44, s100
    s_add_u32 s44, s44, 527360
    v_add_u32 v62, s44, v2
    global_load_dwordx4 v[160:163], v62, s[24:25] offset:-3072 sc1
    v_mfma_f32_32x32x16_bf16 v[168:183], a[160:163], v[120:123], v[168:183]
    global_load_dwordx4 v[128:131], v62, s[24:25] offset:-2048 sc1
    v_mfma_f32_32x32x16_bf16 v[168:183], a[168:171], v[152:155], v[168:183]
    global_load_dwordx4 v[148:151], v62, s[24:25] offset:-1024 sc1
    s_waitcnt lgkmcnt(15)
    v_mfma_f32_32x32x16_bf16 v[168:183], a[176:179], v[132:135], v[168:183]
    s_waitcnt vmcnt(8)
    v_mfma_f32_32x32x16_bf16 v[168:183], a[184:187], v[140:143], v[168:183]
    s_waitcnt vmcnt(7) lgkmcnt(12)
    v_mfma_f32_32x32x16_bf16 v[168:183], a[192:195], v[144:147], v[168:183]
    s_waitcnt vmcnt(6) lgkmcnt(8)
    v_mfma_f32_32x32x16_bf16 v[168:183], a[200:203], v[136:139], v[168:183]
    s_waitcnt vmcnt(5) lgkmcnt(4)
    v_mfma_f32_32x32x16_bf16 v[168:183], a[208:211], v[124:127], v[168:183]
    s_waitcnt vmcnt(4) lgkmcnt(0)
    v_mfma_f32_32x32x16_bf16 v[168:183], a[216:219], v[156:159], v[168:183]
    v_mfma_f32_32x32x16_bf16 v[184:199], a[164:167], v[120:123], v[184:199]
    global_load_dwordx4 v[120:123], v62, s[24:25] offset:0 sc1
    s_barrier
    v_mfma_f32_32x32x16_bf16 v[184:199], a[172:175], v[152:155], v[184:199]
    global_load_dwordx4 v[152:155], v62, s[24:25] offset:1024 sc1
    s_nop 6
    ds_write_b128 v11, v[168:171] offset:0
    v_mfma_f32_32x32x16_bf16 v[184:199], a[180:183], v[132:135], v[184:199]
    global_load_dwordx4 v[132:135], v62, s[24:25] offset:2048 sc1
    v_mfma_f32_32x32x16_bf16 v[184:199], a[188:191], v[140:143], v[184:199]
    global_load_dwordx4 v[140:143], v62, s[24:25] offset:3072 sc1
    ds_write_b128 v12, v[172:175] offset:1024
    v_mfma_f32_32x32x16_bf16 v[184:199], a[196:199], v[144:147], v[184:199]
    s_mul_i32 s44, s97, 7168
    s_add_u32 s44, s44, s100
    s_add_u32 s44, s44, 527360
    v_add_u32 v62, s44, v2
    global_load_dwordx4 v[144:147], v62, s[24:25] offset:-3072 sc1
    v_mfma_f32_32x32x16_bf16 v[184:199], a[204:207], v[136:139], v[184:199]
    global_load_dwordx4 v[136:139], v62, s[24:25] offset:-2048 sc1
    ds_write_b128 v11, v[176:179] offset:2048
    v_mfma_f32_32x32x16_bf16 v[184:199], a[212:215], v[124:127], v[184:199]
    global_load_dwordx4 v[124:127], v62, s[24:25] offset:-1024 sc1
    v_mfma_f32_32x32x16_bf16 v[184:199], a[220:223], v[156:159], v[184:199]
    global_load_dwordx4 v[156:159], v62, s[24:25] offset:0 sc1
    ds_write_b128 v12, v[180:183] offset:3072
    s_waitcnt vmcnt(10)
    v_mfma_f32_32x32x16_bf16 v[200:215], a[0:3], v[160:163], 0
    s_nop 7
    ds_write_b128 v11, v[184:187] offset:4096
    ds_write_b128 v12, v[188:191] offset:5120
    v_mfma_f32_32x32x16_bf16 v[216:231], a[4:7], v[160:163], 0
    global_load_dwordx4 v[160:163], v62, s[24:25] offset:1024 sc1
    ds_write_b128 v11, v[192:195] offset:6144
    ds_write_b128 v12, v[196:199] offset:7168
    s_waitcnt vmcnt(10)
    v_mfma_f32_32x32x16_bf16 v[200:215], a[8:11], v[128:131], v[200:215]
    v_add_u32 v63, 131072, v14
    v_add_u32 v64, 8192, v15
    v_lshlrev_b32 v78, 16, v30
    v_mfma_f32_32x32x16_bf16 v[216:231], a[12:15], v[128:131], v[216:231]
    global_load_dwordx4 v[128:131], v62, s[24:25] offset:2048 sc1
    v_and_b32 v79, 0xffff0000, v30
    v_lshlrev_b32 v80, 16, v31
    s_waitcnt vmcnt(10)
    v_mfma_f32_32x32x16_bf16 v[200:215], a[16:19], v[148:151], v[200:215]
    v_and_b32 v81, 0xffff0000, v31
    v_lshlrev_b32 v82, 16, v32
    v_mfma_f32_32x32x16_bf16 v[216:231], a[20:23], v[148:151], v[216:231]
    global_load_dwordx4 v[148:151], v62, s[24:25] offset:3072 sc1
    v_and_b32 v83, 0xffff0000, v32
    v_lshlrev_b32 v84, 16, v33
    s_waitcnt vmcnt(10)
    v_mfma_f32_32x32x16_bf16 v[200:215], a[24:27], v[120:123], v[200:215]
    v_and_b32 v85, 0xffff0000, v33
    v_lshlrev_b32 v86, 16, v164
    v_and_b32 v87, 0xffff0000, v164
    v_add_f32 v78, v78, v86
    v_add_f32 v79, v79, v87
    v_mfma_f32_32x32x16_bf16 v[216:231], a[28:31], v[120:123], v[216:231]
    s_mul_i32 s44, s98, 7168
    s_add_u32 s44, s44, s100
    s_add_u32 s44, s44, 527360
    v_add_u32 v62, s44, v2
    global_load_dwordx4 v[120:123], v62, s[24:25] offset:-3072 sc1
    v_lshlrev_b32 v86, 16, v165
    v_and_b32 v87, 0xffff0000, v165
    v_add_f32 v80, v80, v86
    v_add_f32 v81, v81, v87
    v_lshlrev_b32 v86, 16, v166
    v_and_b32 v87, 0xffff0000, v166
    v_add_f32 v82, v82, v86
    v_add_f32 v83, v83, v87
    s_waitcnt vmcnt(10)
    v_mfma_f32_32x32x16_bf16 v[200:215], a[32:35], v[152:155], v[200:215]
    v_lshlrev_b32 v86, 16, v167
    v_and_b32 v87, 0xffff0000, v167
    v_add_f32 v84, v84, v86
    v_add_f32 v85, v85, v87
    v_mfma_f32_32x32x16_bf16 v[216:231], a[36:39], v[152:155], v[216:231]
    global_load_dwordx4 v[164:167], v62, s[24:25] offset:-2048 sc1
    s_waitcnt vmcnt(10)
    v_mfma_f32_32x32x16_bf16 v[200:215], a[40:43], v[132:135], v[200:215]
    global_load_dwordx4 v[152:155], v62, s[24:25] offset:-1024 sc1
    s_waitcnt lgkmcnt(0)
    s_barrier
    ds_read_b128 v[168:171], v13 offset:0
    ds_read_b128 v[172:175], v13 offset:8192
    ds_read_b128 v[176:179], v13 offset:16384
    v_mfma_f32_32x32x16_bf16 v[216:231], a[44:47], v[132:135], v[216:231]
    global_load_dwordx4 v[132:135], v62, s[24:25] offset:0 sc1
    ds_read_b128 v[180:183], v13 offset:24576
    ds_read_b128 v[184:187], v13 offset:512
    ds_read_b128 v[188:191], v13 offset:8704
    ds_read_b128 v[192:195], v13 offset:16896
    ds_read_b128 v[196:199], v13 offset:25088
    s_waitcnt vmcnt(11)
    v_mfma_f32_32x32x16_bf16 v[200:215], a[48:51], v[140:143], v[200:215]
    v_mfma_f32_32x32x16_bf16 v[216:231], a[52:55], v[140:143], v[216:231]
    global_load_dwordx4 v[140:143], v62, s[24:25] offset:1024 sc1
    s_waitcnt vmcnt(11)
    v_mfma_f32_32x32x16_bf16 v[200:215], a[56:59], v[144:147], v[200:215]
    s_waitcnt lgkmcnt(6)
    v_add_f32 v168, v168, v172
    v_add_f32 v169, v169, v173
    v_add_f32 v170, v170, v174
    v_mfma_f32_32x32x16_bf16 v[216:231], a[60:63], v[144:147], v[216:231]
    global_load_dwordx4 v[144:147], v62, s[24:25] offset:2048 sc1
    v_add_f32 v171, v171, v175
    v_add_f32 v168, v168, v78
    v_add_f32 v169, v169, v79
    v_add_f32 v170, v170, v80
    s_waitcnt vmcnt(11)
    v_mfma_f32_32x32x16_bf16 v[200:215], a[64:67], v[136:139], v[200:215]
    v_add_f32 v171, v171, v81
    s_waitcnt lgkmcnt(4)
    v_add_f32 v176, v176, v180
    v_add_f32 v177, v177, v181
    v_mfma_f32_32x32x16_bf16 v[216:231], a[68:71], v[136:139], v[216:231]
    global_load_dwordx4 v[136:139], v62, s[24:25] offset:3072 sc1
    v_add_f32 v178, v178, v182
    v_add_f32 v179, v179, v183
    v_add_f32 v168, v168, v176
    v_add_f32 v169, v169, v177
    s_waitcnt vmcnt(11)
    v_mfma_f32_32x32x16_bf16 v[200:215], a[72:75], v[124:127], v[200:215]
    v_add_f32 v170, v170, v178
    v_add_f32 v171, v171, v179
    v_cvt_pk_bf16_f32 v30, v168, v169
    v_cvt_pk_bf16_f32 v31, v170, v171
    v_mfma_f32_32x32x16_bf16 v[216:231], a[76:79], v[124:127], v[216:231]
    s_mul_i32 s44, s99, 7168
    s_add_u32 s44, s44, s100
    s_add_u32 s44, s44, 527360
    v_add_u32 v62, s44, v2
    global_load_dwordx4 v[124:127], v62, s[24:25] offset:-3072 sc1
    v_and_b32 v30, -2, v30
    s_waitcnt lgkmcnt(2)
    v_add_f32 v184, v184, v188
    v_add_f32 v185, v185, v189
    s_waitcnt vmcnt(11)
    v_mfma_f32_32x32x16_bf16 v[200:215], a[80:83], v[156:159], v[200:215]
    v_add_f32 v186, v186, v190
    v_add_f32 v187, v187, v191
    v_add_f32 v184, v184, v82
    v_add_f32 v185, v185, v83
    v_mfma_f32_32x32x16_bf16 v[216:231], a[84:87], v[156:159], v[216:231]
    global_load_dwordx4 v[156:159], v62, s[24:25] offset:-2048 sc1
    v_add_f32 v186, v186, v84
    v_add_f32 v187, v187, v85
    s_waitcnt lgkmcnt(0)
    v_add_f32 v192, v192, v196
    s_waitcnt vmcnt(11)
    v_mfma_f32_32x32x16_bf16 v[200:215], a[88:91], v[160:163], v[200:215]
    v_add_f32 v193, v193, v197
    v_add_f32 v194, v194, v198
    v_add_f32 v195, v195, v199
    v_add_f32 v184, v184, v192
    v_mfma_f32_32x32x16_bf16 v[216:231], a[92:95], v[160:163], v[216:231]
    global_load_dwordx4 v[160:163], v62, s[24:25] offset:-1024 sc1
    v_add_f32 v185, v185, v193
    v_add_f32 v186, v186, v194
    v_add_f32 v187, v187, v195
    v_cvt_pk_bf16_f32 v32, v184, v185
    s_waitcnt vmcnt(11)
    v_mfma_f32_32x32x16_bf16 v[200:215], a[96:99], v[128:131], v[200:215]
    v_cvt_pk_bf16_f32 v33, v186, v187
    s_cmp_eq_u32 s33, 1
    s_cbranch_scc0 .slow_177
    global_store_dwordx4 v63, v[30:33], s[24:25]
.sten_178:
    v_add_f32 v172, v168, v169
    v_mul_f32 v173, v168, v168
    v_mfma_f32_32x32x16_bf16 v[216:231], a[100:103], v[128:131], v[216:231]
    global_load_dwordx4 v[128:131], v62, s[24:25] offset:0 sc1
    v_fmac_f32 v173, v169, v169
    v_add_f32 v172, v172, v170
    v_fmac_f32 v173, v170, v170
    v_add_f32 v172, v172, v171
    s_waitcnt vmcnt(12)
    v_mfma_f32_32x32x16_bf16 v[200:215], a[104:107], v[148:151], v[200:215]
    v_fmac_f32 v173, v171, v171
    v_add_f32 v172, v172, v184
    v_fmac_f32 v173, v184, v184
    v_add_f32 v172, v172, v185
    v_mfma_f32_32x32x16_bf16 v[216:231], a[108:111], v[148:151], v[216:231]
    global_load_dwordx4 v[148:151], v62, s[24:25] offset:1024 sc1
    v_fmac_f32 v173, v185, v185
    v_add_f32 v172, v172, v186
    v_fmac_f32 v173, v186, v186
    v_add_f32 v172, v172, v187
    s_waitcnt vmcnt(12)
    v_mfma_f32_32x32x16_bf16 v[200:215], a[112:115], v[120:123], v[200:215]
    v_fmac_f32 v173, v187, v187
    s_nop 1
    v_permlane32_swap_b32 v172, v173
    v_add_f32 v172, v172, v173
    v_cvt_pk_bf16_f32 v30, v168, v169
    v_mfma_f32_32x32x16_bf16 v[216:231], a[116:119], v[120:123], v[216:231]
    global_load_dwordx4 v[120:123], v62, s[24:25] offset:2048 sc1
    v_mov_b32 v173, v172
    s_nop 1
    v_permlane16_swap_b32 v172, v173
    v_add_f32 v172, v172, v173
    s_nop 1
    v_add_f32_dpp v172, v172, v172 row_ror:8 row_mask:0xf bank_mask:0xf
    s_waitcnt vmcnt(12)
    v_mfma_f32_32x32x16_bf16 v[200:215], a[120:123], v[164:167], v[200:215]
    v_and_b32 v172, -2, v172
    s_cmp_eq_u32 s33, 1
    s_cbranch_scc0 .slow_179
    global_store_dword v64, v172, s[24:25]
.sten_180:
    v_mfma_f32_32x32x16_bf16 v[216:231], a[124:127], v[164:167], v[216:231]
    global_load_dwordx4 v[164:167], v62, s[24:25] offset:3072 sc1
    s_waitcnt vmcnt(13)
    v_mfma_f32_32x32x16_bf16 v[200:215], a[128:131], v[152:155], v[200:215]
    v_mfma_f32_32x32x16_bf16 v[216:231], a[132:135], v[152:155], v[216:231]
    s_lshl_b32 s44, s30, 7
    v_lshrrev_b32 v67, 3, v1
    v_lshl_add_u32 v67, v67, 4, s44
    global_load_dwordx4 v[152:155], v67, s[18:19]
    s_waitcnt vmcnt(13)
    v_mfma_f32_32x32x16_bf16 v[200:215], a[136:139], v[132:135], v[200:215]
    v_mfma_f32_32x32x16_bf16 v[216:231], a[140:143], v[132:135], v[216:231]
    s_waitcnt vmcnt(12)
    v_mfma_f32_32x32x16_bf16 v[200:215], a[144:147], v[140:143], v[200:215]
    v_mfma_f32_32x32x16_bf16 v[216:231], a[148:151], v[140:143], v[216:231]
    s_waitcnt vmcnt(11)
    v_mfma_f32_32x32x16_bf16 v[200:215], a[152:155], v[144:147], v[200:215]
    v_mfma_f32_32x32x16_bf16 v[216:231], a[156:159], v[144:147], v[216:231]
    s_waitcnt vmcnt(10)
    v_mfma_f32_32x32x16_bf16 v[200:215], a[160:163], v[136:139], v[200:215]
    s_waitcnt vmcnt(9)
    v_mfma_f32_32x32x16_bf16 v[200:215], a[168:171], v[124:127], v[200:215]
    s_waitcnt vmcnt(8)
    v_mfma_f32_32x32x16_bf16 v[200:215], a[176:179], v[156:159], v[200:215]
    s_waitcnt vmcnt(7)
    v_mfma_f32_32x32x16_bf16 v[200:215], a[184:187], v[160:163], v[200:215]
    s_waitcnt vmcnt(5)
    v_mfma_f32_32x32x16_bf16 v[200:215], a[192:195], v[128:131], v[200:215]
    s_waitcnt vmcnt(4)
    v_mfma_f32_32x32x16_bf16 v[200:215], a[200:203], v[148:151], v[200:215]
    s_add_u32 s44, s62, s58
    s_add_u32 s44, s44, 135168
    v_add_u32 v62, s44, v2
    global_load_dwordx4 v[132:135], v62, s[24:25] offset:-4096 sc1
    s_waitcnt vmcnt(4)
    v_mfma_f32_32x32x16_bf16 v[200:215], a[208:211], v[120:123], v[200:215]
    global_load_dwordx4 v[140:143], v62, s[24:25] offset:-3072 sc1
    s_waitcnt vmcnt(3)
    v_mfma_f32_32x32x16_bf16 v[200:215], a[216:219], v[164:167], v[200:215]
    global_load_dwordx4 v[144:147], v62, s[24:25] offset:-2048 sc1
    v_mfma_f32_32x32x16_bf16 v[216:231], a[164:167], v[136:139], v[216:231]
    global_load_dwordx4 v[136:139], v62, s[24:25] offset:-1024 sc1
    s_barrier
    v_lshlrev_b32 v78, 16, v34
    v_and_b32 v79, 0xffff0000, v34
    v_mfma_f32_32x32x16_bf16 v[216:231], a[172:175], v[124:127], v[216:231]
    global_load_dwordx4 v[124:127], v62, s[24:25] offset:0 sc1
    s_nop 3
    ds_write_b128 v11, v[200:203] offset:0
    v_lshlrev_b32 v80, 16, v35
    v_and_b32 v81, 0xffff0000, v35
    v_mfma_f32_32x32x16_bf16 v[216:231], a[180:183], v[156:159], v[216:231]
    global_load_dwordx4 v[156:159], v62, s[24:25] offset:1024 sc1
    v_lshlrev_b32 v82, 16, v36
    v_and_b32 v83, 0xffff0000, v36
    v_mfma_f32_32x32x16_bf16 v[216:231], a[188:191], v[160:163], v[216:231]
    global_load_dwordx4 v[160:163], v62, s[24:25] offset:2048 sc1
    ds_write_b128 v12, v[204:207] offset:1024
    v_lshlrev_b32 v84, 16, v37
    v_and_b32 v85, 0xffff0000, v37
    v_mfma_f32_32x32x16_bf16 v[216:231], a[196:199], v[128:131], v[216:231]
    global_load_dwordx4 v[128:131], v62, s[24:25] offset:3072 sc1
    s_waitcnt vmcnt(8)
    v_lshlrev_b32 v86, 16, v152
    v_and_b32 v87, 0xffff0000, v152
    v_add_f32 v78, v78, v86
    v_add_f32 v79, v79, v87
    v_lshlrev_b32 v86, 16, v153
    v_and_b32 v87, 0xffff0000, v153
    v_add_f32 v80, v80, v86
    v_add_f32 v81, v81, v87
    v_mfma_f32_32x32x16_bf16 v[216:231], a[204:207], v[148:151], v[216:231]
    s_add_u32 s44, s62, s59
    s_add_u32 s44, s44, 135168
    v_add_u32 v62, s44, v2
    global_load_dwordx4 v[148:151], v62, s[24:25] offset:-4096 sc1
    ds_write_b128 v11, v[208:211] offset:2048
    v_lshlrev_b32 v86, 16, v154
    v_and_b32 v87, 0xffff0000, v154
    v_add_f32 v82, v82, v86
    v_add_f32 v83, v83, v87
    v_lshlrev_b32 v86, 16, v155
    v_and_b32 v87, 0xffff0000, v155
    v_add_f32 v84, v84, v86
    v_add_f32 v85, v85, v87
    v_mfma_f32_32x32x16_bf16 v[216:231], a[212:215], v[120:123], v[216:231]
    global_load_dwordx4 v[152:155], v62, s[24:25] offset:-3072 sc1
    v_mfma_f32_32x32x16_bf16 v[216:231], a[220:223], v[164:167], v[216:231]
    global_load_dwordx4 v[120:123], v62, s[24:25] offset:-2048 sc1
    ds_write_b128 v12, v[212:215] offset:3072
    ds_read_b64_tr_b16 v[232:233], v5 offset:0
    ds_read_b64_tr_b16 v[234:235], v5 offset:256
    ds_read_b64_tr_b16 v[236:237], v6 offset:0
    ds_read_b64_tr_b16 v[238:239], v6 offset:128
    ds_read_b64_tr_b16 v[240:241], v5 offset:1024
    ds_read_b64_tr_b16 v[242:243], v5 offset:1280
    ds_read_b64_tr_b16 v[244:245], v6 offset:512
    ds_read_b64_tr_b16 v[246:247], v6 offset:640
    global_load_dwordx4 v[164:167], v62, s[24:25] offset:-1024 sc1
    s_waitcnt vmcnt(8)
    v_bitop3_b32 v67, v132, v140, v144 bitop3:0xfe
    v_bitop3_b32 v67, v67, v136, 1 bitop3:0xa8
    v_cmp_ne_u32 vcc, 0, v67
    s_cbranch_vccnz .crt_181
.cok_183:
    s_waitcnt lgkmcnt(6)
    v_mfma_f32_32x32x16_bf16 v[168:183], v[232:235], v[132:135], 0
    ds_read_b64_tr_b16 v[248:249], v5 offset:2048
    ds_read_b64_tr_b16 v[250:251], v5 offset:2304
    ds_write_b128 v11, v[216:219] offset:4096
    s_waitcnt lgkmcnt(7)
    v_mfma_f32_32x32x16_bf16 v[184:199], v[132:135], v[236:239], 0
    ds_read_b64_tr_b16 v[252:253], v6 offset:1024
    ds_read_b64_tr_b16 v[254:255], v6 offset:1152
    global_load_dwordx4 v[132:135], v62, s[24:25] offset:0 sc1
    ds_write_b128 v12, v[220:223] offset:5120
    s_waitcnt lgkmcnt(8)
    v_mfma_f32_32x32x16_bf16 v[168:183], v[240:243], v[140:143], v[168:183]
    ds_read_b64_tr_b16 v[232:233], v5 offset:3072
    ds_read_b64_tr_b16 v[234:235], v5 offset:3328
    ds_write_b128 v11, v[224:227] offset:6144
    s_waitcnt lgkmcnt(9)
    v_mfma_f32_32x32x16_bf16 v[184:199], v[140:143], v[244:247], v[184:199]
    ds_read_b64_tr_b16 v[236:237], v6 offset:1536
    ds_read_b64_tr_b16 v[238:239], v6 offset:1664
    global_load_dwordx4 v[140:143], v62, s[24:25] offset:1024 sc1
    ds_write_b128 v12, v[228:231] offset:7168
    s_waitcnt lgkmcnt(10)
    v_mfma_f32_32x32x16_bf16 v[168:183], v[248:251], v[144:147], v[168:183]
    ds_read_b64_tr_b16 v[240:241], v5 offset:4096
    ds_read_b64_tr_b16 v[242:243], v5 offset:4352
    v_add_u32 v63, 0, v14
    v_add_u32 v64, 0, v15
    s_waitcnt lgkmcnt(9)
    v_mfma_f32_32x32x16_bf16 v[184:199], v[144:147], v[252:255], v[184:199]
    ds_read_b64_tr_b16 v[244:245], v6 offset:2048
    ds_read_b64_tr_b16 v[246:247], v6 offset:2176
    s_add_u32 s44, s36, s34
    s_add_u32 s44, s44, 0x148000
    v_add_u32 v67, s44, v2
    global_load_dwordx4 v[144:147], v67, s[24:25] offset:0 sc1
    s_waitcnt lgkmcnt(8)
    v_mfma_f32_32x32x16_bf16 v[168:183], v[232:235], v[136:139], v[168:183]
    ds_read_b64_tr_b16 v[248:249], v5 offset:5120
    ds_read_b64_tr_b16 v[250:251], v5 offset:5376
    s_waitcnt lgkmcnt(7)
    v_mfma_f32_32x32x16_bf16 v[184:199], v[136:139], v[236:239], v[184:199]
    ds_read_b64_tr_b16 v[252:253], v6 offset:2560
    ds_read_b64_tr_b16 v[254:255], v6 offset:2688
    s_add_u32 s44, s36, s34
    s_add_u32 s44, s44, 0x148000
    v_add_u32 v67, s44, v2
    global_load_dwordx4 v[136:139], v67, s[24:25] offset:1024 sc1
    s_waitcnt vmcnt(8)
    v_bitop3_b32 v67, v124, v156, v160 bitop3:0xfe
    v_bitop3_b32 v67, v67, v128, 1 bitop3:0xa8
    v_cmp_ne_u32 vcc, 0, v67
    s_cbranch_vccnz .crt_184
.cok_186:
    s_waitcnt lgkmcnt(6)
    v_mfma_f32_32x32x16_bf16 v[168:183], v[240:243], v[124:127], v[168:183]
    ds_read_b64_tr_b16 v[232:233], v5 offset:6144
    ds_read_b64_tr_b16 v[234:235], v5 offset:6400
    s_barrier
    ds_read_b128 v[200:203], v13 offset:0
    ds_read_b128 v[204:207], v13 offset:8192
    ds_read_b128 v[208:211], v13 offset:16384
    s_waitcnt lgkmcnt(9)
    v_mfma_f32_32x32x16_bf16 v[184:199], v[124:127], v[244:247], v[184:199]
    ds_read_b64_tr_b16 v[236:237], v6 offset:3072
    ds_read_b64_tr_b16 v[238:239], v6 offset:3200
    global_load_dwordx4 v[124:127], v62, s[24:25] offset:2048 sc1
    ds_read_b128 v[212:215], v13 offset:24576
    ds_read_b128 v[216:219], v13 offset:512
    ds_read_b128 v[220:223], v13 offset:8704
    ds_read_b128 v[224:227], v13 offset:16896
    ds_read_b128 v[228:231], v13 offset:25088
    s_waitcnt lgkmcnt(14)
    v_mfma_f32_32x32x16_bf16 v[168:183], v[248:251], v[156:159], v[168:183]
    ds_read_b64_tr_b16 v[240:241], v5 offset:7168
    ds_read_b64_tr_b16 v[242:243], v5 offset:7424
    s_waitcnt lgkmcnt(14)
    v_mfma_f32_32x32x16_bf16 v[184:199], v[156:159], v[252:255], v[184:199]
    ds_read_b64_tr_b16 v[244:245], v6 offset:3584
    ds_read_b64_tr_b16 v[246:247], v6 offset:3712
    global_load_dwordx4 v[156:159], v62, s[24:25] offset:3072 sc1
    s_waitcnt lgkmcnt(14)
    v_mfma_f32_32x32x16_bf16 v[168:183], v[232:235], v[160:163], v[168:183]
    ds_read_b64_tr_b16 v[248:249], v5 offset:8192
    ds_read_b64_tr_b16 v[250:251], v5 offset:8448
    s_waitcnt lgkmcnt(11)
    v_mfma_f32_32x32x16_bf16 v[184:199], v[160:163], v[236:239], v[184:199]
    ds_read_b64_tr_b16 v[252:253], v6 offset:4096
    ds_read_b64_tr_b16 v[254:255], v6 offset:4224
    s_add_u32 s44, s62, s60
    s_add_u32 s44, s44, 135168
    v_add_u32 v62, s44, v2
    global_load_dwordx4 v[160:163], v62, s[24:25] offset:-4096 sc1
    v_add_f32 v200, v200, v204
    v_add_f32 v201, v201, v205
    v_add_f32 v202, v202, v206
    v_add_f32 v203, v203, v207
    s_waitcnt lgkmcnt(6)
    v_mfma_f32_32x32x16_bf16 v[168:183], v[240:243], v[128:131], v[168:183]
    ds_read_b64_tr_b16 v[232:233], v5 offset:9216
    ds_read_b64_tr_b16 v[234:235], v5 offset:9472
    v_add_f32 v200, v200, v78
    v_add_f32 v201, v201, v79
    v_add_f32 v202, v202, v80
    v_add_f32 v203, v203, v81
    s_waitcnt lgkmcnt(6)
    v_mfma_f32_32x32x16_bf16 v[184:199], v[128:131], v[244:247], v[184:199]
    ds_read_b64_tr_b16 v[236:237], v6 offset:4608
    ds_read_b64_tr_b16 v[238:239], v6 offset:4736
    global_load_dwordx4 v[128:131], v62, s[24:25] offset:-3072 sc1
    v_add_f32 v208, v208, v212
    v_add_f32 v209, v209, v213
    v_add_f32 v210, v210, v214
    v_add_f32 v211, v211, v215
    v_add_f32 v200, v200, v208
    s_waitcnt vmcnt(8)
    v_bitop3_b32 v67, v148, v152, v120 bitop3:0xfe
    v_bitop3_b32 v67, v67, v164, 1 bitop3:0xa8
    v_cmp_ne_u32 vcc, 0, v67
    s_cbranch_vccnz .crt_187
.cok_189:
    s_waitcnt lgkmcnt(6)
    v_mfma_f32_32x32x16_bf16 v[168:183], v[248:251], v[148:151], v[168:183]
    ds_read_b64_tr_b16 v[240:241], v5 offset:10240
    ds_read_b64_tr_b16 v[242:243], v5 offset:10496
    v_add_f32 v201, v201, v209
    v_add_f32 v202, v202, v210
    v_add_f32 v203, v203, v211
    v_cvt_pk_bf16_f32 v34, v200, v201
    v_cvt_pk_bf16_f32 v35, v202, v203
    s_waitcnt lgkmcnt(6)
    v_mfma_f32_32x32x16_bf16 v[184:199], v[148:151], v[252:255], v[184:199]
    ds_read_b64_tr_b16 v[244:245], v6 offset:5120
    ds_read_b64_tr_b16 v[246:247], v6 offset:5248
    global_load_dwordx4 v[148:151], v62, s[24:25] offset:-2048 sc1
    v_and_b32 v34, -2, v34
    v_add_f32 v216, v216, v220
    v_add_f32 v217, v217, v221
    v_add_f32 v218, v218, v222
    s_waitcnt lgkmcnt(6)
    v_mfma_f32_32x32x16_bf16 v[168:183], v[232:235], v[152:155], v[168:183]
    ds_read_b64_tr_b16 v[248:249], v5 offset:11264
    ds_read_b64_tr_b16 v[250:251], v5 offset:11520
    v_add_f32 v219, v219, v223
    v_add_f32 v216, v216, v82
    v_add_f32 v217, v217, v83
    v_add_f32 v218, v218, v84
    v_add_f32 v219, v219, v85
    s_waitcnt lgkmcnt(6)
    v_mfma_f32_32x32x16_bf16 v[184:199], v[152:155], v[236:239], v[184:199]
    ds_read_b64_tr_b16 v[252:253], v6 offset:5632
    ds_read_b64_tr_b16 v[254:255], v6 offset:5760
    global_load_dwordx4 v[152:155], v62, s[24:25] offset:-1024 sc1
    v_add_f32 v224, v224, v228
    v_add_f32 v225, v225, v229
    v_add_f32 v226, v226, v230
    v_add_f32 v227, v227, v231
    s_waitcnt lgkmcnt(6)
    v_mfma_f32_32x32x16_bf16 v[168:183], v[240:243], v[120:123], v[168:183]
    ds_read_b64_tr_b16 v[232:233], v5 offset:12288
    ds_read_b64_tr_b16 v[234:235], v5 offset:12544
    v_add_f32 v216, v216, v224
    v_add_f32 v217, v217, v225
    v_add_f32 v218, v218, v226
    v_add_f32 v219, v219, v227
    v_cvt_pk_bf16_f32 v36, v216, v217
    s_waitcnt lgkmcnt(6)
    v_mfma_f32_32x32x16_bf16 v[184:199], v[120:123], v[244:247], v[184:199]
    ds_read_b64_tr_b16 v[236:237], v6 offset:6144
    ds_read_b64_tr_b16 v[238:239], v6 offset:6272
    global_load_dwordx4 v[120:123], v62, s[24:25] offset:0 sc1
    v_cvt_pk_bf16_f32 v37, v218, v219
    s_cmp_eq_u32 s33, 1
    s_cbranch_scc0 .slow_190
    global_store_dwordx4 v63, v[34:37], s[24:25]
.sten_191:
    v_add_f32 v204, v200, v201
    v_mul_f32 v205, v200, v200
    v_fmac_f32 v205, v201, v201
    s_waitcnt lgkmcnt(6)
    v_mfma_f32_32x32x16_bf16 v[168:183], v[248:251], v[164:167], v[168:183]
    ds_read_b64_tr_b16 v[240:241], v5 offset:13312
    ds_read_b64_tr_b16 v[242:243], v5 offset:13568
    v_add_f32 v204, v204, v202
    v_fmac_f32 v205, v202, v202
    v_add_f32 v204, v204, v203
    v_fmac_f32 v205, v203, v203
    v_add_f32 v204, v204, v216
    s_waitcnt lgkmcnt(6)
    v_mfma_f32_32x32x16_bf16 v[184:199], v[164:167], v[252:255], v[184:199]
    ds_read_b64_tr_b16 v[244:245], v6 offset:6656
    ds_read_b64_tr_b16 v[246:247], v6 offset:6784
    global_load_dwordx4 v[164:167], v62, s[24:25] offset:1024 sc1
    v_fmac_f32 v205, v216, v216
    v_add_f32 v204, v204, v217
    v_fmac_f32 v205, v217, v217
    v_add_f32 v204, v204, v218
    v_fmac_f32 v205, v218, v218
    s_waitcnt vmcnt(7)
    v_bitop3_b32 v67, v132, v140, v124 bitop3:0xfe
    v_bitop3_b32 v67, v67, v156, 1 bitop3:0xa8
    v_cmp_ne_u32 vcc, 0, v67
    s_cbranch_vccnz .crt_192
.cok_194:
    s_waitcnt lgkmcnt(6)
    v_mfma_f32_32x32x16_bf16 v[168:183], v[232:235], v[132:135], v[168:183]
    ds_read_b64_tr_b16 v[248:249], v5 offset:14336
    ds_read_b64_tr_b16 v[250:251], v5 offset:14592
    v_add_f32 v204, v204, v219
    v_fmac_f32 v205, v219, v219
    s_nop 1
    v_permlane32_swap_b32 v204, v205
    v_add_f32 v204, v204, v205
    v_cvt_pk_bf16_f32 v34, v200, v201
    s_waitcnt lgkmcnt(6)
    v_mfma_f32_32x32x16_bf16 v[184:199], v[132:135], v[236:239], v[184:199]
    ds_read_b64_tr_b16 v[252:253], v6 offset:7168
    ds_read_b64_tr_b16 v[254:255], v6 offset:7296
    global_load_dwordx4 v[132:135], v62, s[24:25] offset:2048 sc1
    v_mov_b32 v205, v204
    s_nop 1
    v_permlane16_swap_b32 v204, v205
    v_add_f32 v204, v204, v205
    s_nop 1
    v_add_f32_dpp v204, v204, v204 row_ror:8 row_mask:0xf bank_mask:0xf
    v_and_b32 v204, -2, v204
    s_waitcnt lgkmcnt(6)
    v_mfma_f32_32x32x16_bf16 v[168:183], v[240:243], v[140:143], v[168:183]
    ds_read_b64_tr_b16 v[232:233], v5 offset:15360
    ds_read_b64_tr_b16 v[234:235], v5 offset:15616
    s_cmp_eq_u32 s33, 1
    s_cbranch_scc0 .slow_195
    global_store_dword v64, v204, s[24:25]
.sten_196:
    s_waitcnt lgkmcnt(6)
    v_mfma_f32_32x32x16_bf16 v[184:199], v[140:143], v[244:247], v[184:199]
    ds_read_b64_tr_b16 v[236:237], v6 offset:7680
    ds_read_b64_tr_b16 v[238:239], v6 offset:7808
    global_load_dwordx4 v[140:143], v62, s[24:25] offset:3072 sc1
    s_waitcnt lgkmcnt(6)
    v_mfma_f32_32x32x16_bf16 v[168:183], v[248:251], v[124:127], v[168:183]
    ds_read_b64_tr_b16 v[240:241], v5 offset:16384
    ds_read_b64_tr_b16 v[242:243], v5 offset:16640
    s_waitcnt lgkmcnt(6)
    v_mfma_f32_32x32x16_bf16 v[184:199], v[124:127], v[252:255], v[184:199]
    ds_read_b64_tr_b16 v[244:245], v6 offset:8192
    ds_read_b64_tr_b16 v[246:247], v6 offset:8320
    s_add_u32 s44, s62, s61
    s_add_u32 s44, s44, 135168
    v_add_u32 v62, s44, v2
    global_load_dwordx4 v[124:127], v62, s[24:25] offset:-4096 sc1
    s_waitcnt lgkmcnt(6)
    v_mfma_f32_32x32x16_bf16 v[168:183], v[232:235], v[156:159], v[168:183]
    ds_read_b64_tr_b16 v[248:249], v5 offset:17408
    ds_read_b64_tr_b16 v[250:251], v5 offset:17664
    v_bitop3_b32 v67, v144, v145, v146 bitop3:0xfe
    v_bitop3_b32 v67, v67, v147, v136 bitop3:0xfe
    v_bitop3_b32 v67, v67, v137, v138 bitop3:0xfe
    v_bitop3_b32 v67, v67, v139, 1 bitop3:0xa8
    v_cmp_ne_u32 vcc, 0, v67
    s_cbranch_vccnz .crt_197
.cok_199:
    v_add_f32 v144, v144, v146
    v_add_f32 v145, v145, v147
    v_add_f32 v136, v136, v138
    v_add_f32 v137, v137, v139
    v_add_f32 v70, v144, v136
    v_add_f32 v71, v145, v137
    s_nop 1
    v_permlane32_swap_b32 v70, v71
    s_waitcnt lgkmcnt(6)
    v_mfma_f32_32x32x16_bf16 v[184:199], v[156:159], v[236:239], v[184:199]
    ds_read_b64_tr_b16 v[252:253], v6 offset:8704
    ds_read_b64_tr_b16 v[254:255], v6 offset:8832
    global_load_dwordx4 v[144:147], v62, s[24:25] offset:-3072 sc1
    v_add_f32 v70, v70, v71
    v_mov_b32 v71, v70
    s_waitcnt vmcnt(8)
    v_bitop3_b32 v67, v160, v128, v148 bitop3:0xfe
    v_bitop3_b32 v67, v67, v152, 1 bitop3:0xa8
    v_cmp_ne_u32 vcc, 0, v67
    s_cbranch_vccnz .crt_200
.cok_202:
    s_waitcnt lgkmcnt(6)
    v_mfma_f32_32x32x16_bf16 v[168:183], v[240:243], v[160:163], v[168:183]
    ds_read_b64_tr_b16 v[232:233], v5 offset:18432
    ds_read_b64_tr_b16 v[234:235], v5 offset:18688
    global_load_dwordx4 v[136:139], v62, s[24:25] offset:-2048 sc1
    v_permlane32_swap_b32 v70, v71
    v_mul_f32 v70, 0xbb000000, v70
    s_waitcnt lgkmcnt(6)
    v_mfma_f32_32x32x16_bf16 v[184:199], v[160:163], v[244:247], v[184:199]
    ds_read_b64_tr_b16 v[236:237], v6 offset:9216
    ds_read_b64_tr_b16 v[238:239], v6 offset:9344
    global_load_dwordx4 v[156:159], v62, s[24:25] offset:-1024 sc1
    v_mul_f32 v72, v70, v70
    v_mul_f32 v71, 0x3b000000, v71
    s_waitcnt lgkmcnt(6)
    v_mfma_f32_32x32x16_bf16 v[168:183], v[248:251], v[128:131], v[168:183]
    ds_read_b64_tr_b16 v[240:241], v5 offset:19456
    ds_read_b64_tr_b16 v[242:243], v5 offset:19712
    global_load_dwordx4 v[160:163], v62, s[24:25] offset:0 sc1
    v_sub_f32 v71, v71, v72
    v_max_f32 v71, 0, v71
    s_waitcnt lgkmcnt(6)
    v_mfma_f32_32x32x16_bf16 v[184:199], v[128:131], v[252:255], v[184:199]
    ds_read_b64_tr_b16 v[244:245], v6 offset:9728
    ds_read_b64_tr_b16 v[246:247], v6 offset:9856
    global_load_dwordx4 v[128:131], v62, s[24:25] offset:1024 sc1
    v_add_f32 v72, 0x3727c5ac, v71
    v_rsq_f32 v22, v72
    s_waitcnt lgkmcnt(6)
    v_mfma_f32_32x32x16_bf16 v[168:183], v[232:235], v[148:151], v[168:183]
    ds_read_b64_tr_b16 v[248:249], v5 offset:20480
    ds_read_b64_tr_b16 v[250:251], v5 offset:20736
    v_cvt_pk_bf16_f32 v73, v70, v70
    v_lshlrev_b32 v73, 16, v73
    s_waitcnt lgkmcnt(6)
    v_mfma_f32_32x32x16_bf16 v[184:199], v[148:151], v[236:239], v[184:199]
    ds_read_b64_tr_b16 v[252:253], v6 offset:10240
    ds_read_b64_tr_b16 v[254:255], v6 offset:10368
    global_load_dwordx4 v[148:151], v62, s[24:25] offset:2048 sc1
    v_sub_f32 v73, v70, v73
    v_mul_f32 v73, v73, v8
    s_waitcnt lgkmcnt(6)
    v_mfma_f32_32x32x16_bf16 v[168:183], v[240:243], v[152:155], v[168:183]
    ds_read_b64_tr_b16 v[232:233], v5 offset:21504
    ds_read_b64_tr_b16 v[234:235], v5 offset:21760
    v_cvt_pk_bf16_f32 v18, v70, v73
    v_mul_f32 v23, 0x3eb8aa3b, v22
    s_waitcnt lgkmcnt(6)
    v_mfma_f32_32x32x16_bf16 v[184:199], v[152:155], v[244:247], v[184:199]
    ds_read_b64_tr_b16 v[236:237], v6 offset:10752
    ds_read_b64_tr_b16 v[238:239], v6 offset:10880
    global_load_dwordx4 v[152:155], v62, s[24:25] offset:3072 sc1
    s_waitcnt vmcnt(8)
    v_bitop3_b32 v67, v120, v164, v132 bitop3:0xfe
    v_bitop3_b32 v67, v67, v140, 1 bitop3:0xa8
    v_cmp_ne_u32 vcc, 0, v67
    s_cbranch_vccnz .crt_203
.cok_205:
    s_waitcnt lgkmcnt(6)
    v_mfma_f32_32x32x16_bf16 v[168:183], v[248:251], v[120:123], v[168:183]
    ds_read_b64_tr_b16 v[240:241], v5 offset:22528
    ds_read_b64_tr_b16 v[242:243], v5 offset:22784
    s_waitcnt lgkmcnt(6)
    v_mfma_f32_32x32x16_bf16 v[184:199], v[120:123], v[252:255], v[184:199]
    ds_read_b64_tr_b16 v[244:245], v6 offset:11264
    ds_read_b64_tr_b16 v[246:247], v6 offset:11392
    s_add_u32 s44, s62, s58
    s_add_u32 s44, s44, 4096
    v_add_u32 v62, s44, v2
    global_load_dwordx4 v[120:123], v62, s[24:25] offset:-4096 sc1
    s_waitcnt lgkmcnt(6)
    v_mfma_f32_32x32x16_bf16 v[168:183], v[232:235], v[164:167], v[168:183]
    ds_read_b64_tr_b16 v[248:249], v5 offset:23552
    ds_read_b64_tr_b16 v[250:251], v5 offset:23808
    s_waitcnt lgkmcnt(6)
    v_mfma_f32_32x32x16_bf16 v[184:199], v[164:167], v[236:239], v[184:199]
    ds_read_b64_tr_b16 v[252:253], v6 offset:11776
    ds_read_b64_tr_b16 v[254:255], v6 offset:11904
    global_load_dwordx4 v[164:167], v62, s[24:25] offset:-3072 sc1
    s_waitcnt lgkmcnt(6)
    v_mfma_f32_32x32x16_bf16 v[168:183], v[240:243], v[132:135], v[168:183]
    ds_read_b64_tr_b16 v[232:233], v5 offset:24576
    ds_read_b64_tr_b16 v[234:235], v5 offset:24832
    s_waitcnt lgkmcnt(6)
    v_mfma_f32_32x32x16_bf16 v[184:199], v[132:135], v[244:247], v[184:199]
    ds_read_b64_tr_b16 v[236:237], v6 offset:12288
    ds_read_b64_tr_b16 v[238:239], v6 offset:12416
    global_load_dwordx4 v[132:135], v62, s[24:25] offset:-2048 sc1
    s_waitcnt lgkmcnt(6)
    v_mfma_f32_32x32x16_bf16 v[168:183], v[248:251], v[140:143], v[168:183]
    ds_read_b64_tr_b16 v[240:241], v5 offset:25600
    ds_read_b64_tr_b16 v[242:243], v5 offset:25856
    s_waitcnt lgkmcnt(6)
    v_mfma_f32_32x32x16_bf16 v[184:199], v[140:143], v[252:255], v[184:199]
    ds_read_b64_tr_b16 v[244:245], v6 offset:12800
    ds_read_b64_tr_b16 v[246:247], v6 offset:12928
    global_load_dwordx4 v[140:143], v62, s[24:25] offset:-1024 sc1
    s_waitcnt vmcnt(8)
    v_bitop3_b32 v67, v124, v144, v136 bitop3:0xfe
    v_bitop3_b32 v67, v67, v156, 1 bitop3:0xa8
    v_cmp_ne_u32 vcc, 0, v67
    s_cbranch_vccnz .crt_206
.cok_208:
    s_waitcnt lgkmcnt(6)
    v_mfma_f32_32x32x16_bf16 v[168:183], v[232:235], v[124:127], v[168:183]
    ds_read_b64_tr_b16 v[248:249], v5 offset:26624
    ds_read_b64_tr_b16 v[250:251], v5 offset:26880
    s_barrier
    s_waitcnt lgkmcnt(6)
    v_mfma_f32_32x32x16_bf16 v[184:199], v[124:127], v[236:239], v[184:199]
    ds_read_b64_tr_b16 v[252:253], v6 offset:13312
    ds_read_b64_tr_b16 v[254:255], v6 offset:13440
    global_load_dwordx4 v[124:127], v62, s[24:25] offset:0 sc1
    s_waitcnt lgkmcnt(6)
    v_mfma_f32_32x32x16_bf16 v[168:183], v[240:243], v[144:147], v[168:183]
    ds_read_b64_tr_b16 v[232:233], v5 offset:27648
    ds_read_b64_tr_b16 v[234:235], v5 offset:27904
    s_waitcnt lgkmcnt(6)
    v_mfma_f32_32x32x16_bf16 v[184:199], v[144:147], v[244:247], v[184:199]
    ds_read_b64_tr_b16 v[236:237], v6 offset:13824
    ds_read_b64_tr_b16 v[238:239], v6 offset:13952
    global_load_dwordx4 v[144:147], v62, s[24:25] offset:1024 sc1
    s_waitcnt lgkmcnt(6)
    v_mfma_f32_32x32x16_bf16 v[168:183], v[248:251], v[136:139], v[168:183]
    ds_read_b64_tr_b16 v[240:241], v5 offset:28672
    ds_read_b64_tr_b16 v[242:243], v5 offset:28928
    s_waitcnt lgkmcnt(6)
    v_mfma_f32_32x32x16_bf16 v[184:199], v[136:139], v[252:255], v[184:199]
    ds_read_b64_tr_b16 v[244:245], v6 offset:14336
    ds_read_b64_tr_b16 v[246:247], v6 offset:14464
    global_load_dwordx4 v[136:139], v62, s[24:25] offset:2048 sc1
    s_waitcnt lgkmcnt(6)
    v_mfma_f32_32x32x16_bf16 v[168:183], v[232:235], v[156:159], v[168:183]
    ds_read_b64_tr_b16 v[248:249], v5 offset:29696
    ds_read_b64_tr_b16 v[250:251], v5 offset:29952
    s_waitcnt lgkmcnt(6)
    v_mfma_f32_32x32x16_bf16 v[184:199], v[156:159], v[236:239], v[184:199]
    ds_read_b64_tr_b16 v[252:253], v6 offset:14848
    ds_read_b64_tr_b16 v[254:255], v6 offset:14976
    global_load_dwordx4 v[156:159], v62, s[24:25] offset:3072 sc1
    s_waitcnt vmcnt(8)
    v_bitop3_b32 v67, v160, v128, v148 bitop3:0xfe
    v_bitop3_b32 v67, v67, v152, 1 bitop3:0xa8
    v_cmp_ne_u32 vcc, 0, v67
    s_cbranch_vccnz .crt_209
.cok_211:
    s_waitcnt lgkmcnt(6)
    v_mfma_f32_32x32x16_bf16 v[168:183], v[240:243], v[160:163], v[168:183]
    ds_read_b64_tr_b16 v[232:233], v5 offset:30720
    ds_read_b64_tr_b16 v[234:235], v5 offset:30976
    s_waitcnt lgkmcnt(6)
    v_mfma_f32_32x32x16_bf16 v[184:199], v[160:163], v[244:247], v[184:199]
    ds_read_b64_tr_b16 v[236:237], v6 offset:15360
    ds_read_b64_tr_b16 v[238:239], v6 offset:15488
    s_add_u32 s44, s62, s59
    s_add_u32 s44, s44, 4096
    v_add_u32 v62, s44, v2
    global_load_dwordx4 v[160:163], v62, s[24:25] offset:-4096 sc1
    s_waitcnt lgkmcnt(6)
    v_mfma_f32_32x32x16_bf16 v[168:183], v[248:251], v[128:131], v[168:183]
    ds_read_b64_tr_b16 v[240:241], v5 offset:31744
    ds_read_b64_tr_b16 v[242:243], v5 offset:32000
    s_waitcnt lgkmcnt(6)
    v_mfma_f32_32x32x16_bf16 v[184:199], v[128:131], v[252:255], v[184:199]
    ds_read_b64_tr_b16 v[244:245], v6 offset:15872
    ds_read_b64_tr_b16 v[246:247], v6 offset:16000
    global_load_dwordx4 v[128:131], v62, s[24:25] offset:-3072 sc1
    s_waitcnt lgkmcnt(6)
    v_mfma_f32_32x32x16_bf16 v[168:183], v[232:235], v[148:151], v[168:183]
    ds_read_b64_tr_b16 v[248:249], v5 offset:0
    ds_read_b64_tr_b16 v[250:251], v5 offset:256
    s_waitcnt lgkmcnt(6)
    v_mfma_f32_32x32x16_bf16 v[184:199], v[148:151], v[236:239], v[184:199]
    ds_read_b64_tr_b16 v[252:253], v6 offset:0
    ds_read_b64_tr_b16 v[254:255], v6 offset:128
    global_load_dwordx4 v[148:151], v62, s[24:25] offset:-2048 sc1
    s_waitcnt lgkmcnt(6)
    v_mfma_f32_32x32x16_bf16 v[168:183], v[240:243], v[152:155], v[168:183]
    ds_read_b64_tr_b16 v[232:233], v5 offset:1024
    ds_read_b64_tr_b16 v[234:235], v5 offset:1280
    s_waitcnt lgkmcnt(6)
    v_mfma_f32_32x32x16_bf16 v[184:199], v[152:155], v[244:247], v[184:199]
    ds_read_b64_tr_b16 v[236:237], v6 offset:512
    ds_read_b64_tr_b16 v[238:239], v6 offset:640
    global_load_dwordx4 v[152:155], v62, s[24:25] offset:-1024 sc1
    s_waitcnt vmcnt(8)
    v_bitop3_b32 v67, v120, v164, v132 bitop3:0xfe
    v_bitop3_b32 v67, v67, v140, 1 bitop3:0xa8
    v_cmp_ne_u32 vcc, 0, v67
    s_cbranch_vccnz .crt_212
.cok_214:
    s_waitcnt lgkmcnt(6)
    v_mfma_f32_32x32x16_bf16 v[200:215], v[248:251], v[120:123], 0
    ds_read_b64_tr_b16 v[240:241], v5 offset:2048
    ds_read_b64_tr_b16 v[242:243], v5 offset:2304
    v_mfma_f32_32x32x16_bf16 v[168:183], v[38:41], v[18:21], v[168:183]
    v_lshl_add_u32 v67, v3, 2, s36
    ds_write_b32 v67, v22 offset:24576
    v_mfma_f32_32x32x16_bf16 v[184:199], v[16:19], v[38:41], v[184:199]
    s_waitcnt lgkmcnt(7)
    v_mfma_f32_32x32x16_bf16 v[216:231], v[120:123], v[252:255], 0
    ds_read_b64_tr_b16 v[244:245], v6 offset:1024
    ds_read_b64_tr_b16 v[246:247], v6 offset:1152
    global_load_dwordx4 v[120:123], v62, s[24:25] offset:0 sc1
    s_add_u32 s44, s101, 1585152
    v_add_u32 v63, s44, v2
    ds_read_b128 v[78:81], v10 offset:24576
    ds_read_b128 v[82:85], v10 offset:24608
    s_waitcnt lgkmcnt(9)
    v_mfma_f32_32x32x16_bf16 v[200:215], v[232:235], v[164:167], v[200:215]
    ds_read_b64_tr_b16 v[248:249], v5 offset:3072
    ds_read_b64_tr_b16 v[250:251], v5 offset:3328
    v_mul_f32 v176, v176, v22
    s_waitcnt lgkmcnt(9)
    v_mfma_f32_32x32x16_bf16 v[216:231], v[164:167], v[236:239], v[216:231]
    ds_read_b64_tr_b16 v[252:253], v6 offset:1536
    ds_read_b64_tr_b16 v[254:255], v6 offset:1664
    global_load_dwordx4 v[164:167], v62, s[24:25] offset:1024 sc1
    v_mul_f32 v177, v177, v22
    v_mul_f32 v178, v178, v22
    v_mul_f32 v179, v179, v22
    s_waitcnt lgkmcnt(9)
    v_mfma_f32_32x32x16_bf16 v[200:215], v[240:243], v[132:135], v[200:215]
    ds_read_b64_tr_b16 v[232:233], v5 offset:4096
    ds_read_b64_tr_b16 v[234:235], v5 offset:4352
    v_mul_f32 v180, v180, v22
    v_mul_f32 v181, v181, v22
    v_mul_f32 v182, v182, v22
    s_waitcnt lgkmcnt(8)
    v_mfma_f32_32x32x16_bf16 v[216:231], v[132:135], v[244:247], v[216:231]
    ds_read_b64_tr_b16 v[236:237], v6 offset:2048
    ds_read_b64_tr_b16 v[238:239], v6 offset:2176
    s_add_u32 s44, s36, s34
    s_add_u32 s44, s44, 0x146000
    v_add_u32 v67, s44, v2
    global_load_dwordx4 v[132:135], v67, s[24:25] offset:0 sc1
    v_mul_f32 v183, v183, v22
    v_cvt_pk_bf16_f32 v176, v176, v177
    v_cvt_pk_bf16_f32 v177, v178, v179
    s_waitcnt lgkmcnt(6)
    v_mfma_f32_32x32x16_bf16 v[200:215], v[248:251], v[140:143], v[200:215]
    ds_read_b64_tr_b16 v[240:241], v5 offset:5120
    ds_read_b64_tr_b16 v[242:243], v5 offset:5376
    v_cvt_pk_bf16_f32 v178, v180, v181
    v_cvt_pk_bf16_f32 v179, v182, v183
    ds_write_b128 v9, v[176:179] offset:24576
    s_waitcnt lgkmcnt(7)
    v_mfma_f32_32x32x16_bf16 v[216:231], v[140:143], v[252:255], v[216:231]
    ds_read_b64_tr_b16 v[244:245], v6 offset:2560
    ds_read_b64_tr_b16 v[246:247], v6 offset:2688
    s_add_u32 s44, s36, s34
    s_add_u32 s44, s44, 0x146000
    v_add_u32 v67, s44, v2
    global_load_dwordx4 v[140:143], v67, s[24:25] offset:1024 sc1
    v_cndmask_b32 v184, v192, v184, s[42:43]
    v_cndmask_b32 v185, v193, v185, s[42:43]
    v_cndmask_b32 v186, v194, v186, s[42:43]
    s_waitcnt vmcnt(8)
    v_bitop3_b32 v67, v124, v144, v136 bitop3:0xfe
    v_bitop3_b32 v67, v67, v156, 1 bitop3:0xa8
    v_cmp_ne_u32 vcc, 0, v67
    s_cbranch_vccnz .crt_215
.cok_217:
    s_waitcnt lgkmcnt(7)
    v_mfma_f32_32x32x16_bf16 v[200:215], v[232:235], v[124:127], v[200:215]
    ds_read_b64_tr_b16 v[248:249], v5 offset:6144
    ds_read_b64_tr_b16 v[250:251], v5 offset:6400
    v_cndmask_b32 v187, v195, v187, s[42:43]
    v_cndmask_b32 v188, v196, v188, s[42:43]
    v_cndmask_b32 v189, v197, v189, s[42:43]
    s_waitcnt lgkmcnt(7)
    v_mfma_f32_32x32x16_bf16 v[216:231], v[124:127], v[236:239], v[216:231]
    ds_read_b64_tr_b16 v[252:253], v6 offset:3072
    ds_read_b64_tr_b16 v[254:255], v6 offset:3200
    global_load_dwordx4 v[124:127], v62, s[24:25] offset:2048 sc1
    v_cndmask_b32 v190, v198, v190, s[42:43]
    v_cndmask_b32 v191, v199, v191, s[42:43]
    v_mov_b32 v183, s52
    s_waitcnt lgkmcnt(7)
    v_mfma_f32_32x32x16_bf16 v[200:215], v[240:243], v[144:147], v[200:215]
    ds_read_b64_tr_b16 v[232:233], v5 offset:7168
    ds_read_b64_tr_b16 v[234:235], v5 offset:7424
    v_mov_b32 v180, v179
    v_mov_b32 v179, s52
    v_mov_b32 v182, s52
    s_waitcnt lgkmcnt(6)
    v_mfma_f32_32x32x16_bf16 v[216:231], v[144:147], v[244:247], v[216:231]
    ds_read_b64_tr_b16 v[236:237], v6 offset:3584
    ds_read_b64_tr_b16 v[238:239], v6 offset:3712
    global_load_dwordx4 v[144:147], v62, s[24:25] offset:3072 sc1
    global_store_dwordx4 v63, v[176:179], s[24:25] sc1
    v_mul_f32 v184, v184, v78
    s_waitcnt lgkmcnt(6)
    v_mfma_f32_32x32x16_bf16 v[200:215], v[248:251], v[136:139], v[200:215]
    ds_read_b64_tr_b16 v[240:241], v5 offset:8192
    ds_read_b64_tr_b16 v[242:243], v5 offset:8448
    v_mul_f32 v185, v185, v79
    v_mul_f32 v186, v186, v80
    v_mul_f32 v187, v187, v81
    s_waitcnt lgkmcnt(6)
    v_mfma_f32_32x32x16_bf16 v[216:231], v[136:139], v[252:255], v[216:231]
    ds_read_b64_tr_b16 v[244:245], v6 offset:4096
    ds_read_b64_tr_b16 v[246:247], v6 offset:4224
    s_add_u32 s44, s62, s60
    s_add_u32 s44, s44, 4096
    v_add_u32 v62, s44, v2
    global_load_dwordx4 v[136:139], v62, s[24:25] offset:-4096 sc1
    v_mul_f32 v188, v188, v82
    v_mul_f32 v189, v189, v83
    v_mul_f32 v190, v190, v84
    s_waitcnt lgkmcnt(6)
    v_mfma_f32_32x32x16_bf16 v[200:215], v[232:235], v[156:159], v[200:215]
    ds_read_b64_tr_b16 v[248:249], v5 offset:9216
    ds_read_b64_tr_b16 v[250:251], v5 offset:9472
    v_mul_f32 v191, v191, v85
    v_cvt_pk_bf16_f32 v184, v184, v185
    v_cvt_pk_bf16_f32 v185, v186, v187
    s_waitcnt lgkmcnt(6)
    v_mfma_f32_32x32x16_bf16 v[216:231], v[156:159], v[236:239], v[216:231]
    ds_read_b64_tr_b16 v[252:253], v6 offset:4608
    ds_read_b64_tr_b16 v[254:255], v6 offset:4736
    global_load_dwordx4 v[156:159], v62, s[24:25] offset:-3072 sc1
    v_cvt_pk_bf16_f32 v186, v188, v189
    v_cvt_pk_bf16_f32 v187, v190, v191
    ds_write_b128 v9, v[184:187] offset:25600
    s_waitcnt vmcnt(9)
    v_bitop3_b32 v67, v160, v128, v148 bitop3:0xfe
    v_bitop3_b32 v67, v67, v152, 1 bitop3:0xa8
    v_cmp_ne_u32 vcc, 0, v67
    s_cbranch_vccnz .crt_218
.cok_220:
    s_waitcnt lgkmcnt(7)
    v_mfma_f32_32x32x16_bf16 v[200:215], v[240:243], v[160:163], v[200:215]
    ds_read_b64_tr_b16 v[232:233], v5 offset:10240
    ds_read_b64_tr_b16 v[234:235], v5 offset:10496
    v_mov_b32 v181, v187
    global_store_dwordx4 v63, v[180:183], s[24:25] offset:2048 sc1
    v_mov_b32 v187, s52
    global_store_dwordx4 v63, v[184:187], s[24:25] offset:1024 sc1
    s_waitcnt lgkmcnt(7)
    v_mfma_f32_32x32x16_bf16 v[216:231], v[160:163], v[244:247], v[216:231]
    ds_read_b64_tr_b16 v[236:237], v6 offset:5120
    ds_read_b64_tr_b16 v[238:239], v6 offset:5248
    global_load_dwordx4 v[160:163], v62, s[24:25] offset:-2048 sc1
    v_mul_f32 v168, v168, v23
    v_mul_f32 v169, v169, v23
    v_mul_f32 v170, v170, v23
    s_waitcnt lgkmcnt(7)
    v_mfma_f32_32x32x16_bf16 v[200:215], v[248:251], v[128:131], v[200:215]
    ds_read_b64_tr_b16 v[240:241], v5 offset:11264
    ds_read_b64_tr_b16 v[242:243], v5 offset:11520
    v_mul_f32 v171, v171, v23
    v_mul_f32 v172, v172, v23
    v_mul_f32 v173, v173, v23
    s_waitcnt lgkmcnt(7)
    v_mfma_f32_32x32x16_bf16 v[216:231], v[128:131], v[252:255], v[216:231]
    ds_read_b64_tr_b16 v[244:245], v6 offset:5632
    ds_read_b64_tr_b16 v[246:247], v6 offset:5760
    global_load_dwordx4 v[128:131], v62, s[24:25] offset:-1024 sc1
    v_mul_f32 v174, v174, v23
    v_mul_f32 v175, v175, v23
    v_cvt_pk_bf16_f32 v54, v168, v169
    s_waitcnt lgkmcnt(6)
    v_mfma_f32_32x32x16_bf16 v[200:215], v[232:235], v[148:151], v[200:215]
    ds_read_b64_tr_b16 v[248:249], v5 offset:12288
    ds_read_b64_tr_b16 v[250:251], v5 offset:12544
    v_cvt_pk_bf16_f32 v55, v170, v171
    v_cvt_pk_bf16_f32 v56, v172, v173
    v_cvt_pk_bf16_f32 v57, v174, v175
    s_waitcnt lgkmcnt(6)
    v_mfma_f32_32x32x16_bf16 v[216:231], v[148:151], v[236:239], v[216:231]
    ds_read_b64_tr_b16 v[252:253], v6 offset:6144
    ds_read_b64_tr_b16 v[254:255], v6 offset:6272
    global_load_dwordx4 v[148:151], v62, s[24:25] offset:0 sc1
    s_waitcnt lgkmcnt(6)
    v_mfma_f32_32x32x16_bf16 v[200:215], v[240:243], v[152:155], v[200:215]
    ds_read_b64_tr_b16 v[232:233], v5 offset:13312
    ds_read_b64_tr_b16 v[234:235], v5 offset:13568
    s_waitcnt lgkmcnt(6)
    v_mfma_f32_32x32x16_bf16 v[216:231], v[152:155], v[244:247], v[216:231]
    ds_read_b64_tr_b16 v[236:237], v6 offset:6656
    ds_read_b64_tr_b16 v[238:239], v6 offset:6784
    global_load_dwordx4 v[152:155], v62, s[24:25] offset:1024 sc1
    s_waitcnt vmcnt(9)
    v_bitop3_b32 v67, v120, v164, v124 bitop3:0xfe
    v_bitop3_b32 v67, v67, v144, 1 bitop3:0xa8
    v_cmp_ne_u32 vcc, 0, v67
    s_cbranch_vccnz .crt_221
.cok_223:
    s_waitcnt lgkmcnt(6)
    v_mfma_f32_32x32x16_bf16 v[200:215], v[248:251], v[120:123], v[200:215]
    ds_read_b64_tr_b16 v[240:241], v5 offset:14336
    ds_read_b64_tr_b16 v[242:243], v5 offset:14592
    s_waitcnt lgkmcnt(6)
    v_mfma_f32_32x32x16_bf16 v[216:231], v[120:123], v[252:255], v[216:231]
    ds_read_b64_tr_b16 v[244:245], v6 offset:7168
    ds_read_b64_tr_b16 v[246:247], v6 offset:7296
    global_load_dwordx4 v[120:123], v62, s[24:25] offset:2048 sc1
    s_waitcnt lgkmcnt(6)
    v_mfma_f32_32x32x16_bf16 v[200:215], v[232:235], v[164:167], v[200:215]
    ds_read_b64_tr_b16 v[248:249], v5 offset:15360
    ds_read_b64_tr_b16 v[250:251], v5 offset:15616
    s_waitcnt lgkmcnt(6)
    v_mfma_f32_32x32x16_bf16 v[216:231], v[164:167], v[236:239], v[216:231]
    ds_read_b64_tr_b16 v[252:253], v6 offset:7680
    ds_read_b64_tr_b16 v[254:255], v6 offset:7808
    global_load_dwordx4 v[164:167], v62, s[24:25] offset:3072 sc1
    s_waitcnt lgkmcnt(6)
    v_mfma_f32_32x32x16_bf16 v[200:215], v[240:243], v[124:127], v[200:215]
    ds_read_b64_tr_b16 v[232:233], v5 offset:16384
    ds_read_b64_tr_b16 v[234:235], v5 offset:16640
    s_waitcnt lgkmcnt(6)
    v_mfma_f32_32x32x16_bf16 v[216:231], v[124:127], v[244:247], v[216:231]
    ds_read_b64_tr_b16 v[236:237], v6 offset:8192
    ds_read_b64_tr_b16 v[238:239], v6 offset:8320
    s_add_u32 s44, s62, s61
    s_add_u32 s44, s44, 4096
    v_add_u32 v62, s44, v2
    global_load_dwordx4 v[124:127], v62, s[24:25] offset:-4096 sc1
    s_waitcnt lgkmcnt(6)
    v_mfma_f32_32x32x16_bf16 v[200:215], v[248:251], v[144:147], v[200:215]
    ds_read_b64_tr_b16 v[240:241], v5 offset:17408
    ds_read_b64_tr_b16 v[242:243], v5 offset:17664
    v_bitop3_b32 v67, v132, v133, v134 bitop3:0xfe
    v_bitop3_b32 v67, v67, v135, v140 bitop3:0xfe
    v_bitop3_b32 v67, v67, v141, v142 bitop3:0xfe
    v_bitop3_b32 v67, v67, v143, 1 bitop3:0xa8
    v_cmp_ne_u32 vcc, 0, v67
    s_cbranch_vccnz .crt_224
.cok_226:
    v_add_f32 v132, v132, v134
    v_add_f32 v133, v133, v135
    v_add_f32 v140, v140, v142
    v_add_f32 v141, v141, v143
    v_add_f32 v70, v132, v140
    v_add_f32 v71, v133, v141
    s_nop 1
    v_permlane32_swap_b32 v70, v71
    s_waitcnt lgkmcnt(6)
    v_mfma_f32_32x32x16_bf16 v[216:231], v[144:147], v[252:255], v[216:231]
    ds_read_b64_tr_b16 v[244:245], v6 offset:8704
    ds_read_b64_tr_b16 v[246:247], v6 offset:8832
    global_load_dwordx4 v[132:135], v62, s[24:25] offset:-3072 sc1
    v_add_f32 v70, v70, v71
    v_mov_b32 v71, v70
    s_waitcnt vmcnt(6)
    v_bitop3_b32 v67, v136, v156, v160 bitop3:0xfe
    v_bitop3_b32 v67, v67, v128, 1 bitop3:0xa8
    v_cmp_ne_u32 vcc, 0, v67
    s_cbranch_vccnz .crt_227
.cok_229:
    s_waitcnt lgkmcnt(6)
    v_mfma_f32_32x32x16_bf16 v[200:215], v[232:235], v[136:139], v[200:215]
    ds_read_b64_tr_b16 v[248:249], v5 offset:18432
    ds_read_b64_tr_b16 v[250:251], v5 offset:18688
    global_load_dwordx4 v[140:143], v62, s[24:25] offset:-2048 sc1
    v_permlane32_swap_b32 v70, v71
    v_mul_f32 v70, 0xbb000000, v70
    s_waitcnt lgkmcnt(6)
    v_mfma_f32_32x32x16_bf16 v[216:231], v[136:139], v[236:239], v[216:231]
    ds_read_b64_tr_b16 v[252:253], v6 offset:9216
    ds_read_b64_tr_b16 v[254:255], v6 offset:9344
    global_load_dwordx4 v[144:147], v62, s[24:25] offset:-1024 sc1
    v_mul_f32 v72, v70, v70
    v_mul_f32 v71, 0x3b000000, v71
    s_waitcnt lgkmcnt(6)
    v_mfma_f32_32x32x16_bf16 v[200:215], v[240:243], v[156:159], v[200:215]
    ds_read_b64_tr_b16 v[232:233], v5 offset:19456
    ds_read_b64_tr_b16 v[234:235], v5 offset:19712
    global_load_dwordx4 v[136:139], v62, s[24:25] offset:0 sc1
    v_sub_f32 v71, v71, v72
    v_max_f32 v71, 0, v71
    s_waitcnt lgkmcnt(6)
    v_mfma_f32_32x32x16_bf16 v[216:231], v[156:159], v[244:247], v[216:231]
    ds_read_b64_tr_b16 v[236:237], v6 offset:9728
    ds_read_b64_tr_b16 v[238:239], v6 offset:9856
    global_load_dwordx4 v[156:159], v62, s[24:25] offset:1024 sc1
    v_add_f32 v72, 0x3727c5ac, v71
    v_rsq_f32 v26, v72
    s_waitcnt lgkmcnt(6)
    v_mfma_f32_32x32x16_bf16 v[200:215], v[248:251], v[160:163], v[200:215]
    ds_read_b64_tr_b16 v[240:241], v5 offset:20480
    ds_read_b64_tr_b16 v[242:243], v5 offset:20736
    v_cvt_pk_bf16_f32 v73, v70, v70
    v_lshlrev_b32 v73, 16, v73
    s_waitcnt lgkmcnt(6)
    v_mfma_f32_32x32x16_bf16 v[216:231], v[160:163], v[252:255], v[216:231]
    ds_read_b64_tr_b16 v[244:245], v6 offset:10240
    ds_read_b64_tr_b16 v[246:247], v6 offset:10368
    global_load_dwordx4 v[160:163], v62, s[24:25] offset:2048 sc1
    v_sub_f32 v73, v70, v73
    v_mul_f32 v73, v73, v8
    s_waitcnt lgkmcnt(6)
    v_mfma_f32_32x32x16_bf16 v[200:215], v[232:235], v[128:131], v[200:215]
    ds_read_b64_tr_b16 v[248:249], v5 offset:21504
    ds_read_b64_tr_b16 v[250:251], v5 offset:21760
    v_cvt_pk_bf16_f32 v18, v70, v73
    v_mul_f32 v27, 0x3eb8aa3b, v26
    s_waitcnt lgkmcnt(6)
    v_mfma_f32_32x32x16_bf16 v[216:231], v[128:131], v[236:239], v[216:231]
    ds_read_b64_tr_b16 v[252:253], v6 offset:10752
    ds_read_b64_tr_b16 v[254:255], v6 offset:10880
    global_load_dwordx4 v[128:131], v62, s[24:25] offset:3072 sc1
    s_waitcnt vmcnt(8)
    v_bitop3_b32 v67, v148, v152, v120 bitop3:0xfe
    v_bitop3_b32 v67, v67, v164, 1 bitop3:0xa8
    v_cmp_ne_u32 vcc, 0, v67
    s_cbranch_vccnz .crt_230
.cok_232:
    s_waitcnt lgkmcnt(6)
    v_mfma_f32_32x32x16_bf16 v[200:215], v[240:243], v[148:151], v[200:215]
    ds_read_b64_tr_b16 v[232:233], v5 offset:22528
    ds_read_b64_tr_b16 v[234:235], v5 offset:22784
    s_waitcnt lgkmcnt(6)
    v_mfma_f32_32x32x16_bf16 v[216:231], v[148:151], v[244:247], v[216:231]
    ds_read_b64_tr_b16 v[236:237], v6 offset:11264
    ds_read_b64_tr_b16 v[238:239], v6 offset:11392
    s_waitcnt lgkmcnt(6)
    v_mfma_f32_32x32x16_bf16 v[200:215], v[248:251], v[152:155], v[200:215]
    ds_read_b64_tr_b16 v[240:241], v5 offset:23552
    ds_read_b64_tr_b16 v[242:243], v5 offset:23808
    s_waitcnt lgkmcnt(6)
    v_mfma_f32_32x32x16_bf16 v[216:231], v[152:155], v[252:255], v[216:231]
    ds_read_b64_tr_b16 v[244:245], v6 offset:11776
    ds_read_b64_tr_b16 v[246:247], v6 offset:11904
    s_waitcnt lgkmcnt(6)
    v_mfma_f32_32x32x16_bf16 v[200:215], v[232:235], v[120:123], v[200:215]
    ds_read_b64_tr_b16 v[248:249], v5 offset:24576
    ds_read_b64_tr_b16 v[250:251], v5 offset:24832
    s_waitcnt lgkmcnt(6)
    v_mfma_f32_32x32x16_bf16 v[216:231], v[120:123], v[236:239], v[216:231]
    ds_read_b64_tr_b16 v[252:253], v6 offset:12288
    ds_read_b64_tr_b16 v[254:255], v6 offset:12416
    s_waitcnt lgkmcnt(6)
    v_mfma_f32_32x32x16_bf16 v[200:215], v[240:243], v[164:167], v[200:215]
    ds_read_b64_tr_b16 v[232:233], v5 offset:25600
    ds_read_b64_tr_b16 v[234:235], v5 offset:25856
    s_waitcnt lgkmcnt(6)
    v_mfma_f32_32x32x16_bf16 v[216:231], v[164:167], v[244:247], v[216:231]
    ds_read_b64_tr_b16 v[236:237], v6 offset:12800
    ds_read_b64_tr_b16 v[238:239], v6 offset:12928
    s_waitcnt vmcnt(4)
    v_bitop3_b32 v67, v124, v132, v140 bitop3:0xfe
    v_bitop3_b32 v67, v67, v144, 1 bitop3:0xa8
    v_cmp_ne_u32 vcc, 0, v67
    s_cbranch_vccnz .crt_233
.cok_235:
    s_waitcnt lgkmcnt(6)
    v_mfma_f32_32x32x16_bf16 v[200:215], v[248:251], v[124:127], v[200:215]
    ds_read_b64_tr_b16 v[240:241], v5 offset:26624
    ds_read_b64_tr_b16 v[242:243], v5 offset:26880
    s_waitcnt lgkmcnt(6)
    v_mfma_f32_32x32x16_bf16 v[216:231], v[124:127], v[252:255], v[216:231]
    ds_read_b64_tr_b16 v[244:245], v6 offset:13312
    ds_read_b64_tr_b16 v[246:247], v6 offset:13440
    s_waitcnt lgkmcnt(6)
    v_mfma_f32_32x32x16_bf16 v[200:215], v[232:235], v[132:135], v[200:215]
    ds_read_b64_tr_b16 v[248:249], v5 offset:27648
    ds_read_b64_tr_b16 v[250:251], v5 offset:27904
    s_cmp_eq_u32 s26, 0
    s_cselect_b32 s44, 0, 3145728
    s_sub_u32 s44, s101, s44
    s_add_u32 s44, s44, 1585152
    v_add_u32 v86, s44, v2
    global_load_dwordx4 v[148:151], v86, s[24:25] offset:0 sc1
    global_load_dwordx4 v[152:155], v86, s[24:25] offset:1024 sc1
    global_load_dwordx4 v[120:123], v86, s[24:25] offset:2048 sc1
    s_waitcnt lgkmcnt(6)
    v_mfma_f32_32x32x16_bf16 v[216:231], v[132:135], v[236:239], v[216:231]
    ds_read_b64_tr_b16 v[252:253], v6 offset:13824
    ds_read_b64_tr_b16 v[254:255], v6 offset:13952
    s_waitcnt lgkmcnt(6)
    v_mfma_f32_32x32x16_bf16 v[200:215], v[240:243], v[140:143], v[200:215]
    ds_read_b64_tr_b16 v[232:233], v5 offset:28672
    ds_read_b64_tr_b16 v[234:235], v5 offset:28928
    s_waitcnt lgkmcnt(6)
    v_mfma_f32_32x32x16_bf16 v[216:231], v[140:143], v[244:247], v[216:231]
    ds_read_b64_tr_b16 v[236:237], v6 offset:14336
    ds_read_b64_tr_b16 v[238:239], v6 offset:14464
    s_waitcnt lgkmcnt(6)
    v_mfma_f32_32x32x16_bf16 v[200:215], v[248:251], v[144:147], v[200:215]
    ds_read_b64_tr_b16 v[240:241], v5 offset:29696
    ds_read_b64_tr_b16 v[242:243], v5 offset:29952
    s_waitcnt lgkmcnt(6)
    v_mfma_f32_32x32x16_bf16 v[216:231], v[144:147], v[252:255], v[216:231]
    ds_read_b64_tr_b16 v[244:245], v6 offset:14848
    ds_read_b64_tr_b16 v[246:247], v6 offset:14976
    s_waitcnt vmcnt(3)
    v_bitop3_b32 v67, v136, v156, v160 bitop3:0xfe
    v_bitop3_b32 v67, v67, v128, 1 bitop3:0xa8
    v_cmp_ne_u32 vcc, 0, v67
    s_cbranch_vccnz .crt_236
.cok_238:
    s_waitcnt lgkmcnt(6)
    v_mfma_f32_32x32x16_bf16 v[200:215], v[232:235], v[136:139], v[200:215]
    ds_read_b64_tr_b16 v[248:249], v5 offset:30720
    ds_read_b64_tr_b16 v[250:251], v5 offset:30976
    s_waitcnt lgkmcnt(6)
    v_mfma_f32_32x32x16_bf16 v[216:231], v[136:139], v[236:239], v[216:231]
    ds_read_b64_tr_b16 v[252:253], v6 offset:15360
    ds_read_b64_tr_b16 v[254:255], v6 offset:15488
    s_waitcnt lgkmcnt(6)
    v_mfma_f32_32x32x16_bf16 v[200:215], v[240:243], v[156:159], v[200:215]
    ds_read_b64_tr_b16 v[232:233], v5 offset:31744
    ds_read_b64_tr_b16 v[234:235], v5 offset:32000
    s_waitcnt lgkmcnt(6)
    v_mfma_f32_32x32x16_bf16 v[216:231], v[156:159], v[244:247], v[216:231]
    ds_read_b64_tr_b16 v[236:237], v6 offset:15872
    ds_read_b64_tr_b16 v[238:239], v6 offset:16000
    s_waitcnt lgkmcnt(6)
    v_mfma_f32_32x32x16_bf16 v[200:215], v[248:251], v[160:163], v[200:215]
    s_waitcnt lgkmcnt(4)
    v_mfma_f32_32x32x16_bf16 v[216:231], v[160:163], v[252:255], v[216:231]
    s_waitcnt lgkmcnt(2)
    v_mfma_f32_32x32x16_bf16 v[200:215], v[232:235], v[128:131], v[200:215]
    s_waitcnt lgkmcnt(0)
    v_mfma_f32_32x32x16_bf16 v[216:231], v[128:131], v[236:239], v[216:231]
    ds_read_b128 v[232:235], v9 offset:24576
    v_mfma_f32_32x32x16_bf16 v[200:215], v[38:41], v[18:21], v[200:215]
    v_lshl_add_u32 v67, v3, 2, s36
    ds_write_b32 v67, v26 offset:16384
    v_mfma_f32_32x32x16_bf16 v[216:231], v[16:19], v[38:41], v[216:231]
    s_add_u32 s44, s101, 1572864
    v_add_u32 v63, s44, v2
    ds_read_b128 v[78:81], v10 offset:16384
    ds_read_b128 v[82:85], v10 offset:16416
    s_nop 4
    v_pk_mul_f32 v[208:209], v[208:209], v[26:27] op_sel:[0,0] op_sel_hi:[1,0]
    v_pk_mul_f32 v[210:211], v[210:211], v[26:27] op_sel:[0,0] op_sel_hi:[1,0]
    v_pk_mul_f32 v[212:213], v[212:213], v[26:27] op_sel:[0,0] op_sel_hi:[1,0]
    v_pk_mul_f32 v[214:215], v[214:215], v[26:27] op_sel:[0,0] op_sel_hi:[1,0]
    v_cvt_pk_bf16_f32 v208, v208, v209
    v_cvt_pk_bf16_f32 v209, v210, v211
    v_cvt_pk_bf16_f32 v210, v212, v213
    v_cvt_pk_bf16_f32 v211, v214, v215
    ds_write_b128 v9, v[208:211] offset:16384
    v_cndmask_b32 v216, v224, v216, s[42:43]
    v_cndmask_b32 v217, v225, v217, s[42:43]
    v_cndmask_b32 v218, v226, v218, s[42:43]
    v_cndmask_b32 v219, v227, v219, s[42:43]
    v_cndmask_b32 v220, v228, v220, s[42:43]
    v_cndmask_b32 v221, v229, v221, s[42:43]
    v_cndmask_b32 v222, v230, v222, s[42:43]
    v_cndmask_b32 v223, v231, v223, s[42:43]
    v_mov_b32 v215, s52
    v_mov_b32 v212, v211
    v_mov_b32 v211, s52
    v_mov_b32 v214, s52
    global_store_dwordx4 v63, v[208:211], s[24:25] sc1
    s_waitcnt lgkmcnt(1)
    v_pk_mul_f32 v[216:217], v[216:217], v[78:79]
    v_pk_mul_f32 v[218:219], v[218:219], v[80:81]
    v_pk_mul_f32 v[220:221], v[220:221], v[82:83]
    v_pk_mul_f32 v[222:223], v[222:223], v[84:85]
    v_cvt_pk_bf16_f32 v216, v216, v217
    v_cvt_pk_bf16_f32 v217, v218, v219
    v_cvt_pk_bf16_f32 v218, v220, v221
    v_cvt_pk_bf16_f32 v219, v222, v223
    ds_write_b128 v9, v[216:219] offset:17408
    v_mov_b32 v213, v219
    global_store_dwordx4 v63, v[212:215], s[24:25] offset:2048 sc1
    v_mov_b32 v219, s52
    global_store_dwordx4 v63, v[216:219], s[24:25] offset:1024 sc1
    s_waitcnt vmcnt(3)
    s_mov_b32 s51, 0
.hchk_239:
    v_bitop3_b32 v87, v151, v155, v123 bitop3:0x7e
    v_bitop3_b32 v87, v151, s52, v87 bitop3:0xbe
    v_mov_b32 v151, v120
    v_cmp_ne_u32 vcc, 0, v87
    v_mov_b32 v155, v121
    s_cbranch_vccnz .hrt_240
.hok_241:
    ds_write_b128 v9, v[148:151] offset:8192
    ds_write_b128 v9, v[152:155] offset:9216
    v_mfma_f32_32x32x16_bf16 v[184:199], v[232:235], v[54:57], 0
    v_mov_b32 v254, 0xf149f2ca
    v_mov_b32 v244, s38
    v_mov_b32 v245, s38
    v_mov_b32 v246, s38
    v_mov_b32 v247, s38
    v_mov_b32 v248, s38
    v_mov_b32 v249, s38
    v_mov_b32 v250, s38
    v_mov_b32 v251, s38
    s_waitcnt lgkmcnt(0)
    s_barrier
    ds_read_b128 v[236:239], v9 offset:22528
    ds_read_b128 v[240:243], v9 offset:20480
    ds_read_b128 v[232:235], v9 offset:18432
    v_mov_b32 v78, s38
    v_mov_b32 v79, s38
    v_mov_b32 v80, s38
    v_mov_b32 v81, s38
    v_mov_b32 v82, s38
    v_mov_b32 v83, s38
    v_mov_b32 v84, s38
    v_mov_b32 v85, s38
    s_mov_b64 exec, s[42:43]
    ds_read_b128 v[244:247], v9 offset:25600
    ds_read_b128 v[248:251], v9 offset:25856
    s_mov_b64 exec, -1
    s_mov_b64 exec, s[42:43]
    ds_read_b128 v[78:81], v9 offset:9216
    ds_read_b128 v[82:85], v9 offset:9472
    s_mov_b64 exec, -1
    v_pk_mul_f32 v[200:201], v[200:201], v[26:27] op_sel:[0,1] op_sel_hi:[1,1]
    v_pk_mul_f32 v[202:203], v[202:203], v[26:27] op_sel:[0,1] op_sel_hi:[1,1]
    v_pk_mul_f32 v[204:205], v[204:205], v[26:27] op_sel:[0,1] op_sel_hi:[1,1]
    v_pk_mul_f32 v[206:207], v[206:207], v[26:27] op_sel:[0,1] op_sel_hi:[1,1]
    v_cvt_pk_bf16_f32 v58, v200, v201
    v_cvt_pk_bf16_f32 v59, v202, v203
    v_cvt_pk_bf16_f32 v60, v204, v205
    v_cvt_pk_bf16_f32 v61, v206, v207
    s_waitcnt lgkmcnt(6)
    v_mfma_f32_32x32x16_bf16 v[168:183], v[236:239], v[54:57], 0
    ds_read_b128 v[236:239], v9 offset:16384
    s_waitcnt lgkmcnt(6)
    v_mfma_f32_32x32x16_bf16 v[152:167], v[240:243], v[54:57], 0
    ds_read_b128 v[240:243], v9 offset:8192
    v_mov_b32 v252, v254
    s_waitcnt lgkmcnt(6)
    v_mfma_f32_32x32x16_bf16 v[200:215], v[232:235], v[54:57], 0
    ds_read_b128 v[232:235], v9 offset:14336
    s_nop 3
    v_max3_f32 v252, v168, v169, v252
    v_max3_f32 v252, v170, v171, v252
    v_max3_f32 v252, v172, v173, v252
    v_max3_f32 v252, v174, v175, v252
    v_max3_f32 v252, v176, v177, v252
    v_max3_f32 v252, v178, v179, v252
    v_max3_f32 v252, v180, v181, v252
    v_max3_f32 v252, v182, v183, v252
    s_waitcnt lgkmcnt(2)
    v_mfma_f32_32x32x16_bf16 v[168:183], v[236:239], v[54:57], 0
    ds_read_b128 v[236:239], v9 offset:12288
    v_max3_f32 v252, v152, v153, v252
    v_max3_f32 v252, v154, v155, v252
    v_max3_f32 v252, v156, v157, v252
    v_max3_f32 v252, v158, v159, v252
    v_max3_f32 v252, v160, v161, v252
    v_max3_f32 v252, v162, v163, v252
    v_max3_f32 v252, v164, v165, v252
    v_max3_f32 v252, v166, v167, v252
    s_waitcnt lgkmcnt(2)
    v_mfma_f32_32x32x16_bf16 v[152:167], v[240:243], v[54:57], 0
    ds_read_b128 v[240:243], v9 offset:10240
    v_max3_f32 v252, v200, v201, v252
    v_max3_f32 v252, v202, v203, v252
    v_max3_f32 v252, v204, v205, v252
    v_max3_f32 v252, v206, v207, v252
    v_max3_f32 v252, v208, v209, v252
    v_max3_f32 v252, v210, v211, v252
    v_max3_f32 v252, v212, v213, v252
    v_max3_f32 v252, v214, v215, v252
    s_waitcnt lgkmcnt(2)
    v_mfma_f32_32x32x16_bf16 v[200:215], v[232:235], v[54:57], 0
    ds_read_b128 v[232:235], v9 offset:22528
    v_max3_f32 v252, v168, v169, v252
    v_max3_f32 v252, v170, v171, v252
    v_max3_f32 v252, v172, v173, v252
    v_max3_f32 v252, v174, v175, v252
    v_max3_f32 v252, v176, v177, v252
    v_max3_f32 v252, v178, v179, v252
    v_max3_f32 v252, v180, v181, v252
    v_max3_f32 v252, v182, v183, v252
    s_waitcnt lgkmcnt(2)
    v_mfma_f32_32x32x16_bf16 v[168:183], v[236:239], v[54:57], 0
    ds_read_b128 v[236:239], v9 offset:20480
    s_cmp_eq_u32 s26, 0
    s_cbranch_scc1 .g0_242
.g0r_243:
    v_cndmask_b32 v184, v152, v184, s[64:65]
    v_cndmask_b32 v185, v153, v185, s[66:67]
    v_cndmask_b32 v186, v154, v186, s[68:69]
    v_cndmask_b32 v187, v155, v187, s[70:71]
    v_cndmask_b32 v188, v156, v188, s[72:73]
    v_cndmask_b32 v189, v157, v189, s[74:75]
    v_cndmask_b32 v190, v158, v190, s[76:77]
    v_cndmask_b32 v191, v159, v191, s[78:79]
    v_cndmask_b32 v192, v160, v192, s[80:81]
    v_cndmask_b32 v193, v161, v193, s[82:83]
    v_cndmask_b32 v194, v162, v194, s[84:85]
    v_cndmask_b32 v195, v163, v195, s[86:87]
    v_cndmask_b32 v196, v164, v196, s[88:89]
    v_cndmask_b32 v197, v165, v197, s[90:91]
    v_cndmask_b32 v198, v166, v198, s[92:93]
    v_cndmask_b32 v199, v167, v199, s[94:95]
    s_waitcnt lgkmcnt(2)
    v_mfma_f32_32x32x16_bf16 v[152:167], v[240:243], v[54:57], 0
    ds_read_b128 v[240:243], v9 offset:18432
    v_max3_f32 v252, v184, v185, v252
    v_max3_f32 v252, v186, v187, v252
    v_max3_f32 v252, v188, v189, v252
    v_max3_f32 v252, v190, v191, v252
    v_max3_f32 v252, v192, v193, v252
    v_max3_f32 v252, v194, v195, v252
    v_max3_f32 v252, v196, v197, v252
    v_max3_f32 v252, v198, v199, v252
    s_cmp_ge_i32 s56, 3
    s_cbranch_scc1 .sk_244
    v_max3_f32 v252, v200, v201, v252
    v_max3_f32 v252, v202, v203, v252
    v_max3_f32 v252, v204, v205, v252
    v_max3_f32 v252, v206, v207, v252
    v_max3_f32 v252, v208, v209, v252
    v_max3_f32 v252, v210, v211, v252
    v_max3_f32 v252, v212, v213, v252
    v_max3_f32 v252, v214, v215, v252
.skr_245:
    s_cmp_ge_i32 s56, 2
    s_cbranch_scc1 .sk_246
    v_max3_f32 v252, v168, v169, v252
    v_max3_f32 v252, v170, v171, v252
    v_max3_f32 v252, v172, v173, v252
    v_max3_f32 v252, v174, v175, v252
    v_max3_f32 v252, v176, v177, v252
    v_max3_f32 v252, v178, v179, v252
    v_max3_f32 v252, v180, v181, v252
    v_max3_f32 v252, v182, v183, v252
.skr_247:
    s_cmp_ge_i32 s56, 1
    s_cbranch_scc1 .sk_248
    v_max3_f32 v252, v152, v153, v252
    v_max3_f32 v252, v154, v155, v252
    v_max3_f32 v252, v156, v157, v252
    v_max3_f32 v252, v158, v159, v252
    v_max3_f32 v252, v160, v161, v252
    v_max3_f32 v252, v162, v163, v252
    v_max3_f32 v252, v164, v165, v252
    v_max3_f32 v252, v166, v167, v252
.skr_249:
    v_mov_b32 v255, v252
    s_nop 1
    v_permlane32_swap_b32 v252, v255
    v_min_f32 v252, -v252, -v255
    v_pk_mov_b32 v[168:169], v[252:253], v[252:253] op_sel:[0,0]
    v_pk_mov_b32 v[170:171], v[252:253], v[252:253] op_sel:[0,0]
    v_pk_mov_b32 v[172:173], v[252:253], v[252:253] op_sel:[0,0]
    v_pk_mov_b32 v[174:175], v[252:253], v[252:253] op_sel:[0,0]
    v_pk_mov_b32 v[176:177], v[252:253], v[252:253] op_sel:[0,0]
    v_pk_mov_b32 v[178:179], v[252:253], v[252:253] op_sel:[0,0]
    v_pk_mov_b32 v[180:181], v[252:253], v[252:253] op_sel:[0,0]
    v_pk_mov_b32 v[182:183], v[252:253], v[252:253] op_sel:[0,0]
    v_pk_add_f32 v[184:185], v[184:185], v[252:253] op_sel_hi:[1,0]
    v_pk_add_f32 v[186:187], v[186:187], v[252:253] op_sel_hi:[1,0]
    v_pk_add_f32 v[188:189], v[188:189], v[252:253] op_sel_hi:[1,0]
    v_pk_add_f32 v[190:191], v[190:191], v[252:253] op_sel_hi:[1,0]
    v_pk_add_f32 v[192:193], v[192:193], v[252:253] op_sel_hi:[1,0]
    v_pk_add_f32 v[194:195], v[194:195], v[252:253] op_sel_hi:[1,0]
    v_pk_add_f32 v[196:197], v[196:197], v[252:253] op_sel_hi:[1,0]
    v_pk_add_f32 v[198:199], v[198:199], v[252:253] op_sel_hi:[1,0]
    s_waitcnt lgkmcnt(2)
    v_mfma_f32_32x32x16_bf16 v[200:215], v[232:235], v[54:57], v[168:183]
    ds_read_b128 v[232:235], v9 offset:16384
    v_exp_f32 v184, v184
    v_exp_f32 v185, v185
    v_exp_f32 v186, v186
    v_exp_f32 v187, v187
    v_cvt_pk_bf16_f32 v184, v184, v185
    v_exp_f32 v188, v188
    v_exp_f32 v189, v189
    v_cvt_pk_bf16_f32 v185, v186, v187
    v_exp_f32 v190, v190
    v_exp_f32 v191, v191
    v_cvt_pk_bf16_f32 v186, v188, v189
    v_exp_f32 v192, v192
    v_exp_f32 v193, v193
    v_cvt_pk_bf16_f32 v187, v190, v191
    v_exp_f32 v194, v194
    v_exp_f32 v195, v195
    v_cvt_pk_bf16_f32 v188, v192, v193
    v_exp_f32 v196, v196
    v_exp_f32 v197, v197
    v_cvt_pk_bf16_f32 v189, v194, v195
    v_exp_f32 v198, v198
    v_exp_f32 v199, v199
    v_cvt_pk_bf16_f32 v190, v196, v197
    v_cvt_pk_bf16_f32 v191, v198, v199
    v_and_b32 v192, v184, v46
    v_and_b32 v193, v185, v47
    v_and_b32 v194, v186, v48
    v_and_b32 v195, v187, v49
    v_and_b32 v196, v188, v50
    v_and_b32 v197, v189, v51
    v_and_b32 v198, v190, v52
    v_and_b32 v199, v191, v53
    v_xor_b32 v184, v184, v192
    v_xor_b32 v185, v185, v193
    v_mfma_f32_32x32x16_bf16 v[216:231], v[244:247], v[192:195], 0
    v_xor_b32 v186, v186, v194
    v_xor_b32 v187, v187, v195
    v_xor_b32 v188, v188, v196
    v_xor_b32 v189, v189, v197
    v_xor_b32 v190, v190, v198
    v_xor_b32 v191, v191, v199
    v_mfma_f32_32x32x16_bf16 v[216:231], v[248:251], v[196:199], v[216:231]
    s_mov_b64 exec, s[42:43]
    ds_read_b128 v[244:247], v9 offset:23552
    ds_read_b128 v[248:251], v9 offset:23808
    s_mov_b64 exec, -1
    v_exp_f32 v200, v200
    v_exp_f32 v201, v201
    v_exp_f32 v202, v202
    v_exp_f32 v203, v203
    v_mfma_f32_32x32x16_bf16 v[216:231], v[78:81], v[184:187], v[216:231]
    v_cvt_pk_bf16_f32 v200, v200, v201
    v_exp_f32 v204, v204
    v_exp_f32 v205, v205
    v_cvt_pk_bf16_f32 v201, v202, v203
    v_exp_f32 v206, v206
    v_mfma_f32_32x32x16_bf16 v[216:231], v[82:85], v[188:191], v[216:231]
    s_mov_b64 exec, s[42:43]
    ds_read_b128 v[78:81], v9 offset:21504
    ds_read_b128 v[82:85], v9 offset:21760
    s_mov_b64 exec, -1
    v_exp_f32 v207, v207
    v_cvt_pk_bf16_f32 v202, v204, v205
    v_exp_f32 v208, v208
    v_exp_f32 v209, v209
    v_cvt_pk_bf16_f32 v203, v206, v207
    s_waitcnt lgkmcnt(6)
    v_mfma_f32_32x32x16_bf16 v[184:199], v[236:239], v[54:57], v[168:183]
    ds_read_b128 v[236:239], v9 offset:14336
    v_exp_f32 v210, v210
    v_exp_f32 v211, v211
    v_cvt_pk_bf16_f32 v204, v208, v209
    v_exp_f32 v212, v212
    v_exp_f32 v213, v213
    v_cvt_pk_bf16_f32 v205, v210, v211
    v_exp_f32 v214, v214
    v_exp_f32 v215, v215
    v_cvt_pk_bf16_f32 v206, v212, v213
    v_cvt_pk_bf16_f32 v207, v214, v215
    s_waitcnt lgkmcnt(3)
    v_mfma_f32_32x32x16_bf16 v[216:231], v[244:247], v[200:203], v[216:231]
    v_exp_f32 v184, v184
    v_exp_f32 v185, v185
    v_exp_f32 v186, v186
    v_exp_f32 v187, v187
    v_mfma_f32_32x32x16_bf16 v[216:231], v[248:251], v[204:207], v[216:231]
    s_mov_b64 exec, s[42:43]
    ds_read_b128 v[244:247], v9 offset:19456
    ds_read_b128 v[248:251], v9 offset:19712
    s_mov_b64 exec, -1
    v_cvt_pk_bf16_f32 v184, v184, v185
    v_exp_f32 v188, v188
    v_exp_f32 v189, v189
    v_cvt_pk_bf16_f32 v185, v186, v187
    v_exp_f32 v190, v190
    v_mfma_f32_32x32x16_bf16 v[200:215], v[240:243], v[54:57], v[168:183]
    ds_read_b128 v[240:243], v9 offset:12288
    v_exp_f32 v191, v191
    v_cvt_pk_bf16_f32 v186, v188, v189
    v_exp_f32 v192, v192
    v_exp_f32 v193, v193
    v_cvt_pk_bf16_f32 v187, v190, v191
    v_exp_f32 v194, v194
    v_exp_f32 v195, v195
    v_cvt_pk_bf16_f32 v188, v192, v193
    v_exp_f32 v196, v196
    v_exp_f32 v197, v197
    v_cvt_pk_bf16_f32 v189, v194, v195
    v_exp_f32 v198, v198
    v_exp_f32 v199, v199
    v_cvt_pk_bf16_f32 v190, v196, v197
    v_cvt_pk_bf16_f32 v191, v198, v199
    s_waitcnt lgkmcnt(4)
    v_mfma_f32_32x32x16_bf16 v[216:231], v[78:81], v[184:187], v[216:231]
    v_exp_f32 v200, v200
    v_exp_f32 v201, v201
    v_exp_f32 v202, v202
    v_exp_f32 v203, v203
    v_mfma_f32_32x32x16_bf16 v[216:231], v[82:85], v[188:191], v[216:231]
    s_mov_b64 exec, s[42:43]
    ds_read_b128 v[78:81], v9 offset:17408
    ds_read_b128 v[82:85], v9 offset:17664
    s_mov_b64 exec, -1
    v_cvt_pk_bf16_f32 v200, v200, v201
    v_exp_f32 v204, v204
    v_exp_f32 v205, v205
    v_cvt_pk_bf16_f32 v201, v202, v203
    v_exp_f32 v206, v206
    v_mfma_f32_32x32x16_bf16 v[184:199], v[232:235], v[54:57], v[168:183]
    ds_read_b128 v[232:235], v9 offset:10240
    v_exp_f32 v207, v207
    v_cvt_pk_bf16_f32 v202, v204, v205
    v_exp_f32 v208, v208
    v_exp_f32 v209, v209
    v_cvt_pk_bf16_f32 v203, v206, v207
    s_cmp_eq_u32 s26, 0
    s_cselect_b32 s44, 0, 3145728
    s_sub_u32 s44, s101, s44
    s_add_u32 s44, s44, 1572864
    v_add_u32 v86, s44, v2
    global_load_dwordx4 v[124:127], v86, s[24:25] offset:0 sc1
    global_load_dwordx4 v[132:135], v86, s[24:25] offset:1024 sc1
    global_load_dwordx4 v[140:143], v86, s[24:25] offset:2048 sc1
    v_exp_f32 v210, v210
    v_exp_f32 v211, v211
    v_cvt_pk_bf16_f32 v204, v208, v209
    v_exp_f32 v212, v212
    v_exp_f32 v213, v213
    v_cvt_pk_bf16_f32 v205, v210, v211
    v_exp_f32 v214, v214
    v_exp_f32 v215, v215
    v_cvt_pk_bf16_f32 v206, v212, v213
    v_cvt_pk_bf16_f32 v207, v214, v215
    s_waitcnt lgkmcnt(4)
    v_mfma_f32_32x32x16_bf16 v[216:231], v[244:247], v[200:203], v[216:231]
    v_exp_f32 v184, v184
    v_exp_f32 v185, v185
    v_exp_f32 v186, v186
    v_exp_f32 v187, v187
    v_mfma_f32_32x32x16_bf16 v[216:231], v[248:251], v[204:207], v[216:231]
    s_mov_b64 exec, s[42:43]
    ds_read_b128 v[244:247], v9 offset:15360
    ds_read_b128 v[248:251], v9 offset:15616
    s_mov_b64 exec, -1
    v_cvt_pk_bf16_f32 v184, v184, v185
    v_exp_f32 v188, v188
    v_exp_f32 v189, v189
    v_cvt_pk_bf16_f32 v185, v186, v187
    v_exp_f32 v190, v190
    s_cmp_eq_i32 s56, 3
    s_cbranch_scc1 .fix_250
.fixr_251:
    v_mfma_f32_32x32x16_bf16 v[200:215], v[236:239], v[54:57], v[168:183]
    ds_read_b128 v[236:239], v9 offset:16384
    v_exp_f32 v191, v191
    v_cvt_pk_bf16_f32 v186, v188, v189
    v_exp_f32 v192, v192
    v_exp_f32 v193, v193
    v_cvt_pk_bf16_f32 v187, v190, v191
    v_exp_f32 v194, v194
    v_exp_f32 v195, v195
    v_cvt_pk_bf16_f32 v188, v192, v193
    v_exp_f32 v196, v196
    v_exp_f32 v197, v197
    v_cvt_pk_bf16_f32 v189, v194, v195
    v_exp_f32 v198, v198
    v_exp_f32 v199, v199
    v_cvt_pk_bf16_f32 v190, v196, v197
    v_cvt_pk_bf16_f32 v191, v198, v199
    s_waitcnt lgkmcnt(4)
    v_mfma_f32_32x32x16_bf16 v[216:231], v[78:81], v[184:187], v[216:231]
    v_exp_f32 v200, v200
    v_exp_f32 v201, v201
    v_exp_f32 v202, v202
    v_exp_f32 v203, v203
    v_mfma_f32_32x32x16_bf16 v[216:231], v[82:85], v[188:191], v[216:231]
    s_mov_b64 exec, s[42:43]
    ds_read_b128 v[78:81], v9 offset:13312
    ds_read_b128 v[82:85], v9 offset:13568
    s_mov_b64 exec, -1
    v_cvt_pk_bf16_f32 v200, v200, v201
    v_exp_f32 v204, v204
    v_exp_f32 v205, v205
    v_cvt_pk_bf16_f32 v201, v202, v203
    v_exp_f32 v206, v206
    s_cmp_eq_i32 s56, 2
    s_cbranch_scc1 .fix_252
.fixr_253:
    v_mfma_f32_32x32x16_bf16 v[184:199], v[240:243], v[54:57], v[168:183]
    ds_read_b128 v[240:243], v9 offset:14336
    v_exp_f32 v207, v207
    v_cvt_pk_bf16_f32 v202, v204, v205
    v_exp_f32 v208, v208
    v_exp_f32 v209, v209
    v_cvt_pk_bf16_f32 v203, v206, v207
    v_exp_f32 v210, v210
    v_exp_f32 v211, v211
    v_cvt_pk_bf16_f32 v204, v208, v209
    v_exp_f32 v212, v212
    v_exp_f32 v213, v213
    v_cvt_pk_bf16_f32 v205, v210, v211
    v_exp_f32 v214, v214
    v_exp_f32 v215, v215
    v_cvt_pk_bf16_f32 v206, v212, v213
    v_cvt_pk_bf16_f32 v207, v214, v215
    s_waitcnt lgkmcnt(4)
    v_mfma_f32_32x32x16_bf16 v[216:231], v[244:247], v[200:203], v[216:231]
    v_exp_f32 v184, v184
    v_exp_f32 v185, v185
    v_exp_f32 v186, v186
    v_exp_f32 v187, v187
    v_mfma_f32_32x32x16_bf16 v[216:231], v[248:251], v[204:207], v[216:231]
    s_mov_b64 exec, s[42:43]
    ds_read_b128 v[244:247], v9 offset:11264
    ds_read_b128 v[248:251], v9 offset:11520
    s_mov_b64 exec, -1
    v_cvt_pk_bf16_f32 v184, v184, v185
    v_exp_f32 v188, v188
    v_exp_f32 v189, v189
    v_cvt_pk_bf16_f32 v185, v186, v187
    v_exp_f32 v190, v190
    s_cmp_eq_i32 s56, 1
    s_cbranch_scc1 .fix_254
.fixr_255:
    v_mfma_f32_32x32x16_bf16 v[200:215], v[232:235], v[54:57], v[168:183]
    ds_read_b128 v[232:235], v9 offset:12288
    v_exp_f32 v191, v191
    v_cvt_pk_bf16_f32 v186, v188, v189
    v_exp_f32 v192, v192
    v_exp_f32 v193, v193
    v_cvt_pk_bf16_f32 v187, v190, v191
    v_exp_f32 v194, v194
    v_exp_f32 v195, v195
    v_cvt_pk_bf16_f32 v188, v192, v193
    v_exp_f32 v196, v196
    v_exp_f32 v197, v197
    v_cvt_pk_bf16_f32 v189, v194, v195
    v_exp_f32 v198, v198
    v_exp_f32 v199, v199
    v_cvt_pk_bf16_f32 v190, v196, v197
    v_cvt_pk_bf16_f32 v191, v198, v199
    s_waitcnt lgkmcnt(4)
    v_mfma_f32_32x32x16_bf16 v[216:231], v[78:81], v[184:187], v[216:231]
    v_exp_f32 v200, v200
    v_exp_f32 v201, v201
    v_exp_f32 v202, v202
    v_exp_f32 v203, v203
    v_mfma_f32_32x32x16_bf16 v[216:231], v[82:85], v[188:191], v[216:231]
    s_mov_b64 exec, s[42:43]
    ds_read_b128 v[78:81], v9 offset:17408
    ds_read_b128 v[82:85], v9 offset:17664
    s_mov_b64 exec, -1
    v_cvt_pk_bf16_f32 v200, v200, v201
    v_exp_f32 v204, v204
    v_exp_f32 v205, v205
    v_cvt_pk_bf16_f32 v201, v202, v203
    v_exp_f32 v206, v206
    v_mfma_f32_32x32x16_bf16 v[184:199], v[236:239], v[58:61], 0
    ds_read_b128 v[236:239], v9 offset:10240
    v_exp_f32 v207, v207
    v_cvt_pk_bf16_f32 v202, v204, v205
    v_exp_f32 v208, v208
    v_exp_f32 v209, v209
    v_cvt_pk_bf16_f32 v203, v206, v207
    s_waitcnt lgkmcnt(6)
    v_mfma_f32_32x32x16_bf16 v[168:183], v[240:243], v[58:61], 0
    ds_read_b128 v[240:243], v9 offset:8192
    v_exp_f32 v210, v210
    v_exp_f32 v211, v211
    v_cvt_pk_bf16_f32 v204, v208, v209
    v_exp_f32 v212, v212
    v_exp_f32 v213, v213
    s_waitcnt lgkmcnt(5)
    v_mfma_f32_32x32x16_bf16 v[216:231], v[244:247], v[200:203], v[216:231]
    v_cvt_pk_bf16_f32 v205, v210, v211
    v_exp_f32 v214, v214
    v_exp_f32 v215, v215
    v_cvt_pk_bf16_f32 v206, v212, v213
    v_cvt_pk_bf16_f32 v207, v214, v215
    s_nop 1
    v_mfma_f32_32x32x16_bf16 v[216:231], v[248:251], v[204:207], v[216:231]
    s_waitcnt lgkmcnt(4)
    v_mfma_f32_32x32x16_bf16 v[152:167], v[232:235], v[58:61], 0
    s_lshl_b32 s44, s27, 10
    s_add_u32 s44, s44, s62
    s_add_u32 s44, s44, 393216
    v_add_u32 v63, s44, v2
    s_waitcnt vmcnt(0)
    s_mov_b32 s51, 0
.hchk_256:
    v_bitop3_b32 v87, v127, v135, v143 bitop3:0x7e
    v_bitop3_b32 v87, v127, s52, v87 bitop3:0xbe
    v_mov_b32 v127, v140
    v_cmp_ne_u32 vcc, 0, v87
    v_mov_b32 v135, v141
    s_cbranch_vccnz .hrt_257
.hok_258:
    ds_write_b128 v9, v[124:127] offset:0
    ds_write_b128 v9, v[132:135] offset:1024
    v_rcp_f32 v252, v224
    s_nop 0
    v_mul_f32 v216, v216, v252
    v_mul_f32 v217, v217, v252
    v_mul_f32 v218, v218, v252
    v_mul_f32 v219, v219, v252
    v_mul_f32 v220, v220, v252
    v_mul_f32 v221, v221, v252
    v_mul_f32 v222, v222, v252
    v_mul_f32 v223, v223, v252
    v_cvt_pk_bf16_f32 v216, v216, v217
    v_cvt_pk_bf16_f32 v217, v218, v219
    v_cvt_pk_bf16_f32 v218, v220, v221
    v_cvt_pk_bf16_f32 v219, v222, v223
    v_and_b32 v216, -2, v216
    s_cmp_eq_u32 s33, 1
    s_cbranch_scc0 .slow_259
    global_store_dwordx4 v63, v[216:219], s[24:25]
.sten_260:
    s_waitcnt lgkmcnt(0)
    s_barrier
    ds_read_b128 v[232:235], v9 offset:0
    s_mov_b64 exec, s[42:43]
    ds_read_b128 v[244:247], v9 offset:1024
    ds_read_b128 v[248:251], v9 offset:1280
    s_mov_b64 exec, -1
    v_mov_b32 v252, v254
    v_mfma_f32_32x32x16_bf16 v[200:215], v[236:239], v[58:61], 0
    ds_read_b128 v[236:239], v9 offset:6144
    s_cmp_ge_i32 s57, 7
    s_cbranch_scc1 .sk_261
    v_max3_f32 v252, v168, v169, v252
    v_max3_f32 v252, v170, v171, v252
    v_max3_f32 v252, v172, v173, v252
    v_max3_f32 v252, v174, v175, v252
    v_max3_f32 v252, v176, v177, v252
    v_max3_f32 v252, v178, v179, v252
    v_max3_f32 v252, v180, v181, v252
    v_max3_f32 v252, v182, v183, v252
.skr_262:
    v_mfma_f32_32x32x16_bf16 v[168:183], v[240:243], v[58:61], 0
    ds_read_b128 v[240:243], v9 offset:4096
    s_cmp_ge_i32 s57, 6
    s_cbranch_scc1 .sk_263
    v_max3_f32 v252, v152, v153, v252
    v_max3_f32 v252, v154, v155, v252
    v_max3_f32 v252, v156, v157, v252
    v_max3_f32 v252, v158, v159, v252
    v_max3_f32 v252, v160, v161, v252
    v_max3_f32 v252, v162, v163, v252
    v_max3_f32 v252, v164, v165, v252
    v_max3_f32 v252, v166, v167, v252
.skr_264:
    s_waitcnt lgkmcnt(4)
    v_mfma_f32_32x32x16_bf16 v[152:167], v[232:235], v[58:61], 0
    ds_read_b128 v[232:235], v9 offset:2048
    s_cmp_ge_i32 s57, 5
    s_cbranch_scc1 .sk_265
    v_max3_f32 v252, v200, v201, v252
    v_max3_f32 v252, v202, v203, v252
    v_max3_f32 v252, v204, v205, v252
    v_max3_f32 v252, v206, v207, v252
    v_max3_f32 v252, v208, v209, v252
    v_max3_f32 v252, v210, v211, v252
    v_max3_f32 v252, v212, v213, v252
    v_max3_f32 v252, v214, v215, v252
.skr_266:
    s_waitcnt lgkmcnt(2)
    v_mfma_f32_32x32x16_bf16 v[200:215], v[236:239], v[58:61], 0
    ds_read_b128 v[236:239], v9 offset:14336
    s_cmp_ge_i32 s57, 4
    s_cbranch_scc1 .sk_267
    v_max3_f32 v252, v168, v169, v252
    v_max3_f32 v252, v170, v171, v252
    v_max3_f32 v252, v172, v173, v252
    v_max3_f32 v252, v174, v175, v252
    v_max3_f32 v252, v176, v177, v252
    v_max3_f32 v252, v178, v179, v252
    v_max3_f32 v252, v180, v181, v252
    v_max3_f32 v252, v182, v183, v252
.skr_268:
    s_waitcnt lgkmcnt(2)
    v_mfma_f32_32x32x16_bf16 v[168:183], v[240:243], v[58:61], 0
    ds_read_b128 v[240:243], v9 offset:12288
    s_cmp_eq_u32 s26, 0
    s_cbranch_scc1 .g0_269
.g0r_270:
    v_cndmask_b32 v184, v152, v184, s[64:65]
    v_cndmask_b32 v185, v153, v185, s[66:67]
    v_cndmask_b32 v186, v154, v186, s[68:69]
    v_cndmask_b32 v187, v155, v187, s[70:71]
    v_cndmask_b32 v188, v156, v188, s[72:73]
    v_cndmask_b32 v189, v157, v189, s[74:75]
    v_cndmask_b32 v190, v158, v190, s[76:77]
    v_cndmask_b32 v191, v159, v191, s[78:79]
    v_cndmask_b32 v192, v160, v192, s[80:81]
    v_cndmask_b32 v193, v161, v193, s[82:83]
    v_cndmask_b32 v194, v162, v194, s[84:85]
    v_cndmask_b32 v195, v163, v195, s[86:87]
    v_cndmask_b32 v196, v164, v196, s[88:89]
    v_cndmask_b32 v197, v165, v197, s[90:91]
    v_cndmask_b32 v198, v166, v198, s[92:93]
    v_cndmask_b32 v199, v167, v199, s[94:95]
    s_waitcnt lgkmcnt(2)
    v_mfma_f32_32x32x16_bf16 v[152:167], v[232:235], v[58:61], 0
    ds_read_b128 v[232:235], v9 offset:10240
    v_max3_f32 v252, v184, v185, v252
    v_max3_f32 v252, v186, v187, v252
    v_max3_f32 v252, v188, v189, v252
    v_max3_f32 v252, v190, v191, v252
    v_max3_f32 v252, v192, v193, v252
    v_max3_f32 v252, v194, v195, v252
    v_max3_f32 v252, v196, v197, v252
    v_max3_f32 v252, v198, v199, v252
    s_lshl2_add_u32 s44, s28, s96
    s_lshl_b32 s44, s44, 11
    s_add_u32 s44, s44, s32
    s_add_u32 s44, s44, 396288
    v_add_u32 v62, s44, v2
    global_load_dwordx4 v[144:147], v62, s[24:25] offset:-3072 sc1
    global_load_dwordx4 v[136:139], v62, s[24:25] offset:-2048 sc1
    s_lshl2_add_u32 s44, s28, s97
    s_lshl_b32 s44, s44, 11
    s_add_u32 s44, s44, s32
    s_add_u32 s44, s44, 396288
    v_add_u32 v62, s44, v2
    global_load_dwordx4 v[128:131], v62, s[24:25] offset:-3072 sc1
    s_cmp_ge_i32 s57, 3
    s_cbranch_scc1 .sk_271
    v_max3_f32 v252, v200, v201, v252
    v_max3_f32 v252, v202, v203, v252
    v_max3_f32 v252, v204, v205, v252
    v_max3_f32 v252, v206, v207, v252
    v_max3_f32 v252, v208, v209, v252
    v_max3_f32 v252, v210, v211, v252
    v_max3_f32 v252, v212, v213, v252
    v_max3_f32 v252, v214, v215, v252
.skr_272:
    global_load_dwordx4 v[148:151], v62, s[24:25] offset:-2048 sc1
    s_lshl2_add_u32 s44, s28, s98
    s_lshl_b32 s44, s44, 11
    s_add_u32 s44, s44, s32
    s_add_u32 s44, s44, 396288
    v_add_u32 v62, s44, v2
    global_load_dwordx4 v[120:123], v62, s[24:25] offset:-3072 sc1
    global_load_dwordx4 v[124:127], v62, s[24:25] offset:-2048 sc1
    s_cmp_ge_i32 s57, 2
    s_cbranch_scc1 .sk_273
    v_max3_f32 v252, v168, v169, v252
    v_max3_f32 v252, v170, v171, v252
    v_max3_f32 v252, v172, v173, v252
    v_max3_f32 v252, v174, v175, v252
    v_max3_f32 v252, v176, v177, v252
    v_max3_f32 v252, v178, v179, v252
    v_max3_f32 v252, v180, v181, v252
    v_max3_f32 v252, v182, v183, v252
.skr_274:
    s_lshl2_add_u32 s44, s28, s99
    s_lshl_b32 s44, s44, 11
    s_add_u32 s44, s44, s32
    s_add_u32 s44, s44, 396288
    v_add_u32 v62, s44, v2
    global_load_dwordx4 v[132:135], v62, s[24:25] offset:-3072 sc1
    global_load_dwordx4 v[140:143], v62, s[24:25] offset:-2048 sc1
    s_cmp_ge_i32 s57, 1
    s_cbranch_scc1 .sk_275
    v_max3_f32 v252, v152, v153, v252
    v_max3_f32 v252, v154, v155, v252
    v_max3_f32 v252, v156, v157, v252
    v_max3_f32 v252, v158, v159, v252
    v_max3_f32 v252, v160, v161, v252
    v_max3_f32 v252, v162, v163, v252
    v_max3_f32 v252, v164, v165, v252
    v_max3_f32 v252, v166, v167, v252
.skr_276:
    v_mov_b32 v255, v252
    s_nop 1
    v_permlane32_swap_b32 v252, v255
    v_min_f32 v252, -v252, -v255
    v_pk_mov_b32 v[168:169], v[252:253], v[252:253] op_sel:[0,0]
    v_pk_mov_b32 v[170:171], v[252:253], v[252:253] op_sel:[0,0]
    v_pk_mov_b32 v[172:173], v[252:253], v[252:253] op_sel:[0,0]
    v_pk_mov_b32 v[174:175], v[252:253], v[252:253] op_sel:[0,0]
    v_pk_mov_b32 v[176:177], v[252:253], v[252:253] op_sel:[0,0]
    v_pk_mov_b32 v[178:179], v[252:253], v[252:253] op_sel:[0,0]
    v_pk_mov_b32 v[180:181], v[252:253], v[252:253] op_sel:[0,0]
    v_pk_mov_b32 v[182:183], v[252:253], v[252:253] op_sel:[0,0]
    v_pk_add_f32 v[184:185], v[184:185], v[252:253] op_sel_hi:[1,0]
    v_pk_add_f32 v[186:187], v[186:187], v[252:253] op_sel_hi:[1,0]
    v_pk_add_f32 v[188:189], v[188:189], v[252:253] op_sel_hi:[1,0]
    v_pk_add_f32 v[190:191], v[190:191], v[252:253] op_sel_hi:[1,0]
    v_pk_add_f32 v[192:193], v[192:193], v[252:253] op_sel_hi:[1,0]
    v_pk_add_f32 v[194:195], v[194:195], v[252:253] op_sel_hi:[1,0]
    v_pk_add_f32 v[196:197], v[196:197], v[252:253] op_sel_hi:[1,0]
    v_pk_add_f32 v[198:199], v[198:199], v[252:253] op_sel_hi:[1,0]
    s_cmp_eq_i32 s57, 7
    s_cbranch_scc1 .fix_277
.fixr_278:
    s_waitcnt lgkmcnt(2)
    v_mfma_f32_32x32x16_bf16 v[200:215], v[236:239], v[58:61], v[168:183]
    ds_read_b128 v[236:239], v9 offset:8192
    v_exp_f32 v184, v184
    v_exp_f32 v185, v185
    v_exp_f32 v186, v186
    v_exp_f32 v187, v187
    v_cvt_pk_bf16_f32 v184, v184, v185
    v_exp_f32 v188, v188
    v_exp_f32 v189, v189
    v_cvt_pk_bf16_f32 v185, v186, v187
    v_exp_f32 v190, v190
    v_exp_f32 v191, v191
    v_cvt_pk_bf16_f32 v186, v188, v189
    v_exp_f32 v192, v192
    v_exp_f32 v193, v193
    s_waitcnt vmcnt(4)
    v_bitop3_b32 v67, v144, v136, v128 bitop3:0xfe
    v_bitop3_b32 v67, v67, v148, 1 bitop3:0xa8
    v_cmp_ne_u32 vcc, 0, v67
    s_cbranch_vccnz .crt_279
.cok_281:
    v_mfma_f32_32x32x16_bf16 v[152:167], a[224:227], v[144:147], 0
    v_cvt_pk_bf16_f32 v187, v190, v191
    v_exp_f32 v194, v194
    v_exp_f32 v195, v195
    v_cvt_pk_bf16_f32 v188, v192, v193
    v_mfma_f32_32x32x16_bf16 v[152:167], a[232:235], v[136:139], v[152:167]
    v_exp_f32 v196, v196
    v_exp_f32 v197, v197
    v_cvt_pk_bf16_f32 v189, v194, v195
    v_exp_f32 v198, v198
    v_mfma_f32_32x32x16_bf16 v[152:167], a[240:243], v[128:131], v[152:167]
    v_exp_f32 v199, v199
    v_cvt_pk_bf16_f32 v190, v196, v197
    v_cvt_pk_bf16_f32 v191, v198, v199
    v_and_b32 v192, v184, v46
    v_and_b32 v193, v185, v47
    v_mfma_f32_32x32x16_bf16 v[152:167], a[248:251], v[148:151], v[152:167]
    s_waitcnt vmcnt(0)
    v_bitop3_b32 v67, v120, v124, v132 bitop3:0xfe
    v_bitop3_b32 v67, v67, v140, 1 bitop3:0xa8
    v_cmp_ne_u32 vcc, 0, v67
    s_cbranch_vccnz .crt_282
.cok_284:
    v_and_b32 v194, v186, v48
    v_mfma_f32_32x32x16_bf16 v[152:167], v[88:91], v[120:123], v[152:167]
    v_and_b32 v195, v187, v49
    v_and_b32 v196, v188, v50
    v_and_b32 v197, v189, v51
    v_and_b32 v198, v190, v52
    v_and_b32 v199, v191, v53
    v_xor_b32 v184, v184, v192
    v_mfma_f32_32x32x16_bf16 v[152:167], v[96:99], v[124:127], v[152:167]
    v_xor_b32 v185, v185, v193
    v_mfma_f32_32x32x16_bf16 v[216:231], v[78:81], v[192:195], 0
    v_xor_b32 v186, v186, v194
    v_xor_b32 v187, v187, v195
    v_xor_b32 v188, v188, v196
    v_xor_b32 v189, v189, v197
    v_xor_b32 v190, v190, v198
    v_xor_b32 v191, v191, v199
    v_mfma_f32_32x32x16_bf16 v[216:231], v[82:85], v[196:199], v[216:231]
    s_mov_b64 exec, s[42:43]
    ds_read_b128 v[78:81], v9 offset:15360
    ds_read_b128 v[82:85], v9 offset:15616
    s_mov_b64 exec, -1
    v_exp_f32 v200, v200
    v_exp_f32 v201, v201
    v_exp_f32 v202, v202
    v_mfma_f32_32x32x16_bf16 v[152:167], v[104:107], v[132:135], v[152:167]
    v_exp_f32 v203, v203
    v_mfma_f32_32x32x16_bf16 v[216:231], v[244:247], v[184:187], v[216:231]
    v_cvt_pk_bf16_f32 v200, v200, v201
    v_exp_f32 v204, v204
    v_exp_f32 v205, v205
    v_cvt_pk_bf16_f32 v201, v202, v203
    v_exp_f32 v206, v206
    v_mfma_f32_32x32x16_bf16 v[216:231], v[248:251], v[188:191], v[216:231]
    s_mov_b64 exec, s[42:43]
    ds_read_b128 v[244:247], v9 offset:13312
    ds_read_b128 v[248:251], v9 offset:13568
    s_mov_b64 exec, -1
    v_exp_f32 v207, v207
    v_mfma_f32_32x32x16_bf16 v[152:167], v[112:115], v[140:143], v[152:167]
    v_add_u32 v63, 131072, v14
    v_add_u32 v64, 8192, v15
    v_cvt_pk_bf16_f32 v202, v204, v205
    v_exp_f32 v208, v208
    v_exp_f32 v209, v209
    v_cvt_pk_bf16_f32 v203, v206, v207
    s_cmp_eq_i32 s57, 6
    s_cbranch_scc1 .fix_285
.fixr_286:
    s_waitcnt lgkmcnt(6)
    v_mfma_f32_32x32x16_bf16 v[184:199], v[240:243], v[58:61], v[168:183]
    ds_read_b128 v[240:243], v9 offset:6144
    v_exp_f32 v210, v210
    ds_write_b128 v11, v[152:155] offset:24576
    ds_write_b128 v12, v[156:159] offset:25600
    v_exp_f32 v211, v211
    ds_write_b128 v11, v[160:163] offset:26624
    ds_write_b128 v12, v[164:167] offset:27648
    v_cvt_pk_bf16_f32 v204, v208, v209
    v_mfma_f32_32x32x16_bf16 v[152:167], a[228:231], v[144:147], 0
    v_exp_f32 v212, v212
    v_exp_f32 v213, v213
    v_cvt_pk_bf16_f32 v205, v210, v211
    v_exp_f32 v214, v214
    v_mfma_f32_32x32x16_bf16 v[152:167], a[236:239], v[136:139], v[152:167]
    v_exp_f32 v215, v215
    v_cvt_pk_bf16_f32 v206, v212, v213
    v_cvt_pk_bf16_f32 v207, v214, v215
    s_waitcnt lgkmcnt(7)
    v_mfma_f32_32x32x16_bf16 v[216:231], v[78:81], v[200:203], v[216:231]
    v_exp_f32 v184, v184
    v_exp_f32 v185, v185
    v_exp_f32 v186, v186
    v_mfma_f32_32x32x16_bf16 v[152:167], a[244:247], v[128:131], v[152:167]
    v_exp_f32 v187, v187
    v_mfma_f32_32x32x16_bf16 v[216:231], v[82:85], v[204:207], v[216:231]
    s_mov_b64 exec, s[42:43]
    ds_read_b128 v[78:81], v9 offset:11264
    ds_read_b128 v[82:85], v9 offset:11520
    s_mov_b64 exec, -1
    v_cvt_pk_bf16_f32 v184, v184, v185
    v_exp_f32 v188, v188
    v_exp_f32 v189, v189
    v_mfma_f32_32x32x16_bf16 v[152:167], a[252:255], v[148:151], v[152:167]
    v_cvt_pk_bf16_f32 v185, v186, v187
    v_exp_f32 v190, v190
    s_cmp_eq_i32 s57, 5
    s_cbranch_scc1 .fix_287
.fixr_288:
    v_mfma_f32_32x32x16_bf16 v[200:215], v[232:235], v[58:61], v[168:183]
    ds_read_b128 v[232:235], v9 offset:4096
    v_exp_f32 v191, v191
    v_cvt_pk_bf16_f32 v186, v188, v189
    v_exp_f32 v192, v192
    v_mfma_f32_32x32x16_bf16 v[152:167], v[92:95], v[120:123], v[152:167]
    v_exp_f32 v193, v193
    v_cvt_pk_bf16_f32 v187, v190, v191
    v_exp_f32 v194, v194
    v_exp_f32 v195, v195
    v_mfma_f32_32x32x16_bf16 v[152:167], v[100:103], v[124:127], v[152:167]
    v_cvt_pk_bf16_f32 v188, v192, v193
    v_exp_f32 v196, v196
    v_exp_f32 v197, v197
    v_cvt_pk_bf16_f32 v189, v194, v195
    v_mfma_f32_32x32x16_bf16 v[152:167], v[108:111], v[132:135], v[152:167]
    v_exp_f32 v198, v198
    v_exp_f32 v199, v199
    v_cvt_pk_bf16_f32 v190, v196, v197
    v_cvt_pk_bf16_f32 v191, v198, v199
    v_mfma_f32_32x32x16_bf16 v[152:167], v[116:119], v[140:143], v[152:167]
    s_waitcnt lgkmcnt(8)
    v_mfma_f32_32x32x16_bf16 v[216:231], v[244:247], v[184:187], v[216:231]
    v_exp_f32 v200, v200
    v_exp_f32 v201, v201
    v_exp_f32 v202, v202
    v_exp_f32 v203, v203
    v_mfma_f32_32x32x16_bf16 v[216:231], v[248:251], v[188:191], v[216:231]
    s_mov_b64 exec, s[42:43]
    ds_read_b128 v[244:247], v9 offset:9216
    ds_read_b128 v[248:251], v9 offset:9472
    s_mov_b64 exec, -1
    v_cvt_pk_bf16_f32 v200, v200, v201
    ds_write_b128 v11, v[152:155] offset:28672
    ds_write_b128 v12, v[156:159] offset:29696
    v_exp_f32 v204, v204
    ds_write_b128 v11, v[160:163] offset:30720
    ds_write_b128 v12, v[164:167] offset:31744
    v_exp_f32 v205, v205
    v_lshlrev_b32 v152, 16, v30
    v_and_b32 v153, 0xffff0000, v30
    v_cvt_pk_bf16_f32 v201, v202, v203
    v_lshlrev_b32 v154, 16, v31
    v_and_b32 v155, 0xffff0000, v31
    v_exp_f32 v206, v206
    v_lshlrev_b32 v156, 16, v32
    v_and_b32 v157, 0xffff0000, v32
    s_cmp_eq_i32 s57, 4
    s_cbranch_scc1 .fix_289
.fixr_290:
    v_mfma_f32_32x32x16_bf16 v[184:199], v[236:239], v[58:61], v[168:183]
    ds_read_b128 v[236:239], v9 offset:2048
    v_exp_f32 v207, v207
    v_lshlrev_b32 v158, 16, v33
    v_and_b32 v159, 0xffff0000, v33
    v_cvt_pk_bf16_f32 v202, v204, v205
    v_exp_f32 v208, v208
    v_exp_f32 v209, v209
    v_cvt_pk_bf16_f32 v203, v206, v207
    v_exp_f32 v210, v210
    s_waitcnt lgkmcnt(1)
    s_barrier
    v_exp_f32 v211, v211
    ds_read_b128 v[120:123], v13 offset:24576
    ds_read_b128 v[124:127], v13 offset:32768
    v_cvt_pk_bf16_f32 v204, v208, v209
    ds_read_b128 v[128:131], v13 offset:40960
    ds_read_b128 v[132:135], v13 offset:49152
    v_exp_f32 v212, v212
    ds_read_b128 v[136:139], v13 offset:25088
    ds_read_b128 v[140:143], v13 offset:33280
    v_exp_f32 v213, v213
    ds_read_b128 v[144:147], v13 offset:41472
    ds_read_b128 v[148:151], v13 offset:49664
    v_cvt_pk_bf16_f32 v205, v210, v211
    v_exp_f32 v214, v214
    v_exp_f32 v215, v215
    v_cvt_pk_bf16_f32 v206, v212, v213
    v_cvt_pk_bf16_f32 v207, v214, v215
    v_mfma_f32_32x32x16_bf16 v[216:231], v[78:81], v[200:203], v[216:231]
    v_exp_f32 v184, v184
    v_exp_f32 v185, v185
    s_waitcnt lgkmcnt(6)
    v_add_f32 v120, v120, v124
    v_exp_f32 v186, v186
    v_add_f32 v121, v121, v125
    v_add_f32 v122, v122, v126
    v_exp_f32 v187, v187
    v_add_f32 v123, v123, v127
    v_add_f32 v120, v120, v152
    v_mfma_f32_32x32x16_bf16 v[216:231], v[82:85], v[204:207], v[216:231]
    s_mov_b64 exec, s[42:43]
    ds_read_b128 v[78:81], v9 offset:7168
    ds_read_b128 v[82:85], v9 offset:7424
    s_mov_b64 exec, -1
    v_cvt_pk_bf16_f32 v184, v184, v185
    v_add_f32 v121, v121, v153
    v_add_f32 v122, v122, v154
    v_exp_f32 v188, v188
    v_add_f32 v123, v123, v155
    s_waitcnt lgkmcnt(6)
    v_exp_f32 v189, v189
    v_add_f32 v128, v128, v132
    v_add_f32 v129, v129, v133
    v_cvt_pk_bf16_f32 v185, v186, v187
    v_add_f32 v130, v130, v134
    v_add_f32 v131, v131, v135
    v_exp_f32 v190, v190
    v_add_f32 v120, v120, v128
    v_add_f32 v121, v121, v129
    s_cmp_eq_i32 s57, 3
    s_cbranch_scc1 .fix_291
.fixr_292:
    v_mfma_f32_32x32x16_bf16 v[200:215], v[240:243], v[58:61], v[168:183]
    v_exp_f32 v191, v191
    v_add_f32 v122, v122, v130
    v_add_f32 v123, v123, v131
    v_cvt_pk_bf16_f32 v186, v188, v189
    v_cvt_pk_bf16_f32 v30, v120, v121
    v_cvt_pk_bf16_f32 v31, v122, v123
    v_exp_f32 v192, v192
    v_or_b32 v30, 1, v30
    s_waitcnt lgkmcnt(4)
    v_exp_f32 v193, v193
    v_add_f32 v136, v136, v140
    v_add_f32 v137, v137, v141
    v_cvt_pk_bf16_f32 v187, v190, v191
    v_add_f32 v138, v138, v142
    v_add_f32 v139, v139, v143
    v_exp_f32 v194, v194
    v_add_f32 v136, v136, v156
    v_add_f32 v137, v137, v157
    v_exp_f32 v195, v195
    v_add_f32 v138, v138, v158
    v_add_f32 v139, v139, v159
    v_cvt_pk_bf16_f32 v188, v192, v193
    s_waitcnt lgkmcnt(2)
    v_add_f32 v144, v144, v148
    v_exp_f32 v196, v196
    v_add_f32 v145, v145, v149
    v_add_f32 v146, v146, v150
    v_exp_f32 v197, v197
    v_add_f32 v147, v147, v151
    v_add_f32 v136, v136, v144
    v_cvt_pk_bf16_f32 v189, v194, v195
    v_add_f32 v137, v137, v145
    v_add_f32 v138, v138, v146
    v_exp_f32 v198, v198
    v_add_f32 v139, v139, v147
    v_cvt_pk_bf16_f32 v32, v136, v137
    v_exp_f32 v199, v199
    v_cvt_pk_bf16_f32 v33, v138, v139
    s_cmp_eq_u32 s33, 1
    s_cbranch_scc0 .slow_293
    global_store_dwordx4 v63, v[30:33], s[24:25]
.sten_294:
    v_cvt_pk_bf16_f32 v190, v196, v197
    v_add_f32 v124, v120, v121
    v_mul_f32 v125, v120, v120
    v_cvt_pk_bf16_f32 v191, v198, v199
    v_fmac_f32 v125, v121, v121
    v_add_f32 v124, v124, v122
    v_mfma_f32_32x32x16_bf16 v[216:231], v[244:247], v[184:187], v[216:231]
    v_exp_f32 v200, v200
    v_fmac_f32 v125, v122, v122
    v_add_f32 v124, v124, v123
    v_exp_f32 v201, v201
    v_fmac_f32 v125, v123, v123
    v_add_f32 v124, v124, v136
    v_exp_f32 v202, v202
    v_fmac_f32 v125, v136, v136
    v_add_f32 v124, v124, v137
    v_exp_f32 v203, v203
    v_fmac_f32 v125, v137, v137
    v_add_f32 v124, v124, v138
    v_mfma_f32_32x32x16_bf16 v[216:231], v[248:251], v[188:191], v[216:231]
    s_mov_b64 exec, s[42:43]
    ds_read_b128 v[244:247], v9 offset:5120
    ds_read_b128 v[248:251], v9 offset:5376
    s_mov_b64 exec, -1
    v_cvt_pk_bf16_f32 v200, v200, v201
    v_fmac_f32 v125, v138, v138
    v_add_f32 v124, v124, v139
    v_exp_f32 v204, v204
    v_fmac_f32 v125, v139, v139
    v_exp_f32 v205, v205
    v_cvt_pk_bf16_f32 v201, v202, v203
    v_permlane32_swap_b32 v124, v125
    v_add_f32 v124, v124, v125
    v_exp_f32 v206, v206
    v_cvt_pk_bf16_f32 v30, v120, v121
    v_mov_b32 v125, v124
    s_cmp_eq_i32 s57, 2
    s_cbranch_scc1 .fix_295
.fixr_296:
    v_mfma_f32_32x32x16_bf16 v[184:199], v[232:235], v[58:61], v[168:183]
    v_exp_f32 v207, v207
    v_permlane16_swap_b32 v124, v125
    v_add_f32 v124, v124, v125
    v_cvt_pk_bf16_f32 v202, v204, v205
    v_exp_f32 v208, v208
    v_add_f32_dpp v124, v124, v124 row_ror:8 row_mask:0xf bank_mask:0xf
    v_or_b32 v124, 1, v124
    v_exp_f32 v209, v209
    s_cmp_eq_u32 s33, 1
    s_cbranch_scc0 .slow_297
    global_store_dword v64, v124, s[24:25]
.sten_298:
    v_cvt_pk_bf16_f32 v203, v206, v207
    v_exp_f32 v210, v210
    v_exp_f32 v211, v211
    v_cvt_pk_bf16_f32 v204, v208, v209
    v_exp_f32 v212, v212
    v_exp_f32 v213, v213
    v_cvt_pk_bf16_f32 v205, v210, v211
    v_exp_f32 v214, v214
    v_exp_f32 v215, v215
    v_cvt_pk_bf16_f32 v206, v212, v213
    v_cvt_pk_bf16_f32 v207, v214, v215
    s_waitcnt lgkmcnt(2)
    v_mfma_f32_32x32x16_bf16 v[216:231], v[78:81], v[200:203], v[216:231]
    v_exp_f32 v184, v184
    v_exp_f32 v185, v185
    v_exp_f32 v186, v186
    v_exp_f32 v187, v187
    v_mfma_f32_32x32x16_bf16 v[216:231], v[82:85], v[204:207], v[216:231]
    s_mov_b64 exec, s[42:43]
    ds_read_b128 v[78:81], v9 offset:3072
    ds_read_b128 v[82:85], v9 offset:3328
    s_mov_b64 exec, -1
    v_cvt_pk_bf16_f32 v184, v184, v185
    v_exp_f32 v188, v188
    v_exp_f32 v189, v189
    v_cvt_pk_bf16_f32 v185, v186, v187
    v_exp_f32 v190, v190
    s_cmp_eq_i32 s57, 1
    s_cbranch_scc1 .fix_299
.fixr_300:
    v_mfma_f32_32x32x16_bf16 v[200:215], v[236:239], v[58:61], v[168:183]
    v_exp_f32 v191, v191
    v_cvt_pk_bf16_f32 v186, v188, v189
    v_exp_f32 v192, v192
    v_exp_f32 v193, v193
    v_cvt_pk_bf16_f32 v187, v190, v191
    v_exp_f32 v194, v194
    v_exp_f32 v195, v195
    v_cvt_pk_bf16_f32 v188, v192, v193
    v_exp_f32 v196, v196
    v_exp_f32 v197, v197
    v_cvt_pk_bf16_f32 v189, v194, v195
    v_exp_f32 v198, v198
    v_exp_f32 v199, v199
    v_cvt_pk_bf16_f32 v190, v196, v197
    v_cvt_pk_bf16_f32 v191, v198, v199
    s_waitcnt lgkmcnt(2)
    v_mfma_f32_32x32x16_bf16 v[216:231], v[244:247], v[184:187], v[216:231]
    v_exp_f32 v200, v200
    v_exp_f32 v201, v201
    v_exp_f32 v202, v202
    v_exp_f32 v203, v203
    s_add_u32 s44, s62, s58
    s_add_u32 s44, s44, 135168
    v_add_u32 v62, s44, v2
    global_load_dwordx4 v[144:147], v62, s[24:25] offset:-4096 sc1
    v_mfma_f32_32x32x16_bf16 v[216:231], v[248:251], v[188:191], v[216:231]
    v_cvt_pk_bf16_f32 v200, v200, v201
    v_exp_f32 v204, v204
    global_load_dwordx4 v[136:139], v62, s[24:25] offset:-3072 sc1
    v_exp_f32 v205, v205
    v_cvt_pk_bf16_f32 v201, v202, v203
    v_exp_f32 v206, v206
    global_load_dwordx4 v[128:131], v62, s[24:25] offset:-2048 sc1
    v_exp_f32 v207, v207
    v_cvt_pk_bf16_f32 v202, v204, v205
    v_exp_f32 v208, v208
    global_load_dwordx4 v[148:151], v62, s[24:25] offset:-1024 sc1
    v_exp_f32 v209, v209
    v_cvt_pk_bf16_f32 v203, v206, v207
    v_exp_f32 v210, v210
    global_load_dwordx4 v[120:123], v62, s[24:25] offset:0 sc1
    v_exp_f32 v211, v211
    v_cvt_pk_bf16_f32 v204, v208, v209
    v_exp_f32 v212, v212
    global_load_dwordx4 v[124:127], v62, s[24:25] offset:1024 sc1
    v_exp_f32 v213, v213
    s_waitcnt lgkmcnt(0)
    v_mfma_f32_32x32x16_bf16 v[216:231], v[78:81], v[200:203], v[216:231]
    v_cvt_pk_bf16_f32 v205, v210, v211
    global_load_dwordx4 v[132:135], v62, s[24:25] offset:2048 sc1
    v_exp_f32 v214, v214
    v_exp_f32 v215, v215
    global_load_dwordx4 v[140:143], v62, s[24:25] offset:3072 sc1
    v_cvt_pk_bf16_f32 v206, v212, v213
    v_cvt_pk_bf16_f32 v207, v214, v215
    s_nop 1
    v_mfma_f32_32x32x16_bf16 v[216:231], v[82:85], v[204:207], v[216:231]
    s_lshl_b32 s44, s27, 10
    s_add_u32 s44, s44, s62
    s_add_u32 s44, s44, 262144
    v_add_u32 v63, s44, v2
    s_add_u32 s44, s62, s59
    s_add_u32 s44, s44, 135168
    v_add_u32 v62, s44, v2
    global_load_dwordx4 v[152:155], v62, s[24:25] offset:-4096 sc1
    global_load_dwordx4 v[156:159], v62, s[24:25] offset:-3072 sc1
    global_load_dwordx4 v[160:163], v62, s[24:25] offset:-2048 sc1
    global_load_dwordx4 v[164:167], v62, s[24:25] offset:-1024 sc1
    s_nop 0
    v_rcp_f32 v252, v224
    s_nop 0
    v_pk_mul_f32 v[216:217], v[216:217], v[252:253] op_sel_hi:[1,0]
    v_pk_mul_f32 v[218:219], v[218:219], v[252:253] op_sel_hi:[1,0]
    v_pk_mul_f32 v[220:221], v[220:221], v[252:253] op_sel_hi:[1,0]
    v_pk_mul_f32 v[222:223], v[222:223], v[252:253] op_sel_hi:[1,0]
    v_cvt_pk_bf16_f32 v216, v216, v217
    v_cvt_pk_bf16_f32 v217, v218, v219
    v_cvt_pk_bf16_f32 v218, v220, v221
    v_cvt_pk_bf16_f32 v219, v222, v223
    v_and_b32 v216, -2, v216
    s_cmp_eq_u32 s33, 1
    s_cbranch_scc0 .slow_301
    global_store_dwordx4 v63, v[216:219], s[24:25]
.sten_302:
    ds_read_b64_tr_b16 v[232:233], v7 offset:0
    ds_read_b64_tr_b16 v[234:235], v7 offset:112
    ds_read_b64_tr_b16 v[236:237], v7 offset:64
    ds_read_b64_tr_b16 v[238:239], v7 offset:176
    ds_read_b64_tr_b16 v[240:241], v7 offset:1792
    ds_read_b64_tr_b16 v[242:243], v7 offset:1904
    ds_read_b64_tr_b16 v[244:245], v7 offset:1856
    ds_read_b64_tr_b16 v[246:247], v7 offset:1968
    s_waitcnt vmcnt(9)
    v_bitop3_b32 v67, v144, v136, v128 bitop3:0x80
    v_bitop3_b32 v67, v67, v148, 1 bitop3:0x80
    v_cmp_eq_u32 vcc, 0, v67
    s_cbranch_vccnz .crt_303
.cok_305:
    s_waitcnt lgkmcnt(6)
    v_mfma_f32_32x32x16_bf16 v[168:183], v[232:235], v[144:147], 0
    ds_read_b64_tr_b16 v[248:249], v7 offset:3584
    ds_read_b64_tr_b16 v[250:251], v7 offset:3696
    s_waitcnt lgkmcnt(6)
    v_mfma_f32_32x32x16_bf16 v[184:199], v[236:239], v[144:147], 0
    ds_read_b64_tr_b16 v[252:253], v7 offset:3648
    ds_read_b64_tr_b16 v[254:255], v7 offset:3760
    global_load_dwordx4 v[144:147], v62, s[24:25] offset:0 sc1
    s_waitcnt lgkmcnt(6)
    v_mfma_f32_32x32x16_bf16 v[168:183], v[240:243], v[136:139], v[168:183]
    ds_read_b64_tr_b16 v[232:233], v7 offset:5376
    ds_read_b64_tr_b16 v[234:235], v7 offset:5488
    s_waitcnt lgkmcnt(6)
    v_mfma_f32_32x32x16_bf16 v[184:199], v[244:247], v[136:139], v[184:199]
    ds_read_b64_tr_b16 v[236:237], v7 offset:5440
    ds_read_b64_tr_b16 v[238:239], v7 offset:5552
    global_load_dwordx4 v[136:139], v62, s[24:25] offset:1024 sc1
    s_waitcnt lgkmcnt(6)
    v_mfma_f32_32x32x16_bf16 v[168:183], v[248:251], v[128:131], v[168:183]
    ds_read_b64_tr_b16 v[240:241], v7 offset:7168
    ds_read_b64_tr_b16 v[242:243], v7 offset:7280
    v_lshlrev_b32 v78, 16, v34
    s_waitcnt lgkmcnt(6)
    v_mfma_f32_32x32x16_bf16 v[184:199], v[252:255], v[128:131], v[184:199]
    ds_read_b64_tr_b16 v[244:245], v7 offset:7232
    ds_read_b64_tr_b16 v[246:247], v7 offset:7344
    s_add_u32 s44, s36, s34
    s_add_u32 s44, s44, 0x148000
    v_add_u32 v67, s44, v2
    global_load_dwordx4 v[128:131], v67, s[24:25] offset:0 sc1
    v_and_b32 v79, 0xffff0000, v34
    s_waitcnt lgkmcnt(6)
    v_mfma_f32_32x32x16_bf16 v[168:183], v[232:235], v[148:151], v[168:183]
    ds_read_b64_tr_b16 v[248:249], v7 offset:8960
    ds_read_b64_tr_b16 v[250:251], v7 offset:9072
    v_lshlrev_b32 v80, 16, v35
    s_waitcnt lgkmcnt(6)
    v_mfma_f32_32x32x16_bf16 v[184:199], v[236:239], v[148:151], v[184:199]
    ds_read_b64_tr_b16 v[252:253], v7 offset:9024
    ds_read_b64_tr_b16 v[254:255], v7 offset:9136
    s_add_u32 s44, s36, s34
    s_add_u32 s44, s44, 0x148000
    v_add_u32 v67, s44, v2
    global_load_dwordx4 v[148:151], v67, s[24:25] offset:1024 sc1
    v_and_b32 v81, 0xffff0000, v35
    s_waitcnt vmcnt(9)
    v_bitop3_b32 v67, v120, v124, v132 bitop3:0x80
    v_bitop3_b32 v67, v67, v140, 1 bitop3:0x80
    v_cmp_eq_u32 vcc, 0, v67
    s_cbranch_vccnz .crt_306
.cok_308:
    s_waitcnt lgkmcnt(6)
    v_mfma_f32_32x32x16_bf16 v[168:183], v[240:243], v[120:123], v[168:183]
    ds_read_b64_tr_b16 v[232:233], v7 offset:10752
    ds_read_b64_tr_b16 v[234:235], v7 offset:10864
    v_lshlrev_b32 v82, 16, v36
    s_waitcnt lgkmcnt(6)
    v_mfma_f32_32x32x16_bf16 v[184:199], v[244:247], v[120:123], v[184:199]
    ds_read_b64_tr_b16 v[236:237], v7 offset:10816
    ds_read_b64_tr_b16 v[238:239], v7 offset:10928
    global_load_dwordx4 v[120:123], v62, s[24:25] offset:2048 sc1
    v_and_b32 v83, 0xffff0000, v36
    s_waitcnt lgkmcnt(6)
    v_mfma_f32_32x32x16_bf16 v[168:183], v[248:251], v[124:127], v[168:183]
    ds_read_b64_tr_b16 v[240:241], v7 offset:12544
    ds_read_b64_tr_b16 v[242:243], v7 offset:12656
    v_lshlrev_b32 v84, 16, v37
    s_waitcnt lgkmcnt(6)
    v_mfma_f32_32x32x16_bf16 v[184:199], v[252:255], v[124:127], v[184:199]
    ds_read_b64_tr_b16 v[244:245], v7 offset:12608
    ds_read_b64_tr_b16 v[246:247], v7 offset:12720
    global_load_dwordx4 v[124:127], v62, s[24:25] offset:3072 sc1
    v_and_b32 v85, 0xffff0000, v37
    s_waitcnt lgkmcnt(6)
    v_mfma_f32_32x32x16_bf16 v[168:183], v[232:235], v[132:135], v[168:183]
    ds_read_b64_tr_b16 v[248:249], v7 offset:14336
    ds_read_b64_tr_b16 v[250:251], v7 offset:14448
    s_barrier
    s_waitcnt lgkmcnt(6)
    v_mfma_f32_32x32x16_bf16 v[184:199], v[236:239], v[132:135], v[184:199]
    ds_read_b64_tr_b16 v[252:253], v7 offset:14400
    ds_read_b64_tr_b16 v[254:255], v7 offset:14512
    s_add_u32 s44, s62, s60
    s_add_u32 s44, s44, 135168
    v_add_u32 v62, s44, v2
    global_load_dwordx4 v[132:135], v62, s[24:25] offset:-4096 sc1
    s_waitcnt lgkmcnt(6)
    v_mfma_f32_32x32x16_bf16 v[168:183], v[240:243], v[140:143], v[168:183]
    ds_read_b64_tr_b16 v[232:233], v7 offset:16128
    ds_read_b64_tr_b16 v[234:235], v7 offset:16240
    s_waitcnt lgkmcnt(6)
    v_mfma_f32_32x32x16_bf16 v[184:199], v[244:247], v[140:143], v[184:199]
    ds_read_b64_tr_b16 v[236:237], v7 offset:16192
    ds_read_b64_tr_b16 v[238:239], v7 offset:16304
    global_load_dwordx4 v[140:143], v62, s[24:25] offset:-3072 sc1
    s_waitcnt vmcnt(9)
    v_bitop3_b32 v67, v152, v156, v160 bitop3:0x80
    v_bitop3_b32 v67, v67, v164, 1 bitop3:0x80
    v_cmp_eq_u32 vcc, 0, v67
    s_cbranch_vccnz .crt_309
.cok_311:
    s_waitcnt lgkmcnt(6)
    v_mfma_f32_32x32x16_bf16 v[168:183], v[248:251], v[152:155], v[168:183]
    ds_read_b64_tr_b16 v[240:241], v7 offset:17920
    ds_read_b64_tr_b16 v[242:243], v7 offset:18032
    s_waitcnt lgkmcnt(6)
    v_mfma_f32_32x32x16_bf16 v[184:199], v[252:255], v[152:155], v[184:199]
    ds_read_b64_tr_b16 v[244:245], v7 offset:17984
    ds_read_b64_tr_b16 v[246:247], v7 offset:18096
    s_lshl2_add_u32 s44, s28, s96
    s_lshl_b32 s44, s44, 11
    s_add_u32 s44, s44, s32
    s_add_u32 s44, s44, 265216
    v_add_u32 v62, s44, v2
    global_load_dwordx4 v[152:155], v62, s[24:25] offset:-3072 sc1
    s_waitcnt lgkmcnt(6)
    v_mfma_f32_32x32x16_bf16 v[168:183], v[232:235], v[156:159], v[168:183]
    ds_read_b64_tr_b16 v[248:249], v7 offset:19712
    ds_read_b64_tr_b16 v[250:251], v7 offset:19824
    s_waitcnt lgkmcnt(6)
    v_mfma_f32_32x32x16_bf16 v[184:199], v[236:239], v[156:159], v[184:199]
    ds_read_b64_tr_b16 v[252:253], v7 offset:19776
    ds_read_b64_tr_b16 v[254:255], v7 offset:19888
    global_load_dwordx4 v[156:159], v62, s[24:25] offset:-2048 sc1
    s_waitcnt lgkmcnt(6)
    v_mfma_f32_32x32x16_bf16 v[168:183], v[240:243], v[160:163], v[168:183]
    ds_read_b64_tr_b16 v[232:233], v7 offset:21504
    ds_read_b64_tr_b16 v[234:235], v7 offset:21616
    s_waitcnt lgkmcnt(6)
    v_mfma_f32_32x32x16_bf16 v[184:199], v[244:247], v[160:163], v[184:199]
    ds_read_b64_tr_b16 v[236:237], v7 offset:21568
    ds_read_b64_tr_b16 v[238:239], v7 offset:21680
    s_lshl2_add_u32 s44, s28, s97
    s_lshl_b32 s44, s44, 11
    s_add_u32 s44, s44, s32
    s_add_u32 s44, s44, 265216
    v_add_u32 v62, s44, v2
    global_load_dwordx4 v[160:163], v62, s[24:25] offset:-3072 sc1
    s_waitcnt lgkmcnt(6)
    v_mfma_f32_32x32x16_bf16 v[168:183], v[248:251], v[164:167], v[168:183]
    ds_read_b64_tr_b16 v[240:241], v7 offset:23296
    ds_read_b64_tr_b16 v[242:243], v7 offset:23408
    s_waitcnt lgkmcnt(6)
    v_mfma_f32_32x32x16_bf16 v[184:199], v[252:255], v[164:167], v[184:199]
    ds_read_b64_tr_b16 v[244:245], v7 offset:23360
    ds_read_b64_tr_b16 v[246:247], v7 offset:23472
    global_load_dwordx4 v[164:167], v62, s[24:25] offset:-2048 sc1
    s_waitcnt vmcnt(6)
    v_bitop3_b32 v67, v144, v136, v120 bitop3:0x80
    v_bitop3_b32 v67, v67, v124, 1 bitop3:0x80
    v_cmp_eq_u32 vcc, 0, v67
    s_cbranch_vccnz .crt_312
.cok_314:
    s_waitcnt lgkmcnt(6)
    v_mfma_f32_32x32x16_bf16 v[168:183], v[232:235], v[144:147], v[168:183]
    ds_read_b64_tr_b16 v[248:249], v7 offset:25088
    ds_read_b64_tr_b16 v[250:251], v7 offset:25200
    s_waitcnt lgkmcnt(6)
    v_mfma_f32_32x32x16_bf16 v[184:199], v[236:239], v[144:147], v[184:199]
    ds_read_b64_tr_b16 v[252:253], v7 offset:25152
    ds_read_b64_tr_b16 v[254:255], v7 offset:25264
    s_add_u32 s44, s62, s60
    s_add_u32 s44, s44, 135168
    v_add_u32 v62, s44, v2
    global_load_dwordx4 v[144:147], v62, s[24:25] offset:-2048 sc1
    s_waitcnt lgkmcnt(6)
    v_mfma_f32_32x32x16_bf16 v[168:183], v[240:243], v[136:139], v[168:183]
    ds_read_b64_tr_b16 v[232:233], v7 offset:26880
    ds_read_b64_tr_b16 v[234:235], v7 offset:26992
    s_waitcnt lgkmcnt(6)
    v_mfma_f32_32x32x16_bf16 v[184:199], v[244:247], v[136:139], v[184:199]
    ds_read_b64_tr_b16 v[236:237], v7 offset:26944
    ds_read_b64_tr_b16 v[238:239], v7 offset:27056
    global_load_dwordx4 v[136:139], v62, s[24:25] offset:-1024 sc1
    s_waitcnt lgkmcnt(6)
    v_mfma_f32_32x32x16_bf16 v[168:183], v[248:251], v[120:123], v[168:183]
    ds_read_b64_tr_b16 v[240:241], v7 offset:28672
    ds_read_b64_tr_b16 v[242:243], v7 offset:28784
    s_waitcnt lgkmcnt(6)
    v_mfma_f32_32x32x16_bf16 v[184:199], v[252:255], v[120:123], v[184:199]
    ds_read_b64_tr_b16 v[244:245], v7 offset:28736
    ds_read_b64_tr_b16 v[246:247], v7 offset:28848
    s_lshl2_add_u32 s44, s28, s98
    s_lshl_b32 s44, s44, 11
    s_add_u32 s44, s44, s32
    s_add_u32 s44, s44, 265216
    v_add_u32 v62, s44, v2
    global_load_dwordx4 v[120:123], v62, s[24:25] offset:-3072 sc1
    s_waitcnt lgkmcnt(6)
    v_mfma_f32_32x32x16_bf16 v[168:183], v[232:235], v[124:127], v[168:183]
    ds_read_b64_tr_b16 v[248:249], v7 offset:30464
    ds_read_b64_tr_b16 v[250:251], v7 offset:30576
    s_waitcnt vmcnt(3)
    v_bitop3_b32 v67, v152, v156, v160 bitop3:0xfe
    v_bitop3_b32 v67, v67, v164, 1 bitop3:0xa8
    v_cmp_ne_u32 vcc, 0, v67
    s_cbranch_vccnz .crt_315
.cok_317:
    v_mfma_f32_32x32x16_bf16 v[200:215], a[224:227], v[152:155], 0
    v_mfma_f32_32x32x16_bf16 v[216:231], a[228:231], v[152:155], 0
    global_load_dwordx4 v[152:155], v62, s[24:25] offset:-2048 sc1
    v_bitop3_b32 v67, v128, v129, v130 bitop3:0x80
    v_bitop3_b32 v67, v67, v131, v148 bitop3:0x80
    v_bitop3_b32 v67, v67, v149, v150 bitop3:0x80
    v_bitop3_b32 v67, v67, v151, 1 bitop3:0x80
    v_cmp_eq_u32 vcc, 0, v67
    s_cbranch_vccnz .crt_318
.cok_320:
    v_add_f32 v128, v128, v130
    v_add_f32 v129, v129, v131
    v_add_f32 v148, v148, v150
    v_add_f32 v149, v149, v151
    v_add_f32 v70, v128, v148
    v_add_f32 v71, v129, v149
    s_nop 1
    v_permlane32_swap_b32 v70, v71
    s_waitcnt lgkmcnt(6)
    v_mfma_f32_32x32x16_bf16 v[184:199], v[236:239], v[124:127], v[184:199]
    ds_read_b64_tr_b16 v[252:253], v7 offset:30528
    ds_read_b64_tr_b16 v[254:255], v7 offset:30640
    s_lshl2_add_u32 s44, s28, s99
    s_lshl_b32 s44, s44, 11
    s_add_u32 s44, s44, s32
    s_add_u32 s44, s44, 265216
    v_add_u32 v62, s44, v2
    global_load_dwordx4 v[128:131], v62, s[24:25] offset:-3072 sc1
    v_mfma_f32_32x32x16_bf16 v[200:215], a[232:235], v[156:159], v[200:215]
    global_load_dwordx4 v[148:151], v62, s[24:25] offset:-2048 sc1
    v_mfma_f32_32x32x16_bf16 v[216:231], a[236:239], v[156:159], v[216:231]
    s_add_u32 s44, s62, s60
    s_add_u32 s44, s44, 135168
    v_add_u32 v62, s44, v2
    global_load_dwordx4 v[124:127], v62, s[24:25] offset:0 sc1
    v_add_f32 v70, v70, v71
    v_mov_b32 v71, v70
    s_waitcnt vmcnt(5)
    v_bitop3_b32 v67, v132, v140, v144 bitop3:0x80
    v_bitop3_b32 v67, v67, v136, 1 bitop3:0x80
    v_cmp_eq_u32 vcc, 0, v67
    s_cbranch_vccnz .crt_321
.cok_323:
    s_waitcnt lgkmcnt(6)
    v_mfma_f32_32x32x16_bf16 v[168:183], v[240:243], v[132:135], v[168:183]
    ds_read_b64_tr_b16 v[232:233], v7 offset:32256
    ds_read_b64_tr_b16 v[234:235], v7 offset:32368
    global_load_dwordx4 v[156:159], v62, s[24:25] offset:1024 sc1
    v_mfma_f32_32x32x16_bf16 v[200:215], a[240:243], v[160:163], v[200:215]
    v_mfma_f32_32x32x16_bf16 v[216:231], a[244:247], v[160:163], v[216:231]
    global_load_dwordx4 v[160:163], v62, s[24:25] offset:2048 sc1
    v_permlane32_swap_b32 v70, v71
    v_mul_f32 v70, 0xbb000000, v70
    s_waitcnt lgkmcnt(6)
    v_mfma_f32_32x32x16_bf16 v[184:199], v[244:247], v[132:135], v[184:199]
    ds_read_b64_tr_b16 v[236:237], v7 offset:32320
    ds_read_b64_tr_b16 v[238:239], v7 offset:32432
    global_load_dwordx4 v[132:135], v62, s[24:25] offset:3072 sc1
    v_mfma_f32_32x32x16_bf16 v[200:215], a[248:251], v[164:167], v[200:215]
    v_mfma_f32_32x32x16_bf16 v[216:231], a[252:255], v[164:167], v[216:231]
    s_add_u32 s44, s62, s61
    s_add_u32 s44, s44, 135168
    v_add_u32 v62, s44, v2
    global_load_dwordx4 v[164:167], v62, s[24:25] offset:-4096 sc1
    v_mul_f32 v72, v70, v70
    v_mul_f32 v71, 0x3b000000, v71
    s_waitcnt lgkmcnt(6)
    v_mfma_f32_32x32x16_bf16 v[168:183], v[248:251], v[140:143], v[168:183]
    ds_read_b64_tr_b16 v[240:241], v7 offset:34048
    ds_read_b64_tr_b16 v[242:243], v7 offset:34160
    s_waitcnt vmcnt(5)
    v_bitop3_b32 v67, v120, v152, v128 bitop3:0xfe
    v_bitop3_b32 v67, v67, v148, 1 bitop3:0xa8
    v_cmp_ne_u32 vcc, 0, v67
    s_cbranch_vccnz .crt_324
.cok_326:
    v_mfma_f32_32x32x16_bf16 v[200:215], v[88:91], v[120:123], v[200:215]
    v_mfma_f32_32x32x16_bf16 v[200:215], v[96:99], v[152:155], v[200:215]
    v_sub_f32 v71, v71, v72
    v_max_f32 v71, 0, v71
    s_waitcnt lgkmcnt(6)
    v_mfma_f32_32x32x16_bf16 v[184:199], v[252:255], v[140:143], v[184:199]
    ds_read_b64_tr_b16 v[244:245], v7 offset:34112
    ds_read_b64_tr_b16 v[246:247], v7 offset:34224
    global_load_dwordx4 v[140:143], v62, s[24:25] offset:-3072 sc1
    v_mfma_f32_32x32x16_bf16 v[200:215], v[104:107], v[128:131], v[200:215]
    v_mfma_f32_32x32x16_bf16 v[200:215], v[112:115], v[148:151], v[200:215]
    v_add_f32 v72, 0x3727c5ac, v71
    v_rsq_f32 v22, v72
    s_waitcnt lgkmcnt(6)
    v_mfma_f32_32x32x16_bf16 v[168:183], v[232:235], v[144:147], v[168:183]
    ds_read_b64_tr_b16 v[248:249], v7 offset:35840
    ds_read_b64_tr_b16 v[250:251], v7 offset:35952
    v_mfma_f32_32x32x16_bf16 v[216:231], v[92:95], v[120:123], v[216:231]
    global_load_dwordx4 v[120:123], v62, s[24:25] offset:-2048 sc1
    s_nop 3
    ds_write_b128 v11, v[200:203] offset:0
    v_mfma_f32_32x32x16_bf16 v[216:231], v[100:103], v[152:155], v[216:231]
    global_load_dwordx4 v[152:155], v62, s[24:25] offset:-1024 sc1
    ds_write_b128 v12, v[204:207] offset:1024
    v_cvt_pk_bf16_f32 v73, v70, v70
    v_lshlrev_b32 v73, 16, v73
    s_waitcnt lgkmcnt(8)
    v_mfma_f32_32x32x16_bf16 v[184:199], v[236:239], v[144:147], v[184:199]
    ds_read_b64_tr_b16 v[252:253], v7 offset:35904
    ds_read_b64_tr_b16 v[254:255], v7 offset:36016
    global_load_dwordx4 v[144:147], v62, s[24:25] offset:0 sc1
    v_mfma_f32_32x32x16_bf16 v[216:231], v[108:111], v[128:131], v[216:231]
    global_load_dwordx4 v[128:131], v62, s[24:25] offset:1024 sc1
    ds_write_b128 v11, v[208:211] offset:2048
    v_mfma_f32_32x32x16_bf16 v[216:231], v[116:119], v[148:151], v[216:231]
    global_load_dwordx4 v[148:151], v62, s[24:25] offset:2048 sc1
    ds_write_b128 v12, v[212:215] offset:3072
    v_sub_f32 v73, v70, v73
    v_mul_f32 v73, v73, v8
    s_waitcnt lgkmcnt(10)
    v_mfma_f32_32x32x16_bf16 v[168:183], v[240:243], v[136:139], v[168:183]
    ds_read_b64_tr_b16 v[232:233], v7 offset:37632
    ds_read_b64_tr_b16 v[234:235], v7 offset:37744
    v_cvt_pk_bf16_f32 v18, v70, v73
    v_mul_f32 v74, v22, v22
    s_waitcnt lgkmcnt(10)
    v_mfma_f32_32x32x16_bf16 v[184:199], v[244:247], v[136:139], v[184:199]
    ds_read_b64_tr_b16 v[236:237], v7 offset:37696
    ds_read_b64_tr_b16 v[238:239], v7 offset:37808
    global_load_dwordx4 v[136:139], v62, s[24:25] offset:3072 sc1
    ds_write_b128 v11, v[216:219] offset:4096
    v_mul_f32 v23, v72, v22
    v_mov_b32 v75, 0x3727c5ac
    s_waitcnt vmcnt(8)
    v_bitop3_b32 v67, v124, v156, v160 bitop3:0x80
    v_bitop3_b32 v67, v67, v132, 1 bitop3:0x80
    v_cmp_eq_u32 vcc, 0, v67
    s_cbranch_vccnz .crt_327
.cok_329:
    s_waitcnt lgkmcnt(11)
    v_mfma_f32_32x32x16_bf16 v[168:183], v[248:251], v[124:127], v[168:183]
    ds_read_b64_tr_b16 v[240:241], v7 offset:39424
    ds_read_b64_tr_b16 v[242:243], v7 offset:39536
    ds_write_b128 v12, v[220:223] offset:5120
    v_fma_f32 v74, v71, v74, v75
    v_rsq_f32 v75, v74
    s_waitcnt lgkmcnt(10)
    v_mfma_f32_32x32x16_bf16 v[184:199], v[252:255], v[124:127], v[184:199]
    ds_read_b64_tr_b16 v[244:245], v7 offset:39488
    ds_read_b64_tr_b16 v[246:247], v7 offset:39600
    ds_write_b128 v11, v[224:227] offset:6144
    v_mul_f32 v23, v23, v74
    v_mul_f32 v22, v22, v75
    s_waitcnt lgkmcnt(9)
    v_mfma_f32_32x32x16_bf16 v[168:183], v[232:235], v[156:159], v[168:183]
    ds_read_b64_tr_b16 v[248:249], v7 offset:41216
    ds_read_b64_tr_b16 v[250:251], v7 offset:41328
    ds_write_b128 v12, v[228:231] offset:7168
    v_mul_f32 v23, v23, v75
    v_cvt_pk_bf16_f32 v73, v23, v23
    s_waitcnt lgkmcnt(10)
    v_mfma_f32_32x32x16_bf16 v[184:199], v[236:239], v[156:159], v[184:199]
    ds_read_b64_tr_b16 v[252:253], v7 offset:41280
    ds_read_b64_tr_b16 v[254:255], v7 offset:41392
    v_add_u32 v63, 0, v14
    v_add_u32 v64, 0, v15
    v_lshlrev_b32 v73, 16, v73
    v_sub_f32 v73, v23, v73
    s_waitcnt lgkmcnt(9)
    v_mfma_f32_32x32x16_bf16 v[168:183], v[240:243], v[160:163], v[168:183]
    ds_read_b64_tr_b16 v[232:233], v7 offset:43008
    ds_read_b64_tr_b16 v[234:235], v7 offset:43120
    v_mul_f32 v73, v73, v8
    v_mul_f32 v74, v23, v8
    s_waitcnt lgkmcnt(8)
    v_mfma_f32_32x32x16_bf16 v[184:199], v[244:247], v[160:163], v[184:199]
    ds_read_b64_tr_b16 v[236:237], v7 offset:43072
    ds_read_b64_tr_b16 v[238:239], v7 offset:43184
    s_waitcnt lgkmcnt(6)
    s_barrier
    ds_read_b128 v[200:203], v13 offset:0
    ds_read_b128 v[204:207], v13 offset:8192
    ds_read_b128 v[208:211], v13 offset:16384
    v_cvt_pk_bf16_f32 v19, v74, v73
    v_mul_f32 v72, v22, v22
    v_mfma_f32_32x32x16_bf16 v[168:183], v[248:251], v[132:135], v[168:183]
    ds_read_b64_tr_b16 v[240:241], v7 offset:44800
    ds_read_b64_tr_b16 v[242:243], v7 offset:44912
    ds_read_b128 v[212:215], v13 offset:24576
    ds_read_b128 v[216:219], v13 offset:512
    ds_read_b128 v[220:223], v13 offset:8704
    ds_read_b128 v[224:227], v13 offset:16896
    ds_read_b128 v[228:231], v13 offset:25088
    v_mul_f32 v24, 0xc0135761, v22
    v_mul_f32 v72, v72, v22
    s_waitcnt lgkmcnt(14)
    v_mfma_f32_32x32x16_bf16 v[184:199], v[252:255], v[132:135], v[184:199]
    ds_read_b64_tr_b16 v[244:245], v7 offset:44864
    ds_read_b64_tr_b16 v[246:247], v7 offset:44976
    v_mul_f32 v25, 0xbdd2d3e8, v72
    s_waitcnt vmcnt(4)
    v_bitop3_b32 v67, v164, v140, v120 bitop3:0x80
    v_bitop3_b32 v67, v67, v152, 1 bitop3:0x80
    v_cmp_eq_u32 vcc, 0, v67
    s_cbranch_vccnz .crt_330
.cok_332:
    s_waitcnt lgkmcnt(14)
    v_mfma_f32_32x32x16_bf16 v[168:183], v[232:235], v[164:167], v[168:183]
    ds_read_b64_tr_b16 v[248:249], v7 offset:46592
    ds_read_b64_tr_b16 v[250:251], v7 offset:46704
    s_waitcnt lgkmcnt(14)
    v_mfma_f32_32x32x16_bf16 v[184:199], v[236:239], v[164:167], v[184:199]
    ds_read_b64_tr_b16 v[252:253], v7 offset:46656
    ds_read_b64_tr_b16 v[254:255], v7 offset:46768
    s_waitcnt lgkmcnt(14)
    v_add_f32 v200, v200, v204
    v_add_f32 v201, v201, v205
    v_add_f32 v202, v202, v206
    v_add_f32 v203, v203, v207
    v_add_f32 v200, v200, v78
    v_add_f32 v201, v201, v79
    s_waitcnt lgkmcnt(11)
    v_mfma_f32_32x32x16_bf16 v[168:183], v[240:243], v[140:143], v[168:183]
    ds_read_b64_tr_b16 v[232:233], v7 offset:48384
    ds_read_b64_tr_b16 v[234:235], v7 offset:48496
    v_add_f32 v202, v202, v80
    v_add_f32 v203, v203, v81
    s_waitcnt lgkmcnt(12)
    v_add_f32 v208, v208, v212
    v_add_f32 v209, v209, v213
    v_add_f32 v210, v210, v214
    v_add_f32 v211, v211, v215
    s_waitcnt lgkmcnt(6)
    v_mfma_f32_32x32x16_bf16 v[184:199], v[244:247], v[140:143], v[184:199]
    ds_read_b64_tr_b16 v[236:237], v7 offset:48448
    ds_read_b64_tr_b16 v[238:239], v7 offset:48560
    v_add_f32 v200, v200, v208
    v_add_f32 v201, v201, v209
    v_add_f32 v202, v202, v210
    v_add_f32 v203, v203, v211
    v_cvt_pk_bf16_f32 v34, v200, v201
    v_cvt_pk_bf16_f32 v35, v202, v203
    v_or_b32 v34, 1, v34
    s_waitcnt lgkmcnt(6)
    v_mfma_f32_32x32x16_bf16 v[168:183], v[248:251], v[120:123], v[168:183]
    ds_read_b64_tr_b16 v[240:241], v7 offset:50176
    ds_read_b64_tr_b16 v[242:243], v7 offset:50288
    v_add_f32 v216, v216, v220
    v_add_f32 v217, v217, v221
    v_add_f32 v218, v218, v222
    v_add_f32 v219, v219, v223
    v_add_f32 v216, v216, v82
    v_add_f32 v217, v217, v83
    s_waitcnt lgkmcnt(6)
    v_mfma_f32_32x32x16_bf16 v[184:199], v[252:255], v[120:123], v[184:199]
    ds_read_b64_tr_b16 v[244:245], v7 offset:50240
    ds_read_b64_tr_b16 v[246:247], v7 offset:50352
    v_add_f32 v218, v218, v84
    v_add_f32 v219, v219, v85
    v_add_f32 v224, v224, v228
    v_add_f32 v225, v225, v229
    v_add_f32 v226, v226, v230
    v_add_f32 v227, v227, v231
    s_waitcnt lgkmcnt(6)
    v_mfma_f32_32x32x16_bf16 v[168:183], v[232:235], v[152:155], v[168:183]
    ds_read_b64_tr_b16 v[248:249], v7 offset:51968
    ds_read_b64_tr_b16 v[250:251], v7 offset:52080
    v_add_f32 v216, v216, v224
    v_add_f32 v217, v217, v225
    v_add_f32 v218, v218, v226
    v_add_f32 v219, v219, v227
    v_cvt_pk_bf16_f32 v36, v216, v217
    v_cvt_pk_bf16_f32 v37, v218, v219
    s_cmp_eq_u32 s33, 1
    s_cbranch_scc0 .slow_333
    global_store_dwordx4 v63, v[34:37], s[24:25]
.sten_334:
    s_waitcnt lgkmcnt(6)
    v_mfma_f32_32x32x16_bf16 v[184:199], v[236:239], v[152:155], v[184:199]
    ds_read_b64_tr_b16 v[252:253], v7 offset:52032
    ds_read_b64_tr_b16 v[254:255], v7 offset:52144
    v_add_f32 v204, v200, v201
    v_mul_f32 v205, v200, v200
    v_fmac_f32 v205, v201, v201
    v_add_f32 v204, v204, v202
    v_fmac_f32 v205, v202, v202
    v_add_f32 v204, v204, v203
    v_fmac_f32 v205, v203, v203
    s_waitcnt vmcnt(1)
    v_bitop3_b32 v67, v144, v128, v148 bitop3:0x80
    v_bitop3_b32 v67, v67, v136, 1 bitop3:0x80
    v_cmp_eq_u32 vcc, 0, v67
    s_cbranch_vccnz .crt_335
.cok_337:
    s_waitcnt lgkmcnt(6)
    v_mfma_f32_32x32x16_bf16 v[168:183], v[240:243], v[144:147], v[168:183]
    ds_read_b64_tr_b16 v[232:233], v7 offset:53760
    ds_read_b64_tr_b16 v[234:235], v7 offset:53872
    v_add_f32 v204, v204, v216
    v_fmac_f32 v205, v216, v216
    v_add_f32 v204, v204, v217
    v_fmac_f32 v205, v217, v217
    v_add_f32 v204, v204, v218
    v_fmac_f32 v205, v218, v218
    v_add_f32 v204, v204, v219
    s_waitcnt lgkmcnt(6)
    v_mfma_f32_32x32x16_bf16 v[184:199], v[244:247], v[144:147], v[184:199]
    ds_read_b64_tr_b16 v[236:237], v7 offset:53824
    ds_read_b64_tr_b16 v[238:239], v7 offset:53936
    v_fmac_f32 v205, v219, v219
    s_nop 1
    v_permlane32_swap_b32 v204, v205
    v_add_f32 v204, v204, v205
    v_cvt_pk_bf16_f32 v34, v200, v201
    v_mov_b32 v205, v204
    s_nop 1
    v_permlane16_swap_b32 v204, v205
    v_add_f32 v204, v204, v205
    s_waitcnt lgkmcnt(6)
    v_mfma_f32_32x32x16_bf16 v[168:183], v[248:251], v[128:131], v[168:183]
    ds_read_b64_tr_b16 v[240:241], v7 offset:55552
    ds_read_b64_tr_b16 v[242:243], v7 offset:55664
    v_add_f32_dpp v204, v204, v204 row_ror:8 row_mask:0xf bank_mask:0xf
    v_or_b32 v204, 1, v204
    s_cmp_eq_u32 s33, 1
    s_cbranch_scc0 .slow_338
    global_store_dword v64, v204, s[24:25]
.sten_339:
    s_waitcnt lgkmcnt(6)
    v_mfma_f32_32x32x16_bf16 v[184:199], v[252:255], v[128:131], v[184:199]
    ds_read_b64_tr_b16 v[244:245], v7 offset:55616
    ds_read_b64_tr_b16 v[246:247], v7 offset:55728
    s_waitcnt lgkmcnt(6)
    v_mfma_f32_32x32x16_bf16 v[168:183], v[232:235], v[148:151], v[168:183]
    ds_read_b64_tr_b16 v[248:249], v7 offset:0
    ds_read_b64_tr_b16 v[250:251], v7 offset:112
    s_waitcnt lgkmcnt(6)
    v_mfma_f32_32x32x16_bf16 v[184:199], v[236:239], v[148:151], v[184:199]
    ds_read_b64_tr_b16 v[252:253], v7 offset:64
    ds_read_b64_tr_b16 v[254:255], v7 offset:176
    s_waitcnt lgkmcnt(6)
    v_mfma_f32_32x32x16_bf16 v[168:183], v[240:243], v[136:139], v[168:183]
    ds_read_b64_tr_b16 v[232:233], v7 offset:1792
    ds_read_b64_tr_b16 v[234:235], v7 offset:1904
    s_waitcnt lgkmcnt(6)
    v_mfma_f32_32x32x16_bf16 v[184:199], v[244:247], v[136:139], v[184:199]
    ds_read_b64_tr_b16 v[236:237], v7 offset:1856
    ds_read_b64_tr_b16 v[238:239], v7 offset:1968
    v_mfma_f32_32x32x16_bf16 v[168:183], v[42:45], v[18:21], v[168:183]
    s_and_b32 s44, s27, 1
    s_lshl_b32 s45, s44, 12
    s_add_u32 s45, s45, s63
    s_add_u32 s45, s45, 983040
    v_add_u32 v63, s45, v2
    v_mfma_f32_32x32x16_bf16 v[184:199], v[42:45], v[16:19], v[184:199]
    s_and_b32 s44, s27, 1
    s_lshl_b32 s45, s44, 9
    s_add_u32 s45, s45, s63
    s_add_u32 s45, s45, 986112
    v_lshl_add_u32 v64, v3, 4, s45
    s_nop 0
    v_mul_f32 v78, v168, v168
    v_mul_f32 v79, v169, v169
    v_mul_f32 v80, v170, v170
    v_mul_f32 v81, v171, v171
    v_mul_f32 v82, v172, v172
    v_mul_f32 v83, v173, v173
    s_add_u32 s44, s62, s58
    s_add_u32 s44, s44, 4096
    v_add_u32 v62, s44, v2
    global_load_dwordx4 v[124:127], v62, s[24:25] offset:-4096 sc1
    v_mul_f32 v84, v174, v174
    v_mul_f32 v85, v175, v175
    v_fma_f32 v78, v78, v25, v24
    global_load_dwordx4 v[156:159], v62, s[24:25] offset:-3072 sc1
    v_fma_f32 v79, v79, v25, v24
    v_fma_f32 v80, v80, v25, v24
    v_fma_f32 v81, v81, v25, v24
    global_load_dwordx4 v[160:163], v62, s[24:25] offset:-2048 sc1
    v_fma_f32 v82, v82, v25, v24
    v_fma_f32 v83, v83, v25, v24
    v_fma_f32 v84, v84, v25, v24
    global_load_dwordx4 v[132:135], v62, s[24:25] offset:-1024 sc1
    v_fma_f32 v85, v85, v25, v24
    v_mul_f32 v78, v78, v168
    v_mul_f32 v79, v79, v169
    global_load_dwordx4 v[164:167], v62, s[24:25] offset:0 sc1
    v_mul_f32 v80, v80, v170
    v_mul_f32 v81, v81, v171
    v_mul_f32 v82, v82, v172
    global_load_dwordx4 v[140:143], v62, s[24:25] offset:1024 sc1
    v_mul_f32 v83, v83, v173
    v_mul_f32 v84, v84, v174
    v_mul_f32 v85, v85, v175
    global_load_dwordx4 v[120:123], v62, s[24:25] offset:2048 sc1
    v_exp_f32 v78, v78
    v_exp_f32 v79, v79
    v_exp_f32 v80, v80
    global_load_dwordx4 v[152:155], v62, s[24:25] offset:3072 sc1
    v_exp_f32 v81, v81
    v_exp_f32 v82, v82
    v_exp_f32 v83, v83
    s_add_u32 s44, s62, s59
    s_add_u32 s44, s44, 4096
    v_add_u32 v62, s44, v2
    global_load_dwordx4 v[144:147], v62, s[24:25] offset:-4096 sc1
    v_exp_f32 v84, v84
    v_exp_f32 v85, v85
    v_fma_f32 v78, v78, v23, v23
    global_load_dwordx4 v[128:131], v62, s[24:25] offset:-3072 sc1
    v_fma_f32 v79, v79, v23, v23
    v_fma_f32 v80, v80, v23, v23
    v_fma_f32 v81, v81, v23, v23
    global_load_dwordx4 v[148:151], v62, s[24:25] offset:-2048 sc1
    v_fma_f32 v82, v82, v23, v23
    v_fma_f32 v83, v83, v23, v23
    v_fma_f32 v84, v84, v23, v23
    global_load_dwordx4 v[136:139], v62, s[24:25] offset:-1024 sc1
    v_fma_f32 v85, v85, v23, v23
    v_rcp_f32 v78, v78
    v_rcp_f32 v79, v79
    v_rcp_f32 v80, v80
    v_rcp_f32 v81, v81
    v_rcp_f32 v82, v82
    v_rcp_f32 v83, v83
    v_rcp_f32 v84, v84
    v_rcp_f32 v85, v85
    v_mul_f32 v78, v78, v168
    v_mul_f32 v79, v79, v169
    v_mul_f32 v80, v80, v170
    v_mul_f32 v81, v81, v171
    v_mul_f32 v82, v82, v172
    v_mul_f32 v83, v83, v173
    v_mul_f32 v84, v84, v174
    v_mul_f32 v85, v85, v175
    v_cvt_pk_bf16_f32 v168, v78, v79
    v_cvt_pk_bf16_f32 v169, v80, v81
    v_cvt_pk_bf16_f32 v170, v82, v83
    v_or_b32 v168, 1, v168
    v_cvt_pk_bf16_f32 v171, v84, v85
    global_store_dwordx4 v63, v[168:171], s[24:25] offset:0 sc1
    v_mul_f32 v78, v176, v176
    v_mul_f32 v79, v177, v177
    v_mul_f32 v80, v178, v178
    v_mul_f32 v81, v179, v179
    v_mul_f32 v82, v180, v180
    v_mul_f32 v83, v181, v181
    v_mul_f32 v84, v182, v182
    v_mul_f32 v85, v183, v183
    v_fma_f32 v78, v78, v25, v24
    v_fma_f32 v79, v79, v25, v24
    v_fma_f32 v80, v80, v25, v24
    v_fma_f32 v81, v81, v25, v24
    v_fma_f32 v82, v82, v25, v24
    v_fma_f32 v83, v83, v25, v24
    v_fma_f32 v84, v84, v25, v24
    v_fma_f32 v85, v85, v25, v24
    v_mul_f32 v78, v78, v176
    v_mul_f32 v79, v79, v177
    v_mul_f32 v80, v80, v178
    v_mul_f32 v81, v81, v179
    v_mul_f32 v82, v82, v180
    v_mul_f32 v83, v83, v181
    v_mul_f32 v84, v84, v182
    v_mul_f32 v85, v85, v183
    v_exp_f32 v78, v78
    v_exp_f32 v79, v79
    v_exp_f32 v80, v80
    v_exp_f32 v81, v81
    v_exp_f32 v82, v82
    v_exp_f32 v83, v83
    v_exp_f32 v84, v84
    v_exp_f32 v85, v85
    v_fma_f32 v78, v78, v23, v23
    v_fma_f32 v79, v79, v23, v23
    v_fma_f32 v80, v80, v23, v23
    v_fma_f32 v81, v81, v23, v23
    v_fma_f32 v82, v82, v23, v23
    v_fma_f32 v83, v83, v23, v23
    v_fma_f32 v84, v84, v23, v23
    v_fma_f32 v85, v85, v23, v23
    v_rcp_f32 v78, v78
    v_rcp_f32 v79, v79
    v_rcp_f32 v80, v80
    v_rcp_f32 v81, v81
    v_rcp_f32 v82, v82
    v_rcp_f32 v83, v83
    v_rcp_f32 v84, v84
    v_rcp_f32 v85, v85
    s_waitcnt vmcnt(9)
    v_bitop3_b32 v67, v124, v156, v160 bitop3:0x80
    v_bitop3_b32 v67, v67, v132, 1 bitop3:0x80
    v_cmp_eq_u32 vcc, 0, v67
    s_cbranch_vccnz .crt_340
.cok_342:
    s_waitcnt lgkmcnt(6)
    v_mfma_f32_32x32x16_bf16 v[200:215], v[248:251], v[124:127], 0
    ds_read_b64_tr_b16 v[240:241], v7 offset:3584
    ds_read_b64_tr_b16 v[242:243], v7 offset:3696
    v_mul_f32 v78, v78, v176
    v_mul_f32 v79, v79, v177
    v_mul_f32 v80, v80, v178
    v_mul_f32 v81, v81, v179
    v_mul_f32 v82, v82, v180
    v_mul_f32 v83, v83, v181
    s_waitcnt lgkmcnt(6)
    v_mfma_f32_32x32x16_bf16 v[216:231], v[252:255], v[124:127], 0
    ds_read_b64_tr_b16 v[244:245], v7 offset:3648
    ds_read_b64_tr_b16 v[246:247], v7 offset:3760
    global_load_dwordx4 v[124:127], v62, s[24:25] offset:0 sc1
    v_mul_f32 v84, v84, v182
    v_mul_f32 v85, v85, v183
    v_cvt_pk_bf16_f32 v176, v78, v79
    v_cvt_pk_bf16_f32 v177, v80, v81
    v_cvt_pk_bf16_f32 v178, v82, v83
    v_or_b32 v176, 1, v176
    s_waitcnt lgkmcnt(6)
    v_mfma_f32_32x32x16_bf16 v[200:215], v[232:235], v[156:159], v[200:215]
    ds_read_b64_tr_b16 v[248:249], v7 offset:5376
    ds_read_b64_tr_b16 v[250:251], v7 offset:5488
    v_cvt_pk_bf16_f32 v179, v84, v85
    global_store_dwordx4 v63, v[176:179], s[24:25] offset:1024 sc1
    v_mul_f32 v78, v184, v184
    v_mul_f32 v79, v185, v185
    v_mul_f32 v80, v186, v186
    s_waitcnt lgkmcnt(6)
    v_mfma_f32_32x32x16_bf16 v[216:231], v[236:239], v[156:159], v[216:231]
    ds_read_b64_tr_b16 v[252:253], v7 offset:5440
    ds_read_b64_tr_b16 v[254:255], v7 offset:5552
    global_load_dwordx4 v[156:159], v62, s[24:25] offset:1024 sc1
    v_mul_f32 v81, v187, v187
    v_mul_f32 v82, v188, v188
    v_mul_f32 v83, v189, v189
    v_mul_f32 v84, v190, v190
    v_mul_f32 v85, v191, v191
    v_fma_f32 v78, v78, v25, v24
    s_waitcnt lgkmcnt(6)
    v_mfma_f32_32x32x16_bf16 v[200:215], v[240:243], v[160:163], v[200:215]
    ds_read_b64_tr_b16 v[232:233], v7 offset:7168
    ds_read_b64_tr_b16 v[234:235], v7 offset:7280
    v_fma_f32 v79, v79, v25, v24
    v_fma_f32 v80, v80, v25, v24
    v_fma_f32 v81, v81, v25, v24
    v_fma_f32 v82, v82, v25, v24
    v_fma_f32 v83, v83, v25, v24
    v_fma_f32 v84, v84, v25, v24
    s_waitcnt lgkmcnt(6)
    v_mfma_f32_32x32x16_bf16 v[216:231], v[244:247], v[160:163], v[216:231]
    ds_read_b64_tr_b16 v[236:237], v7 offset:7232
    ds_read_b64_tr_b16 v[238:239], v7 offset:7344
    s_add_u32 s44, s36, s34
    s_add_u32 s44, s44, 0x146000
    v_add_u32 v67, s44, v2
    global_load_dwordx4 v[160:163], v67, s[24:25] offset:0 sc1
    v_fma_f32 v85, v85, v25, v24
    v_mul_f32 v78, v78, v184
    v_mul_f32 v79, v79, v185
    v_mul_f32 v80, v80, v186
    v_mul_f32 v81, v81, v187
    v_mul_f32 v82, v82, v188
    s_waitcnt lgkmcnt(6)
    v_mfma_f32_32x32x16_bf16 v[200:215], v[248:251], v[132:135], v[200:215]
    ds_read_b64_tr_b16 v[240:241], v7 offset:8960
    ds_read_b64_tr_b16 v[242:243], v7 offset:9072
    v_mul_f32 v83, v83, v189
    v_mul_f32 v84, v84, v190
    v_mul_f32 v85, v85, v191
    v_exp_f32 v78, v78
    v_exp_f32 v79, v79
    s_waitcnt lgkmcnt(6)
    v_mfma_f32_32x32x16_bf16 v[216:231], v[252:255], v[132:135], v[216:231]
    ds_read_b64_tr_b16 v[244:245], v7 offset:9024
    ds_read_b64_tr_b16 v[246:247], v7 offset:9136
    s_add_u32 s44, s36, s34
    s_add_u32 s44, s44, 0x146000
    v_add_u32 v67, s44, v2
    global_load_dwordx4 v[132:135], v67, s[24:25] offset:1024 sc1
    v_exp_f32 v80, v80
    v_exp_f32 v81, v81
    v_exp_f32 v82, v82
    s_waitcnt vmcnt(10)
    v_bitop3_b32 v67, v164, v140, v120 bitop3:0x80
    v_bitop3_b32 v67, v67, v152, 1 bitop3:0x80
    v_cmp_eq_u32 vcc, 0, v67
    s_cbranch_vccnz .crt_343
.cok_345:
    s_waitcnt lgkmcnt(6)
    v_mfma_f32_32x32x16_bf16 v[200:215], v[232:235], v[164:167], v[200:215]
    ds_read_b64_tr_b16 v[248:249], v7 offset:10752
    ds_read_b64_tr_b16 v[250:251], v7 offset:10864
    v_exp_f32 v83, v83
    v_exp_f32 v84, v84
    v_exp_f32 v85, v85
    s_waitcnt lgkmcnt(6)
    v_mfma_f32_32x32x16_bf16 v[216:231], v[236:239], v[164:167], v[216:231]
    ds_read_b64_tr_b16 v[252:253], v7 offset:10816
    ds_read_b64_tr_b16 v[254:255], v7 offset:10928
    global_load_dwordx4 v[164:167], v62, s[24:25] offset:2048 sc1
    v_fma_f32 v78, v78, v23, v23
    v_fma_f32 v79, v79, v23, v23
    v_fma_f32 v80, v80, v23, v23
    v_fma_f32 v81, v81, v23, v23
    v_fma_f32 v82, v82, v23, v23
    s_waitcnt lgkmcnt(6)
    v_mfma_f32_32x32x16_bf16 v[200:215], v[240:243], v[140:143], v[200:215]
    ds_read_b64_tr_b16 v[232:233], v7 offset:12544
    ds_read_b64_tr_b16 v[234:235], v7 offset:12656
    v_fma_f32 v83, v83, v23, v23
    v_fma_f32 v84, v84, v23, v23
    v_fma_f32 v85, v85, v23, v23
    v_rcp_f32 v78, v78
    v_rcp_f32 v79, v79
    s_waitcnt lgkmcnt(6)
    v_mfma_f32_32x32x16_bf16 v[216:231], v[244:247], v[140:143], v[216:231]
    ds_read_b64_tr_b16 v[236:237], v7 offset:12608
    ds_read_b64_tr_b16 v[238:239], v7 offset:12720
    global_load_dwordx4 v[140:143], v62, s[24:25] offset:3072 sc1
    v_rcp_f32 v80, v80
    v_rcp_f32 v81, v81
    v_rcp_f32 v82, v82
    s_waitcnt lgkmcnt(6)
    v_mfma_f32_32x32x16_bf16 v[200:215], v[248:251], v[120:123], v[200:215]
    ds_read_b64_tr_b16 v[240:241], v7 offset:14336
    ds_read_b64_tr_b16 v[242:243], v7 offset:14448
    v_rcp_f32 v83, v83
    v_rcp_f32 v84, v84
    v_rcp_f32 v85, v85
    s_waitcnt lgkmcnt(6)
    v_mfma_f32_32x32x16_bf16 v[216:231], v[252:255], v[120:123], v[216:231]
    ds_read_b64_tr_b16 v[244:245], v7 offset:14400
    ds_read_b64_tr_b16 v[246:247], v7 offset:14512
    s_add_u32 s44, s62, s60
    s_add_u32 s44, s44, 4096
    v_add_u32 v62, s44, v2
    global_load_dwordx4 v[120:123], v62, s[24:25] offset:-4096 sc1
    v_mul_f32 v78, v78, v184
    v_mul_f32 v79, v79, v185
    v_mul_f32 v80, v80, v186
    v_mul_f32 v81, v81, v187
    v_mul_f32 v82, v82, v188
    s_waitcnt lgkmcnt(6)
    v_mfma_f32_32x32x16_bf16 v[200:215], v[232:235], v[152:155], v[200:215]
    ds_read_b64_tr_b16 v[248:249], v7 offset:16128
    ds_read_b64_tr_b16 v[250:251], v7 offset:16240
    v_mul_f32 v83, v83, v189
    v_mul_f32 v84, v84, v190
    v_mul_f32 v85, v85, v191
    v_cvt_pk_bf16_f32 v184, v78, v79
    v_cvt_pk_bf16_f32 v185, v80, v81
    v_cvt_pk_bf16_f32 v186, v82, v83
    s_waitcnt lgkmcnt(6)
    v_mfma_f32_32x32x16_bf16 v[216:231], v[236:239], v[152:155], v[216:231]
    ds_read_b64_tr_b16 v[252:253], v7 offset:16192
    ds_read_b64_tr_b16 v[254:255], v7 offset:16304
    global_load_dwordx4 v[152:155], v62, s[24:25] offset:-3072 sc1
    v_or_b32 v184, 1, v184
    v_cvt_pk_bf16_f32 v187, v84, v85
    global_store_dwordx4 v63, v[184:187], s[24:25] offset:2048 sc1
    v_mul_f32 v78, v192, v192
    v_mul_f32 v79, v193, v193
    s_waitcnt vmcnt(11)
    v_bitop3_b32 v67, v144, v128, v148 bitop3:0x80
    v_bitop3_b32 v67, v67, v136, 1 bitop3:0x80
    v_cmp_eq_u32 vcc, 0, v67
    s_cbranch_vccnz .crt_346
.cok_348:
    s_waitcnt lgkmcnt(6)
    v_mfma_f32_32x32x16_bf16 v[200:215], v[240:243], v[144:147], v[200:215]
    ds_read_b64_tr_b16 v[232:233], v7 offset:17920
    ds_read_b64_tr_b16 v[234:235], v7 offset:18032
    v_mul_f32 v80, v194, v194
    v_mul_f32 v81, v195, v195
    v_fma_f32 v78, v78, v25, v24
    v_fma_f32 v79, v79, v25, v24
    v_fma_f32 v80, v80, v25, v24
    v_fma_f32 v81, v81, v25, v24
    s_waitcnt lgkmcnt(6)
    v_mfma_f32_32x32x16_bf16 v[216:231], v[244:247], v[144:147], v[216:231]
    ds_read_b64_tr_b16 v[236:237], v7 offset:17984
    ds_read_b64_tr_b16 v[238:239], v7 offset:18096
    global_load_dwordx4 v[144:147], v62, s[24:25] offset:-2048 sc1
    v_mul_f32 v78, v78, v192
    v_mul_f32 v79, v79, v193
    v_mul_f32 v80, v80, v194
    v_mul_f32 v81, v81, v195
    v_exp_f32 v78, v78
    s_waitcnt lgkmcnt(6)
    v_mfma_f32_32x32x16_bf16 v[200:215], v[248:251], v[128:131], v[200:215]
    ds_read_b64_tr_b16 v[240:241], v7 offset:19712
    ds_read_b64_tr_b16 v[242:243], v7 offset:19824
    v_exp_f32 v79, v79
    v_exp_f32 v80, v80
    v_exp_f32 v81, v81
    s_waitcnt lgkmcnt(6)
    v_mfma_f32_32x32x16_bf16 v[216:231], v[252:255], v[128:131], v[216:231]
    ds_read_b64_tr_b16 v[244:245], v7 offset:19776
    ds_read_b64_tr_b16 v[246:247], v7 offset:19888
    global_load_dwordx4 v[128:131], v62, s[24:25] offset:-1024 sc1
    v_fma_f32 v78, v78, v23, v23
    v_fma_f32 v79, v79, v23, v23
    v_fma_f32 v80, v80, v23, v23
    v_fma_f32 v81, v81, v23, v23
    v_rcp_f32 v78, v78
    s_waitcnt lgkmcnt(6)
    v_mfma_f32_32x32x16_bf16 v[200:215], v[232:235], v[148:151], v[200:215]
    ds_read_b64_tr_b16 v[248:249], v7 offset:21504
    ds_read_b64_tr_b16 v[250:251], v7 offset:21616
    v_rcp_f32 v79, v79
    v_rcp_f32 v80, v80
    v_rcp_f32 v81, v81
    s_waitcnt lgkmcnt(6)
    v_mfma_f32_32x32x16_bf16 v[216:231], v[236:239], v[148:151], v[216:231]
    ds_read_b64_tr_b16 v[252:253], v7 offset:21568
    ds_read_b64_tr_b16 v[254:255], v7 offset:21680
    global_load_dwordx4 v[148:151], v62, s[24:25] offset:0 sc1
    v_mul_f32 v78, v78, v192
    v_mul_f32 v79, v79, v193
    v_mul_f32 v80, v80, v194
    v_mul_f32 v81, v81, v195
    v_cvt_pk_bf16_f32 v192, v78, v79
    v_cvt_pk_bf16_f32 v193, v80, v81
    s_waitcnt lgkmcnt(6)
    v_mfma_f32_32x32x16_bf16 v[200:215], v[240:243], v[136:139], v[200:215]
    ds_read_b64_tr_b16 v[232:233], v7 offset:23296
    ds_read_b64_tr_b16 v[234:235], v7 offset:23408
    v_mov_b32 v194, v192
    v_mov_b32 v195, v193
    s_nop 0
    v_permlane32_swap_b32 v192, v194
    v_permlane32_swap_b32 v193, v195
    v_or_b32 v192, 1, v192
    global_store_dwordx4 v64, v[192:195], s[24:25] sc1
    s_waitcnt lgkmcnt(6)
    v_mfma_f32_32x32x16_bf16 v[216:231], v[244:247], v[136:139], v[216:231]
    ds_read_b64_tr_b16 v[236:237], v7 offset:23360
    ds_read_b64_tr_b16 v[238:239], v7 offset:23472
    global_load_dwordx4 v[136:139], v62, s[24:25] offset:1024 sc1
    s_waitcnt vmcnt(8)
    v_bitop3_b32 v67, v124, v156, v164 bitop3:0x80
    v_bitop3_b32 v67, v67, v140, 1 bitop3:0x80
    v_cmp_eq_u32 vcc, 0, v67
    s_cbranch_vccnz .crt_349
.cok_351:
    s_waitcnt lgkmcnt(6)
    v_mfma_f32_32x32x16_bf16 v[200:215], v[248:251], v[124:127], v[200:215]
    ds_read_b64_tr_b16 v[240:241], v7 offset:25088
    ds_read_b64_tr_b16 v[242:243], v7 offset:25200
    s_waitcnt lgkmcnt(6)
    v_mfma_f32_32x32x16_bf16 v[216:231], v[252:255], v[124:127], v[216:231]
    ds_read_b64_tr_b16 v[244:245], v7 offset:25152
    ds_read_b64_tr_b16 v[246:247], v7 offset:25264
    global_load_dwordx4 v[124:127], v62, s[24:25] offset:2048 sc1
    s_waitcnt lgkmcnt(6)
    v_mfma_f32_32x32x16_bf16 v[200:215], v[232:235], v[156:159], v[200:215]
    ds_read_b64_tr_b16 v[248:249], v7 offset:26880
    ds_read_b64_tr_b16 v[250:251], v7 offset:26992
    s_waitcnt lgkmcnt(6)
    v_mfma_f32_32x32x16_bf16 v[216:231], v[236:239], v[156:159], v[216:231]
    ds_read_b64_tr_b16 v[252:253], v7 offset:26944
    ds_read_b64_tr_b16 v[254:255], v7 offset:27056
    global_load_dwordx4 v[156:159], v62, s[24:25] offset:3072 sc1
    s_waitcnt lgkmcnt(6)
    v_mfma_f32_32x32x16_bf16 v[200:215], v[240:243], v[164:167], v[200:215]
    ds_read_b64_tr_b16 v[232:233], v7 offset:28672
    ds_read_b64_tr_b16 v[234:235], v7 offset:28784
    s_waitcnt lgkmcnt(6)
    v_mfma_f32_32x32x16_bf16 v[216:231], v[244:247], v[164:167], v[216:231]
    ds_read_b64_tr_b16 v[236:237], v7 offset:28736
    ds_read_b64_tr_b16 v[238:239], v7 offset:28848
    s_add_u32 s44, s62, s61
    s_add_u32 s44, s44, 4096
    v_add_u32 v62, s44, v2
    global_load_dwordx4 v[164:167], v62, s[24:25] offset:-4096 sc1
    s_waitcnt lgkmcnt(6)
    v_mfma_f32_32x32x16_bf16 v[200:215], v[248:251], v[140:143], v[200:215]
    ds_read_b64_tr_b16 v[240:241], v7 offset:30464
    ds_read_b64_tr_b16 v[242:243], v7 offset:30576
    v_bitop3_b32 v67, v160, v161, v162 bitop3:0x80
    v_bitop3_b32 v67, v67, v163, v132 bitop3:0x80
    v_bitop3_b32 v67, v67, v133, v134 bitop3:0x80
    v_bitop3_b32 v67, v67, v135, 1 bitop3:0x80
    v_cmp_eq_u32 vcc, 0, v67
    s_cbranch_vccnz .crt_352
.cok_354:
    v_add_f32 v160, v160, v162
    v_add_f32 v161, v161, v163
    v_add_f32 v132, v132, v134
    v_add_f32 v133, v133, v135
    v_add_f32 v70, v160, v132
    v_add_f32 v71, v161, v133
    s_nop 1
    v_permlane32_swap_b32 v70, v71
    s_waitcnt lgkmcnt(6)
    v_mfma_f32_32x32x16_bf16 v[216:231], v[252:255], v[140:143], v[216:231]
    ds_read_b64_tr_b16 v[244:245], v7 offset:30528
    ds_read_b64_tr_b16 v[246:247], v7 offset:30640
    global_load_dwordx4 v[160:163], v62, s[24:25] offset:-3072 sc1
    v_add_f32 v70, v70, v71
    v_mov_b32 v71, v70
    s_waitcnt vmcnt(7)
    v_bitop3_b32 v67, v120, v152, v144 bitop3:0x80
    v_bitop3_b32 v67, v67, v128, 1 bitop3:0x80
    v_cmp_eq_u32 vcc, 0, v67
    s_cbranch_vccnz .crt_355
.cok_357:
    s_waitcnt lgkmcnt(6)
    v_mfma_f32_32x32x16_bf16 v[200:215], v[232:235], v[120:123], v[200:215]
    ds_read_b64_tr_b16 v[248:249], v7 offset:32256
    ds_read_b64_tr_b16 v[250:251], v7 offset:32368
    global_load_dwordx4 v[132:135], v62, s[24:25] offset:-2048 sc1
    v_permlane32_swap_b32 v70, v71
    v_mul_f32 v70, 0xbb000000, v70
    s_waitcnt lgkmcnt(6)
    v_mfma_f32_32x32x16_bf16 v[216:231], v[236:239], v[120:123], v[216:231]
    ds_read_b64_tr_b16 v[252:253], v7 offset:32320
    ds_read_b64_tr_b16 v[254:255], v7 offset:32432
    global_load_dwordx4 v[140:143], v62, s[24:25] offset:-1024 sc1
    v_mul_f32 v72, v70, v70
    v_mul_f32 v71, 0x3b000000, v71
    s_waitcnt lgkmcnt(6)
    v_mfma_f32_32x32x16_bf16 v[200:215], v[240:243], v[152:155], v[200:215]
    ds_read_b64_tr_b16 v[232:233], v7 offset:34048
    ds_read_b64_tr_b16 v[234:235], v7 offset:34160
    global_load_dwordx4 v[120:123], v62, s[24:25] offset:0 sc1
    v_sub_f32 v71, v71, v72
    v_max_f32 v71, 0, v71
    s_waitcnt lgkmcnt(6)
    v_mfma_f32_32x32x16_bf16 v[216:231], v[244:247], v[152:155], v[216:231]
    ds_read_b64_tr_b16 v[236:237], v7 offset:34112
    ds_read_b64_tr_b16 v[238:239], v7 offset:34224
    global_load_dwordx4 v[152:155], v62, s[24:25] offset:1024 sc1
    v_add_f32 v72, 0x3727c5ac, v71
    v_rsq_f32 v26, v72
    s_waitcnt lgkmcnt(6)
    v_mfma_f32_32x32x16_bf16 v[200:215], v[248:251], v[144:147], v[200:215]
    ds_read_b64_tr_b16 v[240:241], v7 offset:35840
    ds_read_b64_tr_b16 v[242:243], v7 offset:35952
    v_cvt_pk_bf16_f32 v73, v70, v70
    v_lshlrev_b32 v73, 16, v73
    s_waitcnt lgkmcnt(6)
    v_mfma_f32_32x32x16_bf16 v[216:231], v[252:255], v[144:147], v[216:231]
    ds_read_b64_tr_b16 v[244:245], v7 offset:35904
    ds_read_b64_tr_b16 v[246:247], v7 offset:36016
    global_load_dwordx4 v[144:147], v62, s[24:25] offset:2048 sc1
    v_sub_f32 v73, v70, v73
    v_mul_f32 v73, v73, v8
    s_waitcnt lgkmcnt(6)
    v_mfma_f32_32x32x16_bf16 v[200:215], v[232:235], v[128:131], v[200:215]
    ds_read_b64_tr_b16 v[248:249], v7 offset:37632
    ds_read_b64_tr_b16 v[250:251], v7 offset:37744
    v_cvt_pk_bf16_f32 v18, v70, v73
    v_mul_f32 v74, v26, v26
    s_waitcnt lgkmcnt(6)
    v_mfma_f32_32x32x16_bf16 v[216:231], v[236:239], v[128:131], v[216:231]
    ds_read_b64_tr_b16 v[252:253], v7 offset:37696
    ds_read_b64_tr_b16 v[254:255], v7 offset:37808
    global_load_dwordx4 v[128:131], v62, s[24:25] offset:3072 sc1
    v_mul_f32 v27, v72, v26
    v_mov_b32 v75, 0x3727c5ac
    s_waitcnt vmcnt(8)
    v_bitop3_b32 v67, v148, v136, v124 bitop3:0x80
    v_bitop3_b32 v67, v67, v156, 1 bitop3:0x80
    v_cmp_eq_u32 vcc, 0, v67
    s_cbranch_vccnz .crt_358
.cok_360:
    s_waitcnt lgkmcnt(6)
    v_mfma_f32_32x32x16_bf16 v[200:215], v[240:243], v[148:151], v[200:215]
    ds_read_b64_tr_b16 v[232:233], v7 offset:39424
    ds_read_b64_tr_b16 v[234:235], v7 offset:39536
    v_fma_f32 v74, v71, v74, v75
    v_rsq_f32 v75, v74
    s_waitcnt lgkmcnt(6)
    v_mfma_f32_32x32x16_bf16 v[216:231], v[244:247], v[148:151], v[216:231]
    ds_read_b64_tr_b16 v[236:237], v7 offset:39488
    ds_read_b64_tr_b16 v[238:239], v7 offset:39600
    v_mul_f32 v27, v27, v74
    v_mul_f32 v26, v26, v75
    s_waitcnt lgkmcnt(6)
    v_mfma_f32_32x32x16_bf16 v[200:215], v[248:251], v[136:139], v[200:215]
    ds_read_b64_tr_b16 v[240:241], v7 offset:41216
    ds_read_b64_tr_b16 v[242:243], v7 offset:41328
    v_mul_f32 v27, v27, v75
    v_cvt_pk_bf16_f32 v73, v27, v27
    s_waitcnt lgkmcnt(6)
    v_mfma_f32_32x32x16_bf16 v[216:231], v[252:255], v[136:139], v[216:231]
    ds_read_b64_tr_b16 v[244:245], v7 offset:41280
    ds_read_b64_tr_b16 v[246:247], v7 offset:41392
    v_lshlrev_b32 v73, 16, v73
    v_sub_f32 v73, v27, v73
    s_waitcnt lgkmcnt(6)
    v_mfma_f32_32x32x16_bf16 v[200:215], v[232:235], v[124:127], v[200:215]
    ds_read_b64_tr_b16 v[248:249], v7 offset:43008
    ds_read_b64_tr_b16 v[250:251], v7 offset:43120
    v_mul_f32 v73, v73, v8
    v_mul_f32 v74, v27, v8
    s_waitcnt lgkmcnt(6)
    v_mfma_f32_32x32x16_bf16 v[216:231], v[236:239], v[124:127], v[216:231]
    ds_read_b64_tr_b16 v[252:253], v7 offset:43072
    ds_read_b64_tr_b16 v[254:255], v7 offset:43184
    v_cvt_pk_bf16_f32 v19, v74, v73
    v_mul_f32 v72, v26, v26
    s_waitcnt lgkmcnt(6)
    v_mfma_f32_32x32x16_bf16 v[200:215], v[240:243], v[156:159], v[200:215]
    ds_read_b64_tr_b16 v[232:233], v7 offset:44800
    ds_read_b64_tr_b16 v[234:235], v7 offset:44912
    v_mul_f32 v28, 0xc0135761, v26
    v_mul_f32 v72, v72, v26
    s_waitcnt lgkmcnt(6)
    v_mfma_f32_32x32x16_bf16 v[216:231], v[244:247], v[156:159], v[216:231]
    ds_read_b64_tr_b16 v[236:237], v7 offset:44864
    ds_read_b64_tr_b16 v[238:239], v7 offset:44976
    v_mul_f32 v29, 0xbdd2d3e8, v72
    s_waitcnt vmcnt(4)
    v_bitop3_b32 v67, v164, v160, v132 bitop3:0x80
    v_bitop3_b32 v67, v67, v140, 1 bitop3:0x80
    v_cmp_eq_u32 vcc, 0, v67
    s_cbranch_vccnz .crt_361
.cok_363:
    s_waitcnt lgkmcnt(6)
    v_mfma_f32_32x32x16_bf16 v[200:215], v[248:251], v[164:167], v[200:215]
    ds_read_b64_tr_b16 v[240:241], v7 offset:46592
    ds_read_b64_tr_b16 v[242:243], v7 offset:46704
    s_waitcnt lgkmcnt(6)
    v_mfma_f32_32x32x16_bf16 v[216:231], v[252:255], v[164:167], v[216:231]
    ds_read_b64_tr_b16 v[244:245], v7 offset:46656
    ds_read_b64_tr_b16 v[246:247], v7 offset:46768
    s_waitcnt lgkmcnt(6)
    v_mfma_f32_32x32x16_bf16 v[200:215], v[232:235], v[160:163], v[200:215]
    ds_read_b64_tr_b16 v[248:249], v7 offset:48384
    ds_read_b64_tr_b16 v[250:251], v7 offset:48496
    s_waitcnt lgkmcnt(6)
    v_mfma_f32_32x32x16_bf16 v[216:231], v[236:239], v[160:163], v[216:231]
    ds_read_b64_tr_b16 v[252:253], v7 offset:48448
    ds_read_b64_tr_b16 v[254:255], v7 offset:48560
    s_waitcnt lgkmcnt(6)
    v_mfma_f32_32x32x16_bf16 v[200:215], v[240:243], v[132:135], v[200:215]
    ds_read_b64_tr_b16 v[232:233], v7 offset:50176
    ds_read_b64_tr_b16 v[234:235], v7 offset:50288
    s_waitcnt lgkmcnt(6)
    v_mfma_f32_32x32x16_bf16 v[216:231], v[244:247], v[132:135], v[216:231]
    ds_read_b64_tr_b16 v[236:237], v7 offset:50240
    ds_read_b64_tr_b16 v[238:239], v7 offset:50352
    s_waitcnt lgkmcnt(6)
    v_mfma_f32_32x32x16_bf16 v[200:215], v[248:251], v[140:143], v[200:215]
    ds_read_b64_tr_b16 v[240:241], v7 offset:51968
    ds_read_b64_tr_b16 v[242:243], v7 offset:52080
    s_waitcnt lgkmcnt(6)
    v_mfma_f32_32x32x16_bf16 v[216:231], v[252:255], v[140:143], v[216:231]
    ds_read_b64_tr_b16 v[244:245], v7 offset:52032
    ds_read_b64_tr_b16 v[246:247], v7 offset:52144
    s_waitcnt vmcnt(0)
    v_bitop3_b32 v67, v120, v152, v144 bitop3:0x80
    v_bitop3_b32 v67, v67, v128, 1 bitop3:0x80
    v_cmp_eq_u32 vcc, 0, v67
    s_cbranch_vccnz .crt_364
.cok_366:
    s_waitcnt lgkmcnt(6)
    v_mfma_f32_32x32x16_bf16 v[200:215], v[232:235], v[120:123], v[200:215]
    ds_read_b64_tr_b16 v[248:249], v7 offset:53760
    ds_read_b64_tr_b16 v[250:251], v7 offset:53872
    s_waitcnt lgkmcnt(6)
    v_mfma_f32_32x32x16_bf16 v[216:231], v[236:239], v[120:123], v[216:231]
    ds_read_b64_tr_b16 v[252:253], v7 offset:53824
    ds_read_b64_tr_b16 v[254:255], v7 offset:53936
    s_waitcnt lgkmcnt(6)
    v_mfma_f32_32x32x16_bf16 v[200:215], v[240:243], v[152:155], v[200:215]
    ds_read_b64_tr_b16 v[232:233], v7 offset:55552
    ds_read_b64_tr_b16 v[234:235], v7 offset:55664
    s_waitcnt lgkmcnt(6)
    v_mfma_f32_32x32x16_bf16 v[216:231], v[244:247], v[152:155], v[216:231]
    ds_read_b64_tr_b16 v[236:237], v7 offset:55616
    ds_read_b64_tr_b16 v[238:239], v7 offset:55728
    s_waitcnt lgkmcnt(6)
    v_mfma_f32_32x32x16_bf16 v[200:215], v[248:251], v[144:147], v[200:215]
    s_waitcnt lgkmcnt(4)
    v_mfma_f32_32x32x16_bf16 v[216:231], v[252:255], v[144:147], v[216:231]
    s_waitcnt lgkmcnt(2)
    v_mfma_f32_32x32x16_bf16 v[200:215], v[232:235], v[128:131], v[200:215]
    s_waitcnt lgkmcnt(0)
    v_mfma_f32_32x32x16_bf16 v[216:231], v[236:239], v[128:131], v[216:231]
    v_mfma_f32_32x32x16_bf16 v[200:215], v[42:45], v[18:21], v[200:215]
    s_and_b32 s44, s27, 1
    s_lshl_b32 s45, s44, 12
    s_add_u32 s45, s45, s63
    s_add_u32 s45, s45, 524288
    v_add_u32 v63, s45, v2
    v_mfma_f32_32x32x16_bf16 v[216:231], v[42:45], v[16:19], v[216:231]
    s_and_b32 s44, s27, 1
    s_lshl_b32 s45, s44, 9
    s_add_u32 s45, s45, s63
    s_add_u32 s45, s45, 527360
    v_lshl_add_u32 v64, v3, 4, s45
    s_nop 0
    v_pk_mul_f32 v[78:79], v[200:201], v[200:201]
    v_pk_mul_f32 v[80:81], v[202:203], v[202:203]
    v_pk_mul_f32 v[82:83], v[204:205], v[204:205]
    v_pk_mul_f32 v[84:85], v[206:207], v[206:207]
    v_pk_fma_f32 v[78:79], v[78:79], v[28:29], v[28:29] op_sel:[0,1,0] op_sel_hi:[1,1,0]
    v_pk_fma_f32 v[80:81], v[80:81], v[28:29], v[28:29] op_sel:[0,1,0] op_sel_hi:[1,1,0]
    v_pk_fma_f32 v[82:83], v[82:83], v[28:29], v[28:29] op_sel:[0,1,0] op_sel_hi:[1,1,0]
    v_pk_fma_f32 v[84:85], v[84:85], v[28:29], v[28:29] op_sel:[0,1,0] op_sel_hi:[1,1,0]
    v_pk_mul_f32 v[78:79], v[78:79], v[200:201]
    v_pk_mul_f32 v[80:81], v[80:81], v[202:203]
    v_pk_mul_f32 v[82:83], v[82:83], v[204:205]
    v_pk_mul_f32 v[84:85], v[84:85], v[206:207]
    v_exp_f32 v78, v78
    v_exp_f32 v79, v79
    v_exp_f32 v80, v80
    v_exp_f32 v81, v81
    v_exp_f32 v82, v82
    v_exp_f32 v83, v83
    v_exp_f32 v84, v84
    v_exp_f32 v85, v85
    v_pk_fma_f32 v[78:79], v[78:79], v[26:27], v[26:27] op_sel:[0,1,1] op_sel_hi:[1,1,1]
    v_pk_fma_f32 v[80:81], v[80:81], v[26:27], v[26:27] op_sel:[0,1,1] op_sel_hi:[1,1,1]
    v_pk_fma_f32 v[82:83], v[82:83], v[26:27], v[26:27] op_sel:[0,1,1] op_sel_hi:[1,1,1]
    v_pk_fma_f32 v[84:85], v[84:85], v[26:27], v[26:27] op_sel:[0,1,1] op_sel_hi:[1,1,1]
    v_rcp_f32 v78, v78
    v_rcp_f32 v79, v79
    v_rcp_f32 v80, v80
    v_rcp_f32 v81, v81
    v_rcp_f32 v82, v82
    v_rcp_f32 v83, v83
    v_rcp_f32 v84, v84
    v_rcp_f32 v85, v85
    v_pk_mul_f32 v[78:79], v[78:79], v[200:201]
    v_pk_mul_f32 v[80:81], v[80:81], v[202:203]
    v_pk_mul_f32 v[82:83], v[82:83], v[204:205]
    v_pk_mul_f32 v[84:85], v[84:85], v[206:207]
    v_cvt_pk_bf16_f32 v200, v78, v79
    v_cvt_pk_bf16_f32 v201, v80, v81
    v_cvt_pk_bf16_f32 v202, v82, v83
    v_or_b32 v200, 1, v200
    v_cvt_pk_bf16_f32 v203, v84, v85
    global_store_dwordx4 v63, v[200:203], s[24:25] offset:0 sc1
    v_pk_mul_f32 v[78:79], v[208:209], v[208:209]
    v_pk_mul_f32 v[80:81], v[210:211], v[210:211]
    v_pk_mul_f32 v[82:83], v[212:213], v[212:213]
    v_pk_mul_f32 v[84:85], v[214:215], v[214:215]
    v_pk_fma_f32 v[78:79], v[78:79], v[28:29], v[28:29] op_sel:[0,1,0] op_sel_hi:[1,1,0]
    v_pk_fma_f32 v[80:81], v[80:81], v[28:29], v[28:29] op_sel:[0,1,0] op_sel_hi:[1,1,0]
    v_pk_fma_f32 v[82:83], v[82:83], v[28:29], v[28:29] op_sel:[0,1,0] op_sel_hi:[1,1,0]
    v_pk_fma_f32 v[84:85], v[84:85], v[28:29], v[28:29] op_sel:[0,1,0] op_sel_hi:[1,1,0]
    v_pk_mul_f32 v[78:79], v[78:79], v[208:209]
    v_pk_mul_f32 v[80:81], v[80:81], v[210:211]
    v_pk_mul_f32 v[82:83], v[82:83], v[212:213]
    v_pk_mul_f32 v[84:85], v[84:85], v[214:215]
    v_exp_f32 v78, v78
    s_mul_i32 s44, s96, 7168
    s_add_u32 s44, s44, s100
    s_add_u32 s44, s44, 986112
    v_add_u32 v62, s44, v2
    global_load_dwordx4 v[148:151], v62, s[24:25] offset:-3072 sc1
    v_exp_f32 v79, v79
    v_exp_f32 v80, v80
    v_exp_f32 v81, v81
    v_exp_f32 v82, v82
    global_load_dwordx4 v[136:139], v62, s[24:25] offset:-2048 sc1
    v_exp_f32 v83, v83
    v_exp_f32 v84, v84
    v_exp_f32 v85, v85
    v_pk_fma_f32 v[78:79], v[78:79], v[26:27], v[26:27] op_sel:[0,1,1] op_sel_hi:[1,1,1]
    global_load_dwordx4 v[124:127], v62, s[24:25] offset:-1024 sc1
    v_pk_fma_f32 v[80:81], v[80:81], v[26:27], v[26:27] op_sel:[0,1,1] op_sel_hi:[1,1,1]
    v_pk_fma_f32 v[82:83], v[82:83], v[26:27], v[26:27] op_sel:[0,1,1] op_sel_hi:[1,1,1]
    v_pk_fma_f32 v[84:85], v[84:85], v[26:27], v[26:27] op_sel:[0,1,1] op_sel_hi:[1,1,1]
    v_rcp_f32 v78, v78
    global_load_dwordx4 v[156:159], v62, s[24:25] offset:0 sc1
    v_rcp_f32 v79, v79
    v_rcp_f32 v80, v80
    v_rcp_f32 v81, v81
    v_rcp_f32 v82, v82
    global_load_dwordx4 v[164:167], v62, s[24:25] offset:1024 sc1
    v_rcp_f32 v83, v83
    v_rcp_f32 v84, v84
    v_rcp_f32 v85, v85
    v_pk_mul_f32 v[78:79], v[78:79], v[208:209]
    global_load_dwordx4 v[160:163], v62, s[24:25] offset:2048 sc1
    v_pk_mul_f32 v[80:81], v[80:81], v[210:211]
    v_pk_mul_f32 v[82:83], v[82:83], v[212:213]
    v_pk_mul_f32 v[84:85], v[84:85], v[214:215]
    v_cvt_pk_bf16_f32 v208, v78, v79
    global_load_dwordx4 v[132:135], v62, s[24:25] offset:3072 sc1
    v_cvt_pk_bf16_f32 v209, v80, v81
    v_cvt_pk_bf16_f32 v210, v82, v83
    v_or_b32 v208, 1, v208
    v_cvt_pk_bf16_f32 v211, v84, v85
    s_mul_i32 s44, s97, 7168
    s_add_u32 s44, s44, s100
    s_add_u32 s44, s44, 986112
    v_add_u32 v62, s44, v2
    global_load_dwordx4 v[140:143], v62, s[24:25] offset:-3072 sc1
    global_store_dwordx4 v63, v[208:211], s[24:25] offset:1024 sc1
    v_pk_mul_f32 v[78:79], v[216:217], v[216:217]
    v_pk_mul_f32 v[80:81], v[218:219], v[218:219]
    v_pk_mul_f32 v[82:83], v[220:221], v[220:221]
    global_load_dwordx4 v[120:123], v62, s[24:25] offset:-2048 sc1
    v_pk_mul_f32 v[84:85], v[222:223], v[222:223]
    v_pk_fma_f32 v[78:79], v[78:79], v[28:29], v[28:29] op_sel:[0,1,0] op_sel_hi:[1,1,0]
    v_pk_fma_f32 v[80:81], v[80:81], v[28:29], v[28:29] op_sel:[0,1,0] op_sel_hi:[1,1,0]
    v_pk_fma_f32 v[82:83], v[82:83], v[28:29], v[28:29] op_sel:[0,1,0] op_sel_hi:[1,1,0]
    global_load_dwordx4 v[152:155], v62, s[24:25] offset:-1024 sc1
    v_pk_fma_f32 v[84:85], v[84:85], v[28:29], v[28:29] op_sel:[0,1,0] op_sel_hi:[1,1,0]
    v_pk_mul_f32 v[78:79], v[78:79], v[216:217]
    v_pk_mul_f32 v[80:81], v[80:81], v[218:219]
    v_pk_mul_f32 v[82:83], v[82:83], v[220:221]
    global_load_dwordx4 v[144:147], v62, s[24:25] offset:0 sc1
    v_pk_mul_f32 v[84:85], v[84:85], v[222:223]
    v_exp_f32 v78, v78
    v_exp_f32 v79, v79
    v_exp_f32 v80, v80
    global_load_dwordx4 v[128:131], v62, s[24:25] offset:1024 sc1
    v_exp_f32 v81, v81
    v_exp_f32 v82, v82
    v_exp_f32 v83, v83
    v_exp_f32 v84, v84
    v_exp_f32 v85, v85
    v_pk_fma_f32 v[78:79], v[78:79], v[26:27], v[26:27] op_sel:[0,1,1] op_sel_hi:[1,1,1]
    v_pk_fma_f32 v[80:81], v[80:81], v[26:27], v[26:27] op_sel:[0,1,1] op_sel_hi:[1,1,1]
    v_pk_fma_f32 v[82:83], v[82:83], v[26:27], v[26:27] op_sel:[0,1,1] op_sel_hi:[1,1,1]
    v_pk_fma_f32 v[84:85], v[84:85], v[26:27], v[26:27] op_sel:[0,1,1] op_sel_hi:[1,1,1]
    v_rcp_f32 v78, v78
    v_rcp_f32 v79, v79
    v_rcp_f32 v80, v80
    v_rcp_f32 v81, v81
    v_rcp_f32 v82, v82
    v_rcp_f32 v83, v83
    v_rcp_f32 v84, v84
    v_rcp_f32 v85, v85
    v_pk_mul_f32 v[78:79], v[78:79], v[216:217]
    v_pk_mul_f32 v[80:81], v[80:81], v[218:219]
    v_pk_mul_f32 v[82:83], v[82:83], v[220:221]
    v_pk_mul_f32 v[84:85], v[84:85], v[222:223]
    v_cvt_pk_bf16_f32 v216, v78, v79
    v_cvt_pk_bf16_f32 v217, v80, v81
    v_cvt_pk_bf16_f32 v218, v82, v83
    v_or_b32 v216, 1, v216
    v_cvt_pk_bf16_f32 v219, v84, v85
    global_store_dwordx4 v63, v[216:219], s[24:25] offset:2048 sc1
    v_pk_mul_f32 v[78:79], v[224:225], v[224:225]
    v_pk_mul_f32 v[80:81], v[226:227], v[226:227]
    v_pk_fma_f32 v[78:79], v[78:79], v[28:29], v[28:29] op_sel:[0,1,0] op_sel_hi:[1,1,0]
    v_pk_fma_f32 v[80:81], v[80:81], v[28:29], v[28:29] op_sel:[0,1,0] op_sel_hi:[1,1,0]
    v_pk_mul_f32 v[78:79], v[78:79], v[224:225]
    v_pk_mul_f32 v[80:81], v[80:81], v[226:227]
    v_exp_f32 v78, v78
    v_exp_f32 v79, v79
    v_exp_f32 v80, v80
    v_exp_f32 v81, v81
    v_pk_fma_f32 v[78:79], v[78:79], v[26:27], v[26:27] op_sel:[0,1,1] op_sel_hi:[1,1,1]
    v_pk_fma_f32 v[80:81], v[80:81], v[26:27], v[26:27] op_sel:[0,1,1] op_sel_hi:[1,1,1]
    v_rcp_f32 v78, v78
    v_rcp_f32 v79, v79
    v_rcp_f32 v80, v80
    v_rcp_f32 v81, v81
    v_pk_mul_f32 v[78:79], v[78:79], v[224:225]
    v_pk_mul_f32 v[80:81], v[80:81], v[226:227]
    v_cvt_pk_bf16_f32 v224, v78, v79
    v_cvt_pk_bf16_f32 v225, v80, v81
    v_mov_b32 v226, v224
    v_mov_b32 v227, v225
    s_nop 0
    v_permlane32_swap_b32 v224, v226
    v_permlane32_swap_b32 v225, v227
    v_or_b32 v224, 1, v224
    global_store_dwordx4 v64, v[224:227], s[24:25] sc1
    s_add_u32 s52, s52, 1
    s_waitcnt vmcnt(11)
    v_bitop3_b32 v67, v148, v136, v124 bitop3:0x80
    v_bitop3_b32 v67, v67, v156, 1 bitop3:0x80
    v_cmp_eq_u32 vcc, 0, v67
    s_cbranch_vccnz .crt_367
.cok_369:
    v_mfma_f32_32x32x16_bf16 v[168:183], a[0:3], v[148:151], 0
    v_mfma_f32_32x32x16_bf16 v[184:199], a[4:7], v[148:151], 0
    global_load_dwordx4 v[148:151], v62, s[24:25] offset:2048 sc1
    v_mfma_f32_32x32x16_bf16 v[168:183], a[8:11], v[136:139], v[168:183]
    v_mfma_f32_32x32x16_bf16 v[184:199], a[12:15], v[136:139], v[184:199]
    global_load_dwordx4 v[136:139], v62, s[24:25] offset:3072 sc1
    v_mfma_f32_32x32x16_bf16 v[168:183], a[16:19], v[124:127], v[168:183]
    v_mfma_f32_32x32x16_bf16 v[184:199], a[20:23], v[124:127], v[184:199]
    s_mul_i32 s44, s98, 7168
    s_add_u32 s44, s44, s100
    s_add_u32 s44, s44, 986112
    v_add_u32 v62, s44, v2
    global_load_dwordx4 v[124:127], v62, s[24:25] offset:-3072 sc1
    v_mfma_f32_32x32x16_bf16 v[168:183], a[24:27], v[156:159], v[168:183]
    v_mfma_f32_32x32x16_bf16 v[184:199], a[28:31], v[156:159], v[184:199]
    global_load_dwordx4 v[156:159], v62, s[24:25] offset:-2048 sc1
    s_cmp_eq_u32 s2, 1
    s_cbranch_scc1 .fi_370
.fib_371:
    s_waitcnt vmcnt(11)
    v_bitop3_b32 v67, v164, v160, v132 bitop3:0x80
    v_bitop3_b32 v67, v67, v140, 1 bitop3:0x80
    v_cmp_eq_u32 vcc, 0, v67
    s_cbranch_vccnz .crt_372
.cok_374:
    v_mfma_f32_32x32x16_bf16 v[168:183], a[32:35], v[164:167], v[168:183]
    v_mfma_f32_32x32x16_bf16 v[184:199], a[36:39], v[164:167], v[184:199]
    global_load_dwordx4 v[164:167], v62, s[24:25] offset:-1024 sc1
    v_mfma_f32_32x32x16_bf16 v[168:183], a[40:43], v[160:163], v[168:183]
    v_mfma_f32_32x32x16_bf16 v[184:199], a[44:47], v[160:163], v[184:199]
    global_load_dwordx4 v[160:163], v62, s[24:25] offset:0 sc1
    v_mfma_f32_32x32x16_bf16 v[168:183], a[48:51], v[132:135], v[168:183]
    v_mfma_f32_32x32x16_bf16 v[184:199], a[52:55], v[132:135], v[184:199]
    global_load_dwordx4 v[132:135], v62, s[24:25] offset:1024 sc1
    v_mfma_f32_32x32x16_bf16 v[168:183], a[56:59], v[140:143], v[168:183]
    v_mfma_f32_32x32x16_bf16 v[184:199], a[60:63], v[140:143], v[184:199]
    global_load_dwordx4 v[140:143], v62, s[24:25] offset:2048 sc1
    s_waitcnt vmcnt(10)
    v_bitop3_b32 v67, v120, v152, v144 bitop3:0x80
    v_bitop3_b32 v67, v67, v128, 1 bitop3:0x80
    v_cmp_eq_u32 vcc, 0, v67
    s_cbranch_vccnz .crt_375
.cok_377:
    v_mfma_f32_32x32x16_bf16 v[168:183], a[64:67], v[120:123], v[168:183]
    v_mfma_f32_32x32x16_bf16 v[184:199], a[68:71], v[120:123], v[184:199]
    global_load_dwordx4 v[120:123], v62, s[24:25] offset:3072 sc1
    v_mfma_f32_32x32x16_bf16 v[168:183], a[72:75], v[152:155], v[168:183]
    v_mfma_f32_32x32x16_bf16 v[184:199], a[76:79], v[152:155], v[184:199]
    s_mul_i32 s44, s99, 7168
    s_add_u32 s44, s44, s100
    s_add_u32 s44, s44, 986112
    v_add_u32 v62, s44, v2
    global_load_dwordx4 v[152:155], v62, s[24:25] offset:-3072 sc1
    v_mfma_f32_32x32x16_bf16 v[168:183], a[80:83], v[144:147], v[168:183]
    v_mfma_f32_32x32x16_bf16 v[184:199], a[84:87], v[144:147], v[184:199]
    global_load_dwordx4 v[144:147], v62, s[24:25] offset:-2048 sc1
    v_mfma_f32_32x32x16_bf16 v[168:183], a[88:91], v[128:131], v[168:183]
    v_mfma_f32_32x32x16_bf16 v[184:199], a[92:95], v[128:131], v[184:199]
    global_load_dwordx4 v[128:131], v62, s[24:25] offset:-1024 sc1
    s_waitcnt vmcnt(8)
    v_bitop3_b32 v67, v148, v136, v124 bitop3:0x80
    v_bitop3_b32 v67, v67, v156, 1 bitop3:0x80
    v_cmp_eq_u32 vcc, 0, v67
    s_cbranch_vccnz .crt_378
.cok_380:
    v_mfma_f32_32x32x16_bf16 v[168:183], a[96:99], v[148:151], v[168:183]
    v_mfma_f32_32x32x16_bf16 v[184:199], a[100:103], v[148:151], v[184:199]
    global_load_dwordx4 v[148:151], v62, s[24:25] offset:0 sc1
    v_mfma_f32_32x32x16_bf16 v[168:183], a[104:107], v[136:139], v[168:183]
    v_mfma_f32_32x32x16_bf16 v[184:199], a[108:111], v[136:139], v[184:199]
    global_load_dwordx4 v[136:139], v62, s[24:25] offset:1024 sc1
    v_mfma_f32_32x32x16_bf16 v[168:183], a[112:115], v[124:127], v[168:183]
    v_mfma_f32_32x32x16_bf16 v[184:199], a[116:119], v[124:127], v[184:199]
    global_load_dwordx4 v[124:127], v62, s[24:25] offset:2048 sc1
    v_mfma_f32_32x32x16_bf16 v[168:183], a[120:123], v[156:159], v[168:183]
    v_mfma_f32_32x32x16_bf16 v[184:199], a[124:127], v[156:159], v[184:199]
    global_load_dwordx4 v[156:159], v62, s[24:25] offset:3072 sc1
    s_waitcnt vmcnt(8)
    v_bitop3_b32 v67, v164, v160, v132 bitop3:0x80
    v_bitop3_b32 v67, v67, v140, 1 bitop3:0x80
    v_cmp_eq_u32 vcc, 0, v67
    s_cbranch_vccnz .crt_381
.cok_383:
    v_mfma_f32_32x32x16_bf16 v[168:183], a[128:131], v[164:167], v[168:183]
    v_mfma_f32_32x32x16_bf16 v[184:199], a[132:135], v[164:167], v[184:199]
    s_lshl_b32 s44, s30, 7
    v_lshrrev_b32 v67, 3, v1
    v_lshl_add_u32 v67, v67, 4, s44
    global_load_dwordx4 v[164:167], v67, s[18:19]
    v_mfma_f32_32x32x16_bf16 v[168:183], a[136:139], v[160:163], v[168:183]
    v_mfma_f32_32x32x16_bf16 v[184:199], a[140:143], v[160:163], v[184:199]
    s_mul_i32 s44, s96, 7168
    s_add_u32 s44, s44, s100
    s_add_u32 s44, s44, 527360
    v_add_u32 v62, s44, v2
    global_load_dwordx4 v[160:163], v62, s[24:25] offset:-3072 sc1
    v_mfma_f32_32x32x16_bf16 v[168:183], a[144:147], v[132:135], v[168:183]
    v_mfma_f32_32x32x16_bf16 v[184:199], a[148:151], v[132:135], v[184:199]
    global_load_dwordx4 v[132:135], v62, s[24:25] offset:-2048 sc1
    v_mfma_f32_32x32x16_bf16 v[168:183], a[152:155], v[140:143], v[168:183]
    v_mfma_f32_32x32x16_bf16 v[184:199], a[156:159], v[140:143], v[184:199]
    global_load_dwordx4 v[140:143], v62, s[24:25] offset:-1024 sc1
    s_waitcnt vmcnt(8)
    v_bitop3_b32 v67, v120, v152, v144 bitop3:0x80
    v_bitop3_b32 v67, v67, v128, 1 bitop3:0x80
    v_cmp_eq_u32 vcc, 0, v67
    s_cbranch_vccnz .crt_384
.cok_386:
    v_mfma_f32_32x32x16_bf16 v[168:183], a[160:163], v[120:123], v[168:183]
    v_mfma_f32_32x32x16_bf16 v[168:183], a[168:171], v[152:155], v[168:183]
    v_mfma_f32_32x32x16_bf16 v[168:183], a[176:179], v[144:147], v[168:183]
    v_mfma_f32_32x32x16_bf16 v[168:183], a[184:187], v[128:131], v[168:183]
    s_waitcnt vmcnt(4)
    v_bitop3_b32 v67, v148, v136, v124 bitop3:0x80
    v_bitop3_b32 v67, v67, v156, 1 bitop3:0x80
    v_cmp_eq_u32 vcc, 0, v67
    s_cbranch_vccnz .crt_387
.cok_389:
    v_mfma_f32_32x32x16_bf16 v[168:183], a[192:195], v[148:151], v[168:183]
    s_cmp_eq_u32 s2, 1
    s_cbranch_scc1 .fc_390
.fcb_391:
    v_mfma_f32_32x32x16_bf16 v[168:183], a[200:203], v[136:139], v[168:183]
    v_mfma_f32_32x32x16_bf16 v[168:183], a[208:211], v[124:127], v[168:183]
    v_mfma_f32_32x32x16_bf16 v[168:183], a[216:219], v[156:159], v[168:183]
    v_mfma_f32_32x32x16_bf16 v[184:199], a[164:167], v[120:123], v[184:199]
    global_load_dwordx4 v[120:123], v62, s[24:25] offset:0 sc1
    s_barrier
    v_mfma_f32_32x32x16_bf16 v[184:199], a[172:175], v[152:155], v[184:199]
    global_load_dwordx4 v[152:155], v62, s[24:25] offset:1024 sc1
    s_nop 6
    ds_write_b128 v11, v[168:171] offset:0
    v_mfma_f32_32x32x16_bf16 v[184:199], a[180:183], v[144:147], v[184:199]
    global_load_dwordx4 v[144:147], v62, s[24:25] offset:2048 sc1
    v_mfma_f32_32x32x16_bf16 v[184:199], a[188:191], v[128:131], v[184:199]
    global_load_dwordx4 v[128:131], v62, s[24:25] offset:3072 sc1
    ds_write_b128 v12, v[172:175] offset:1024
    v_mfma_f32_32x32x16_bf16 v[184:199], a[196:199], v[148:151], v[184:199]
    s_mul_i32 s44, s97, 7168
    s_add_u32 s44, s44, s100
    s_add_u32 s44, s44, 527360
    v_add_u32 v62, s44, v2
    global_load_dwordx4 v[148:151], v62, s[24:25] offset:-3072 sc1
    v_mfma_f32_32x32x16_bf16 v[184:199], a[204:207], v[136:139], v[184:199]
    global_load_dwordx4 v[136:139], v62, s[24:25] offset:-2048 sc1
    ds_write_b128 v11, v[176:179] offset:2048
    v_mfma_f32_32x32x16_bf16 v[184:199], a[212:215], v[124:127], v[184:199]
    global_load_dwordx4 v[124:127], v62, s[24:25] offset:-1024 sc1
    v_mfma_f32_32x32x16_bf16 v[184:199], a[220:223], v[156:159], v[184:199]
    global_load_dwordx4 v[156:159], v62, s[24:25] offset:0 sc1
    ds_write_b128 v12, v[180:183] offset:3072
    s_waitcnt vmcnt(7)
    v_bitop3_b32 v67, v160, v132, v140 bitop3:0x80
    v_bitop3_b32 v67, v67, v120, 1 bitop3:0x80
    v_cmp_eq_u32 vcc, 0, v67
    s_cbranch_vccnz .crt_393
.cok_395:
    v_mfma_f32_32x32x16_bf16 v[200:215], a[0:3], v[160:163], 0
    s_lshl2_add_u32 s44, s2, s28
    s_cmp_eq_u32 s44, 4
    s_cbranch_scc1 .fs_396
.fsb_397:
    s_nop 0
    ds_write_b128 v11, v[184:187] offset:4096
    v_mfma_f32_32x32x16_bf16 v[216:231], a[4:7], v[160:163], 0
    global_load_dwordx4 v[160:163], v62, s[24:25] offset:1024 sc1
    ds_write_b128 v12, v[188:191] offset:5120
    ds_write_b128 v11, v[192:195] offset:6144
    v_mfma_f32_32x32x16_bf16 v[200:215], a[8:11], v[132:135], v[200:215]
    ds_write_b128 v12, v[196:199] offset:7168
    v_and_b32 v63, 7, v1
    s_add_u32 s44, s39, 131072
    v_lshl_add_u32 v63, v63, 10, s44
    v_lshrrev_b32 v67, 3, v1
    v_lshl_add_u32 v63, v67, 4, v63
    v_mfma_f32_32x32x16_bf16 v[216:231], a[12:15], v[132:135], v[216:231]
    global_load_dwordx4 v[132:135], v62, s[24:25] offset:2048 sc1
    v_lshlrev_b32 v78, 16, v30
    v_and_b32 v79, 0xffff0000, v30
    v_mfma_f32_32x32x16_bf16 v[200:215], a[16:19], v[140:143], v[200:215]
    v_lshlrev_b32 v80, 16, v31
    v_and_b32 v81, 0xffff0000, v31
    v_mfma_f32_32x32x16_bf16 v[216:231], a[20:23], v[140:143], v[216:231]
    global_load_dwordx4 v[140:143], v62, s[24:25] offset:3072 sc1
    v_lshlrev_b32 v82, 16, v32
    v_and_b32 v83, 0xffff0000, v32
    v_mfma_f32_32x32x16_bf16 v[200:215], a[24:27], v[120:123], v[200:215]
    v_lshlrev_b32 v84, 16, v33
    v_and_b32 v85, 0xffff0000, v33
    v_mfma_f32_32x32x16_bf16 v[216:231], a[28:31], v[120:123], v[216:231]
    s_mul_i32 s44, s98, 7168
    s_add_u32 s44, s44, s100
    s_add_u32 s44, s44, 527360
    v_add_u32 v62, s44, v2
    global_load_dwordx4 v[120:123], v62, s[24:25] offset:-3072 sc1
    v_lshlrev_b32 v86, 16, v164
    v_and_b32 v87, 0xffff0000, v164
    v_add_f32 v78, v78, v86
    v_add_f32 v79, v79, v87
    v_lshlrev_b32 v86, 16, v165
    v_and_b32 v87, 0xffff0000, v165
    v_add_f32 v80, v80, v86
    v_add_f32 v81, v81, v87
    s_waitcnt vmcnt(7)
    v_bitop3_b32 v67, v152, v144, v128 bitop3:0x80
    v_bitop3_b32 v67, v67, v148, 1 bitop3:0x80
    v_cmp_eq_u32 vcc, 0, v67
    s_cbranch_vccnz .crt_398
.cok_400:
    v_mfma_f32_32x32x16_bf16 v[200:215], a[32:35], v[152:155], v[200:215]
    v_lshlrev_b32 v86, 16, v166
    v_and_b32 v87, 0xffff0000, v166
    v_add_f32 v82, v82, v86
    v_add_f32 v83, v83, v87
    v_lshlrev_b32 v86, 16, v167
    v_and_b32 v87, 0xffff0000, v167
    v_add_f32 v84, v84, v86
    v_add_f32 v85, v85, v87
    v_mfma_f32_32x32x16_bf16 v[216:231], a[36:39], v[152:155], v[216:231]
    global_load_dwordx4 v[164:167], v62, s[24:25] offset:-2048 sc1
    v_mfma_f32_32x32x16_bf16 v[200:215], a[40:43], v[144:147], v[200:215]
    global_load_dwordx4 v[152:155], v62, s[24:25] offset:-1024 sc1
    s_waitcnt lgkmcnt(0)
    s_barrier
    ds_read_b128 v[168:171], v13 offset:0
    ds_read_b128 v[172:175], v13 offset:8192
    ds_read_b128 v[176:179], v13 offset:16384
    v_mfma_f32_32x32x16_bf16 v[216:231], a[44:47], v[144:147], v[216:231]
    global_load_dwordx4 v[144:147], v62, s[24:25] offset:0 sc1
    ds_read_b128 v[180:183], v13 offset:24576
    ds_read_b128 v[184:187], v13 offset:512
    ds_read_b128 v[188:191], v13 offset:8704
    ds_read_b128 v[192:195], v13 offset:16896
    ds_read_b128 v[196:199], v13 offset:25088
    v_mfma_f32_32x32x16_bf16 v[200:215], a[48:51], v[128:131], v[200:215]
    v_mfma_f32_32x32x16_bf16 v[216:231], a[52:55], v[128:131], v[216:231]
    global_load_dwordx4 v[128:131], v62, s[24:25] offset:1024 sc1
    v_mfma_f32_32x32x16_bf16 v[200:215], a[56:59], v[148:151], v[200:215]
    s_waitcnt lgkmcnt(6)
    v_add_f32 v168, v168, v172
    v_add_f32 v169, v169, v173
    v_add_f32 v170, v170, v174
    v_mfma_f32_32x32x16_bf16 v[216:231], a[60:63], v[148:151], v[216:231]
    global_load_dwordx4 v[148:151], v62, s[24:25] offset:2048 sc1
    v_add_f32 v171, v171, v175
    v_add_f32 v168, v168, v78
    v_add_f32 v169, v169, v79
    v_add_f32 v170, v170, v80
    s_waitcnt vmcnt(8)
    v_bitop3_b32 v67, v136, v124, v156 bitop3:0x80
    v_bitop3_b32 v67, v67, v160, 1 bitop3:0x80
    v_cmp_eq_u32 vcc, 0, v67
    s_cbranch_vccnz .crt_401
.cok_403:
    v_mfma_f32_32x32x16_bf16 v[200:215], a[64:67], v[136:139], v[200:215]
    v_add_f32 v171, v171, v81
    s_waitcnt lgkmcnt(4)
    v_add_f32 v176, v176, v180
    v_add_f32 v177, v177, v181
    v_mfma_f32_32x32x16_bf16 v[216:231], a[68:71], v[136:139], v[216:231]
    global_load_dwordx4 v[136:139], v62, s[24:25] offset:3072 sc1
    v_add_f32 v178, v178, v182
    v_add_f32 v179, v179, v183
    v_add_f32 v168, v168, v176
    v_add_f32 v169, v169, v177
    v_mfma_f32_32x32x16_bf16 v[200:215], a[72:75], v[124:127], v[200:215]
    v_add_f32 v170, v170, v178
    v_add_f32 v171, v171, v179
    v_cvt_pk_bf16_f32 v30, v168, v169
    v_cvt_pk_bf16_f32 v31, v170, v171
    v_mfma_f32_32x32x16_bf16 v[216:231], a[76:79], v[124:127], v[216:231]
    s_mul_i32 s44, s99, 7168
    s_add_u32 s44, s44, s100
    s_add_u32 s44, s44, 527360
    v_add_u32 v62, s44, v2
    global_load_dwordx4 v[124:127], v62, s[24:25] offset:-3072 sc1
    s_waitcnt lgkmcnt(2)
    v_add_f32 v184, v184, v188
    v_add_f32 v185, v185, v189
    v_add_f32 v186, v186, v190
    v_mfma_f32_32x32x16_bf16 v[200:215], a[80:83], v[156:159], v[200:215]
    v_add_f32 v187, v187, v191
    v_add_f32 v184, v184, v82
    v_add_f32 v185, v185, v83
    v_add_f32 v186, v186, v84
    v_mfma_f32_32x32x16_bf16 v[216:231], a[84:87], v[156:159], v[216:231]
    global_load_dwordx4 v[156:159], v62, s[24:25] offset:-2048 sc1
    v_add_f32 v187, v187, v85
    s_waitcnt lgkmcnt(0)
    v_add_f32 v192, v192, v196
    v_add_f32 v193, v193, v197
    v_mfma_f32_32x32x16_bf16 v[200:215], a[88:91], v[160:163], v[200:215]
    v_add_f32 v194, v194, v198
    v_add_f32 v195, v195, v199
    v_add_f32 v184, v184, v192
    v_add_f32 v185, v185, v193
    v_mfma_f32_32x32x16_bf16 v[216:231], a[92:95], v[160:163], v[216:231]
    global_load_dwordx4 v[160:163], v62, s[24:25] offset:-1024 sc1
    v_add_f32 v186, v186, v194
    v_add_f32 v187, v187, v195
    v_cvt_pk_bf16_f32 v32, v184, v185
    v_cvt_pk_bf16_f32 v33, v186, v187
    s_waitcnt vmcnt(8)
    v_bitop3_b32 v67, v132, v140, v120 bitop3:0x80
    v_bitop3_b32 v67, v67, v164, 1 bitop3:0x80
    v_cmp_eq_u32 vcc, 0, v67
    s_cbranch_vccnz .crt_404
.cok_406:
    v_mfma_f32_32x32x16_bf16 v[200:215], a[96:99], v[132:135], v[200:215]
    v_mfma_f32_32x32x16_bf16 v[216:231], a[100:103], v[132:135], v[216:231]
    global_load_dwordx4 v[132:135], v62, s[24:25] offset:0 sc1
    v_mfma_f32_32x32x16_bf16 v[200:215], a[104:107], v[140:143], v[200:215]
    v_mfma_f32_32x32x16_bf16 v[216:231], a[108:111], v[140:143], v[216:231]
    global_load_dwordx4 v[140:143], v62, s[24:25] offset:1024 sc1
    v_mfma_f32_32x32x16_bf16 v[200:215], a[112:115], v[120:123], v[200:215]
    v_mfma_f32_32x32x16_bf16 v[216:231], a[116:119], v[120:123], v[216:231]
    global_load_dwordx4 v[120:123], v62, s[24:25] offset:2048 sc1
    v_mfma_f32_32x32x16_bf16 v[200:215], a[120:123], v[164:167], v[200:215]
    v_mfma_f32_32x32x16_bf16 v[216:231], a[124:127], v[164:167], v[216:231]
    global_load_dwordx4 v[164:167], v62, s[24:25] offset:3072 sc1
    s_waitcnt vmcnt(8)
    v_bitop3_b32 v67, v152, v144, v128 bitop3:0x80
    v_bitop3_b32 v67, v67, v148, 1 bitop3:0x80
    v_cmp_eq_u32 vcc, 0, v67
    s_cbranch_vccnz .crt_407
.cok_409:
    v_mfma_f32_32x32x16_bf16 v[200:215], a[128:131], v[152:155], v[200:215]
    v_mfma_f32_32x32x16_bf16 v[216:231], a[132:135], v[152:155], v[216:231]
    s_lshl_b32 s44, s30, 7
    v_lshrrev_b32 v67, 3, v1
    v_lshl_add_u32 v67, v67, 4, s44
    global_load_dwordx4 v[152:155], v67, s[18:19]
    v_mfma_f32_32x32x16_bf16 v[200:215], a[136:139], v[144:147], v[200:215]
    v_mfma_f32_32x32x16_bf16 v[216:231], a[140:143], v[144:147], v[216:231]
    v_mfma_f32_32x32x16_bf16 v[200:215], a[144:147], v[128:131], v[200:215]
    global_store_dwordx4 v63, v[30:33], s[20:21]
    v_mfma_f32_32x32x16_bf16 v[216:231], a[148:151], v[128:131], v[216:231]
    v_mfma_f32_32x32x16_bf16 v[200:215], a[152:155], v[148:151], v[200:215]
    v_mfma_f32_32x32x16_bf16 v[216:231], a[156:159], v[148:151], v[216:231]
    s_waitcnt vmcnt(6)
    v_bitop3_b32 v67, v136, v124, v156 bitop3:0x80
    v_bitop3_b32 v67, v67, v160, 1 bitop3:0x80
    v_cmp_eq_u32 vcc, 0, v67
    s_cbranch_vccnz .crt_410
.cok_412:
    v_mfma_f32_32x32x16_bf16 v[200:215], a[160:163], v[136:139], v[200:215]
    v_mfma_f32_32x32x16_bf16 v[200:215], a[168:171], v[124:127], v[200:215]
    s_lshl2_add_u32 s44, s27, s28
    s_cmp_eq_u32 s44, 0
    s_cbranch_scc1 .wb_413
    global_load_dword v76, v62, s[24:25]
.wbb_414:
    v_mfma_f32_32x32x16_bf16 v[200:215], a[176:179], v[156:159], v[200:215]
    v_mfma_f32_32x32x16_bf16 v[200:215], a[184:187], v[160:163], v[200:215]
    s_waitcnt vmcnt(3)
    v_bitop3_b32 v67, v132, v140, v120 bitop3:0x80
    v_bitop3_b32 v67, v67, v164, 1 bitop3:0x80
    v_cmp_eq_u32 vcc, 0, v67
    s_cbranch_vccnz .crt_415
.cok_417:
    v_mfma_f32_32x32x16_bf16 v[200:215], a[192:195], v[132:135], v[200:215]
    v_mfma_f32_32x32x16_bf16 v[200:215], a[200:203], v[140:143], v[200:215]
    v_mfma_f32_32x32x16_bf16 v[200:215], a[208:211], v[120:123], v[200:215]
    v_mfma_f32_32x32x16_bf16 v[200:215], a[216:219], v[164:167], v[200:215]
    v_mfma_f32_32x32x16_bf16 v[216:231], a[164:167], v[136:139], v[216:231]
    s_barrier
    v_lshlrev_b32 v78, 16, v34
    v_and_b32 v79, 0xffff0000, v34
    v_mfma_f32_32x32x16_bf16 v[216:231], a[172:175], v[124:127], v[216:231]
    s_nop 6
    ds_write_b128 v11, v[200:203] offset:0
    v_lshlrev_b32 v80, 16, v35
    v_and_b32 v81, 0xffff0000, v35
    v_mfma_f32_32x32x16_bf16 v[216:231], a[180:183], v[156:159], v[216:231]
    v_lshlrev_b32 v82, 16, v36
    v_and_b32 v83, 0xffff0000, v36
    v_mfma_f32_32x32x16_bf16 v[216:231], a[188:191], v[160:163], v[216:231]
    ds_write_b128 v12, v[204:207] offset:1024
    v_lshlrev_b32 v84, 16, v37
    v_and_b32 v85, 0xffff0000, v37
    v_mfma_f32_32x32x16_bf16 v[216:231], a[196:199], v[132:135], v[216:231]
    s_waitcnt vmcnt(2)
    v_lshlrev_b32 v86, 16, v152
    v_and_b32 v87, 0xffff0000, v152
    v_add_f32 v78, v78, v86
    v_add_f32 v79, v79, v87
    v_lshlrev_b32 v86, 16, v153
    v_and_b32 v87, 0xffff0000, v153
    v_add_f32 v80, v80, v86
    v_add_f32 v81, v81, v87
    v_mfma_f32_32x32x16_bf16 v[216:231], a[204:207], v[140:143], v[216:231]
    ds_write_b128 v11, v[208:211] offset:2048
    v_lshlrev_b32 v86, 16, v154
    v_and_b32 v87, 0xffff0000, v154
    v_add_f32 v82, v82, v86
    v_add_f32 v83, v83, v87
    v_lshlrev_b32 v86, 16, v155
    v_and_b32 v87, 0xffff0000, v155
    v_add_f32 v84, v84, v86
    v_add_f32 v85, v85, v87
    v_mfma_f32_32x32x16_bf16 v[216:231], a[212:215], v[120:123], v[216:231]
    v_mfma_f32_32x32x16_bf16 v[216:231], a[220:223], v[164:167], v[216:231]
    ds_write_b128 v12, v[212:215] offset:3072
    s_nop 10
    ds_write_b128 v11, v[216:219] offset:4096
    ds_write_b128 v12, v[220:223] offset:5120
    ds_write_b128 v11, v[224:227] offset:6144
    ds_write_b128 v12, v[228:231] offset:7168
    v_and_b32 v63, 7, v1
    s_add_u32 s44, s39, 0
    v_lshl_add_u32 v63, v63, 10, s44
    v_lshrrev_b32 v67, 3, v1
    v_lshl_add_u32 v63, v67, 4, v63
    s_waitcnt lgkmcnt(0)
    s_barrier
    ds_read_b128 v[200:203], v13 offset:0
    ds_read_b128 v[204:207], v13 offset:8192
    ds_read_b128 v[208:211], v13 offset:16384
    ds_read_b128 v[212:215], v13 offset:24576
    ds_read_b128 v[216:219], v13 offset:512
    ds_read_b128 v[220:223], v13 offset:8704
    ds_read_b128 v[224:227], v13 offset:16896
    ds_read_b128 v[228:231], v13 offset:25088
    s_waitcnt lgkmcnt(6)
    v_pk_add_f32 v[200:201], v[200:201], v[204:205]
    v_pk_add_f32 v[202:203], v[202:203], v[206:207]
    v_pk_add_f32 v[200:201], v[200:201], v[78:79]
    v_pk_add_f32 v[202:203], v[202:203], v[80:81]
    s_waitcnt lgkmcnt(4)
    v_pk_add_f32 v[208:209], v[208:209], v[212:213]
    v_pk_add_f32 v[210:211], v[210:211], v[214:215]
    v_pk_add_f32 v[200:201], v[200:201], v[208:209]
    v_pk_add_f32 v[202:203], v[202:203], v[210:211]
    v_cvt_pk_bf16_f32 v34, v200, v201
    v_cvt_pk_bf16_f32 v35, v202, v203
    s_waitcnt lgkmcnt(2)
    v_pk_add_f32 v[216:217], v[216:217], v[220:221]
    v_pk_add_f32 v[218:219], v[218:219], v[222:223]
    v_pk_add_f32 v[216:217], v[216:217], v[82:83]
    v_pk_add_f32 v[218:219], v[218:219], v[84:85]
    s_waitcnt lgkmcnt(0)
    v_pk_add_f32 v[224:225], v[224:225], v[228:229]
    v_pk_add_f32 v[226:227], v[226:227], v[230:231]
    v_pk_add_f32 v[216:217], v[216:217], v[224:225]
    v_pk_add_f32 v[218:219], v[218:219], v[226:227]
    v_cvt_pk_bf16_f32 v36, v216, v217
    v_cvt_pk_bf16_f32 v37, v218, v219
    global_store_dwordx4 v63, v[34:37], s[20:21]
.EXIT:
    s_endpgm
.hrt_2:
    global_load_dwordx4 v[136:139], v86, s[24:25] sc1
    global_load_dwordx4 v[140:143], v86, s[24:25] offset:1024 sc1
    global_load_dwordx4 v[144:147], v86, s[24:25] offset:2048 sc1
    s_add_u32 s51, s51, 1
    s_waitcnt vmcnt(0)
    s_cmp_lt_u32 s51, s37
    s_cbranch_scc1 .hchk_1
    s_mov_b32 s37, 1
    s_branch .hok_3
.g0_4:
    s_nop 15
    v_mov_b32 v152, v254
    v_mov_b32 v153, v254
    v_mov_b32 v154, v254
    v_mov_b32 v155, v254
    v_mov_b32 v156, v254
    v_mov_b32 v157, v254
    v_mov_b32 v158, v254
    v_mov_b32 v159, v254
    v_mov_b32 v160, v254
    v_mov_b32 v161, v254
    v_mov_b32 v162, v254
    v_mov_b32 v163, v254
    v_mov_b32 v164, v254
    v_mov_b32 v165, v254
    v_mov_b32 v166, v254
    v_mov_b32 v167, v254
    s_branch .g0r_5
.sk_6:
    s_nop 7
    s_nop 0
    s_branch .skr_7
.sk_8:
    s_nop 7
    s_nop 0
    s_branch .skr_9
.sk_10:
    s_nop 7
    s_nop 0
    s_branch .skr_11
.fix_12:
    s_nop 15
    v_mov_b32 v168, v254
    v_mov_b32 v169, v254
    v_mov_b32 v170, v254
    v_mov_b32 v171, v254
    v_mov_b32 v172, v254
    v_mov_b32 v173, v254
    v_mov_b32 v174, v254
    v_mov_b32 v175, v254
    v_mov_b32 v176, v254
    v_mov_b32 v177, v254
    v_mov_b32 v178, v254
    v_mov_b32 v179, v254
    v_mov_b32 v180, v254
    v_mov_b32 v181, v254
    v_mov_b32 v182, v254
    v_mov_b32 v183, v254
    s_nop 3
    s_branch .fixr_13
.fix_14:
    s_nop 15
    v_mov_b32 v168, v254
    v_mov_b32 v169, v254
    v_mov_b32 v170, v254
    v_mov_b32 v171, v254
    v_mov_b32 v172, v254
    v_mov_b32 v173, v254
    v_mov_b32 v174, v254
    v_mov_b32 v175, v254
    v_mov_b32 v176, v254
    v_mov_b32 v177, v254
    v_mov_b32 v178, v254
    v_mov_b32 v179, v254
    v_mov_b32 v180, v254
    v_mov_b32 v181, v254
    v_mov_b32 v182, v254
    v_mov_b32 v183, v254
    s_nop 3
    s_branch .fixr_15
.fix_16:
    s_nop 15
    v_mov_b32 v168, v254
    v_mov_b32 v169, v254
    v_mov_b32 v170, v254
    v_mov_b32 v171, v254
    v_mov_b32 v172, v254
    v_mov_b32 v173, v254
    v_mov_b32 v174, v254
    v_mov_b32 v175, v254
    v_mov_b32 v176, v254
    v_mov_b32 v177, v254
    v_mov_b32 v178, v254
    v_mov_b32 v179, v254
    v_mov_b32 v180, v254
    v_mov_b32 v181, v254
    v_mov_b32 v182, v254
    v_mov_b32 v183, v254
    s_nop 3
    s_branch .fixr_17
.hrt_19:
    global_load_dwordx4 v[120:123], v86, s[24:25] sc1
    global_load_dwordx4 v[124:127], v86, s[24:25] offset:1024 sc1
    global_load_dwordx4 v[128:131], v86, s[24:25] offset:2048 sc1
    s_add_u32 s51, s51, 1
    s_waitcnt vmcnt(0)
    s_cmp_lt_u32 s51, s37
    s_cbranch_scc1 .hchk_18
    s_mov_b32 s37, 1
    s_branch .hok_20
.irt_22:
    global_load_dwordx4 v[148:151], v69, s[24:25] sc1
    s_add_u32 s51, s51, 1
    s_waitcnt vmcnt(0)
    s_cmp_lt_u32 s51, s37
    s_cbranch_scc1 .ichk_21
    s_mov_b32 s37, 1
    s_branch .iok_23
.slow_24:
    s_nop 15
    global_store_dwordx4 v63, v[216:219], s[24:25] sc1
    s_nop 1
    s_branch .sten_25
.sk_26:
    s_nop 7
    s_nop 0
    s_branch .skr_27
.sk_28:
    s_nop 7
    s_nop 0
    s_branch .skr_29
.sk_30:
    s_nop 7
    s_nop 0
    s_branch .skr_31
.sk_32:
    s_nop 7
    s_nop 0
    s_branch .skr_33
.g0_34:
    s_nop 15
    v_mov_b32 v152, v254
    v_mov_b32 v153, v254
    v_mov_b32 v154, v254
    v_mov_b32 v155, v254
    v_mov_b32 v156, v254
    v_mov_b32 v157, v254
    v_mov_b32 v158, v254
    v_mov_b32 v159, v254
    v_mov_b32 v160, v254
    v_mov_b32 v161, v254
    v_mov_b32 v162, v254
    v_mov_b32 v163, v254
    v_mov_b32 v164, v254
    v_mov_b32 v165, v254
    v_mov_b32 v166, v254
    v_mov_b32 v167, v254
    s_branch .g0r_35
.sk_36:
    s_nop 7
    s_nop 0
    s_branch .skr_37
.sk_38:
    s_nop 7
    s_nop 0
    s_branch .skr_39
.sk_40:
    s_nop 7
    s_nop 0
    s_branch .skr_41
.fix_42:
    s_nop 15
    v_mov_b32 v168, v254
    v_mov_b32 v169, v254
    v_mov_b32 v170, v254
    v_mov_b32 v171, v254
    v_mov_b32 v172, v254
    v_mov_b32 v173, v254
    v_mov_b32 v174, v254
    v_mov_b32 v175, v254
    v_mov_b32 v176, v254
    v_mov_b32 v177, v254
    v_mov_b32 v178, v254
    v_mov_b32 v179, v254
    v_mov_b32 v180, v254
    v_mov_b32 v181, v254
    v_mov_b32 v182, v254
    v_mov_b32 v183, v254
    s_nop 3
    s_branch .fixr_43
.crt_44:
    s_mov_b32 s51, 0
.clp_45:
    s_lshl2_add_u32 s44, s28, s96
    s_lshl_b32 s44, s44, 11
    s_add_u32 s44, s44, s32
    s_add_u32 s44, s44, 396288
    v_add_u32 v68, s44, v2
    global_load_dwordx4 v[132:135], v68, s[24:25] offset:-3072 sc1
    global_load_dwordx4 v[136:139], v68, s[24:25] offset:-2048 sc1
    s_lshl2_add_u32 s44, s28, s97
    s_lshl_b32 s44, s44, 11
    s_add_u32 s44, s44, s32
    s_add_u32 s44, s44, 396288
    v_add_u32 v68, s44, v2
    global_load_dwordx4 v[140:143], v68, s[24:25] offset:-3072 sc1
    global_load_dwordx4 v[144:147], v68, s[24:25] offset:-2048 sc1
    s_lshl2_add_u32 s44, s28, s98
    s_lshl_b32 s44, s44, 11
    s_add_u32 s44, s44, s32
    s_add_u32 s44, s44, 396288
    v_add_u32 v68, s44, v2
    global_load_dwordx4 v[120:123], v68, s[24:25] offset:-3072 sc1
    global_load_dwordx4 v[124:127], v68, s[24:25] offset:-2048 sc1
    s_lshl2_add_u32 s44, s28, s99
    s_lshl_b32 s44, s44, 11
    s_add_u32 s44, s44, s32
    s_add_u32 s44, s44, 396288
    v_add_u32 v68, s44, v2
    global_load_dwordx4 v[128:131], v68, s[24:25] offset:-3072 sc1
    global_load_dwordx4 v[148:151], v68, s[24:25] offset:-2048 sc1
    s_add_u32 s51, s51, 1
    s_waitcnt vmcnt(0)
    v_bitop3_b32 v67, v132, v136, v140 bitop3:0x80
    v_bitop3_b32 v67, v67, v144, 1 bitop3:0x80
    v_cmp_eq_u32 vcc, 0, v67
    s_cbranch_vccz .cok_46
    s_cmp_lt_u32 s51, s37
    s_cbranch_scc1 .clp_45
    s_mov_b32 s37, 1
    s_branch .cok_46
.crt_47:
    s_mov_b32 s51, 0
.clp_48:
    s_lshl2_add_u32 s44, s28, s98
    s_lshl_b32 s44, s44, 11
    s_add_u32 s44, s44, s32
    s_add_u32 s44, s44, 396288
    v_add_u32 v68, s44, v2
    global_load_dwordx4 v[120:123], v68, s[24:25] offset:-3072 sc1
    global_load_dwordx4 v[124:127], v68, s[24:25] offset:-2048 sc1
    s_lshl2_add_u32 s44, s28, s99
    s_lshl_b32 s44, s44, 11
    s_add_u32 s44, s44, s32
    s_add_u32 s44, s44, 396288
    v_add_u32 v68, s44, v2
    global_load_dwordx4 v[128:131], v68, s[24:25] offset:-3072 sc1
    global_load_dwordx4 v[148:151], v68, s[24:25] offset:-2048 sc1
    s_lshl2_add_u32 s44, s28, s96
    s_lshl_b32 s44, s44, 11
    s_add_u32 s44, s44, s32
    s_add_u32 s44, s44, 396288
    v_add_u32 v68, s44, v2
    global_load_dwordx4 v[132:135], v68, s[24:25] offset:-3072 sc1
    global_load_dwordx4 v[136:139], v68, s[24:25] offset:-2048 sc1
    s_lshl2_add_u32 s44, s28, s97
    s_lshl_b32 s44, s44, 11
    s_add_u32 s44, s44, s32
    s_add_u32 s44, s44, 396288
    v_add_u32 v68, s44, v2
    global_load_dwordx4 v[140:143], v68, s[24:25] offset:-3072 sc1
    global_load_dwordx4 v[144:147], v68, s[24:25] offset:-2048 sc1
    s_add_u32 s51, s51, 1
    s_waitcnt vmcnt(0)
    v_bitop3_b32 v67, v120, v124, v128 bitop3:0x80
    v_bitop3_b32 v67, v67, v148, 1 bitop3:0x80
    v_cmp_eq_u32 vcc, 0, v67
    s_cbranch_vccz .cok_49
    s_cmp_lt_u32 s51, s37
    s_cbranch_scc1 .clp_48
    s_mov_b32 s37, 1
    s_branch .cok_49
.fix_50:
    s_nop 15
    v_mov_b32 v168, v254
    v_mov_b32 v169, v254
    v_mov_b32 v170, v254
    v_mov_b32 v171, v254
    v_mov_b32 v172, v254
    v_mov_b32 v173, v254
    v_mov_b32 v174, v254
    v_mov_b32 v175, v254
    v_mov_b32 v176, v254
    v_mov_b32 v177, v254
    v_mov_b32 v178, v254
    v_mov_b32 v179, v254
    v_mov_b32 v180, v254
    v_mov_b32 v181, v254
    v_mov_b32 v182, v254
    v_mov_b32 v183, v254
    s_nop 3
    s_branch .fixr_51
.fix_52:
    s_nop 15
    v_mov_b32 v168, v254
    v_mov_b32 v169, v254
    v_mov_b32 v170, v254
    v_mov_b32 v171, v254
    v_mov_b32 v172, v254
    v_mov_b32 v173, v254
    v_mov_b32 v174, v254
    v_mov_b32 v175, v254
    v_mov_b32 v176, v254
    v_mov_b32 v177, v254
    v_mov_b32 v178, v254
    v_mov_b32 v179, v254
    v_mov_b32 v180, v254
    v_mov_b32 v181, v254
    v_mov_b32 v182, v254
    v_mov_b32 v183, v254
    s_nop 3
    s_branch .fixr_53
.fix_54:
    s_nop 15
    v_mov_b32 v168, v254
    v_mov_b32 v169, v254
    v_mov_b32 v170, v254
    v_mov_b32 v171, v254
    v_mov_b32 v172, v254
    v_mov_b32 v173, v254
    v_mov_b32 v174, v254
    v_mov_b32 v175, v254
    v_mov_b32 v176, v254
    v_mov_b32 v177, v254
    v_mov_b32 v178, v254
    v_mov_b32 v179, v254
    v_mov_b32 v180, v254
    v_mov_b32 v181, v254
    v_mov_b32 v182, v254
    v_mov_b32 v183, v254
    s_nop 3
    s_branch .fixr_55
.fix_56:
    s_nop 15
    v_mov_b32 v168, v254
    v_mov_b32 v169, v254
    v_mov_b32 v170, v254
    v_mov_b32 v171, v254
    v_mov_b32 v172, v254
    v_mov_b32 v173, v254
    v_mov_b32 v174, v254
    v_mov_b32 v175, v254
    v_mov_b32 v176, v254
    v_mov_b32 v177, v254
    v_mov_b32 v178, v254
    v_mov_b32 v179, v254
    v_mov_b32 v180, v254
    v_mov_b32 v181, v254
    v_mov_b32 v182, v254
    v_mov_b32 v183, v254
    s_nop 3
    s_branch .fixr_57
.slow_58:
    s_nop 15
    global_store_dwordx4 v63, v[30:33], s[24:25] sc1
    s_nop 1
    s_branch .sten_59
.slow_60:
    s_nop 15
    global_store_dword v64, v124, s[24:25] sc1
    s_nop 1
    s_branch .sten_61
.fix_62:
    s_nop 15
    v_mov_b32 v168, v254
    v_mov_b32 v169, v254
    v_mov_b32 v170, v254
    v_mov_b32 v171, v254
    v_mov_b32 v172, v254
    v_mov_b32 v173, v254
    v_mov_b32 v174, v254
    v_mov_b32 v175, v254
    v_mov_b32 v176, v254
    v_mov_b32 v177, v254
    v_mov_b32 v178, v254
    v_mov_b32 v179, v254
    v_mov_b32 v180, v254
    v_mov_b32 v181, v254
    v_mov_b32 v182, v254
    v_mov_b32 v183, v254
    s_nop 3
    s_branch .fixr_63
.fix_64:
    s_nop 15
    v_mov_b32 v168, v254
    v_mov_b32 v169, v254
    v_mov_b32 v170, v254
    v_mov_b32 v171, v254
    v_mov_b32 v172, v254
    v_mov_b32 v173, v254
    v_mov_b32 v174, v254
    v_mov_b32 v175, v254
    v_mov_b32 v176, v254
    v_mov_b32 v177, v254
    v_mov_b32 v178, v254
    v_mov_b32 v179, v254
    v_mov_b32 v180, v254
    v_mov_b32 v181, v254
    v_mov_b32 v182, v254
    v_mov_b32 v183, v254
    s_nop 3
    s_branch .fixr_65
.slow_66:
    s_nop 15
    global_store_dwordx4 v63, v[216:219], s[24:25] sc1
    s_nop 1
    s_branch .sten_67
.crt_68:
    s_mov_b32 s51, 0
.clp_69:
    s_add_u32 s44, s62, s58
    s_add_u32 s44, s44, 135168
    v_add_u32 v68, s44, v2
    global_load_dwordx4 v[132:135], v68, s[24:25] offset:-4096 sc1
    global_load_dwordx4 v[136:139], v68, s[24:25] offset:-3072 sc1
    global_load_dwordx4 v[140:143], v68, s[24:25] offset:-2048 sc1
    global_load_dwordx4 v[144:147], v68, s[24:25] offset:-1024 sc1
    global_load_dwordx4 v[120:123], v68, s[24:25] offset:0 sc1
    global_load_dwordx4 v[124:127], v68, s[24:25] offset:1024 sc1
    global_load_dwordx4 v[128:131], v68, s[24:25] offset:2048 sc1
    global_load_dwordx4 v[148:151], v68, s[24:25] offset:3072 sc1
    s_add_u32 s44, s62, s59
    s_add_u32 s44, s44, 135168
    v_add_u32 v68, s44, v2
    global_load_dwordx4 v[152:155], v68, s[24:25] offset:-4096 sc1
    global_load_dwordx4 v[156:159], v68, s[24:25] offset:-3072 sc1
    global_load_dwordx4 v[160:163], v68, s[24:25] offset:-2048 sc1
    global_load_dwordx4 v[164:167], v68, s[24:25] offset:-1024 sc1
    s_add_u32 s51, s51, 1
    s_waitcnt vmcnt(0)
    v_bitop3_b32 v67, v132, v136, v140 bitop3:0x80
    v_bitop3_b32 v67, v67, v144, 1 bitop3:0x80
    v_cmp_eq_u32 vcc, 0, v67
    s_cbranch_vccz .cok_70
    s_cmp_lt_u32 s51, s37
    s_cbranch_scc1 .clp_69
    s_mov_b32 s37, 1
    s_branch .cok_70
.crt_75:
    s_mov_b32 s51, 0
.clp_76:
    s_add_u32 s44, s62, s58
    s_add_u32 s44, s44, 135168
    v_add_u32 v68, s44, v2
    global_load_dwordx4 v[120:123], v68, s[24:25] offset:0 sc1
    global_load_dwordx4 v[124:127], v68, s[24:25] offset:1024 sc1
    global_load_dwordx4 v[128:131], v68, s[24:25] offset:2048 sc1
    global_load_dwordx4 v[148:151], v68, s[24:25] offset:3072 sc1
    s_add_u32 s44, s62, s59
    s_add_u32 s44, s44, 135168
    v_add_u32 v68, s44, v2
    global_load_dwordx4 v[152:155], v68, s[24:25] offset:-4096 sc1
    global_load_dwordx4 v[156:159], v68, s[24:25] offset:-3072 sc1
    global_load_dwordx4 v[160:163], v68, s[24:25] offset:-2048 sc1
    global_load_dwordx4 v[164:167], v68, s[24:25] offset:-1024 sc1
    global_load_dwordx4 v[132:135], v68, s[24:25] offset:0 sc1
    global_load_dwordx4 v[136:139], v68, s[24:25] offset:1024 sc1
    s_add_u32 s44, s36, s34
    s_add_u32 s44, s44, 0x148000
    v_add_u32 v68, s44, v2
    global_load_dwordx4 v[140:143], v68, s[24:25] offset:0 sc1
    global_load_dwordx4 v[144:147], v68, s[24:25] offset:1024 sc1
    s_add_u32 s51, s51, 1
    s_waitcnt vmcnt(0)
    v_bitop3_b32 v67, v120, v124, v128 bitop3:0x80
    v_bitop3_b32 v67, v67, v148, 1 bitop3:0x80
    v_cmp_eq_u32 vcc, 0, v67
    s_cbranch_vccz .cok_77
    s_cmp_lt_u32 s51, s37
    s_cbranch_scc1 .clp_76
    s_mov_b32 s37, 1
    s_branch .cok_77
.crt_82:
    s_mov_b32 s51, 0
.clp_83:
    s_add_u32 s44, s62, s59
    s_add_u32 s44, s44, 135168
    v_add_u32 v68, s44, v2
    global_load_dwordx4 v[152:155], v68, s[24:25] offset:-4096 sc1
    global_load_dwordx4 v[156:159], v68, s[24:25] offset:-3072 sc1
    global_load_dwordx4 v[160:163], v68, s[24:25] offset:-2048 sc1
    global_load_dwordx4 v[164:167], v68, s[24:25] offset:-1024 sc1
    global_load_dwordx4 v[132:135], v68, s[24:25] offset:0 sc1
    global_load_dwordx4 v[136:139], v68, s[24:25] offset:1024 sc1
    s_add_u32 s44, s36, s34
    s_add_u32 s44, s44, 0x148000
    v_add_u32 v68, s44, v2
    global_load_dwordx4 v[140:143], v68, s[24:25] offset:0 sc1
    global_load_dwordx4 v[144:147], v68, s[24:25] offset:1024 sc1
    s_add_u32 s44, s62, s59
    s_add_u32 s44, s44, 135168
    v_add_u32 v68, s44, v2
    global_load_dwordx4 v[120:123], v68, s[24:25] offset:2048 sc1
    global_load_dwordx4 v[124:127], v68, s[24:25] offset:3072 sc1
    s_add_u32 s44, s62, s60
    s_add_u32 s44, s44, 135168
    v_add_u32 v68, s44, v2
    global_load_dwordx4 v[128:131], v68, s[24:25] offset:-4096 sc1
    global_load_dwordx4 v[148:151], v68, s[24:25] offset:-3072 sc1
    s_add_u32 s51, s51, 1
    s_waitcnt vmcnt(0)
    v_bitop3_b32 v67, v152, v156, v160 bitop3:0x80
    v_bitop3_b32 v67, v67, v164, 1 bitop3:0x80
    v_cmp_eq_u32 vcc, 0, v67
    s_cbranch_vccz .cok_84
    s_cmp_lt_u32 s51, s37
    s_cbranch_scc1 .clp_83
    s_mov_b32 s37, 1
    s_branch .cok_84
.crt_89:
    s_mov_b32 s51, 0
.clp_90:
    s_add_u32 s44, s62, s59
    s_add_u32 s44, s44, 135168
    v_add_u32 v68, s44, v2
    global_load_dwordx4 v[132:135], v68, s[24:25] offset:0 sc1
    global_load_dwordx4 v[136:139], v68, s[24:25] offset:1024 sc1
    global_load_dwordx4 v[120:123], v68, s[24:25] offset:2048 sc1
    global_load_dwordx4 v[124:127], v68, s[24:25] offset:3072 sc1
    s_add_u32 s44, s36, s34
    s_add_u32 s44, s44, 0x148000
    v_add_u32 v68, s44, v2
    global_load_dwordx4 v[140:143], v68, s[24:25] offset:0 sc1
    global_load_dwordx4 v[144:147], v68, s[24:25] offset:1024 sc1
    s_add_u32 s44, s62, s60
    s_add_u32 s44, s44, 135168
    v_add_u32 v68, s44, v2
    global_load_dwordx4 v[128:131], v68, s[24:25] offset:-4096 sc1
    global_load_dwordx4 v[148:151], v68, s[24:25] offset:-3072 sc1
    s_add_u32 s51, s51, 1
    s_waitcnt vmcnt(0)
    v_bitop3_b32 v67, v132, v136, v120 bitop3:0x80
    v_bitop3_b32 v67, v67, v124, 1 bitop3:0x80
    v_cmp_eq_u32 vcc, 0, v67
    s_cbranch_vccz .cok_91
    s_cmp_lt_u32 s51, s37
    s_cbranch_scc1 .clp_90
    s_mov_b32 s37, 1
    s_branch .cok_91
.crt_95:
    s_mov_b32 s51, 0
.clp_96:
    s_lshl2_add_u32 s44, s28, s96
    s_lshl_b32 s44, s44, 11
    s_add_u32 s44, s44, s32
    s_add_u32 s44, s44, 265216
    v_add_u32 v68, s44, v2
    global_load_dwordx4 v[152:155], v68, s[24:25] offset:-3072 sc1
    global_load_dwordx4 v[156:159], v68, s[24:25] offset:-2048 sc1
    s_lshl2_add_u32 s44, s28, s97
    s_lshl_b32 s44, s44, 11
    s_add_u32 s44, s44, s32
    s_add_u32 s44, s44, 265216
    v_add_u32 v68, s44, v2
    global_load_dwordx4 v[160:163], v68, s[24:25] offset:-3072 sc1
    global_load_dwordx4 v[164:167], v68, s[24:25] offset:-2048 sc1
    s_lshl2_add_u32 s44, s28, s98
    s_lshl_b32 s44, s44, 11
    s_add_u32 s44, s44, s32
    s_add_u32 s44, s44, 265216
    v_add_u32 v68, s44, v2
    global_load_dwordx4 v[120:123], v68, s[24:25] offset:-3072 sc1
    s_add_u32 s51, s51, 1
    s_waitcnt vmcnt(0)
    v_bitop3_b32 v67, v152, v156, v160 bitop3:0x80
    v_bitop3_b32 v67, v67, v164, 1 bitop3:0x80
    v_cmp_eq_u32 vcc, 0, v67
    s_cbranch_vccz .cok_97
    s_cmp_lt_u32 s51, s37
    s_cbranch_scc1 .clp_96
    s_mov_b32 s37, 1
    s_branch .cok_97
.crt_98:
    s_mov_b32 s51, 0
.clp_99:
    s_add_u32 s44, s36, s34
    s_add_u32 s44, s44, 0x148000
    v_add_u32 v68, s44, v2
    global_load_dwordx4 v[140:143], v68, s[24:25] offset:0 sc1
    global_load_dwordx4 v[144:147], v68, s[24:25] offset:1024 sc1
    s_add_u32 s44, s62, s59
    s_add_u32 s44, s44, 135168
    v_add_u32 v68, s44, v2
    global_load_dwordx4 v[124:127], v68, s[24:25] offset:3072 sc1
    s_add_u32 s44, s62, s60
    s_add_u32 s44, s44, 135168
    v_add_u32 v68, s44, v2
    global_load_dwordx4 v[128:131], v68, s[24:25] offset:-4096 sc1
    global_load_dwordx4 v[148:151], v68, s[24:25] offset:-3072 sc1
    global_load_dwordx4 v[132:135], v68, s[24:25] offset:-2048 sc1
    global_load_dwordx4 v[136:139], v68, s[24:25] offset:-1024 sc1
    s_add_u32 s51, s51, 1
    s_waitcnt vmcnt(0)
    v_bitop3_b32 v67, v140, v141, v142 bitop3:0x80
    v_bitop3_b32 v67, v67, v143, v144 bitop3:0x80
    v_bitop3_b32 v67, v67, v145, v146 bitop3:0x80
    v_bitop3_b32 v67, v67, v147, 1 bitop3:0x80
    v_cmp_eq_u32 vcc, 0, v67
    s_cbranch_vccz .cok_100
    s_cmp_lt_u32 s51, s37
    s_cbranch_scc1 .clp_99
    s_mov_b32 s37, 1
    s_branch .cok_100
.crt_102:
    s_mov_b32 s51, 0
.clp_103:
    s_add_u32 s44, s62, s60
    s_add_u32 s44, s44, 135168
    v_add_u32 v68, s44, v2
    global_load_dwordx4 v[128:131], v68, s[24:25] offset:-4096 sc1
    global_load_dwordx4 v[148:151], v68, s[24:25] offset:-3072 sc1
    global_load_dwordx4 v[132:135], v68, s[24:25] offset:-2048 sc1
    global_load_dwordx4 v[136:139], v68, s[24:25] offset:-1024 sc1
    global_load_dwordx4 v[124:127], v68, s[24:25] offset:0 sc1
    s_add_u32 s51, s51, 1
    s_waitcnt vmcnt(0)
    v_bitop3_b32 v67, v128, v148, v132 bitop3:0x80
    v_bitop3_b32 v67, v67, v136, 1 bitop3:0x80
    v_cmp_eq_u32 vcc, 0, v67
    s_cbranch_vccz .cok_104
    s_cmp_lt_u32 s51, s37
    s_cbranch_scc1 .clp_103
    s_mov_b32 s37, 1
    s_branch .cok_104
.crt_106:
    s_mov_b32 s51, 0
.clp_107:
    s_lshl2_add_u32 s44, s28, s98
    s_lshl_b32 s44, s44, 11
    s_add_u32 s44, s44, s32
    s_add_u32 s44, s44, 265216
    v_add_u32 v68, s44, v2
    global_load_dwordx4 v[120:123], v68, s[24:25] offset:-3072 sc1
    global_load_dwordx4 v[152:155], v68, s[24:25] offset:-2048 sc1
    s_lshl2_add_u32 s44, s28, s99
    s_lshl_b32 s44, s44, 11
    s_add_u32 s44, s44, s32
    s_add_u32 s44, s44, 265216
    v_add_u32 v68, s44, v2
    global_load_dwordx4 v[140:143], v68, s[24:25] offset:-3072 sc1
    global_load_dwordx4 v[144:147], v68, s[24:25] offset:-2048 sc1
    s_add_u32 s51, s51, 1
    s_waitcnt vmcnt(0)
    v_bitop3_b32 v67, v120, v152, v140 bitop3:0x80
    v_bitop3_b32 v67, v67, v144, 1 bitop3:0x80
    v_cmp_eq_u32 vcc, 0, v67
    s_cbranch_vccz .cok_108
    s_cmp_lt_u32 s51, s37
    s_cbranch_scc1 .clp_107
    s_mov_b32 s37, 1
    s_branch .cok_108
.crt_112:
    s_mov_b32 s51, 0
.clp_113:
    s_add_u32 s44, s62, s60
    s_add_u32 s44, s44, 135168
    v_add_u32 v68, s44, v2
    global_load_dwordx4 v[124:127], v68, s[24:25] offset:0 sc1
    global_load_dwordx4 v[156:159], v68, s[24:25] offset:1024 sc1
    global_load_dwordx4 v[160:163], v68, s[24:25] offset:2048 sc1
    global_load_dwordx4 v[128:131], v68, s[24:25] offset:3072 sc1
    s_add_u32 s44, s62, s61
    s_add_u32 s44, s44, 135168
    v_add_u32 v68, s44, v2
    global_load_dwordx4 v[164:167], v68, s[24:25] offset:-4096 sc1
    global_load_dwordx4 v[148:151], v68, s[24:25] offset:-3072 sc1
    global_load_dwordx4 v[120:123], v68, s[24:25] offset:-2048 sc1
    global_load_dwordx4 v[152:155], v68, s[24:25] offset:-1024 sc1
    global_load_dwordx4 v[132:135], v68, s[24:25] offset:0 sc1
    global_load_dwordx4 v[140:143], v68, s[24:25] offset:1024 sc1
    global_load_dwordx4 v[144:147], v68, s[24:25] offset:2048 sc1
    global_load_dwordx4 v[136:139], v68, s[24:25] offset:3072 sc1
    s_add_u32 s51, s51, 1
    s_waitcnt vmcnt(0)
    v_bitop3_b32 v67, v124, v156, v160 bitop3:0x80
    v_bitop3_b32 v67, v67, v128, 1 bitop3:0x80
    v_cmp_eq_u32 vcc, 0, v67
    s_cbranch_vccz .cok_114
    s_cmp_lt_u32 s51, s37
    s_cbranch_scc1 .clp_113
    s_mov_b32 s37, 1
    s_branch .cok_114
.crt_119:
    s_mov_b32 s51, 0
.clp_120:
    s_add_u32 s44, s62, s61
    s_add_u32 s44, s44, 135168
    v_add_u32 v68, s44, v2
    global_load_dwordx4 v[164:167], v68, s[24:25] offset:-4096 sc1
    global_load_dwordx4 v[148:151], v68, s[24:25] offset:-3072 sc1
    global_load_dwordx4 v[120:123], v68, s[24:25] offset:-2048 sc1
    global_load_dwordx4 v[152:155], v68, s[24:25] offset:-1024 sc1
    global_load_dwordx4 v[132:135], v68, s[24:25] offset:0 sc1
    global_load_dwordx4 v[140:143], v68, s[24:25] offset:1024 sc1
    global_load_dwordx4 v[144:147], v68, s[24:25] offset:2048 sc1
    global_load_dwordx4 v[136:139], v68, s[24:25] offset:3072 sc1
    s_add_u32 s51, s51, 1
    s_waitcnt vmcnt(0)
    v_bitop3_b32 v67, v164, v148, v120 bitop3:0x80
    v_bitop3_b32 v67, v67, v152, 1 bitop3:0x80
    v_cmp_eq_u32 vcc, 0, v67
    s_cbranch_vccz .cok_121
    s_cmp_lt_u32 s51, s37
    s_cbranch_scc1 .clp_120
    s_mov_b32 s37, 1
    s_branch .cok_121
.slow_125:
    s_nop 15
    global_store_dwordx4 v63, v[34:37], s[24:25] sc1
    s_nop 1
    s_branch .sten_126
.crt_128:
    s_mov_b32 s51, 0
.clp_129:
    s_add_u32 s44, s62, s61
    s_add_u32 s44, s44, 135168
    v_add_u32 v68, s44, v2
    global_load_dwordx4 v[132:135], v68, s[24:25] offset:0 sc1
    global_load_dwordx4 v[140:143], v68, s[24:25] offset:1024 sc1
    global_load_dwordx4 v[144:147], v68, s[24:25] offset:2048 sc1
    global_load_dwordx4 v[136:139], v68, s[24:25] offset:3072 sc1
    s_add_u32 s51, s51, 1
    s_waitcnt vmcnt(0)
    v_bitop3_b32 v67, v132, v140, v144 bitop3:0x80
    v_bitop3_b32 v67, v67, v136, 1 bitop3:0x80
    v_cmp_eq_u32 vcc, 0, v67
    s_cbranch_vccz .cok_130
    s_cmp_lt_u32 s51, s37
    s_cbranch_scc1 .clp_129
    s_mov_b32 s37, 1
    s_branch .cok_130
.slow_132:
    s_nop 15
    global_store_dword v64, v204, s[24:25] sc1
    s_nop 1
    s_branch .sten_133
.crt_137:
    s_mov_b32 s51, 0
.clp_138:
    s_add_u32 s44, s62, s58
    s_add_u32 s44, s44, 4096
    v_add_u32 v68, s44, v2
    global_load_dwordx4 v[124:127], v68, s[24:25] offset:-4096 sc1
    global_load_dwordx4 v[156:159], v68, s[24:25] offset:-3072 sc1
    global_load_dwordx4 v[160:163], v68, s[24:25] offset:-2048 sc1
    global_load_dwordx4 v[128:131], v68, s[24:25] offset:-1024 sc1
    global_load_dwordx4 v[164:167], v68, s[24:25] offset:0 sc1
    global_load_dwordx4 v[148:151], v68, s[24:25] offset:1024 sc1
    global_load_dwordx4 v[120:123], v68, s[24:25] offset:2048 sc1
    global_load_dwordx4 v[152:155], v68, s[24:25] offset:3072 sc1
    s_add_u32 s44, s62, s59
    s_add_u32 s44, s44, 4096
    v_add_u32 v68, s44, v2
    global_load_dwordx4 v[132:135], v68, s[24:25] offset:-4096 sc1
    global_load_dwordx4 v[140:143], v68, s[24:25] offset:-3072 sc1
    global_load_dwordx4 v[144:147], v68, s[24:25] offset:-2048 sc1
    global_load_dwordx4 v[136:139], v68, s[24:25] offset:-1024 sc1
    s_add_u32 s51, s51, 1
    s_waitcnt vmcnt(0)
    v_bitop3_b32 v67, v124, v156, v160 bitop3:0x80
    v_bitop3_b32 v67, v67, v128, 1 bitop3:0x80
    v_cmp_eq_u32 vcc, 0, v67
    s_cbranch_vccz .cok_139
    s_cmp_lt_u32 s51, s37
    s_cbranch_scc1 .clp_138
    s_mov_b32 s37, 1
    s_branch .cok_139
.crt_140:
    s_mov_b32 s51, 0
.clp_141:
    s_add_u32 s44, s62, s58
    s_add_u32 s44, s44, 4096
    v_add_u32 v68, s44, v2
    global_load_dwordx4 v[164:167], v68, s[24:25] offset:0 sc1
    global_load_dwordx4 v[148:151], v68, s[24:25] offset:1024 sc1
    global_load_dwordx4 v[120:123], v68, s[24:25] offset:2048 sc1
    global_load_dwordx4 v[152:155], v68, s[24:25] offset:3072 sc1
    s_add_u32 s44, s62, s59
    s_add_u32 s44, s44, 4096
    v_add_u32 v68, s44, v2
    global_load_dwordx4 v[132:135], v68, s[24:25] offset:-4096 sc1
    global_load_dwordx4 v[140:143], v68, s[24:25] offset:-3072 sc1
    global_load_dwordx4 v[144:147], v68, s[24:25] offset:-2048 sc1
    global_load_dwordx4 v[136:139], v68, s[24:25] offset:-1024 sc1
    global_load_dwordx4 v[124:127], v68, s[24:25] offset:0 sc1
    global_load_dwordx4 v[156:159], v68, s[24:25] offset:1024 sc1
    s_add_u32 s44, s36, s34
    s_add_u32 s44, s44, 0x146000
    v_add_u32 v68, s44, v2
    global_load_dwordx4 v[160:163], v68, s[24:25] offset:0 sc1
    global_load_dwordx4 v[128:131], v68, s[24:25] offset:1024 sc1
    s_add_u32 s51, s51, 1
    s_waitcnt vmcnt(0)
    v_bitop3_b32 v67, v164, v148, v120 bitop3:0x80
    v_bitop3_b32 v67, v67, v152, 1 bitop3:0x80
    v_cmp_eq_u32 vcc, 0, v67
    s_cbranch_vccz .cok_142
    s_cmp_lt_u32 s51, s37
    s_cbranch_scc1 .clp_141
    s_mov_b32 s37, 1
    s_branch .cok_142
.crt_143:
    s_mov_b32 s51, 0
.clp_144:
    s_add_u32 s44, s62, s59
    s_add_u32 s44, s44, 4096
    v_add_u32 v68, s44, v2
    global_load_dwordx4 v[132:135], v68, s[24:25] offset:-4096 sc1
    global_load_dwordx4 v[140:143], v68, s[24:25] offset:-3072 sc1
    global_load_dwordx4 v[144:147], v68, s[24:25] offset:-2048 sc1
    global_load_dwordx4 v[136:139], v68, s[24:25] offset:-1024 sc1
    global_load_dwordx4 v[124:127], v68, s[24:25] offset:0 sc1
    global_load_dwordx4 v[156:159], v68, s[24:25] offset:1024 sc1
    s_add_u32 s44, s36, s34
    s_add_u32 s44, s44, 0x146000
    v_add_u32 v68, s44, v2
    global_load_dwordx4 v[160:163], v68, s[24:25] offset:0 sc1
    global_load_dwordx4 v[128:131], v68, s[24:25] offset:1024 sc1
    s_add_u32 s44, s62, s59
    s_add_u32 s44, s44, 4096
    v_add_u32 v68, s44, v2
    global_load_dwordx4 v[164:167], v68, s[24:25] offset:2048 sc1
    global_load_dwordx4 v[148:151], v68, s[24:25] offset:3072 sc1
    s_add_u32 s44, s62, s60
    s_add_u32 s44, s44, 4096
    v_add_u32 v68, s44, v2
    global_load_dwordx4 v[120:123], v68, s[24:25] offset:-4096 sc1
    global_load_dwordx4 v[152:155], v68, s[24:25] offset:-3072 sc1
    s_add_u32 s51, s51, 1
    s_waitcnt vmcnt(0)
    v_bitop3_b32 v67, v132, v140, v144 bitop3:0x80
    v_bitop3_b32 v67, v67, v136, 1 bitop3:0x80
    v_cmp_eq_u32 vcc, 0, v67
    s_cbranch_vccz .cok_145
    s_cmp_lt_u32 s51, s37
    s_cbranch_scc1 .clp_144
    s_mov_b32 s37, 1
    s_branch .cok_145
.crt_146:
    s_mov_b32 s51, 0
.clp_147:
    s_add_u32 s44, s62, s59
    s_add_u32 s44, s44, 4096
    v_add_u32 v68, s44, v2
    global_load_dwordx4 v[124:127], v68, s[24:25] offset:0 sc1
    global_load_dwordx4 v[156:159], v68, s[24:25] offset:1024 sc1
    global_load_dwordx4 v[164:167], v68, s[24:25] offset:2048 sc1
    global_load_dwordx4 v[148:151], v68, s[24:25] offset:3072 sc1
    s_add_u32 s44, s36, s34
    s_add_u32 s44, s44, 0x146000
    v_add_u32 v68, s44, v2
    global_load_dwordx4 v[160:163], v68, s[24:25] offset:0 sc1
    global_load_dwordx4 v[128:131], v68, s[24:25] offset:1024 sc1
    s_add_u32 s44, s62, s60
    s_add_u32 s44, s44, 4096
    v_add_u32 v68, s44, v2
    global_load_dwordx4 v[120:123], v68, s[24:25] offset:-4096 sc1
    global_load_dwordx4 v[152:155], v68, s[24:25] offset:-3072 sc1
    global_load_dwordx4 v[132:135], v68, s[24:25] offset:-2048 sc1
    global_load_dwordx4 v[140:143], v68, s[24:25] offset:-1024 sc1
    global_load_dwordx4 v[144:147], v68, s[24:25] offset:0 sc1
    global_load_dwordx4 v[136:139], v68, s[24:25] offset:1024 sc1
    s_add_u32 s51, s51, 1
    s_waitcnt vmcnt(0)
    v_bitop3_b32 v67, v124, v156, v164 bitop3:0x80
    v_bitop3_b32 v67, v67, v148, 1 bitop3:0x80
    v_cmp_eq_u32 vcc, 0, v67
    s_cbranch_vccz .cok_148
    s_cmp_lt_u32 s51, s37
    s_cbranch_scc1 .clp_147
    s_mov_b32 s37, 1
    s_branch .cok_148
.crt_149:
    s_mov_b32 s51, 0
.clp_150:
    s_add_u32 s44, s36, s34
    s_add_u32 s44, s44, 0x146000
    v_add_u32 v68, s44, v2
    global_load_dwordx4 v[160:163], v68, s[24:25] offset:0 sc1
    global_load_dwordx4 v[128:131], v68, s[24:25] offset:1024 sc1
    s_add_u32 s44, s62, s59
    s_add_u32 s44, s44, 4096
    v_add_u32 v68, s44, v2
    global_load_dwordx4 v[148:151], v68, s[24:25] offset:3072 sc1
    s_add_u32 s44, s62, s60
    s_add_u32 s44, s44, 4096
    v_add_u32 v68, s44, v2
    global_load_dwordx4 v[120:123], v68, s[24:25] offset:-4096 sc1
    global_load_dwordx4 v[152:155], v68, s[24:25] offset:-3072 sc1
    global_load_dwordx4 v[132:135], v68, s[24:25] offset:-2048 sc1
    global_load_dwordx4 v[140:143], v68, s[24:25] offset:-1024 sc1
    global_load_dwordx4 v[144:147], v68, s[24:25] offset:0 sc1
    global_load_dwordx4 v[136:139], v68, s[24:25] offset:1024 sc1
    global_load_dwordx4 v[124:127], v68, s[24:25] offset:2048 sc1
    global_load_dwordx4 v[156:159], v68, s[24:25] offset:3072 sc1
    s_add_u32 s44, s62, s61
    s_add_u32 s44, s44, 4096
    v_add_u32 v68, s44, v2
    global_load_dwordx4 v[164:167], v68, s[24:25] offset:-4096 sc1
    s_add_u32 s51, s51, 1
    s_waitcnt vmcnt(0)
    v_bitop3_b32 v67, v160, v161, v162 bitop3:0x80
    v_bitop3_b32 v67, v67, v163, v128 bitop3:0x80
    v_bitop3_b32 v67, v67, v129, v130 bitop3:0x80
    v_bitop3_b32 v67, v67, v131, 1 bitop3:0x80
    v_cmp_eq_u32 vcc, 0, v67
    s_cbranch_vccz .cok_151
    s_cmp_lt_u32 s51, s37
    s_cbranch_scc1 .clp_150
    s_mov_b32 s37, 1
    s_branch .cok_151
.crt_152:
    s_mov_b32 s51, 0
.clp_153:
    s_add_u32 s44, s62, s60
    s_add_u32 s44, s44, 4096
    v_add_u32 v68, s44, v2
    global_load_dwordx4 v[120:123], v68, s[24:25] offset:-4096 sc1
    global_load_dwordx4 v[152:155], v68, s[24:25] offset:-3072 sc1
    global_load_dwordx4 v[132:135], v68, s[24:25] offset:-2048 sc1
    global_load_dwordx4 v[140:143], v68, s[24:25] offset:-1024 sc1
    global_load_dwordx4 v[144:147], v68, s[24:25] offset:0 sc1
    global_load_dwordx4 v[136:139], v68, s[24:25] offset:1024 sc1
    global_load_dwordx4 v[124:127], v68, s[24:25] offset:2048 sc1
    global_load_dwordx4 v[156:159], v68, s[24:25] offset:3072 sc1
    s_add_u32 s44, s62, s61
    s_add_u32 s44, s44, 4096
    v_add_u32 v68, s44, v2
    global_load_dwordx4 v[164:167], v68, s[24:25] offset:-4096 sc1
    global_load_dwordx4 v[160:163], v68, s[24:25] offset:-3072 sc1
    s_add_u32 s51, s51, 1
    s_waitcnt vmcnt(0)
    v_bitop3_b32 v67, v120, v152, v132 bitop3:0x80
    v_bitop3_b32 v67, v67, v140, 1 bitop3:0x80
    v_cmp_eq_u32 vcc, 0, v67
    s_cbranch_vccz .cok_154
    s_cmp_lt_u32 s51, s37
    s_cbranch_scc1 .clp_153
    s_mov_b32 s37, 1
    s_branch .cok_154
.crt_155:
    s_mov_b32 s51, 0
.clp_156:
    s_add_u32 s44, s62, s60
    s_add_u32 s44, s44, 4096
    v_add_u32 v68, s44, v2
    global_load_dwordx4 v[144:147], v68, s[24:25] offset:0 sc1
    global_load_dwordx4 v[136:139], v68, s[24:25] offset:1024 sc1
    global_load_dwordx4 v[124:127], v68, s[24:25] offset:2048 sc1
    global_load_dwordx4 v[156:159], v68, s[24:25] offset:3072 sc1
    s_add_u32 s44, s62, s61
    s_add_u32 s44, s44, 4096
    v_add_u32 v68, s44, v2
    global_load_dwordx4 v[164:167], v68, s[24:25] offset:-4096 sc1
    global_load_dwordx4 v[160:163], v68, s[24:25] offset:-3072 sc1
    global_load_dwordx4 v[128:131], v68, s[24:25] offset:-2048 sc1
    global_load_dwordx4 v[148:151], v68, s[24:25] offset:-1024 sc1
    global_load_dwordx4 v[120:123], v68, s[24:25] offset:0 sc1
    global_load_dwordx4 v[152:155], v68, s[24:25] offset:1024 sc1
    global_load_dwordx4 v[132:135], v68, s[24:25] offset:2048 sc1
    global_load_dwordx4 v[140:143], v68, s[24:25] offset:3072 sc1
    s_add_u32 s51, s51, 1
    s_waitcnt vmcnt(0)
    v_bitop3_b32 v67, v144, v136, v124 bitop3:0x80
    v_bitop3_b32 v67, v67, v156, 1 bitop3:0x80
    v_cmp_eq_u32 vcc, 0, v67
    s_cbranch_vccz .cok_157
    s_cmp_lt_u32 s51, s37
    s_cbranch_scc1 .clp_156
    s_mov_b32 s37, 1
    s_branch .cok_157
.slow_158:
    s_nop 15
    global_store_dword v68, v67, s[24:25] offset:1536 sc1
    s_nop 1
    s_branch .sten_159
.crt_160:
    s_mov_b32 s51, 0
.clp_161:
    s_add_u32 s44, s62, s61
    s_add_u32 s44, s44, 4096
    v_add_u32 v68, s44, v2
    global_load_dwordx4 v[164:167], v68, s[24:25] offset:-4096 sc1
    global_load_dwordx4 v[160:163], v68, s[24:25] offset:-3072 sc1
    global_load_dwordx4 v[128:131], v68, s[24:25] offset:-2048 sc1
    global_load_dwordx4 v[148:151], v68, s[24:25] offset:-1024 sc1
    global_load_dwordx4 v[120:123], v68, s[24:25] offset:0 sc1
    global_load_dwordx4 v[152:155], v68, s[24:25] offset:1024 sc1
    global_load_dwordx4 v[132:135], v68, s[24:25] offset:2048 sc1
    global_load_dwordx4 v[140:143], v68, s[24:25] offset:3072 sc1
    s_add_u32 s51, s51, 1
    s_waitcnt vmcnt(0)
    v_bitop3_b32 v67, v164, v160, v128 bitop3:0x80
    v_bitop3_b32 v67, v67, v148, 1 bitop3:0x80
    v_cmp_eq_u32 vcc, 0, v67
    s_cbranch_vccz .cok_162
    s_cmp_lt_u32 s51, s37
    s_cbranch_scc1 .clp_161
    s_mov_b32 s37, 1
    s_branch .cok_162
.crt_163:
    s_mov_b32 s51, 0
.clp_164:
    s_add_u32 s44, s62, s61
    s_add_u32 s44, s44, 4096
    v_add_u32 v68, s44, v2
    global_load_dwordx4 v[120:123], v68, s[24:25] offset:0 sc1
    global_load_dwordx4 v[152:155], v68, s[24:25] offset:1024 sc1
    global_load_dwordx4 v[132:135], v68, s[24:25] offset:2048 sc1
    global_load_dwordx4 v[140:143], v68, s[24:25] offset:3072 sc1
    s_add_u32 s51, s51, 1
    s_waitcnt vmcnt(0)
    v_bitop3_b32 v67, v120, v152, v132 bitop3:0x80
    v_bitop3_b32 v67, v67, v140, 1 bitop3:0x80
    v_cmp_eq_u32 vcc, 0, v67
    s_cbranch_vccz .cok_165
    s_cmp_lt_u32 s51, s37
    s_cbranch_scc1 .clp_164
    s_mov_b32 s37, 1
    s_branch .cok_165
.slow_169:
    s_nop 15
    global_store_dword v68, v67, s[24:25] offset:1024 sc1
    s_nop 1
    s_branch .sten_170
.art_172:
    s_cmp_eq_u32 s26, 7
    s_cbranch_scc1 .aok_173
    s_add_u32 s44, s101, 1574920
    v_mov_b32 v68, s44
    global_load_dword v76, v68, s[24:25] sc1
    s_add_u32 s51, s51, 1
    s_waitcnt vmcnt(0)
    s_cmp_lt_u32 s51, s37
    s_cbranch_scc1 .achk_171
    s_mov_b32 s37, 1
    s_branch .aok_173
.slow_177:
    s_nop 15
    global_store_dwordx4 v63, v[30:33], s[24:25] sc1
    s_nop 1
    s_branch .sten_178
.slow_179:
    s_nop 15
    global_store_dword v64, v172, s[24:25] sc1
    s_nop 1
    s_branch .sten_180
.crt_181:
    s_mov_b32 s51, 0
.clp_182:
    s_add_u32 s44, s62, s58
    s_add_u32 s44, s44, 135168
    v_add_u32 v68, s44, v2
    global_load_dwordx4 v[132:135], v68, s[24:25] offset:-4096 sc1
    global_load_dwordx4 v[140:143], v68, s[24:25] offset:-3072 sc1
    global_load_dwordx4 v[144:147], v68, s[24:25] offset:-2048 sc1
    global_load_dwordx4 v[136:139], v68, s[24:25] offset:-1024 sc1
    global_load_dwordx4 v[124:127], v68, s[24:25] offset:0 sc1
    global_load_dwordx4 v[156:159], v68, s[24:25] offset:1024 sc1
    global_load_dwordx4 v[160:163], v68, s[24:25] offset:2048 sc1
    global_load_dwordx4 v[128:131], v68, s[24:25] offset:3072 sc1
    s_add_u32 s44, s62, s59
    s_add_u32 s44, s44, 135168
    v_add_u32 v68, s44, v2
    global_load_dwordx4 v[148:151], v68, s[24:25] offset:-4096 sc1
    global_load_dwordx4 v[152:155], v68, s[24:25] offset:-3072 sc1
    global_load_dwordx4 v[120:123], v68, s[24:25] offset:-2048 sc1
    global_load_dwordx4 v[164:167], v68, s[24:25] offset:-1024 sc1
    s_add_u32 s51, s51, 1
    s_waitcnt vmcnt(0)
    v_bitop3_b32 v67, v132, v140, v144 bitop3:0xfe
    v_bitop3_b32 v67, v67, v136, 1 bitop3:0xa8
    v_cmp_ne_u32 vcc, 0, v67
    s_cbranch_vccz .cok_183
    s_cmp_lt_u32 s51, s37
    s_cbranch_scc1 .clp_182
    s_mov_b32 s37, 1
    s_branch .cok_183
.crt_184:
    s_mov_b32 s51, 0
.clp_185:
    s_add_u32 s44, s62, s58
    s_add_u32 s44, s44, 135168
    v_add_u32 v68, s44, v2
    global_load_dwordx4 v[124:127], v68, s[24:25] offset:0 sc1
    global_load_dwordx4 v[156:159], v68, s[24:25] offset:1024 sc1
    global_load_dwordx4 v[160:163], v68, s[24:25] offset:2048 sc1
    global_load_dwordx4 v[128:131], v68, s[24:25] offset:3072 sc1
    s_add_u32 s44, s62, s59
    s_add_u32 s44, s44, 135168
    v_add_u32 v68, s44, v2
    global_load_dwordx4 v[148:151], v68, s[24:25] offset:-4096 sc1
    global_load_dwordx4 v[152:155], v68, s[24:25] offset:-3072 sc1
    global_load_dwordx4 v[120:123], v68, s[24:25] offset:-2048 sc1
    global_load_dwordx4 v[164:167], v68, s[24:25] offset:-1024 sc1
    global_load_dwordx4 v[132:135], v68, s[24:25] offset:0 sc1
    global_load_dwordx4 v[140:143], v68, s[24:25] offset:1024 sc1
    s_add_u32 s44, s36, s34
    s_add_u32 s44, s44, 0x148000
    v_add_u32 v68, s44, v2
    global_load_dwordx4 v[144:147], v68, s[24:25] offset:0 sc1
    global_load_dwordx4 v[136:139], v68, s[24:25] offset:1024 sc1
    s_add_u32 s51, s51, 1
    s_waitcnt vmcnt(0)
    v_bitop3_b32 v67, v124, v156, v160 bitop3:0xfe
    v_bitop3_b32 v67, v67, v128, 1 bitop3:0xa8
    v_cmp_ne_u32 vcc, 0, v67
    s_cbranch_vccz .cok_186
    s_cmp_lt_u32 s51, s37
    s_cbranch_scc1 .clp_185
    s_mov_b32 s37, 1
    s_branch .cok_186
.crt_187:
    s_mov_b32 s51, 0
.clp_188:
    s_add_u32 s44, s62, s59
    s_add_u32 s44, s44, 135168
    v_add_u32 v68, s44, v2
    global_load_dwordx4 v[148:151], v68, s[24:25] offset:-4096 sc1
    global_load_dwordx4 v[152:155], v68, s[24:25] offset:-3072 sc1
    global_load_dwordx4 v[120:123], v68, s[24:25] offset:-2048 sc1
    global_load_dwordx4 v[164:167], v68, s[24:25] offset:-1024 sc1
    global_load_dwordx4 v[132:135], v68, s[24:25] offset:0 sc1
    global_load_dwordx4 v[140:143], v68, s[24:25] offset:1024 sc1
    s_add_u32 s44, s36, s34
    s_add_u32 s44, s44, 0x148000
    v_add_u32 v68, s44, v2
    global_load_dwordx4 v[144:147], v68, s[24:25] offset:0 sc1
    global_load_dwordx4 v[136:139], v68, s[24:25] offset:1024 sc1
    s_add_u32 s44, s62, s59
    s_add_u32 s44, s44, 135168
    v_add_u32 v68, s44, v2
    global_load_dwordx4 v[124:127], v68, s[24:25] offset:2048 sc1
    global_load_dwordx4 v[156:159], v68, s[24:25] offset:3072 sc1
    s_add_u32 s44, s62, s60
    s_add_u32 s44, s44, 135168
    v_add_u32 v68, s44, v2
    global_load_dwordx4 v[160:163], v68, s[24:25] offset:-4096 sc1
    global_load_dwordx4 v[128:131], v68, s[24:25] offset:-3072 sc1
    s_add_u32 s51, s51, 1
    s_waitcnt vmcnt(0)
    v_bitop3_b32 v67, v148, v152, v120 bitop3:0xfe
    v_bitop3_b32 v67, v67, v164, 1 bitop3:0xa8
    v_cmp_ne_u32 vcc, 0, v67
    s_cbranch_vccz .cok_189
    s_cmp_lt_u32 s51, s37
    s_cbranch_scc1 .clp_188
    s_mov_b32 s37, 1
    s_branch .cok_189
.slow_190:
    s_nop 15
    global_store_dwordx4 v63, v[34:37], s[24:25] sc1
    s_nop 1
    s_branch .sten_191
.crt_192:
    s_mov_b32 s51, 0
.clp_193:
    s_add_u32 s44, s62, s59
    s_add_u32 s44, s44, 135168
    v_add_u32 v68, s44, v2
    global_load_dwordx4 v[132:135], v68, s[24:25] offset:0 sc1
    global_load_dwordx4 v[140:143], v68, s[24:25] offset:1024 sc1
    global_load_dwordx4 v[124:127], v68, s[24:25] offset:2048 sc1
    global_load_dwordx4 v[156:159], v68, s[24:25] offset:3072 sc1
    s_add_u32 s44, s36, s34
    s_add_u32 s44, s44, 0x148000
    v_add_u32 v68, s44, v2
    global_load_dwordx4 v[144:147], v68, s[24:25] offset:0 sc1
    global_load_dwordx4 v[136:139], v68, s[24:25] offset:1024 sc1
    s_add_u32 s44, s62, s60
    s_add_u32 s44, s44, 135168
    v_add_u32 v68, s44, v2
    global_load_dwordx4 v[160:163], v68, s[24:25] offset:-4096 sc1
    global_load_dwordx4 v[128:131], v68, s[24:25] offset:-3072 sc1
    global_load_dwordx4 v[148:151], v68, s[24:25] offset:-2048 sc1
    global_load_dwordx4 v[152:155], v68, s[24:25] offset:-1024 sc1
    global_load_dwordx4 v[120:123], v68, s[24:25] offset:0 sc1
    global_load_dwordx4 v[164:167], v68, s[24:25] offset:1024 sc1
    s_add_u32 s51, s51, 1
    s_waitcnt vmcnt(0)
    v_bitop3_b32 v67, v132, v140, v124 bitop3:0xfe
    v_bitop3_b32 v67, v67, v156, 1 bitop3:0xa8
    v_cmp_ne_u32 vcc, 0, v67
    s_cbranch_vccz .cok_194
    s_cmp_lt_u32 s51, s37
    s_cbranch_scc1 .clp_193
    s_mov_b32 s37, 1
    s_branch .cok_194
.slow_195:
    s_nop 15
    global_store_dword v64, v204, s[24:25] sc1
    s_nop 1
    s_branch .sten_196
.crt_197:
    s_mov_b32 s51, 0
.clp_198:
    s_add_u32 s44, s36, s34
    s_add_u32 s44, s44, 0x148000
    v_add_u32 v68, s44, v2
    global_load_dwordx4 v[144:147], v68, s[24:25] offset:0 sc1
    global_load_dwordx4 v[136:139], v68, s[24:25] offset:1024 sc1
    s_add_u32 s44, s62, s59
    s_add_u32 s44, s44, 135168
    v_add_u32 v68, s44, v2
    global_load_dwordx4 v[156:159], v68, s[24:25] offset:3072 sc1
    s_add_u32 s44, s62, s60
    s_add_u32 s44, s44, 135168
    v_add_u32 v68, s44, v2
    global_load_dwordx4 v[160:163], v68, s[24:25] offset:-4096 sc1
    global_load_dwordx4 v[128:131], v68, s[24:25] offset:-3072 sc1
    global_load_dwordx4 v[148:151], v68, s[24:25] offset:-2048 sc1
    global_load_dwordx4 v[152:155], v68, s[24:25] offset:-1024 sc1
    global_load_dwordx4 v[120:123], v68, s[24:25] offset:0 sc1
    global_load_dwordx4 v[164:167], v68, s[24:25] offset:1024 sc1
    global_load_dwordx4 v[132:135], v68, s[24:25] offset:2048 sc1
    global_load_dwordx4 v[140:143], v68, s[24:25] offset:3072 sc1
    s_add_u32 s44, s62, s61
    s_add_u32 s44, s44, 135168
    v_add_u32 v68, s44, v2
    global_load_dwordx4 v[124:127], v68, s[24:25] offset:-4096 sc1
    s_add_u32 s51, s51, 1
    s_waitcnt vmcnt(0)
    v_bitop3_b32 v67, v144, v145, v146 bitop3:0xfe
    v_bitop3_b32 v67, v67, v147, v136 bitop3:0xfe
    v_bitop3_b32 v67, v67, v137, v138 bitop3:0xfe
    v_bitop3_b32 v67, v67, v139, 1 bitop3:0xa8
    v_cmp_ne_u32 vcc, 0, v67
    s_cbranch_vccz .cok_199
    s_cmp_lt_u32 s51, s37
    s_cbranch_scc1 .clp_198
    s_mov_b32 s37, 1
    s_branch .cok_199
.crt_200:
    s_mov_b32 s51, 0
.clp_201:
    s_add_u32 s44, s62, s60
    s_add_u32 s44, s44, 135168
    v_add_u32 v68, s44, v2
    global_load_dwordx4 v[160:163], v68, s[24:25] offset:-4096 sc1
    global_load_dwordx4 v[128:131], v68, s[24:25] offset:-3072 sc1
    global_load_dwordx4 v[148:151], v68, s[24:25] offset:-2048 sc1
    global_load_dwordx4 v[152:155], v68, s[24:25] offset:-1024 sc1
    global_load_dwordx4 v[120:123], v68, s[24:25] offset:0 sc1
    global_load_dwordx4 v[164:167], v68, s[24:25] offset:1024 sc1
    global_load_dwordx4 v[132:135], v68, s[24:25] offset:2048 sc1
    global_load_dwordx4 v[140:143], v68, s[24:25] offset:3072 sc1
    s_add_u32 s44, s62, s61
    s_add_u32 s44, s44, 135168
    v_add_u32 v68, s44, v2
    global_load_dwordx4 v[124:127], v68, s[24:25] offset:-4096 sc1
    global_load_dwordx4 v[144:147], v68, s[24:25] offset:-3072 sc1
    s_add_u32 s51, s51, 1
    s_waitcnt vmcnt(0)
    v_bitop3_b32 v67, v160, v128, v148 bitop3:0xfe
    v_bitop3_b32 v67, v67, v152, 1 bitop3:0xa8
    v_cmp_ne_u32 vcc, 0, v67
    s_cbranch_vccz .cok_202
    s_cmp_lt_u32 s51, s37
    s_cbranch_scc1 .clp_201
    s_mov_b32 s37, 1
    s_branch .cok_202
.crt_203:
    s_mov_b32 s51, 0
.clp_204:
    s_add_u32 s44, s62, s60
    s_add_u32 s44, s44, 135168
    v_add_u32 v68, s44, v2
    global_load_dwordx4 v[120:123], v68, s[24:25] offset:0 sc1
    global_load_dwordx4 v[164:167], v68, s[24:25] offset:1024 sc1
    global_load_dwordx4 v[132:135], v68, s[24:25] offset:2048 sc1
    global_load_dwordx4 v[140:143], v68, s[24:25] offset:3072 sc1
    s_add_u32 s44, s62, s61
    s_add_u32 s44, s44, 135168
    v_add_u32 v68, s44, v2
    global_load_dwordx4 v[124:127], v68, s[24:25] offset:-4096 sc1
    global_load_dwordx4 v[144:147], v68, s[24:25] offset:-3072 sc1
    global_load_dwordx4 v[136:139], v68, s[24:25] offset:-2048 sc1
    global_load_dwordx4 v[156:159], v68, s[24:25] offset:-1024 sc1
    global_load_dwordx4 v[160:163], v68, s[24:25] offset:0 sc1
    global_load_dwordx4 v[128:131], v68, s[24:25] offset:1024 sc1
    global_load_dwordx4 v[148:151], v68, s[24:25] offset:2048 sc1
    global_load_dwordx4 v[152:155], v68, s[24:25] offset:3072 sc1
    s_add_u32 s51, s51, 1
    s_waitcnt vmcnt(0)
    v_bitop3_b32 v67, v120, v164, v132 bitop3:0xfe
    v_bitop3_b32 v67, v67, v140, 1 bitop3:0xa8
    v_cmp_ne_u32 vcc, 0, v67
    s_cbranch_vccz .cok_205
    s_cmp_lt_u32 s51, s37
    s_cbranch_scc1 .clp_204
    s_mov_b32 s37, 1
    s_branch .cok_205
.crt_206:
    s_mov_b32 s51, 0
.clp_207:
    s_add_u32 s44, s62, s61
    s_add_u32 s44, s44, 135168
    v_add_u32 v68, s44, v2
    global_load_dwordx4 v[124:127], v68, s[24:25] offset:-4096 sc1
    global_load_dwordx4 v[144:147], v68, s[24:25] offset:-3072 sc1
    global_load_dwordx4 v[136:139], v68, s[24:25] offset:-2048 sc1
    global_load_dwordx4 v[156:159], v68, s[24:25] offset:-1024 sc1
    global_load_dwordx4 v[160:163], v68, s[24:25] offset:0 sc1
    global_load_dwordx4 v[128:131], v68, s[24:25] offset:1024 sc1
    global_load_dwordx4 v[148:151], v68, s[24:25] offset:2048 sc1
    global_load_dwordx4 v[152:155], v68, s[24:25] offset:3072 sc1
    s_add_u32 s51, s51, 1
    s_waitcnt vmcnt(0)
    v_bitop3_b32 v67, v124, v144, v136 bitop3:0xfe
    v_bitop3_b32 v67, v67, v156, 1 bitop3:0xa8
    v_cmp_ne_u32 vcc, 0, v67
    s_cbranch_vccz .cok_208
    s_cmp_lt_u32 s51, s37
    s_cbranch_scc1 .clp_207
    s_mov_b32 s37, 1
    s_branch .cok_208
.crt_209:
    s_mov_b32 s51, 0
.clp_210:
    s_add_u32 s44, s62, s61
    s_add_u32 s44, s44, 135168
    v_add_u32 v68, s44, v2
    global_load_dwordx4 v[160:163], v68, s[24:25] offset:0 sc1
    global_load_dwordx4 v[128:131], v68, s[24:25] offset:1024 sc1
    global_load_dwordx4 v[148:151], v68, s[24:25] offset:2048 sc1
    global_load_dwordx4 v[152:155], v68, s[24:25] offset:3072 sc1
    s_add_u32 s51, s51, 1
    s_waitcnt vmcnt(0)
    v_bitop3_b32 v67, v160, v128, v148 bitop3:0xfe
    v_bitop3_b32 v67, v67, v152, 1 bitop3:0xa8
    v_cmp_ne_u32 vcc, 0, v67
    s_cbranch_vccz .cok_211
    s_cmp_lt_u32 s51, s37
    s_cbranch_scc1 .clp_210
    s_mov_b32 s37, 1
    s_branch .cok_211
.crt_212:
    s_mov_b32 s51, 0
.clp_213:
    s_add_u32 s44, s62, s58
    s_add_u32 s44, s44, 4096
    v_add_u32 v68, s44, v2
    global_load_dwordx4 v[120:123], v68, s[24:25] offset:-4096 sc1
    global_load_dwordx4 v[164:167], v68, s[24:25] offset:-3072 sc1
    global_load_dwordx4 v[132:135], v68, s[24:25] offset:-2048 sc1
    global_load_dwordx4 v[140:143], v68, s[24:25] offset:-1024 sc1
    global_load_dwordx4 v[124:127], v68, s[24:25] offset:0 sc1
    global_load_dwordx4 v[144:147], v68, s[24:25] offset:1024 sc1
    global_load_dwordx4 v[136:139], v68, s[24:25] offset:2048 sc1
    global_load_dwordx4 v[156:159], v68, s[24:25] offset:3072 sc1
    s_add_u32 s44, s62, s59
    s_add_u32 s44, s44, 4096
    v_add_u32 v68, s44, v2
    global_load_dwordx4 v[160:163], v68, s[24:25] offset:-4096 sc1
    global_load_dwordx4 v[128:131], v68, s[24:25] offset:-3072 sc1
    global_load_dwordx4 v[148:151], v68, s[24:25] offset:-2048 sc1
    global_load_dwordx4 v[152:155], v68, s[24:25] offset:-1024 sc1
    s_add_u32 s51, s51, 1
    s_waitcnt vmcnt(0)
    v_bitop3_b32 v67, v120, v164, v132 bitop3:0xfe
    v_bitop3_b32 v67, v67, v140, 1 bitop3:0xa8
    v_cmp_ne_u32 vcc, 0, v67
    s_cbranch_vccz .cok_214
    s_cmp_lt_u32 s51, s37
    s_cbranch_scc1 .clp_213
    s_mov_b32 s37, 1
    s_branch .cok_214
.crt_215:
    s_mov_b32 s51, 0
.clp_216:
    s_add_u32 s44, s62, s58
    s_add_u32 s44, s44, 4096
    v_add_u32 v68, s44, v2
    global_load_dwordx4 v[124:127], v68, s[24:25] offset:0 sc1
    global_load_dwordx4 v[144:147], v68, s[24:25] offset:1024 sc1
    global_load_dwordx4 v[136:139], v68, s[24:25] offset:2048 sc1
    global_load_dwordx4 v[156:159], v68, s[24:25] offset:3072 sc1
    s_add_u32 s44, s62, s59
    s_add_u32 s44, s44, 4096
    v_add_u32 v68, s44, v2
    global_load_dwordx4 v[160:163], v68, s[24:25] offset:-4096 sc1
    global_load_dwordx4 v[128:131], v68, s[24:25] offset:-3072 sc1
    global_load_dwordx4 v[148:151], v68, s[24:25] offset:-2048 sc1
    global_load_dwordx4 v[152:155], v68, s[24:25] offset:-1024 sc1
    global_load_dwordx4 v[120:123], v68, s[24:25] offset:0 sc1
    global_load_dwordx4 v[164:167], v68, s[24:25] offset:1024 sc1
    s_add_u32 s44, s36, s34
    s_add_u32 s44, s44, 0x146000
    v_add_u32 v68, s44, v2
    global_load_dwordx4 v[132:135], v68, s[24:25] offset:0 sc1
    global_load_dwordx4 v[140:143], v68, s[24:25] offset:1024 sc1
    s_add_u32 s51, s51, 1
    s_waitcnt vmcnt(0)
    v_bitop3_b32 v67, v124, v144, v136 bitop3:0xfe
    v_bitop3_b32 v67, v67, v156, 1 bitop3:0xa8
    v_cmp_ne_u32 vcc, 0, v67
    s_cbranch_vccz .cok_217
    s_cmp_lt_u32 s51, s37
    s_cbranch_scc1 .clp_216
    s_mov_b32 s37, 1
    s_branch .cok_217
.crt_218:
    s_mov_b32 s51, 0
.clp_219:
    s_add_u32 s44, s62, s59
    s_add_u32 s44, s44, 4096
    v_add_u32 v68, s44, v2
    global_load_dwordx4 v[160:163], v68, s[24:25] offset:-4096 sc1
    global_load_dwordx4 v[128:131], v68, s[24:25] offset:-3072 sc1
    global_load_dwordx4 v[148:151], v68, s[24:25] offset:-2048 sc1
    global_load_dwordx4 v[152:155], v68, s[24:25] offset:-1024 sc1
    global_load_dwordx4 v[120:123], v68, s[24:25] offset:0 sc1
    global_load_dwordx4 v[164:167], v68, s[24:25] offset:1024 sc1
    s_add_u32 s44, s36, s34
    s_add_u32 s44, s44, 0x146000
    v_add_u32 v68, s44, v2
    global_load_dwordx4 v[132:135], v68, s[24:25] offset:0 sc1
    global_load_dwordx4 v[140:143], v68, s[24:25] offset:1024 sc1
    s_add_u32 s44, s62, s59
    s_add_u32 s44, s44, 4096
    v_add_u32 v68, s44, v2
    global_load_dwordx4 v[124:127], v68, s[24:25] offset:2048 sc1
    global_load_dwordx4 v[144:147], v68, s[24:25] offset:3072 sc1
    s_add_u32 s44, s62, s60
    s_add_u32 s44, s44, 4096
    v_add_u32 v68, s44, v2
    global_load_dwordx4 v[136:139], v68, s[24:25] offset:-4096 sc1
    global_load_dwordx4 v[156:159], v68, s[24:25] offset:-3072 sc1
    s_add_u32 s51, s51, 1
    s_waitcnt vmcnt(0)
    v_bitop3_b32 v67, v160, v128, v148 bitop3:0xfe
    v_bitop3_b32 v67, v67, v152, 1 bitop3:0xa8
    v_cmp_ne_u32 vcc, 0, v67
    s_cbranch_vccz .cok_220
    s_cmp_lt_u32 s51, s37
    s_cbranch_scc1 .clp_219
    s_mov_b32 s37, 1
    s_branch .cok_220
.crt_221:
    s_mov_b32 s51, 0
.clp_222:
    s_add_u32 s44, s62, s59
    s_add_u32 s44, s44, 4096
    v_add_u32 v68, s44, v2
    global_load_dwordx4 v[120:123], v68, s[24:25] offset:0 sc1
    global_load_dwordx4 v[164:167], v68, s[24:25] offset:1024 sc1
    global_load_dwordx4 v[124:127], v68, s[24:25] offset:2048 sc1
    global_load_dwordx4 v[144:147], v68, s[24:25] offset:3072 sc1
    s_add_u32 s44, s36, s34
    s_add_u32 s44, s44, 0x146000
    v_add_u32 v68, s44, v2
    global_load_dwordx4 v[132:135], v68, s[24:25] offset:0 sc1
    global_load_dwordx4 v[140:143], v68, s[24:25] offset:1024 sc1
    s_add_u32 s44, s62, s60
    s_add_u32 s44, s44, 4096
    v_add_u32 v68, s44, v2
    global_load_dwordx4 v[136:139], v68, s[24:25] offset:-4096 sc1
    global_load_dwordx4 v[156:159], v68, s[24:25] offset:-3072 sc1
    global_load_dwordx4 v[160:163], v68, s[24:25] offset:-2048 sc1
    global_load_dwordx4 v[128:131], v68, s[24:25] offset:-1024 sc1
    global_load_dwordx4 v[148:151], v68, s[24:25] offset:0 sc1
    global_load_dwordx4 v[152:155], v68, s[24:25] offset:1024 sc1
    s_add_u32 s51, s51, 1
    s_waitcnt vmcnt(0)
    v_bitop3_b32 v67, v120, v164, v124 bitop3:0xfe
    v_bitop3_b32 v67, v67, v144, 1 bitop3:0xa8
    v_cmp_ne_u32 vcc, 0, v67
    s_cbranch_vccz .cok_223
    s_cmp_lt_u32 s51, s37
    s_cbranch_scc1 .clp_222
    s_mov_b32 s37, 1
    s_branch .cok_223
.crt_224:
    s_mov_b32 s51, 0
.clp_225:
    s_add_u32 s44, s36, s34
    s_add_u32 s44, s44, 0x146000
    v_add_u32 v68, s44, v2
    global_load_dwordx4 v[132:135], v68, s[24:25] offset:0 sc1
    global_load_dwordx4 v[140:143], v68, s[24:25] offset:1024 sc1
    s_add_u32 s44, s62, s59
    s_add_u32 s44, s44, 4096
    v_add_u32 v68, s44, v2
    global_load_dwordx4 v[144:147], v68, s[24:25] offset:3072 sc1
    s_add_u32 s44, s62, s60
    s_add_u32 s44, s44, 4096
    v_add_u32 v68, s44, v2
    global_load_dwordx4 v[136:139], v68, s[24:25] offset:-4096 sc1
    global_load_dwordx4 v[156:159], v68, s[24:25] offset:-3072 sc1
    global_load_dwordx4 v[160:163], v68, s[24:25] offset:-2048 sc1
    global_load_dwordx4 v[128:131], v68, s[24:25] offset:-1024 sc1
    global_load_dwordx4 v[148:151], v68, s[24:25] offset:0 sc1
    global_load_dwordx4 v[152:155], v68, s[24:25] offset:1024 sc1
    global_load_dwordx4 v[120:123], v68, s[24:25] offset:2048 sc1
    global_load_dwordx4 v[164:167], v68, s[24:25] offset:3072 sc1
    s_add_u32 s44, s62, s61
    s_add_u32 s44, s44, 4096
    v_add_u32 v68, s44, v2
    global_load_dwordx4 v[124:127], v68, s[24:25] offset:-4096 sc1
    s_add_u32 s51, s51, 1
    s_waitcnt vmcnt(0)
    v_bitop3_b32 v67, v132, v133, v134 bitop3:0xfe
    v_bitop3_b32 v67, v67, v135, v140 bitop3:0xfe
    v_bitop3_b32 v67, v67, v141, v142 bitop3:0xfe
    v_bitop3_b32 v67, v67, v143, 1 bitop3:0xa8
    v_cmp_ne_u32 vcc, 0, v67
    s_cbranch_vccz .cok_226
    s_cmp_lt_u32 s51, s37
    s_cbranch_scc1 .clp_225
    s_mov_b32 s37, 1
    s_branch .cok_226
.crt_227:
    s_mov_b32 s51, 0
.clp_228:
    s_add_u32 s44, s62, s60
    s_add_u32 s44, s44, 4096
    v_add_u32 v68, s44, v2
    global_load_dwordx4 v[136:139], v68, s[24:25] offset:-4096 sc1
    global_load_dwordx4 v[156:159], v68, s[24:25] offset:-3072 sc1
    global_load_dwordx4 v[160:163], v68, s[24:25] offset:-2048 sc1
    global_load_dwordx4 v[128:131], v68, s[24:25] offset:-1024 sc1
    global_load_dwordx4 v[148:151], v68, s[24:25] offset:0 sc1
    global_load_dwordx4 v[152:155], v68, s[24:25] offset:1024 sc1
    global_load_dwordx4 v[120:123], v68, s[24:25] offset:2048 sc1
    global_load_dwordx4 v[164:167], v68, s[24:25] offset:3072 sc1
    s_add_u32 s44, s62, s61
    s_add_u32 s44, s44, 4096
    v_add_u32 v68, s44, v2
    global_load_dwordx4 v[124:127], v68, s[24:25] offset:-4096 sc1
    global_load_dwordx4 v[132:135], v68, s[24:25] offset:-3072 sc1
    s_add_u32 s51, s51, 1
    s_waitcnt vmcnt(0)
    v_bitop3_b32 v67, v136, v156, v160 bitop3:0xfe
    v_bitop3_b32 v67, v67, v128, 1 bitop3:0xa8
    v_cmp_ne_u32 vcc, 0, v67
    s_cbranch_vccz .cok_229
    s_cmp_lt_u32 s51, s37
    s_cbranch_scc1 .clp_228
    s_mov_b32 s37, 1
    s_branch .cok_229
.crt_230:
    s_mov_b32 s51, 0
.clp_231:
    s_add_u32 s44, s62, s60
    s_add_u32 s44, s44, 4096
    v_add_u32 v68, s44, v2
    global_load_dwordx4 v[148:151], v68, s[24:25] offset:0 sc1
    global_load_dwordx4 v[152:155], v68, s[24:25] offset:1024 sc1
    global_load_dwordx4 v[120:123], v68, s[24:25] offset:2048 sc1
    global_load_dwordx4 v[164:167], v68, s[24:25] offset:3072 sc1
    s_add_u32 s44, s62, s61
    s_add_u32 s44, s44, 4096
    v_add_u32 v68, s44, v2
    global_load_dwordx4 v[124:127], v68, s[24:25] offset:-4096 sc1
    global_load_dwordx4 v[132:135], v68, s[24:25] offset:-3072 sc1
    global_load_dwordx4 v[140:143], v68, s[24:25] offset:-2048 sc1
    global_load_dwordx4 v[144:147], v68, s[24:25] offset:-1024 sc1
    global_load_dwordx4 v[136:139], v68, s[24:25] offset:0 sc1
    global_load_dwordx4 v[156:159], v68, s[24:25] offset:1024 sc1
    global_load_dwordx4 v[160:163], v68, s[24:25] offset:2048 sc1
    global_load_dwordx4 v[128:131], v68, s[24:25] offset:3072 sc1
    s_add_u32 s51, s51, 1
    s_waitcnt vmcnt(0)
    v_bitop3_b32 v67, v148, v152, v120 bitop3:0xfe
    v_bitop3_b32 v67, v67, v164, 1 bitop3:0xa8
    v_cmp_ne_u32 vcc, 0, v67
    s_cbranch_vccz .cok_232
    s_cmp_lt_u32 s51, s37
    s_cbranch_scc1 .clp_231
    s_mov_b32 s37, 1
    s_branch .cok_232
.crt_233:
    s_mov_b32 s51, 0
.clp_234:
    s_add_u32 s44, s62, s61
    s_add_u32 s44, s44, 4096
    v_add_u32 v68, s44, v2
    global_load_dwordx4 v[124:127], v68, s[24:25] offset:-4096 sc1
    global_load_dwordx4 v[132:135], v68, s[24:25] offset:-3072 sc1
    global_load_dwordx4 v[140:143], v68, s[24:25] offset:-2048 sc1
    global_load_dwordx4 v[144:147], v68, s[24:25] offset:-1024 sc1
    global_load_dwordx4 v[136:139], v68, s[24:25] offset:0 sc1
    global_load_dwordx4 v[156:159], v68, s[24:25] offset:1024 sc1
    global_load_dwordx4 v[160:163], v68, s[24:25] offset:2048 sc1
    global_load_dwordx4 v[128:131], v68, s[24:25] offset:3072 sc1
    s_add_u32 s51, s51, 1
    s_waitcnt vmcnt(0)
    v_bitop3_b32 v67, v124, v132, v140 bitop3:0xfe
    v_bitop3_b32 v67, v67, v144, 1 bitop3:0xa8
    v_cmp_ne_u32 vcc, 0, v67
    s_cbranch_vccz .cok_235
    s_cmp_lt_u32 s51, s37
    s_cbranch_scc1 .clp_234
    s_mov_b32 s37, 1
    s_branch .cok_235
.crt_236:
    s_mov_b32 s51, 0
.clp_237:
    s_add_u32 s44, s62, s61
    s_add_u32 s44, s44, 4096
    v_add_u32 v68, s44, v2
    global_load_dwordx4 v[136:139], v68, s[24:25] offset:0 sc1
    global_load_dwordx4 v[156:159], v68, s[24:25] offset:1024 sc1
    global_load_dwordx4 v[160:163], v68, s[24:25] offset:2048 sc1
    global_load_dwordx4 v[128:131], v68, s[24:25] offset:3072 sc1
    s_add_u32 s51, s51, 1
    s_waitcnt vmcnt(0)
    v_bitop3_b32 v67, v136, v156, v160 bitop3:0xfe
    v_bitop3_b32 v67, v67, v128, 1 bitop3:0xa8
    v_cmp_ne_u32 vcc, 0, v67
    s_cbranch_vccz .cok_238
    s_cmp_lt_u32 s51, s37
    s_cbranch_scc1 .clp_237
    s_mov_b32 s37, 1
    s_branch .cok_238
.hrt_240:
    global_load_dwordx4 v[148:151], v86, s[24:25] sc1
    global_load_dwordx4 v[152:155], v86, s[24:25] offset:1024 sc1
    global_load_dwordx4 v[120:123], v86, s[24:25] offset:2048 sc1
    s_add_u32 s51, s51, 1
    s_waitcnt vmcnt(0)
    s_cmp_lt_u32 s51, s37
    s_cbranch_scc1 .hchk_239
    s_mov_b32 s37, 1
    s_branch .hok_241
.g0_242:
    s_nop 15
    v_mov_b32 v152, v254
    v_mov_b32 v153, v254
    v_mov_b32 v154, v254
    v_mov_b32 v155, v254
    v_mov_b32 v156, v254
    v_mov_b32 v157, v254
    v_mov_b32 v158, v254
    v_mov_b32 v159, v254
    v_mov_b32 v160, v254
    v_mov_b32 v161, v254
    v_mov_b32 v162, v254
    v_mov_b32 v163, v254
    v_mov_b32 v164, v254
    v_mov_b32 v165, v254
    v_mov_b32 v166, v254
    v_mov_b32 v167, v254
    s_branch .g0r_243
.sk_244:
    s_nop 7
    s_nop 0
    s_branch .skr_245
.sk_246:
    s_nop 7
    s_nop 0
    s_branch .skr_247
.sk_248:
    s_nop 7
    s_nop 0
    s_branch .skr_249
.fix_250:
    s_nop 15
    v_mov_b32 v168, v254
    v_mov_b32 v169, v254
    v_mov_b32 v170, v254
    v_mov_b32 v171, v254
    v_mov_b32 v172, v254
    v_mov_b32 v173, v254
    v_mov_b32 v174, v254
    v_mov_b32 v175, v254
    v_mov_b32 v176, v254
    v_mov_b32 v177, v254
    v_mov_b32 v178, v254
    v_mov_b32 v179, v254
    v_mov_b32 v180, v254
    v_mov_b32 v181, v254
    v_mov_b32 v182, v254
    v_mov_b32 v183, v254
    s_nop 3
    s_branch .fixr_251
.fix_252:
    s_nop 15
    v_mov_b32 v168, v254
    v_mov_b32 v169, v254
    v_mov_b32 v170, v254
    v_mov_b32 v171, v254
    v_mov_b32 v172, v254
    v_mov_b32 v173, v254
    v_mov_b32 v174, v254
    v_mov_b32 v175, v254
    v_mov_b32 v176, v254
    v_mov_b32 v177, v254
    v_mov_b32 v178, v254
    v_mov_b32 v179, v254
    v_mov_b32 v180, v254
    v_mov_b32 v181, v254
    v_mov_b32 v182, v254
    v_mov_b32 v183, v254
    s_nop 3
    s_branch .fixr_253
.fix_254:
    s_nop 15
    v_mov_b32 v168, v254
    v_mov_b32 v169, v254
    v_mov_b32 v170, v254
    v_mov_b32 v171, v254
    v_mov_b32 v172, v254
    v_mov_b32 v173, v254
    v_mov_b32 v174, v254
    v_mov_b32 v175, v254
    v_mov_b32 v176, v254
    v_mov_b32 v177, v254
    v_mov_b32 v178, v254
    v_mov_b32 v179, v254
    v_mov_b32 v180, v254
    v_mov_b32 v181, v254
    v_mov_b32 v182, v254
    v_mov_b32 v183, v254
    s_nop 3
    s_branch .fixr_255
.hrt_257:
    global_load_dwordx4 v[124:127], v86, s[24:25] sc1
    global_load_dwordx4 v[132:135], v86, s[24:25] offset:1024 sc1
    global_load_dwordx4 v[140:143], v86, s[24:25] offset:2048 sc1
    s_add_u32 s51, s51, 1
    s_waitcnt vmcnt(0)
    s_cmp_lt_u32 s51, s37
    s_cbranch_scc1 .hchk_256
    s_mov_b32 s37, 1
    s_branch .hok_258
.slow_259:
    s_nop 15
    global_store_dwordx4 v63, v[216:219], s[24:25] sc1
    s_nop 1
    s_branch .sten_260
.sk_261:
    s_nop 7
    s_nop 0
    s_branch .skr_262
.sk_263:
    s_nop 7
    s_nop 0
    s_branch .skr_264
.sk_265:
    s_nop 7
    s_nop 0
    s_branch .skr_266
.sk_267:
    s_nop 7
    s_nop 0
    s_branch .skr_268
.g0_269:
    s_nop 15
    v_mov_b32 v152, v254
    v_mov_b32 v153, v254
    v_mov_b32 v154, v254
    v_mov_b32 v155, v254
    v_mov_b32 v156, v254
    v_mov_b32 v157, v254
    v_mov_b32 v158, v254
    v_mov_b32 v159, v254
    v_mov_b32 v160, v254
    v_mov_b32 v161, v254
    v_mov_b32 v162, v254
    v_mov_b32 v163, v254
    v_mov_b32 v164, v254
    v_mov_b32 v165, v254
    v_mov_b32 v166, v254
    v_mov_b32 v167, v254
    s_branch .g0r_270
.sk_271:
    s_nop 7
    s_nop 0
    s_branch .skr_272
.sk_273:
    s_nop 7
    s_nop 0
    s_branch .skr_274
.sk_275:
    s_nop 7
    s_nop 0
    s_branch .skr_276
.fix_277:
    s_nop 15
    v_mov_b32 v168, v254
    v_mov_b32 v169, v254
    v_mov_b32 v170, v254
    v_mov_b32 v171, v254
    v_mov_b32 v172, v254
    v_mov_b32 v173, v254
    v_mov_b32 v174, v254
    v_mov_b32 v175, v254
    v_mov_b32 v176, v254
    v_mov_b32 v177, v254
    v_mov_b32 v178, v254
    v_mov_b32 v179, v254
    v_mov_b32 v180, v254
    v_mov_b32 v181, v254
    v_mov_b32 v182, v254
    v_mov_b32 v183, v254
    s_nop 3
    s_branch .fixr_278
.crt_279:
    s_mov_b32 s51, 0
.clp_280:
    s_lshl2_add_u32 s44, s28, s96
    s_lshl_b32 s44, s44, 11
    s_add_u32 s44, s44, s32
    s_add_u32 s44, s44, 396288
    v_add_u32 v68, s44, v2
    global_load_dwordx4 v[144:147], v68, s[24:25] offset:-3072 sc1
    global_load_dwordx4 v[136:139], v68, s[24:25] offset:-2048 sc1
    s_lshl2_add_u32 s44, s28, s97
    s_lshl_b32 s44, s44, 11
    s_add_u32 s44, s44, s32
    s_add_u32 s44, s44, 396288
    v_add_u32 v68, s44, v2
    global_load_dwordx4 v[128:131], v68, s[24:25] offset:-3072 sc1
    global_load_dwordx4 v[148:151], v68, s[24:25] offset:-2048 sc1
    s_lshl2_add_u32 s44, s28, s98
    s_lshl_b32 s44, s44, 11
    s_add_u32 s44, s44, s32
    s_add_u32 s44, s44, 396288
    v_add_u32 v68, s44, v2
    global_load_dwordx4 v[120:123], v68, s[24:25] offset:-3072 sc1
    global_load_dwordx4 v[124:127], v68, s[24:25] offset:-2048 sc1
    s_lshl2_add_u32 s44, s28, s99
    s_lshl_b32 s44, s44, 11
    s_add_u32 s44, s44, s32
    s_add_u32 s44, s44, 396288
    v_add_u32 v68, s44, v2
    global_load_dwordx4 v[132:135], v68, s[24:25] offset:-3072 sc1
    global_load_dwordx4 v[140:143], v68, s[24:25] offset:-2048 sc1
    s_add_u32 s51, s51, 1
    s_waitcnt vmcnt(0)
    v_bitop3_b32 v67, v144, v136, v128 bitop3:0xfe
    v_bitop3_b32 v67, v67, v148, 1 bitop3:0xa8
    v_cmp_ne_u32 vcc, 0, v67
    s_cbranch_vccz .cok_281
    s_cmp_lt_u32 s51, s37
    s_cbranch_scc1 .clp_280
    s_mov_b32 s37, 1
    s_branch .cok_281
.crt_282:
    s_mov_b32 s51, 0
.clp_283:
    s_lshl2_add_u32 s44, s28, s98
    s_lshl_b32 s44, s44, 11
    s_add_u32 s44, s44, s32
    s_add_u32 s44, s44, 396288
    v_add_u32 v68, s44, v2
    global_load_dwordx4 v[120:123], v68, s[24:25] offset:-3072 sc1
    global_load_dwordx4 v[124:127], v68, s[24:25] offset:-2048 sc1
    s_lshl2_add_u32 s44, s28, s99
    s_lshl_b32 s44, s44, 11
    s_add_u32 s44, s44, s32
    s_add_u32 s44, s44, 396288
    v_add_u32 v68, s44, v2
    global_load_dwordx4 v[132:135], v68, s[24:25] offset:-3072 sc1
    global_load_dwordx4 v[140:143], v68, s[24:25] offset:-2048 sc1
    s_lshl2_add_u32 s44, s28, s96
    s_lshl_b32 s44, s44, 11
    s_add_u32 s44, s44, s32
    s_add_u32 s44, s44, 396288
    v_add_u32 v68, s44, v2
    global_load_dwordx4 v[144:147], v68, s[24:25] offset:-3072 sc1
    global_load_dwordx4 v[136:139], v68, s[24:25] offset:-2048 sc1
    s_lshl2_add_u32 s44, s28, s97
    s_lshl_b32 s44, s44, 11
    s_add_u32 s44, s44, s32
    s_add_u32 s44, s44, 396288
    v_add_u32 v68, s44, v2
    global_load_dwordx4 v[128:131], v68, s[24:25] offset:-3072 sc1
    global_load_dwordx4 v[148:151], v68, s[24:25] offset:-2048 sc1
    s_add_u32 s51, s51, 1
    s_waitcnt vmcnt(0)
    v_bitop3_b32 v67, v120, v124, v132 bitop3:0xfe
    v_bitop3_b32 v67, v67, v140, 1 bitop3:0xa8
    v_cmp_ne_u32 vcc, 0, v67
    s_cbranch_vccz .cok_284
    s_cmp_lt_u32 s51, s37
    s_cbranch_scc1 .clp_283
    s_mov_b32 s37, 1
    s_branch .cok_284
.fix_285:
    s_nop 15
    v_mov_b32 v168, v254
    v_mov_b32 v169, v254
    v_mov_b32 v170, v254
    v_mov_b32 v171, v254
    v_mov_b32 v172, v254
    v_mov_b32 v173, v254
    v_mov_b32 v174, v254
    v_mov_b32 v175, v254
    v_mov_b32 v176, v254
    v_mov_b32 v177, v254
    v_mov_b32 v178, v254
    v_mov_b32 v179, v254
    v_mov_b32 v180, v254
    v_mov_b32 v181, v254
    v_mov_b32 v182, v254
    v_mov_b32 v183, v254
    s_nop 3
    s_branch .fixr_286
.fix_287:
    s_nop 15
    v_mov_b32 v168, v254
    v_mov_b32 v169, v254
    v_mov_b32 v170, v254
    v_mov_b32 v171, v254
    v_mov_b32 v172, v254
    v_mov_b32 v173, v254
    v_mov_b32 v174, v254
    v_mov_b32 v175, v254
    v_mov_b32 v176, v254
    v_mov_b32 v177, v254
    v_mov_b32 v178, v254
    v_mov_b32 v179, v254
    v_mov_b32 v180, v254
    v_mov_b32 v181, v254
    v_mov_b32 v182, v254
    v_mov_b32 v183, v254
    s_nop 3
    s_branch .fixr_288
.fix_289:
    s_nop 15
    v_mov_b32 v168, v254
    v_mov_b32 v169, v254
    v_mov_b32 v170, v254
    v_mov_b32 v171, v254
    v_mov_b32 v172, v254
    v_mov_b32 v173, v254
    v_mov_b32 v174, v254
    v_mov_b32 v175, v254
    v_mov_b32 v176, v254
    v_mov_b32 v177, v254
    v_mov_b32 v178, v254
    v_mov_b32 v179, v254
    v_mov_b32 v180, v254
    v_mov_b32 v181, v254
    v_mov_b32 v182, v254
    v_mov_b32 v183, v254
    s_nop 3
    s_branch .fixr_290
.fix_291:
    s_nop 15
    v_mov_b32 v168, v254
    v_mov_b32 v169, v254
    v_mov_b32 v170, v254
    v_mov_b32 v171, v254
    v_mov_b32 v172, v254
    v_mov_b32 v173, v254
    v_mov_b32 v174, v254
    v_mov_b32 v175, v254
    v_mov_b32 v176, v254
    v_mov_b32 v177, v254
    v_mov_b32 v178, v254
    v_mov_b32 v179, v254
    v_mov_b32 v180, v254
    v_mov_b32 v181, v254
    v_mov_b32 v182, v254
    v_mov_b32 v183, v254
    s_nop 3
    s_branch .fixr_292
.slow_293:
    s_nop 15
    global_store_dwordx4 v63, v[30:33], s[24:25] sc1
    s_nop 1
    s_branch .sten_294
.fix_295:
    s_nop 15
    v_mov_b32 v168, v254
    v_mov_b32 v169, v254
    v_mov_b32 v170, v254
    v_mov_b32 v171, v254
    v_mov_b32 v172, v254
    v_mov_b32 v173, v254
    v_mov_b32 v174, v254
    v_mov_b32 v175, v254
    v_mov_b32 v176, v254
    v_mov_b32 v177, v254
    v_mov_b32 v178, v254
    v_mov_b32 v179, v254
    v_mov_b32 v180, v254
    v_mov_b32 v181, v254
    v_mov_b32 v182, v254
    v_mov_b32 v183, v254
    s_nop 3
    s_branch .fixr_296
.slow_297:
    s_nop 15
    global_store_dword v64, v124, s[24:25] sc1
    s_nop 1
    s_branch .sten_298
.fix_299:
    s_nop 15
    v_mov_b32 v168, v254
    v_mov_b32 v169, v254
    v_mov_b32 v170, v254
    v_mov_b32 v171, v254
    v_mov_b32 v172, v254
    v_mov_b32 v173, v254
    v_mov_b32 v174, v254
    v_mov_b32 v175, v254
    v_mov_b32 v176, v254
    v_mov_b32 v177, v254
    v_mov_b32 v178, v254
    v_mov_b32 v179, v254
    v_mov_b32 v180, v254
    v_mov_b32 v181, v254
    v_mov_b32 v182, v254
    v_mov_b32 v183, v254
    s_nop 3
    s_branch .fixr_300
.slow_301:
    s_nop 15
    global_store_dwordx4 v63, v[216:219], s[24:25] sc1
    s_nop 1
    s_branch .sten_302
.crt_303:
    s_mov_b32 s51, 0
.clp_304:
    s_add_u32 s44, s62, s58
    s_add_u32 s44, s44, 135168
    v_add_u32 v68, s44, v2
    global_load_dwordx4 v[144:147], v68, s[24:25] offset:-4096 sc1
    global_load_dwordx4 v[136:139], v68, s[24:25] offset:-3072 sc1
    global_load_dwordx4 v[128:131], v68, s[24:25] offset:-2048 sc1
    global_load_dwordx4 v[148:151], v68, s[24:25] offset:-1024 sc1
    global_load_dwordx4 v[120:123], v68, s[24:25] offset:0 sc1
    global_load_dwordx4 v[124:127], v68, s[24:25] offset:1024 sc1
    global_load_dwordx4 v[132:135], v68, s[24:25] offset:2048 sc1
    global_load_dwordx4 v[140:143], v68, s[24:25] offset:3072 sc1
    s_add_u32 s44, s62, s59
    s_add_u32 s44, s44, 135168
    v_add_u32 v68, s44, v2
    global_load_dwordx4 v[152:155], v68, s[24:25] offset:-4096 sc1
    global_load_dwordx4 v[156:159], v68, s[24:25] offset:-3072 sc1
    global_load_dwordx4 v[160:163], v68, s[24:25] offset:-2048 sc1
    global_load_dwordx4 v[164:167], v68, s[24:25] offset:-1024 sc1
    s_add_u32 s51, s51, 1
    s_waitcnt vmcnt(0)
    v_bitop3_b32 v67, v144, v136, v128 bitop3:0x80
    v_bitop3_b32 v67, v67, v148, 1 bitop3:0x80
    v_cmp_eq_u32 vcc, 0, v67
    s_cbranch_vccz .cok_305
    s_cmp_lt_u32 s51, s37
    s_cbranch_scc1 .clp_304
    s_mov_b32 s37, 1
    s_branch .cok_305
.crt_306:
    s_mov_b32 s51, 0
.clp_307:
    s_add_u32 s44, s62, s58
    s_add_u32 s44, s44, 135168
    v_add_u32 v68, s44, v2
    global_load_dwordx4 v[120:123], v68, s[24:25] offset:0 sc1
    global_load_dwordx4 v[124:127], v68, s[24:25] offset:1024 sc1
    global_load_dwordx4 v[132:135], v68, s[24:25] offset:2048 sc1
    global_load_dwordx4 v[140:143], v68, s[24:25] offset:3072 sc1
    s_add_u32 s44, s62, s59
    s_add_u32 s44, s44, 135168
    v_add_u32 v68, s44, v2
    global_load_dwordx4 v[152:155], v68, s[24:25] offset:-4096 sc1
    global_load_dwordx4 v[156:159], v68, s[24:25] offset:-3072 sc1
    global_load_dwordx4 v[160:163], v68, s[24:25] offset:-2048 sc1
    global_load_dwordx4 v[164:167], v68, s[24:25] offset:-1024 sc1
    global_load_dwordx4 v[144:147], v68, s[24:25] offset:0 sc1
    global_load_dwordx4 v[136:139], v68, s[24:25] offset:1024 sc1
    s_add_u32 s44, s36, s34
    s_add_u32 s44, s44, 0x148000
    v_add_u32 v68, s44, v2
    global_load_dwordx4 v[128:131], v68, s[24:25] offset:0 sc1
    global_load_dwordx4 v[148:151], v68, s[24:25] offset:1024 sc1
    s_add_u32 s51, s51, 1
    s_waitcnt vmcnt(0)
    v_bitop3_b32 v67, v120, v124, v132 bitop3:0x80
    v_bitop3_b32 v67, v67, v140, 1 bitop3:0x80
    v_cmp_eq_u32 vcc, 0, v67
    s_cbranch_vccz .cok_308
    s_cmp_lt_u32 s51, s37
    s_cbranch_scc1 .clp_307
    s_mov_b32 s37, 1
    s_branch .cok_308
.crt_309:
    s_mov_b32 s51, 0
.clp_310:
    s_add_u32 s44, s62, s59
    s_add_u32 s44, s44, 135168
    v_add_u32 v68, s44, v2
    global_load_dwordx4 v[152:155], v68, s[24:25] offset:-4096 sc1
    global_load_dwordx4 v[156:159], v68, s[24:25] offset:-3072 sc1
    global_load_dwordx4 v[160:163], v68, s[24:25] offset:-2048 sc1
    global_load_dwordx4 v[164:167], v68, s[24:25] offset:-1024 sc1
    global_load_dwordx4 v[144:147], v68, s[24:25] offset:0 sc1
    global_load_dwordx4 v[136:139], v68, s[24:25] offset:1024 sc1
    s_add_u32 s44, s36, s34
    s_add_u32 s44, s44, 0x148000
    v_add_u32 v68, s44, v2
    global_load_dwordx4 v[128:131], v68, s[24:25] offset:0 sc1
    global_load_dwordx4 v[148:151], v68, s[24:25] offset:1024 sc1
    s_add_u32 s44, s62, s59
    s_add_u32 s44, s44, 135168
    v_add_u32 v68, s44, v2
    global_load_dwordx4 v[120:123], v68, s[24:25] offset:2048 sc1
    global_load_dwordx4 v[124:127], v68, s[24:25] offset:3072 sc1
    s_add_u32 s44, s62, s60
    s_add_u32 s44, s44, 135168
    v_add_u32 v68, s44, v2
    global_load_dwordx4 v[132:135], v68, s[24:25] offset:-4096 sc1
    global_load_dwordx4 v[140:143], v68, s[24:25] offset:-3072 sc1
    s_add_u32 s51, s51, 1
    s_waitcnt vmcnt(0)
    v_bitop3_b32 v67, v152, v156, v160 bitop3:0x80
    v_bitop3_b32 v67, v67, v164, 1 bitop3:0x80
    v_cmp_eq_u32 vcc, 0, v67
    s_cbranch_vccz .cok_311
    s_cmp_lt_u32 s51, s37
    s_cbranch_scc1 .clp_310
    s_mov_b32 s37, 1
    s_branch .cok_311
.crt_312:
    s_mov_b32 s51, 0
.clp_313:
    s_add_u32 s44, s62, s59
    s_add_u32 s44, s44, 135168
    v_add_u32 v68, s44, v2
    global_load_dwordx4 v[144:147], v68, s[24:25] offset:0 sc1
    global_load_dwordx4 v[136:139], v68, s[24:25] offset:1024 sc1
    global_load_dwordx4 v[120:123], v68, s[24:25] offset:2048 sc1
    global_load_dwordx4 v[124:127], v68, s[24:25] offset:3072 sc1
    s_add_u32 s44, s36, s34
    s_add_u32 s44, s44, 0x148000
    v_add_u32 v68, s44, v2
    global_load_dwordx4 v[128:131], v68, s[24:25] offset:0 sc1
    global_load_dwordx4 v[148:151], v68, s[24:25] offset:1024 sc1
    s_add_u32 s44, s62, s60
    s_add_u32 s44, s44, 135168
    v_add_u32 v68, s44, v2
    global_load_dwordx4 v[132:135], v68, s[24:25] offset:-4096 sc1
    global_load_dwordx4 v[140:143], v68, s[24:25] offset:-3072 sc1
    s_add_u32 s51, s51, 1
    s_waitcnt vmcnt(0)
    v_bitop3_b32 v67, v144, v136, v120 bitop3:0x80
    v_bitop3_b32 v67, v67, v124, 1 bitop3:0x80
    v_cmp_eq_u32 vcc, 0, v67
    s_cbranch_vccz .cok_314
    s_cmp_lt_u32 s51, s37
    s_cbranch_scc1 .clp_313
    s_mov_b32 s37, 1
    s_branch .cok_314
.crt_315:
    s_mov_b32 s51, 0
.clp_316:
    s_lshl2_add_u32 s44, s28, s96
    s_lshl_b32 s44, s44, 11
    s_add_u32 s44, s44, s32
    s_add_u32 s44, s44, 265216
    v_add_u32 v68, s44, v2
    global_load_dwordx4 v[152:155], v68, s[24:25] offset:-3072 sc1
    global_load_dwordx4 v[156:159], v68, s[24:25] offset:-2048 sc1
    s_lshl2_add_u32 s44, s28, s97
    s_lshl_b32 s44, s44, 11
    s_add_u32 s44, s44, s32
    s_add_u32 s44, s44, 265216
    v_add_u32 v68, s44, v2
    global_load_dwordx4 v[160:163], v68, s[24:25] offset:-3072 sc1
    global_load_dwordx4 v[164:167], v68, s[24:25] offset:-2048 sc1
    s_lshl2_add_u32 s44, s28, s98
    s_lshl_b32 s44, s44, 11
    s_add_u32 s44, s44, s32
    s_add_u32 s44, s44, 265216
    v_add_u32 v68, s44, v2
    global_load_dwordx4 v[120:123], v68, s[24:25] offset:-3072 sc1
    s_add_u32 s51, s51, 1
    s_waitcnt vmcnt(0)
    v_bitop3_b32 v67, v152, v156, v160 bitop3:0xfe
    v_bitop3_b32 v67, v67, v164, 1 bitop3:0xa8
    v_cmp_ne_u32 vcc, 0, v67
    s_cbranch_vccz .cok_317
    s_cmp_lt_u32 s51, s37
    s_cbranch_scc1 .clp_316
    s_mov_b32 s37, 1
    s_branch .cok_317
.crt_318:
    s_mov_b32 s51, 0
.clp_319:
    s_add_u32 s44, s36, s34
    s_add_u32 s44, s44, 0x148000
    v_add_u32 v68, s44, v2
    global_load_dwordx4 v[128:131], v68, s[24:25] offset:0 sc1
    global_load_dwordx4 v[148:151], v68, s[24:25] offset:1024 sc1
    s_add_u32 s44, s62, s59
    s_add_u32 s44, s44, 135168
    v_add_u32 v68, s44, v2
    global_load_dwordx4 v[124:127], v68, s[24:25] offset:3072 sc1
    s_add_u32 s44, s62, s60
    s_add_u32 s44, s44, 135168
    v_add_u32 v68, s44, v2
    global_load_dwordx4 v[132:135], v68, s[24:25] offset:-4096 sc1
    global_load_dwordx4 v[140:143], v68, s[24:25] offset:-3072 sc1
    global_load_dwordx4 v[144:147], v68, s[24:25] offset:-2048 sc1
    global_load_dwordx4 v[136:139], v68, s[24:25] offset:-1024 sc1
    s_add_u32 s51, s51, 1
    s_waitcnt vmcnt(0)
    v_bitop3_b32 v67, v128, v129, v130 bitop3:0x80
    v_bitop3_b32 v67, v67, v131, v148 bitop3:0x80
    v_bitop3_b32 v67, v67, v149, v150 bitop3:0x80
    v_bitop3_b32 v67, v67, v151, 1 bitop3:0x80
    v_cmp_eq_u32 vcc, 0, v67
    s_cbranch_vccz .cok_320
    s_cmp_lt_u32 s51, s37
    s_cbranch_scc1 .clp_319
    s_mov_b32 s37, 1
    s_branch .cok_320
.crt_321:
    s_mov_b32 s51, 0
.clp_322:
    s_add_u32 s44, s62, s60
    s_add_u32 s44, s44, 135168
    v_add_u32 v68, s44, v2
    global_load_dwordx4 v[132:135], v68, s[24:25] offset:-4096 sc1
    global_load_dwordx4 v[140:143], v68, s[24:25] offset:-3072 sc1
    global_load_dwordx4 v[144:147], v68, s[24:25] offset:-2048 sc1
    global_load_dwordx4 v[136:139], v68, s[24:25] offset:-1024 sc1
    global_load_dwordx4 v[124:127], v68, s[24:25] offset:0 sc1
    s_add_u32 s51, s51, 1
    s_waitcnt vmcnt(0)
    v_bitop3_b32 v67, v132, v140, v144 bitop3:0x80
    v_bitop3_b32 v67, v67, v136, 1 bitop3:0x80
    v_cmp_eq_u32 vcc, 0, v67
    s_cbranch_vccz .cok_323
    s_cmp_lt_u32 s51, s37
    s_cbranch_scc1 .clp_322
    s_mov_b32 s37, 1
    s_branch .cok_323
.crt_324:
    s_mov_b32 s51, 0
.clp_325:
    s_lshl2_add_u32 s44, s28, s98
    s_lshl_b32 s44, s44, 11
    s_add_u32 s44, s44, s32
    s_add_u32 s44, s44, 265216
    v_add_u32 v68, s44, v2
    global_load_dwordx4 v[120:123], v68, s[24:25] offset:-3072 sc1
    global_load_dwordx4 v[152:155], v68, s[24:25] offset:-2048 sc1
    s_lshl2_add_u32 s44, s28, s99
    s_lshl_b32 s44, s44, 11
    s_add_u32 s44, s44, s32
    s_add_u32 s44, s44, 265216
    v_add_u32 v68, s44, v2
    global_load_dwordx4 v[128:131], v68, s[24:25] offset:-3072 sc1
    global_load_dwordx4 v[148:151], v68, s[24:25] offset:-2048 sc1
    s_add_u32 s51, s51, 1
    s_waitcnt vmcnt(0)
    v_bitop3_b32 v67, v120, v152, v128 bitop3:0xfe
    v_bitop3_b32 v67, v67, v148, 1 bitop3:0xa8
    v_cmp_ne_u32 vcc, 0, v67
    s_cbranch_vccz .cok_326
    s_cmp_lt_u32 s51, s37
    s_cbranch_scc1 .clp_325
    s_mov_b32 s37, 1
    s_branch .cok_326
.crt_327:
    s_mov_b32 s51, 0
.clp_328:
    s_add_u32 s44, s62, s60
    s_add_u32 s44, s44, 135168
    v_add_u32 v68, s44, v2
    global_load_dwordx4 v[124:127], v68, s[24:25] offset:0 sc1
    global_load_dwordx4 v[156:159], v68, s[24:25] offset:1024 sc1
    global_load_dwordx4 v[160:163], v68, s[24:25] offset:2048 sc1
    global_load_dwordx4 v[132:135], v68, s[24:25] offset:3072 sc1
    s_add_u32 s44, s62, s61
    s_add_u32 s44, s44, 135168
    v_add_u32 v68, s44, v2
    global_load_dwordx4 v[164:167], v68, s[24:25] offset:-4096 sc1
    global_load_dwordx4 v[140:143], v68, s[24:25] offset:-3072 sc1
    global_load_dwordx4 v[120:123], v68, s[24:25] offset:-2048 sc1
    global_load_dwordx4 v[152:155], v68, s[24:25] offset:-1024 sc1
    global_load_dwordx4 v[144:147], v68, s[24:25] offset:0 sc1
    global_load_dwordx4 v[128:131], v68, s[24:25] offset:1024 sc1
    global_load_dwordx4 v[148:151], v68, s[24:25] offset:2048 sc1
    global_load_dwordx4 v[136:139], v68, s[24:25] offset:3072 sc1
    s_add_u32 s51, s51, 1
    s_waitcnt vmcnt(0)
    v_bitop3_b32 v67, v124, v156, v160 bitop3:0x80
    v_bitop3_b32 v67, v67, v132, 1 bitop3:0x80
    v_cmp_eq_u32 vcc, 0, v67
    s_cbranch_vccz .cok_329
    s_cmp_lt_u32 s51, s37
    s_cbranch_scc1 .clp_328
    s_mov_b32 s37, 1
    s_branch .cok_329
.crt_330:
    s_mov_b32 s51, 0
.clp_331:
    s_add_u32 s44, s62, s61
    s_add_u32 s44, s44, 135168
    v_add_u32 v68, s44, v2
    global_load_dwordx4 v[164:167], v68, s[24:25] offset:-4096 sc1
    global_load_dwordx4 v[140:143], v68, s[24:25] offset:-3072 sc1
    global_load_dwordx4 v[120:123], v68, s[24:25] offset:-2048 sc1
    global_load_dwordx4 v[152:155], v68, s[24:25] offset:-1024 sc1
    global_load_dwordx4 v[144:147], v68, s[24:25] offset:0 sc1
    global_load_dwordx4 v[128:131], v68, s[24:25] offset:1024 sc1
    global_load_dwordx4 v[148:151], v68, s[24:25] offset:2048 sc1
    global_load_dwordx4 v[136:139], v68, s[24:25] offset:3072 sc1
    s_add_u32 s51, s51, 1
    s_waitcnt vmcnt(0)
    v_bitop3_b32 v67, v164, v140, v120 bitop3:0x80
    v_bitop3_b32 v67, v67, v152, 1 bitop3:0x80
    v_cmp_eq_u32 vcc, 0, v67
    s_cbranch_vccz .cok_332
    s_cmp_lt_u32 s51, s37
    s_cbranch_scc1 .clp_331
    s_mov_b32 s37, 1
    s_branch .cok_332
.slow_333:
    s_nop 15
    global_store_dwordx4 v63, v[34:37], s[24:25] sc1
    s_nop 1
    s_branch .sten_334
.crt_335:
    s_mov_b32 s51, 0
.clp_336:
    s_add_u32 s44, s62, s61
    s_add_u32 s44, s44, 135168
    v_add_u32 v68, s44, v2
    global_load_dwordx4 v[144:147], v68, s[24:25] offset:0 sc1
    global_load_dwordx4 v[128:131], v68, s[24:25] offset:1024 sc1
    global_load_dwordx4 v[148:151], v68, s[24:25] offset:2048 sc1
    global_load_dwordx4 v[136:139], v68, s[24:25] offset:3072 sc1
    s_add_u32 s51, s51, 1
    s_waitcnt vmcnt(0)
    v_bitop3_b32 v67, v144, v128, v148 bitop3:0x80
    v_bitop3_b32 v67, v67, v136, 1 bitop3:0x80
    v_cmp_eq_u32 vcc, 0, v67
    s_cbranch_vccz .cok_337
    s_cmp_lt_u32 s51, s37
    s_cbranch_scc1 .clp_336
    s_mov_b32 s37, 1
    s_branch .cok_337
.slow_338:
    s_nop 15
    global_store_dword v64, v204, s[24:25] sc1
    s_nop 1
    s_branch .sten_339
.crt_340:
    s_mov_b32 s51, 0
.clp_341:
    s_add_u32 s44, s62, s58
    s_add_u32 s44, s44, 4096
    v_add_u32 v68, s44, v2
    global_load_dwordx4 v[124:127], v68, s[24:25] offset:-4096 sc1
    global_load_dwordx4 v[156:159], v68, s[24:25] offset:-3072 sc1
    global_load_dwordx4 v[160:163], v68, s[24:25] offset:-2048 sc1
    global_load_dwordx4 v[132:135], v68, s[24:25] offset:-1024 sc1
    global_load_dwordx4 v[164:167], v68, s[24:25] offset:0 sc1
    global_load_dwordx4 v[140:143], v68, s[24:25] offset:1024 sc1
    global_load_dwordx4 v[120:123], v68, s[24:25] offset:2048 sc1
    global_load_dwordx4 v[152:155], v68, s[24:25] offset:3072 sc1
    s_add_u32 s44, s62, s59
    s_add_u32 s44, s44, 4096
    v_add_u32 v68, s44, v2
    global_load_dwordx4 v[144:147], v68, s[24:25] offset:-4096 sc1
    global_load_dwordx4 v[128:131], v68, s[24:25] offset:-3072 sc1
    global_load_dwordx4 v[148:151], v68, s[24:25] offset:-2048 sc1
    global_load_dwordx4 v[136:139], v68, s[24:25] offset:-1024 sc1
    s_add_u32 s51, s51, 1
    s_waitcnt vmcnt(0)
    v_bitop3_b32 v67, v124, v156, v160 bitop3:0x80
    v_bitop3_b32 v67, v67, v132, 1 bitop3:0x80
    v_cmp_eq_u32 vcc, 0, v67
    s_cbranch_vccz .cok_342
    s_cmp_lt_u32 s51, s37
    s_cbranch_scc1 .clp_341
    s_mov_b32 s37, 1
    s_branch .cok_342
.crt_343:
    s_mov_b32 s51, 0
.clp_344:
    s_add_u32 s44, s62, s58
    s_add_u32 s44, s44, 4096
    v_add_u32 v68, s44, v2
    global_load_dwordx4 v[164:167], v68, s[24:25] offset:0 sc1
    global_load_dwordx4 v[140:143], v68, s[24:25] offset:1024 sc1
    global_load_dwordx4 v[120:123], v68, s[24:25] offset:2048 sc1
    global_load_dwordx4 v[152:155], v68, s[24:25] offset:3072 sc1
    s_add_u32 s44, s62, s59
    s_add_u32 s44, s44, 4096
    v_add_u32 v68, s44, v2
    global_load_dwordx4 v[144:147], v68, s[24:25] offset:-4096 sc1
    global_load_dwordx4 v[128:131], v68, s[24:25] offset:-3072 sc1
    global_load_dwordx4 v[148:151], v68, s[24:25] offset:-2048 sc1
    global_load_dwordx4 v[136:139], v68, s[24:25] offset:-1024 sc1
    global_load_dwordx4 v[124:127], v68, s[24:25] offset:0 sc1
    global_load_dwordx4 v[156:159], v68, s[24:25] offset:1024 sc1
    s_add_u32 s44, s36, s34
    s_add_u32 s44, s44, 0x146000
    v_add_u32 v68, s44, v2
    global_load_dwordx4 v[160:163], v68, s[24:25] offset:0 sc1
    global_load_dwordx4 v[132:135], v68, s[24:25] offset:1024 sc1
    s_add_u32 s51, s51, 1
    s_waitcnt vmcnt(0)
    v_bitop3_b32 v67, v164, v140, v120 bitop3:0x80
    v_bitop3_b32 v67, v67, v152, 1 bitop3:0x80
    v_cmp_eq_u32 vcc, 0, v67
    s_cbranch_vccz .cok_345
    s_cmp_lt_u32 s51, s37
    s_cbranch_scc1 .clp_344
    s_mov_b32 s37, 1
    s_branch .cok_345
.crt_346:
    s_mov_b32 s51, 0
.clp_347:
    s_add_u32 s44, s62, s59
    s_add_u32 s44, s44, 4096
    v_add_u32 v68, s44, v2
    global_load_dwordx4 v[144:147], v68, s[24:25] offset:-4096 sc1
    global_load_dwordx4 v[128:131], v68, s[24:25] offset:-3072 sc1
    global_load_dwordx4 v[148:151], v68, s[24:25] offset:-2048 sc1
    global_load_dwordx4 v[136:139], v68, s[24:25] offset:-1024 sc1
    global_load_dwordx4 v[124:127], v68, s[24:25] offset:0 sc1
    global_load_dwordx4 v[156:159], v68, s[24:25] offset:1024 sc1
    s_add_u32 s44, s36, s34
    s_add_u32 s44, s44, 0x146000
    v_add_u32 v68, s44, v2
    global_load_dwordx4 v[160:163], v68, s[24:25] offset:0 sc1
    global_load_dwordx4 v[132:135], v68, s[24:25] offset:1024 sc1
    s_add_u32 s44, s62, s59
    s_add_u32 s44, s44, 4096
    v_add_u32 v68, s44, v2
    global_load_dwordx4 v[164:167], v68, s[24:25] offset:2048 sc1
    global_load_dwordx4 v[140:143], v68, s[24:25] offset:3072 sc1
    s_add_u32 s44, s62, s60
    s_add_u32 s44, s44, 4096
    v_add_u32 v68, s44, v2
    global_load_dwordx4 v[120:123], v68, s[24:25] offset:-4096 sc1
    global_load_dwordx4 v[152:155], v68, s[24:25] offset:-3072 sc1
    s_add_u32 s51, s51, 1
    s_waitcnt vmcnt(0)
    v_bitop3_b32 v67, v144, v128, v148 bitop3:0x80
    v_bitop3_b32 v67, v67, v136, 1 bitop3:0x80
    v_cmp_eq_u32 vcc, 0, v67
    s_cbranch_vccz .cok_348
    s_cmp_lt_u32 s51, s37
    s_cbranch_scc1 .clp_347
    s_mov_b32 s37, 1
    s_branch .cok_348
.crt_349:
    s_mov_b32 s51, 0
.clp_350:
    s_add_u32 s44, s62, s59
    s_add_u32 s44, s44, 4096
    v_add_u32 v68, s44, v2
    global_load_dwordx4 v[124:127], v68, s[24:25] offset:0 sc1
    global_load_dwordx4 v[156:159], v68, s[24:25] offset:1024 sc1
    global_load_dwordx4 v[164:167], v68, s[24:25] offset:2048 sc1
    global_load_dwordx4 v[140:143], v68, s[24:25] offset:3072 sc1
    s_add_u32 s44, s36, s34
    s_add_u32 s44, s44, 0x146000
    v_add_u32 v68, s44, v2
    global_load_dwordx4 v[160:163], v68, s[24:25] offset:0 sc1
    global_load_dwordx4 v[132:135], v68, s[24:25] offset:1024 sc1
    s_add_u32 s44, s62, s60
    s_add_u32 s44, s44, 4096
    v_add_u32 v68, s44, v2
    global_load_dwordx4 v[120:123], v68, s[24:25] offset:-4096 sc1
    global_load_dwordx4 v[152:155], v68, s[24:25] offset:-3072 sc1
    global_load_dwordx4 v[144:147], v68, s[24:25] offset:-2048 sc1
    global_load_dwordx4 v[128:131], v68, s[24:25] offset:-1024 sc1
    global_load_dwordx4 v[148:151], v68, s[24:25] offset:0 sc1
    global_load_dwordx4 v[136:139], v68, s[24:25] offset:1024 sc1
    s_add_u32 s51, s51, 1
    s_waitcnt vmcnt(0)
    v_bitop3_b32 v67, v124, v156, v164 bitop3:0x80
    v_bitop3_b32 v67, v67, v140, 1 bitop3:0x80
    v_cmp_eq_u32 vcc, 0, v67
    s_cbranch_vccz .cok_351
    s_cmp_lt_u32 s51, s37
    s_cbranch_scc1 .clp_350
    s_mov_b32 s37, 1
    s_branch .cok_351
.crt_352:
    s_mov_b32 s51, 0
.clp_353:
    s_add_u32 s44, s36, s34
    s_add_u32 s44, s44, 0x146000
    v_add_u32 v68, s44, v2
    global_load_dwordx4 v[160:163], v68, s[24:25] offset:0 sc1
    global_load_dwordx4 v[132:135], v68, s[24:25] offset:1024 sc1
    s_add_u32 s44, s62, s59
    s_add_u32 s44, s44, 4096
    v_add_u32 v68, s44, v2
    global_load_dwordx4 v[140:143], v68, s[24:25] offset:3072 sc1
    s_add_u32 s44, s62, s60
    s_add_u32 s44, s44, 4096
    v_add_u32 v68, s44, v2
    global_load_dwordx4 v[120:123], v68, s[24:25] offset:-4096 sc1
    global_load_dwordx4 v[152:155], v68, s[24:25] offset:-3072 sc1
    global_load_dwordx4 v[144:147], v68, s[24:25] offset:-2048 sc1
    global_load_dwordx4 v[128:131], v68, s[24:25] offset:-1024 sc1
    global_load_dwordx4 v[148:151], v68, s[24:25] offset:0 sc1
    global_load_dwordx4 v[136:139], v68, s[24:25] offset:1024 sc1
    global_load_dwordx4 v[124:127], v68, s[24:25] offset:2048 sc1
    global_load_dwordx4 v[156:159], v68, s[24:25] offset:3072 sc1
    s_add_u32 s44, s62, s61
    s_add_u32 s44, s44, 4096
    v_add_u32 v68, s44, v2
    global_load_dwordx4 v[164:167], v68, s[24:25] offset:-4096 sc1
    s_add_u32 s51, s51, 1
    s_waitcnt vmcnt(0)
    v_bitop3_b32 v67, v160, v161, v162 bitop3:0x80
    v_bitop3_b32 v67, v67, v163, v132 bitop3:0x80
    v_bitop3_b32 v67, v67, v133, v134 bitop3:0x80
    v_bitop3_b32 v67, v67, v135, 1 bitop3:0x80
    v_cmp_eq_u32 vcc, 0, v67
    s_cbranch_vccz .cok_354
    s_cmp_lt_u32 s51, s37
    s_cbranch_scc1 .clp_353
    s_mov_b32 s37, 1
    s_branch .cok_354
.crt_355:
    s_mov_b32 s51, 0
.clp_356:
    s_add_u32 s44, s62, s60
    s_add_u32 s44, s44, 4096
    v_add_u32 v68, s44, v2
    global_load_dwordx4 v[120:123], v68, s[24:25] offset:-4096 sc1
    global_load_dwordx4 v[152:155], v68, s[24:25] offset:-3072 sc1
    global_load_dwordx4 v[144:147], v68, s[24:25] offset:-2048 sc1
    global_load_dwordx4 v[128:131], v68, s[24:25] offset:-1024 sc1
    global_load_dwordx4 v[148:151], v68, s[24:25] offset:0 sc1
    global_load_dwordx4 v[136:139], v68, s[24:25] offset:1024 sc1
    global_load_dwordx4 v[124:127], v68, s[24:25] offset:2048 sc1
    global_load_dwordx4 v[156:159], v68, s[24:25] offset:3072 sc1
    s_add_u32 s44, s62, s61
    s_add_u32 s44, s44, 4096
    v_add_u32 v68, s44, v2
    global_load_dwordx4 v[164:167], v68, s[24:25] offset:-4096 sc1
    global_load_dwordx4 v[160:163], v68, s[24:25] offset:-3072 sc1
    s_add_u32 s51, s51, 1
    s_waitcnt vmcnt(0)
    v_bitop3_b32 v67, v120, v152, v144 bitop3:0x80
    v_bitop3_b32 v67, v67, v128, 1 bitop3:0x80
    v_cmp_eq_u32 vcc, 0, v67
    s_cbranch_vccz .cok_357
    s_cmp_lt_u32 s51, s37
    s_cbranch_scc1 .clp_356
    s_mov_b32 s37, 1
    s_branch .cok_357
.crt_358:
    s_mov_b32 s51, 0
.clp_359:
    s_add_u32 s44, s62, s60
    s_add_u32 s44, s44, 4096
    v_add_u32 v68, s44, v2
    global_load_dwordx4 v[148:151], v68, s[24:25] offset:0 sc1
    global_load_dwordx4 v[136:139], v68, s[24:25] offset:1024 sc1
    global_load_dwordx4 v[124:127], v68, s[24:25] offset:2048 sc1
    global_load_dwordx4 v[156:159], v68, s[24:25] offset:3072 sc1
    s_add_u32 s44, s62, s61
    s_add_u32 s44, s44, 4096
    v_add_u32 v68, s44, v2
    global_load_dwordx4 v[164:167], v68, s[24:25] offset:-4096 sc1
    global_load_dwordx4 v[160:163], v68, s[24:25] offset:-3072 sc1
    global_load_dwordx4 v[132:135], v68, s[24:25] offset:-2048 sc1
    global_load_dwordx4 v[140:143], v68, s[24:25] offset:-1024 sc1
    global_load_dwordx4 v[120:123], v68, s[24:25] offset:0 sc1
    global_load_dwordx4 v[152:155], v68, s[24:25] offset:1024 sc1
    global_load_dwordx4 v[144:147], v68, s[24:25] offset:2048 sc1
    global_load_dwordx4 v[128:131], v68, s[24:25] offset:3072 sc1
    s_add_u32 s51, s51, 1
    s_waitcnt vmcnt(0)
    v_bitop3_b32 v67, v148, v136, v124 bitop3:0x80
    v_bitop3_b32 v67, v67, v156, 1 bitop3:0x80
    v_cmp_eq_u32 vcc, 0, v67
    s_cbranch_vccz .cok_360
    s_cmp_lt_u32 s51, s37
    s_cbranch_scc1 .clp_359
    s_mov_b32 s37, 1
    s_branch .cok_360
.crt_361:
    s_mov_b32 s51, 0
.clp_362:
    s_add_u32 s44, s62, s61
    s_add_u32 s44, s44, 4096
    v_add_u32 v68, s44, v2
    global_load_dwordx4 v[164:167], v68, s[24:25] offset:-4096 sc1
    global_load_dwordx4 v[160:163], v68, s[24:25] offset:-3072 sc1
    global_load_dwordx4 v[132:135], v68, s[24:25] offset:-2048 sc1
    global_load_dwordx4 v[140:143], v68, s[24:25] offset:-1024 sc1
    global_load_dwordx4 v[120:123], v68, s[24:25] offset:0 sc1
    global_load_dwordx4 v[152:155], v68, s[24:25] offset:1024 sc1
    global_load_dwordx4 v[144:147], v68, s[24:25] offset:2048 sc1
    global_load_dwordx4 v[128:131], v68, s[24:25] offset:3072 sc1
    s_add_u32 s51, s51, 1
    s_waitcnt vmcnt(0)
    v_bitop3_b32 v67, v164, v160, v132 bitop3:0x80
    v_bitop3_b32 v67, v67, v140, 1 bitop3:0x80
    v_cmp_eq_u32 vcc, 0, v67
    s_cbranch_vccz .cok_363
    s_cmp_lt_u32 s51, s37
    s_cbranch_scc1 .clp_362
    s_mov_b32 s37, 1
    s_branch .cok_363
.crt_364:
    s_mov_b32 s51, 0
.clp_365:
    s_add_u32 s44, s62, s61
    s_add_u32 s44, s44, 4096
    v_add_u32 v68, s44, v2
    global_load_dwordx4 v[120:123], v68, s[24:25] offset:0 sc1
    global_load_dwordx4 v[152:155], v68, s[24:25] offset:1024 sc1
    global_load_dwordx4 v[144:147], v68, s[24:25] offset:2048 sc1
    global_load_dwordx4 v[128:131], v68, s[24:25] offset:3072 sc1
    s_add_u32 s51, s51, 1
    s_waitcnt vmcnt(0)
    v_bitop3_b32 v67, v120, v152, v144 bitop3:0x80
    v_bitop3_b32 v67, v67, v128, 1 bitop3:0x80
    v_cmp_eq_u32 vcc, 0, v67
    s_cbranch_vccz .cok_366
    s_cmp_lt_u32 s51, s37
    s_cbranch_scc1 .clp_365
    s_mov_b32 s37, 1
    s_branch .cok_366
.crt_367:
    s_mov_b32 s51, 0
.clp_368:
    s_mul_i32 s44, s96, 7168
    s_add_u32 s44, s44, s100
    s_add_u32 s44, s44, 986112
    v_add_u32 v68, s44, v2
    global_load_dwordx4 v[148:151], v68, s[24:25] offset:-3072 sc1
    global_load_dwordx4 v[136:139], v68, s[24:25] offset:-2048 sc1
    global_load_dwordx4 v[124:127], v68, s[24:25] offset:-1024 sc1
    global_load_dwordx4 v[156:159], v68, s[24:25] offset:0 sc1
    global_load_dwordx4 v[164:167], v68, s[24:25] offset:1024 sc1
    global_load_dwordx4 v[160:163], v68, s[24:25] offset:2048 sc1
    global_load_dwordx4 v[132:135], v68, s[24:25] offset:3072 sc1
    s_mul_i32 s44, s97, 7168
    s_add_u32 s44, s44, s100
    s_add_u32 s44, s44, 986112
    v_add_u32 v68, s44, v2
    global_load_dwordx4 v[140:143], v68, s[24:25] offset:-3072 sc1
    global_load_dwordx4 v[120:123], v68, s[24:25] offset:-2048 sc1
    global_load_dwordx4 v[152:155], v68, s[24:25] offset:-1024 sc1
    global_load_dwordx4 v[144:147], v68, s[24:25] offset:0 sc1
    global_load_dwordx4 v[128:131], v68, s[24:25] offset:1024 sc1
    s_add_u32 s51, s51, 1
    s_waitcnt vmcnt(0)
    v_bitop3_b32 v67, v148, v136, v124 bitop3:0x80
    v_bitop3_b32 v67, v67, v156, 1 bitop3:0x80
    v_cmp_eq_u32 vcc, 0, v67
    s_cbranch_vccz .cok_369
    s_cmp_lt_u32 s51, s37
    s_cbranch_scc1 .clp_368
    s_mov_b32 s37, 1
    s_branch .cok_369
.fi_370:
    v_add_u32 v65, s53, v2
    v_lshlrev_b32 v65, 3, v65
    v_add_u32 v65, 131072, v65
    global_load_dwordx4 v[78:81], v65, s[24:25] sc1
    s_branch .fib_371
.crt_372:
    s_mov_b32 s51, 0
.clp_373:
    s_mul_i32 s44, s96, 7168
    s_add_u32 s44, s44, s100
    s_add_u32 s44, s44, 986112
    v_add_u32 v68, s44, v2
    global_load_dwordx4 v[164:167], v68, s[24:25] offset:1024 sc1
    global_load_dwordx4 v[160:163], v68, s[24:25] offset:2048 sc1
    global_load_dwordx4 v[132:135], v68, s[24:25] offset:3072 sc1
    s_mul_i32 s44, s97, 7168
    s_add_u32 s44, s44, s100
    s_add_u32 s44, s44, 986112
    v_add_u32 v68, s44, v2
    global_load_dwordx4 v[140:143], v68, s[24:25] offset:-3072 sc1
    global_load_dwordx4 v[120:123], v68, s[24:25] offset:-2048 sc1
    global_load_dwordx4 v[152:155], v68, s[24:25] offset:-1024 sc1
    global_load_dwordx4 v[144:147], v68, s[24:25] offset:0 sc1
    global_load_dwordx4 v[128:131], v68, s[24:25] offset:1024 sc1
    global_load_dwordx4 v[148:151], v68, s[24:25] offset:2048 sc1
    global_load_dwordx4 v[136:139], v68, s[24:25] offset:3072 sc1
    s_mul_i32 s44, s98, 7168
    s_add_u32 s44, s44, s100
    s_add_u32 s44, s44, 986112
    v_add_u32 v68, s44, v2
    global_load_dwordx4 v[124:127], v68, s[24:25] offset:-3072 sc1
    global_load_dwordx4 v[156:159], v68, s[24:25] offset:-2048 sc1
    s_add_u32 s51, s51, 1
    s_waitcnt vmcnt(0)
    v_bitop3_b32 v67, v164, v160, v132 bitop3:0x80
    v_bitop3_b32 v67, v67, v140, 1 bitop3:0x80
    v_cmp_eq_u32 vcc, 0, v67
    s_cbranch_vccz .cok_374
    s_cmp_lt_u32 s51, s37
    s_cbranch_scc1 .clp_373
    s_mov_b32 s37, 1
    s_branch .cok_374
.crt_375:
    s_mov_b32 s51, 0
.clp_376:
    s_mul_i32 s44, s97, 7168
    s_add_u32 s44, s44, s100
    s_add_u32 s44, s44, 986112
    v_add_u32 v68, s44, v2
    global_load_dwordx4 v[120:123], v68, s[24:25] offset:-2048 sc1
    global_load_dwordx4 v[152:155], v68, s[24:25] offset:-1024 sc1
    global_load_dwordx4 v[144:147], v68, s[24:25] offset:0 sc1
    global_load_dwordx4 v[128:131], v68, s[24:25] offset:1024 sc1
    global_load_dwordx4 v[148:151], v68, s[24:25] offset:2048 sc1
    global_load_dwordx4 v[136:139], v68, s[24:25] offset:3072 sc1
    s_mul_i32 s44, s98, 7168
    s_add_u32 s44, s44, s100
    s_add_u32 s44, s44, 986112
    v_add_u32 v68, s44, v2
    global_load_dwordx4 v[124:127], v68, s[24:25] offset:-3072 sc1
    global_load_dwordx4 v[156:159], v68, s[24:25] offset:-2048 sc1
    global_load_dwordx4 v[164:167], v68, s[24:25] offset:-1024 sc1
    global_load_dwordx4 v[160:163], v68, s[24:25] offset:0 sc1
    global_load_dwordx4 v[132:135], v68, s[24:25] offset:1024 sc1
    global_load_dwordx4 v[140:143], v68, s[24:25] offset:2048 sc1
    s_add_u32 s51, s51, 1
    s_waitcnt vmcnt(0)
    v_bitop3_b32 v67, v120, v152, v144 bitop3:0x80
    v_bitop3_b32 v67, v67, v128, 1 bitop3:0x80
    v_cmp_eq_u32 vcc, 0, v67
    s_cbranch_vccz .cok_377
    s_cmp_lt_u32 s51, s37
    s_cbranch_scc1 .clp_376
    s_mov_b32 s37, 1
    s_branch .cok_377
.crt_378:
    s_mov_b32 s51, 0
.clp_379:
    s_mul_i32 s44, s97, 7168
    s_add_u32 s44, s44, s100
    s_add_u32 s44, s44, 986112
    v_add_u32 v68, s44, v2
    global_load_dwordx4 v[148:151], v68, s[24:25] offset:2048 sc1
    global_load_dwordx4 v[136:139], v68, s[24:25] offset:3072 sc1
    s_mul_i32 s44, s98, 7168
    s_add_u32 s44, s44, s100
    s_add_u32 s44, s44, 986112
    v_add_u32 v68, s44, v2
    global_load_dwordx4 v[124:127], v68, s[24:25] offset:-3072 sc1
    global_load_dwordx4 v[156:159], v68, s[24:25] offset:-2048 sc1
    global_load_dwordx4 v[164:167], v68, s[24:25] offset:-1024 sc1
    global_load_dwordx4 v[160:163], v68, s[24:25] offset:0 sc1
    global_load_dwordx4 v[132:135], v68, s[24:25] offset:1024 sc1
    global_load_dwordx4 v[140:143], v68, s[24:25] offset:2048 sc1
    global_load_dwordx4 v[120:123], v68, s[24:25] offset:3072 sc1
    s_mul_i32 s44, s99, 7168
    s_add_u32 s44, s44, s100
    s_add_u32 s44, s44, 986112
    v_add_u32 v68, s44, v2
    global_load_dwordx4 v[152:155], v68, s[24:25] offset:-3072 sc1
    global_load_dwordx4 v[144:147], v68, s[24:25] offset:-2048 sc1
    global_load_dwordx4 v[128:131], v68, s[24:25] offset:-1024 sc1
    s_add_u32 s51, s51, 1
    s_waitcnt vmcnt(0)
    v_bitop3_b32 v67, v148, v136, v124 bitop3:0x80
    v_bitop3_b32 v67, v67, v156, 1 bitop3:0x80
    v_cmp_eq_u32 vcc, 0, v67
    s_cbranch_vccz .cok_380
    s_cmp_lt_u32 s51, s37
    s_cbranch_scc1 .clp_379
    s_mov_b32 s37, 1
    s_branch .cok_380
.crt_381:
    s_mov_b32 s51, 0
.clp_382:
    s_mul_i32 s44, s98, 7168
    s_add_u32 s44, s44, s100
    s_add_u32 s44, s44, 986112
    v_add_u32 v68, s44, v2
    global_load_dwordx4 v[164:167], v68, s[24:25] offset:-1024 sc1
    global_load_dwordx4 v[160:163], v68, s[24:25] offset:0 sc1
    global_load_dwordx4 v[132:135], v68, s[24:25] offset:1024 sc1
    global_load_dwordx4 v[140:143], v68, s[24:25] offset:2048 sc1
    global_load_dwordx4 v[120:123], v68, s[24:25] offset:3072 sc1
    s_mul_i32 s44, s99, 7168
    s_add_u32 s44, s44, s100
    s_add_u32 s44, s44, 986112
    v_add_u32 v68, s44, v2
    global_load_dwordx4 v[152:155], v68, s[24:25] offset:-3072 sc1
    global_load_dwordx4 v[144:147], v68, s[24:25] offset:-2048 sc1
    global_load_dwordx4 v[128:131], v68, s[24:25] offset:-1024 sc1
    global_load_dwordx4 v[148:151], v68, s[24:25] offset:0 sc1
    global_load_dwordx4 v[136:139], v68, s[24:25] offset:1024 sc1
    global_load_dwordx4 v[124:127], v68, s[24:25] offset:2048 sc1
    global_load_dwordx4 v[156:159], v68, s[24:25] offset:3072 sc1
    s_add_u32 s51, s51, 1
    s_waitcnt vmcnt(0)
    v_bitop3_b32 v67, v164, v160, v132 bitop3:0x80
    v_bitop3_b32 v67, v67, v140, 1 bitop3:0x80
    v_cmp_eq_u32 vcc, 0, v67
    s_cbranch_vccz .cok_383
    s_cmp_lt_u32 s51, s37
    s_cbranch_scc1 .clp_382
    s_mov_b32 s37, 1
    s_branch .cok_383
.crt_384:
    s_mov_b32 s51, 0
.clp_385:
    s_mul_i32 s44, s98, 7168
    s_add_u32 s44, s44, s100
    s_add_u32 s44, s44, 986112
    v_add_u32 v68, s44, v2
    global_load_dwordx4 v[120:123], v68, s[24:25] offset:3072 sc1
    s_mul_i32 s44, s99, 7168
    s_add_u32 s44, s44, s100
    s_add_u32 s44, s44, 986112
    v_add_u32 v68, s44, v2
    global_load_dwordx4 v[152:155], v68, s[24:25] offset:-3072 sc1
    global_load_dwordx4 v[144:147], v68, s[24:25] offset:-2048 sc1
    global_load_dwordx4 v[128:131], v68, s[24:25] offset:-1024 sc1
    global_load_dwordx4 v[148:151], v68, s[24:25] offset:0 sc1
    global_load_dwordx4 v[136:139], v68, s[24:25] offset:1024 sc1
    global_load_dwordx4 v[124:127], v68, s[24:25] offset:2048 sc1
    global_load_dwordx4 v[156:159], v68, s[24:25] offset:3072 sc1
    s_add_u32 s51, s51, 1
    s_waitcnt vmcnt(0)
    v_bitop3_b32 v67, v120, v152, v144 bitop3:0x80
    v_bitop3_b32 v67, v67, v128, 1 bitop3:0x80
    v_cmp_eq_u32 vcc, 0, v67
    s_cbranch_vccz .cok_386
    s_cmp_lt_u32 s51, s37
    s_cbranch_scc1 .clp_385
    s_mov_b32 s37, 1
    s_branch .cok_386
.crt_387:
    s_mov_b32 s51, 0
.clp_388:
    s_mul_i32 s44, s99, 7168
    s_add_u32 s44, s44, s100
    s_add_u32 s44, s44, 986112
    v_add_u32 v68, s44, v2
    global_load_dwordx4 v[148:151], v68, s[24:25] offset:0 sc1
    global_load_dwordx4 v[136:139], v68, s[24:25] offset:1024 sc1
    global_load_dwordx4 v[124:127], v68, s[24:25] offset:2048 sc1
    global_load_dwordx4 v[156:159], v68, s[24:25] offset:3072 sc1
    s_mul_i32 s44, s98, 7168
    s_add_u32 s44, s44, s100
    s_add_u32 s44, s44, 986112
    v_add_u32 v68, s44, v2
    global_load_dwordx4 v[120:123], v68, s[24:25] offset:3072 sc1
    s_mul_i32 s44, s99, 7168
    s_add_u32 s44, s44, s100
    s_add_u32 s44, s44, 986112
    v_add_u32 v68, s44, v2
    global_load_dwordx4 v[152:155], v68, s[24:25] offset:-3072 sc1
    global_load_dwordx4 v[144:147], v68, s[24:25] offset:-2048 sc1
    global_load_dwordx4 v[128:131], v68, s[24:25] offset:-1024 sc1
    s_add_u32 s51, s51, 1
    s_waitcnt vmcnt(0)
    v_bitop3_b32 v67, v148, v136, v124 bitop3:0x80
    v_bitop3_b32 v67, v67, v156, 1 bitop3:0x80
    v_cmp_eq_u32 vcc, 0, v67
    s_cbranch_vccz .cok_389
    s_cmp_lt_u32 s51, s37
    s_cbranch_scc1 .clp_388
    s_mov_b32 s37, 1
    s_branch .cok_389
.fc_390:
    s_waitcnt vmcnt(16)
    s_mov_b32 s51, 0
.fl_392:
    v_xor_b32 v78, s31, v78
    v_xor_b32 v79, s31, v79
    v_xor_b32 v80, s31, v80
    v_xor_b32 v81, s31, v81
    v_or3_b32 v78, v78, v79, v80
    v_or_b32 v78, v78, v81
    v_cmp_le_u32 vcc, 8, v78
    s_add_u32 s51, s51, 1
    s_cbranch_vccz .fcb_391
    global_load_dwordx4 v[78:81], v65, s[24:25] sc1
    s_waitcnt vmcnt(0)
    s_cmp_lt_u32 s51, s37
    s_cbranch_scc1 .fl_392
    s_branch .fcb_391
.crt_393:
    s_mov_b32 s51, 0
.clp_394:
    s_mul_i32 s44, s96, 7168
    s_add_u32 s44, s44, s100
    s_add_u32 s44, s44, 527360
    v_add_u32 v68, s44, v2
    global_load_dwordx4 v[160:163], v68, s[24:25] offset:-3072 sc1
    global_load_dwordx4 v[132:135], v68, s[24:25] offset:-2048 sc1
    global_load_dwordx4 v[140:143], v68, s[24:25] offset:-1024 sc1
    global_load_dwordx4 v[120:123], v68, s[24:25] offset:0 sc1
    global_load_dwordx4 v[152:155], v68, s[24:25] offset:1024 sc1
    global_load_dwordx4 v[144:147], v68, s[24:25] offset:2048 sc1
    global_load_dwordx4 v[128:131], v68, s[24:25] offset:3072 sc1
    s_mul_i32 s44, s97, 7168
    s_add_u32 s44, s44, s100
    s_add_u32 s44, s44, 527360
    v_add_u32 v68, s44, v2
    global_load_dwordx4 v[148:151], v68, s[24:25] offset:-3072 sc1
    global_load_dwordx4 v[136:139], v68, s[24:25] offset:-2048 sc1
    global_load_dwordx4 v[124:127], v68, s[24:25] offset:-1024 sc1
    global_load_dwordx4 v[156:159], v68, s[24:25] offset:0 sc1
    s_add_u32 s51, s51, 1
    s_waitcnt vmcnt(0)
    v_bitop3_b32 v67, v160, v132, v140 bitop3:0x80
    v_bitop3_b32 v67, v67, v120, 1 bitop3:0x80
    v_cmp_eq_u32 vcc, 0, v67
    s_cbranch_vccz .cok_395
    s_cmp_lt_u32 s51, s37
    s_cbranch_scc1 .clp_394
    s_mov_b32 s37, 1
    s_branch .cok_395
.fs_396:
    v_mov_b32 v65, 0
    v_mov_b32 v78, s31
    global_store_dword v65, v78, s[24:25] sc1
    s_branch .fsb_397
.crt_398:
    s_mov_b32 s51, 0
.clp_399:
    s_mul_i32 s44, s96, 7168
    s_add_u32 s44, s44, s100
    s_add_u32 s44, s44, 527360
    v_add_u32 v68, s44, v2
    global_load_dwordx4 v[152:155], v68, s[24:25] offset:1024 sc1
    global_load_dwordx4 v[144:147], v68, s[24:25] offset:2048 sc1
    global_load_dwordx4 v[128:131], v68, s[24:25] offset:3072 sc1
    s_mul_i32 s44, s97, 7168
    s_add_u32 s44, s44, s100
    s_add_u32 s44, s44, 527360
    v_add_u32 v68, s44, v2
    global_load_dwordx4 v[148:151], v68, s[24:25] offset:-3072 sc1
    global_load_dwordx4 v[136:139], v68, s[24:25] offset:-2048 sc1
    global_load_dwordx4 v[124:127], v68, s[24:25] offset:-1024 sc1
    global_load_dwordx4 v[156:159], v68, s[24:25] offset:0 sc1
    global_load_dwordx4 v[160:163], v68, s[24:25] offset:1024 sc1
    global_load_dwordx4 v[132:135], v68, s[24:25] offset:2048 sc1
    global_load_dwordx4 v[140:143], v68, s[24:25] offset:3072 sc1
    s_mul_i32 s44, s98, 7168
    s_add_u32 s44, s44, s100
    s_add_u32 s44, s44, 527360
    v_add_u32 v68, s44, v2
    global_load_dwordx4 v[120:123], v68, s[24:25] offset:-3072 sc1
    s_add_u32 s51, s51, 1
    s_waitcnt vmcnt(0)
    v_bitop3_b32 v67, v152, v144, v128 bitop3:0x80
    v_bitop3_b32 v67, v67, v148, 1 bitop3:0x80
    v_cmp_eq_u32 vcc, 0, v67
    s_cbranch_vccz .cok_400
    s_cmp_lt_u32 s51, s37
    s_cbranch_scc1 .clp_399
    s_mov_b32 s37, 1
    s_branch .cok_400
.crt_401:
    s_mov_b32 s51, 0
.clp_402:
    s_mul_i32 s44, s97, 7168
    s_add_u32 s44, s44, s100
    s_add_u32 s44, s44, 527360
    v_add_u32 v68, s44, v2
    global_load_dwordx4 v[136:139], v68, s[24:25] offset:-2048 sc1
    global_load_dwordx4 v[124:127], v68, s[24:25] offset:-1024 sc1
    global_load_dwordx4 v[156:159], v68, s[24:25] offset:0 sc1
    global_load_dwordx4 v[160:163], v68, s[24:25] offset:1024 sc1
    global_load_dwordx4 v[132:135], v68, s[24:25] offset:2048 sc1
    global_load_dwordx4 v[140:143], v68, s[24:25] offset:3072 sc1
    s_mul_i32 s44, s98, 7168
    s_add_u32 s44, s44, s100
    s_add_u32 s44, s44, 527360
    v_add_u32 v68, s44, v2
    global_load_dwordx4 v[120:123], v68, s[24:25] offset:-3072 sc1
    global_load_dwordx4 v[164:167], v68, s[24:25] offset:-2048 sc1
    global_load_dwordx4 v[152:155], v68, s[24:25] offset:-1024 sc1
    global_load_dwordx4 v[144:147], v68, s[24:25] offset:0 sc1
    global_load_dwordx4 v[128:131], v68, s[24:25] offset:1024 sc1
    global_load_dwordx4 v[148:151], v68, s[24:25] offset:2048 sc1
    s_add_u32 s51, s51, 1
    s_waitcnt vmcnt(0)
    v_bitop3_b32 v67, v136, v124, v156 bitop3:0x80
    v_bitop3_b32 v67, v67, v160, 1 bitop3:0x80
    v_cmp_eq_u32 vcc, 0, v67
    s_cbranch_vccz .cok_403
    s_cmp_lt_u32 s51, s37
    s_cbranch_scc1 .clp_402
    s_mov_b32 s37, 1
    s_branch .cok_403
.crt_404:
    s_mov_b32 s51, 0
.clp_405:
    s_mul_i32 s44, s97, 7168
    s_add_u32 s44, s44, s100
    s_add_u32 s44, s44, 527360
    v_add_u32 v68, s44, v2
    global_load_dwordx4 v[132:135], v68, s[24:25] offset:2048 sc1
    global_load_dwordx4 v[140:143], v68, s[24:25] offset:3072 sc1
    s_mul_i32 s44, s98, 7168
    s_add_u32 s44, s44, s100
    s_add_u32 s44, s44, 527360
    v_add_u32 v68, s44, v2
    global_load_dwordx4 v[120:123], v68, s[24:25] offset:-3072 sc1
    global_load_dwordx4 v[164:167], v68, s[24:25] offset:-2048 sc1
    global_load_dwordx4 v[152:155], v68, s[24:25] offset:-1024 sc1
    global_load_dwordx4 v[144:147], v68, s[24:25] offset:0 sc1
    global_load_dwordx4 v[128:131], v68, s[24:25] offset:1024 sc1
    global_load_dwordx4 v[148:151], v68, s[24:25] offset:2048 sc1
    global_load_dwordx4 v[136:139], v68, s[24:25] offset:3072 sc1
    s_mul_i32 s44, s99, 7168
    s_add_u32 s44, s44, s100
    s_add_u32 s44, s44, 527360
    v_add_u32 v68, s44, v2
    global_load_dwordx4 v[124:127], v68, s[24:25] offset:-3072 sc1
    global_load_dwordx4 v[156:159], v68, s[24:25] offset:-2048 sc1
    global_load_dwordx4 v[160:163], v68, s[24:25] offset:-1024 sc1
    s_add_u32 s51, s51, 1
    s_waitcnt vmcnt(0)
    v_bitop3_b32 v67, v132, v140, v120 bitop3:0x80
    v_bitop3_b32 v67, v67, v164, 1 bitop3:0x80
    v_cmp_eq_u32 vcc, 0, v67
    s_cbranch_vccz .cok_406
    s_cmp_lt_u32 s51, s37
    s_cbranch_scc1 .clp_405
    s_mov_b32 s37, 1
    s_branch .cok_406
.crt_407:
    s_mov_b32 s51, 0
.clp_408:
    s_mul_i32 s44, s98, 7168
    s_add_u32 s44, s44, s100
    s_add_u32 s44, s44, 527360
    v_add_u32 v68, s44, v2
    global_load_dwordx4 v[152:155], v68, s[24:25] offset:-1024 sc1
    global_load_dwordx4 v[144:147], v68, s[24:25] offset:0 sc1
    global_load_dwordx4 v[128:131], v68, s[24:25] offset:1024 sc1
    global_load_dwordx4 v[148:151], v68, s[24:25] offset:2048 sc1
    global_load_dwordx4 v[136:139], v68, s[24:25] offset:3072 sc1
    s_mul_i32 s44, s99, 7168
    s_add_u32 s44, s44, s100
    s_add_u32 s44, s44, 527360
    v_add_u32 v68, s44, v2
    global_load_dwordx4 v[124:127], v68, s[24:25] offset:-3072 sc1
    global_load_dwordx4 v[156:159], v68, s[24:25] offset:-2048 sc1
    global_load_dwordx4 v[160:163], v68, s[24:25] offset:-1024 sc1
    global_load_dwordx4 v[132:135], v68, s[24:25] offset:0 sc1
    global_load_dwordx4 v[140:143], v68, s[24:25] offset:1024 sc1
    global_load_dwordx4 v[120:123], v68, s[24:25] offset:2048 sc1
    global_load_dwordx4 v[164:167], v68, s[24:25] offset:3072 sc1
    s_add_u32 s51, s51, 1
    s_waitcnt vmcnt(0)
    v_bitop3_b32 v67, v152, v144, v128 bitop3:0x80
    v_bitop3_b32 v67, v67, v148, 1 bitop3:0x80
    v_cmp_eq_u32 vcc, 0, v67
    s_cbranch_vccz .cok_409
    s_cmp_lt_u32 s51, s37
    s_cbranch_scc1 .clp_408
    s_mov_b32 s37, 1
    s_branch .cok_409
.crt_410:
    s_mov_b32 s51, 0
.clp_411:
    s_mul_i32 s44, s98, 7168
    s_add_u32 s44, s44, s100
    s_add_u32 s44, s44, 527360
    v_add_u32 v68, s44, v2
    global_load_dwordx4 v[136:139], v68, s[24:25] offset:3072 sc1
    s_mul_i32 s44, s99, 7168
    s_add_u32 s44, s44, s100
    s_add_u32 s44, s44, 527360
    v_add_u32 v68, s44, v2
    global_load_dwordx4 v[124:127], v68, s[24:25] offset:-3072 sc1
    global_load_dwordx4 v[156:159], v68, s[24:25] offset:-2048 sc1
    global_load_dwordx4 v[160:163], v68, s[24:25] offset:-1024 sc1
    global_load_dwordx4 v[132:135], v68, s[24:25] offset:0 sc1
    global_load_dwordx4 v[140:143], v68, s[24:25] offset:1024 sc1
    global_load_dwordx4 v[120:123], v68, s[24:25] offset:2048 sc1
    global_load_dwordx4 v[164:167], v68, s[24:25] offset:3072 sc1
    s_add_u32 s51, s51, 1
    s_waitcnt vmcnt(0)
    v_bitop3_b32 v67, v136, v124, v156 bitop3:0x80
    v_bitop3_b32 v67, v67, v160, 1 bitop3:0x80
    v_cmp_eq_u32 vcc, 0, v67
    s_cbranch_vccz .cok_412
    s_cmp_lt_u32 s51, s37
    s_cbranch_scc1 .clp_411
    s_mov_b32 s37, 1
    s_branch .cok_412
.wb_413:
    buffer_wbl2 sc1
    s_branch .wbb_414
.crt_415:
    s_mov_b32 s51, 0
.clp_416:
    s_mul_i32 s44, s99, 7168
    s_add_u32 s44, s44, s100
    s_add_u32 s44, s44, 527360
    v_add_u32 v68, s44, v2
    global_load_dwordx4 v[132:135], v68, s[24:25] offset:0 sc1
    global_load_dwordx4 v[140:143], v68, s[24:25] offset:1024 sc1
    global_load_dwordx4 v[120:123], v68, s[24:25] offset:2048 sc1
    global_load_dwordx4 v[164:167], v68, s[24:25] offset:3072 sc1
    s_mul_i32 s44, s98, 7168
    s_add_u32 s44, s44, s100
    s_add_u32 s44, s44, 527360
    v_add_u32 v68, s44, v2
    global_load_dwordx4 v[136:139], v68, s[24:25] offset:3072 sc1
    s_mul_i32 s44, s99, 7168
    s_add_u32 s44, s44, s100
    s_add_u32 s44, s44, 527360
    v_add_u32 v68, s44, v2
    global_load_dwordx4 v[124:127], v68, s[24:25] offset:-3072 sc1
    global_load_dwordx4 v[156:159], v68, s[24:25] offset:-2048 sc1
    global_load_dwordx4 v[160:163], v68, s[24:25] offset:-1024 sc1
    s_add_u32 s51, s51, 1
    s_waitcnt vmcnt(0)
    v_bitop3_b32 v67, v132, v140, v120 bitop3:0x80
    v_bitop3_b32 v67, v67, v164, 1 bitop3:0x80
    v_cmp_eq_u32 vcc, 0, v67
    s_cbranch_vccz .cok_417
    s_cmp_lt_u32 s51, s37
    s_cbranch_scc1 .clp_416
    s_mov_b32 s37, 1
    s_branch .cok_417
.CEND:
.section .rodata,"a"
.p2align 6
.amdhsa_kernel interleave_layers__sliding_block__mixer_channel_mlp__prompt_kernel
  .amdhsa_next_free_vgpr 512
  .amdhsa_next_free_sgpr 102
  .amdhsa_accum_offset 256
  .amdhsa_group_segment_fixed_size 0
  .amdhsa_kernarg_size 88
  .amdhsa_user_sgpr_count 2
  .amdhsa_user_sgpr_kernarg_segment_ptr 1
  .amdhsa_system_sgpr_workgroup_id_x 1
.end_amdhsa_kernel
```
